```python
import torch

def _softmax(x, axis=-1):
    return torch.softmax(x, dim=axis)
def _gelu(x):
    return torch.nn.functional.gelu(x, approximate="tanh")
def _silu(x):
    return torch.nn.functional.silu(x)
def _sigmoid(x):
    return torch.sigmoid(x)
def _layernorm(x, axis=-1, eps=1e-5):
    m = x.mean(dim=axis, keepdim=True)
    v = x.var(dim=axis, keepdim=True, unbiased=False)
    return (x - m) / torch.sqrt(v + eps)
def _scatter_add(tgt, idx, src, axis=0):
    return tgt.clone().index_add_(axis, idx, src)
def _segment_sum(src, seg, n):
    out = torch.zeros((n,) + src.shape[1:], dtype=src.dtype)
    return out.index_add_(0, seg, src)
def _pad(x, pw):
    flat = tuple(v for pair in reversed(pw) for v in pair)
    return torch.nn.functional.pad(x, flat)

kernel_name = 'sequential_preLN__sliding_block__glu_gated_swiglu__prompt'

def setup_inputs():

    _w = (lambda a: (lambda t: t.to(torch.bfloat16) if t.is_floating_point() else t)(torch.as_tensor(a)))
    def _A_setup():
        B, S, D = 1, 2048, 1024
        return {
            "x": _w((lambda *s: torch.randn(*s, dtype=torch.bfloat16) * 0.05)(B, S, D)),
            "wqkv": _w((lambda *s: torch.randn(*s, dtype=torch.bfloat16) * 0.05)(D, 3 * D)),
            "wo": _w((lambda *s: torch.randn(*s, dtype=torch.bfloat16) * 0.05)(D, D)),
        }
    _A_in = _A_setup()

    def _B_setup():
        B, S, D, F = 1, 2048, 1024, 3584
        return {
            "x": _w((lambda *s: torch.randn(*s, dtype=torch.bfloat16) * 0.05)(B, S, D)),
            "w1": _w((lambda *s: torch.randn(*s, dtype=torch.bfloat16) * 0.8)(D, F) * (2.0 / D) ** 0.5),
            "w3": _w((lambda *s: torch.randn(*s, dtype=torch.bfloat16) * 0.8)(D, F) * (2.0 / D) ** 0.5),
            "w2": _w((lambda *s: torch.randn(*s, dtype=torch.bfloat16) * 0.8)(F, D) * (2.0 / F) ** 0.5),
        }
    _B_in = _B_setup()

    return {
        "A_x": _A_in["x"],
        "A_wqkv": _A_in["wqkv"],
        "A_wo": _A_in["wo"],
        "B_x": _B_in["x"],
        "B_w1": _B_in["w1"],
        "B_w3": _B_in["w3"],
        "B_w2": _B_in["w2"],
    }

def reference(A_x, A_wqkv, A_wo, B_x, B_w1, B_w3, B_w2):
    def _A_ref(x, wqkv, wo):
        B, S, D = x.shape
        H = 32; Dh = D // H; W = 256
        qkv = (lambda x, *d: x.permute(*d))((x @ wqkv).reshape(B, S, 3, H, Dh), 2, 0, 3, 1, 4)
        q, k, v = qkv[0], qkv[1], qkv[2]
        scores = torch.einsum("bhqd,bhkd->bhqk", q, k) * (Dh ** -0.5)
        idx = torch.arange(S)
        mask = (idx[:, None] - idx[None, :] >= 0) & (idx[:, None] - idx[None, :] < W)
        scores = torch.where(mask[None, None], scores, -1e9)
        p = _softmax(scores, axis=-1)
        o = torch.einsum("bhqk,bhkd->bhqd", p, v)
        return (lambda x, *d: x.permute(*d))(o, 0, 2, 1, 3).reshape(B, S, D) @ wo

    def _B_ref(x, w1, w3, w2):
        gate = torch.einsum("bsd,df->bsf", x, w1)
        up = torch.einsum("bsd,df->bsf", x, w3)
        h = _silu(gate) * up
        out = torch.einsum("bsf,fd->bsd", h, w2)
        return out

    x = A_x
    h = x + _A_ref(_layernorm(x, axis=-1), A_wqkv, A_wo)
    h2 = h + _B_ref(_layernorm(h, axis=-1), B_w1, B_w3, B_w2)
    return h2
```

```asm
; @launch kernel=ln1_kernel grid=(512,1,1) block=(256,1,1) lds=0
; @launch kernel=qkv_kernel grid=(256,1,1) block=(256,1,1) lds=122880
; @launch kernel=attn_kernel grid=(512,1,1) block=(256,1,1) lds=73728
; @launch kernel=wo_kernel grid=(256,1,1) block=(256,1,1) lds=98304
; @launch kernel=ln2_kernel grid=(512,1,1) block=(256,1,1) lds=0
; @launch kernel=gu_kernel grid=(256,1,1) block=(256,1,1) lds=131072
; @launch kernel=dn_kernel grid=(256,1,1) block=(256,1,1) lds=98304
.amdgcn_target "amdgcn-amd-amdhsa--gfx950"
.text
.globl ln1_kernel
.p2align 8
.type ln1_kernel,@function
ln1_kernel:
    s_cmp_ge_u32 s2, 512
    s_cbranch_scc1 L_ln1_kernel_end
    s_load_dwordx2 s[4:5], s[0:1], 0
    s_load_dwordx2 s[8:9], s[0:1], 72
    s_waitcnt lgkmcnt(0)
    s_mov_b32 s6, 4194304
    s_mov_b32 s7, 0x00020000
    s_mov_b32 s10, 4194304
    s_mov_b32 s11, 0x00020000
    s_load_dwordx2 s[12:13], s[0:1], 72
    s_waitcnt lgkmcnt(0)
    s_add_u32 s12, s12, 83886080
    s_addc_u32 s13, s13, 0
    s_mov_b32 s14, 8192
    s_mov_b32 s15, 0x00020000
    s_cmp_lg_u32 s2, 0
    s_cbranch_scc1 L_ln1_kernel_nz
    v_lshlrev_b32 v1, 5, v0
    v_mov_b32 v4, 0
    v_mov_b32 v5, 0
    v_mov_b32 v6, 0
    v_mov_b32 v7, 0
    buffer_store_dwordx4 v[4:7], v1, s[12:15], 0 offen
    buffer_store_dwordx4 v[4:7], v1, s[12:15], 0 offen offset:16
L_ln1_kernel_nz:
    v_lshrrev_b32 v1, 6, v0
    v_and_b32 v2, 63, v0
    s_lshl_b32 s3, s2, 2
    v_add_u32 v1, s3, v1
    v_lshlrev_b32 v1, 11, v1
    v_lshl_add_u32 v1, v2, 4, v1
    buffer_load_dwordx4 v[4:7], v1, s[4:7], 0 offen
    buffer_load_dwordx4 v[8:11], v1, s[4:7], 0 offen offset:1024
    s_waitcnt vmcnt(0)
    v_lshlrev_b32 v16, 16, v4
    v_and_b32 v17, 0xffff0000, v4
    v_lshlrev_b32 v18, 16, v5
    v_and_b32 v19, 0xffff0000, v5
    v_lshlrev_b32 v20, 16, v6
    v_and_b32 v21, 0xffff0000, v6
    v_lshlrev_b32 v22, 16, v7
    v_and_b32 v23, 0xffff0000, v7
    v_lshlrev_b32 v24, 16, v8
    v_and_b32 v25, 0xffff0000, v8
    v_lshlrev_b32 v26, 16, v9
    v_and_b32 v27, 0xffff0000, v9
    v_lshlrev_b32 v28, 16, v10
    v_and_b32 v29, 0xffff0000, v10
    v_lshlrev_b32 v30, 16, v11
    v_and_b32 v31, 0xffff0000, v11
    v_add_f32 v12, v16, v17
    v_add_f32 v12, v12, v18
    v_add_f32 v12, v12, v19
    v_add_f32 v12, v12, v20
    v_add_f32 v12, v12, v21
    v_add_f32 v12, v12, v22
    v_add_f32 v12, v12, v23
    v_add_f32 v12, v12, v24
    v_add_f32 v12, v12, v25
    v_add_f32 v12, v12, v26
    v_add_f32 v12, v12, v27
    v_add_f32 v12, v12, v28
    v_add_f32 v12, v12, v29
    v_add_f32 v12, v12, v30
    v_add_f32 v12, v12, v31
    ds_swizzle_b32 v13, v12 offset:0x41f
    s_waitcnt lgkmcnt(0)
    v_add_f32 v12, v12, v13
    ds_swizzle_b32 v13, v12 offset:0x81f
    s_waitcnt lgkmcnt(0)
    v_add_f32 v12, v12, v13
    ds_swizzle_b32 v13, v12 offset:0x101f
    s_waitcnt lgkmcnt(0)
    v_add_f32 v12, v12, v13
    ds_swizzle_b32 v13, v12 offset:0x201f
    s_waitcnt lgkmcnt(0)
    v_add_f32 v12, v12, v13
    ds_swizzle_b32 v13, v12 offset:0x401f
    s_waitcnt lgkmcnt(0)
    v_add_f32 v12, v12, v13
    s_nop 1
    v_readlane_b32 s20, v12, 0
    v_readlane_b32 s21, v12, 32
    s_nop 3
    v_mov_b32 v12, s20
    v_add_f32 v12, s21, v12
    v_mul_f32 v12, 0.0009765625, v12
    v_sub_f32 v16, v16, v12
    v_sub_f32 v17, v17, v12
    v_sub_f32 v18, v18, v12
    v_sub_f32 v19, v19, v12
    v_sub_f32 v20, v20, v12
    v_sub_f32 v21, v21, v12
    v_sub_f32 v22, v22, v12
    v_sub_f32 v23, v23, v12
    v_sub_f32 v24, v24, v12
    v_sub_f32 v25, v25, v12
    v_sub_f32 v26, v26, v12
    v_sub_f32 v27, v27, v12
    v_sub_f32 v28, v28, v12
    v_sub_f32 v29, v29, v12
    v_sub_f32 v30, v30, v12
    v_sub_f32 v31, v31, v12
    v_mul_f32 v14, v16, v16
    v_fmac_f32 v14, v17, v17
    v_fmac_f32 v14, v18, v18
    v_fmac_f32 v14, v19, v19
    v_fmac_f32 v14, v20, v20
    v_fmac_f32 v14, v21, v21
    v_fmac_f32 v14, v22, v22
    v_fmac_f32 v14, v23, v23
    v_fmac_f32 v14, v24, v24
    v_fmac_f32 v14, v25, v25
    v_fmac_f32 v14, v26, v26
    v_fmac_f32 v14, v27, v27
    v_fmac_f32 v14, v28, v28
    v_fmac_f32 v14, v29, v29
    v_fmac_f32 v14, v30, v30
    v_fmac_f32 v14, v31, v31
    ds_swizzle_b32 v13, v14 offset:0x41f
    s_waitcnt lgkmcnt(0)
    v_add_f32 v14, v14, v13
    ds_swizzle_b32 v13, v14 offset:0x81f
    s_waitcnt lgkmcnt(0)
    v_add_f32 v14, v14, v13
    ds_swizzle_b32 v13, v14 offset:0x101f
    s_waitcnt lgkmcnt(0)
    v_add_f32 v14, v14, v13
    ds_swizzle_b32 v13, v14 offset:0x201f
    s_waitcnt lgkmcnt(0)
    v_add_f32 v14, v14, v13
    ds_swizzle_b32 v13, v14 offset:0x401f
    s_waitcnt lgkmcnt(0)
    v_add_f32 v14, v14, v13
    s_nop 1
    v_readlane_b32 s20, v14, 0
    v_readlane_b32 s21, v14, 32
    s_nop 3
    v_mov_b32 v14, s20
    v_add_f32 v14, s21, v14
    v_mov_b32 v15, 0x3727c5ac
    v_fmac_f32 v15, 0.0009765625, v14
    v_rsq_f32 v15, v15
    s_nop 0
    v_mul_f32 v16, v16, v15
    v_mul_f32 v17, v17, v15
    v_mul_f32 v18, v18, v15
    v_mul_f32 v19, v19, v15
    v_mul_f32 v20, v20, v15
    v_mul_f32 v21, v21, v15
    v_mul_f32 v22, v22, v15
    v_mul_f32 v23, v23, v15
    v_mul_f32 v24, v24, v15
    v_mul_f32 v25, v25, v15
    v_mul_f32 v26, v26, v15
    v_mul_f32 v27, v27, v15
    v_mul_f32 v28, v28, v15
    v_mul_f32 v29, v29, v15
    v_mul_f32 v30, v30, v15
    v_mul_f32 v31, v31, v15
    v_cvt_pk_bf16_f32 v4, v16, v17
    v_cvt_pk_bf16_f32 v5, v18, v19
    v_cvt_pk_bf16_f32 v6, v20, v21
    v_cvt_pk_bf16_f32 v7, v22, v23
    v_cvt_pk_bf16_f32 v8, v24, v25
    v_cvt_pk_bf16_f32 v9, v26, v27
    v_cvt_pk_bf16_f32 v10, v28, v29
    v_cvt_pk_bf16_f32 v11, v30, v31
    buffer_store_dwordx4 v[4:7], v1, s[8:11], 0 offen
    buffer_store_dwordx4 v[8:11], v1, s[8:11], 0 offen offset:1024
L_ln1_kernel_end:
    s_endpgm
.section .rodata,"a"
.p2align 6
.amdhsa_kernel ln1_kernel
  .amdhsa_next_free_vgpr 32
  .amdhsa_next_free_sgpr 96
  .amdhsa_accum_offset 32
  .amdhsa_group_segment_fixed_size 0
  .amdhsa_kernarg_size 80
  .amdhsa_user_sgpr_count 2
  .amdhsa_user_sgpr_kernarg_segment_ptr 1
  .amdhsa_system_sgpr_workgroup_id_x 1
.end_amdhsa_kernel
.text
.globl qkv_kernel
.p2align 8
.type qkv_kernel,@function
qkv_kernel:
    s_cmp_ge_u32 s2, 256
    s_cbranch_scc1 L_qkv_kernel_end
    s_load_dwordx2 s[4:5], s[0:1], 72
    s_load_dwordx2 s[8:9], s[0:1], 8
    s_load_dwordx2 s[16:17], s[0:1], 72
    s_and_b32 s30, s2, 7
    s_lshr_b32 s31, s2, 3
    s_and_b32 s33, s31, 0
    s_lshr_b32 s31, s31, 0
    s_mul_i32 s34, s30, 32
    s_add_u32 s34, s34, s31
    s_and_b32 s24, s31, 7
    s_lshr_b32 s25, s31, 3
    s_lshr_b32 s31, s30, 2
    s_mul_i32 s31, s31, 8
    s_add_u32 s24, s24, s31
    s_and_b32 s31, s30, 3
    s_mul_i32 s31, s31, 4
    s_add_u32 s25, s25, s31
    s_mul_i32 s24, s24, 128
    s_mul_i32 s25, s25, 192
    v_lshrrev_b32 v1, 6, v0
    s_nop 0
    v_readfirstlane_b32 s31, v1
    v_and_b32 v0, 63, v0
    s_nop 3
    s_lshr_b32 s26, s31, 1
    s_and_b32 s27, s31, 1
    s_mul_i32 s60, s33, 2048
    s_mul_i32 s61, s33, 6291456
    s_add_u32 s62, s60, 2048
    s_lshr_b32 s30, s2, 3
    s_mul_i32 s30, s30, 0
    s_mul_hi_u32 s28, s30, 268435456
    s_mul_i32 s28, s28, 16
    s_sub_u32 s30, s30, s28
    s_mul_i32 s28, s30, 128
    s_add_u32 s28, s28, s60
    s_mul_i32 s29, s30, 393216
    s_add_u32 s29, s29, s61
    s_waitcnt lgkmcnt(0)
    s_mov_b32 s6, 4194304
    s_mov_b32 s7, 0x00020000
    s_mov_b32 s10, 6291456
    s_mov_b32 s11, 0x00020000
    s_add_u32 s16, s16, 4194304
    s_addc_u32 s17, s17, 0
    s_mov_b32 s18, 12582912
    s_mov_b32 s19, 0x00020000
    s_add_u32 s30, s31, 0
    s_min_u32 s30, s30, 15
    s_lshl_b32 s30, s30, 10
    s_add_u32 s36, s30, 0
    v_lshlrev_b32 v30, 4, v0
    v_add_u32 v30, s30, v30
    s_mov_b32 s30, 8192
    v_mul_lo_u32 v31, v30, s30
    v_lshrrev_b32 v31, 20, v31
    s_mov_b32 s30, 128
    v_mul_lo_u32 v32, v31, s30
    v_sub_u32 v32, v30, v32
    v_lshrrev_b32 v32, 4, v32
    v_bfe_u32 v33, v31, 1, 3
    v_xor_b32 v32, v32, v33
    v_add_u32 v31, s24, v31
    s_mov_b32 s30, 2048
    v_mul_lo_u32 v31, v31, s30
    v_lshl_add_u32 v2, v32, 4, v31
    s_add_u32 s30, s31, 4
    s_min_u32 s30, s30, 15
    s_lshl_b32 s30, s30, 10
    s_add_u32 s37, s30, 0
    v_lshlrev_b32 v30, 4, v0
    v_add_u32 v30, s30, v30
    s_mov_b32 s30, 8192
    v_mul_lo_u32 v31, v30, s30
    v_lshrrev_b32 v31, 20, v31
    s_mov_b32 s30, 128
    v_mul_lo_u32 v32, v31, s30
    v_sub_u32 v32, v30, v32
    v_lshrrev_b32 v32, 4, v32
    v_bfe_u32 v33, v31, 1, 3
    v_xor_b32 v32, v32, v33
    v_add_u32 v31, s24, v31
    s_mov_b32 s30, 2048
    v_mul_lo_u32 v31, v31, s30
    v_lshl_add_u32 v3, v32, 4, v31
    s_add_u32 s30, s31, 8
    s_min_u32 s30, s30, 15
    s_lshl_b32 s30, s30, 10
    s_add_u32 s38, s30, 0
    v_lshlrev_b32 v30, 4, v0
    v_add_u32 v30, s30, v30
    s_mov_b32 s30, 8192
    v_mul_lo_u32 v31, v30, s30
    v_lshrrev_b32 v31, 20, v31
    s_mov_b32 s30, 128
    v_mul_lo_u32 v32, v31, s30
    v_sub_u32 v32, v30, v32
    v_lshrrev_b32 v32, 4, v32
    v_bfe_u32 v33, v31, 1, 3
    v_xor_b32 v32, v32, v33
    v_add_u32 v31, s24, v31
    s_mov_b32 s30, 2048
    v_mul_lo_u32 v31, v31, s30
    v_lshl_add_u32 v4, v32, 4, v31
    s_add_u32 s30, s31, 12
    s_min_u32 s30, s30, 15
    s_lshl_b32 s30, s30, 10
    s_add_u32 s39, s30, 0
    v_lshlrev_b32 v30, 4, v0
    v_add_u32 v30, s30, v30
    s_mov_b32 s30, 8192
    v_mul_lo_u32 v31, v30, s30
    v_lshrrev_b32 v31, 20, v31
    s_mov_b32 s30, 128
    v_mul_lo_u32 v32, v31, s30
    v_sub_u32 v32, v30, v32
    v_lshrrev_b32 v32, 4, v32
    v_bfe_u32 v33, v31, 1, 3
    v_xor_b32 v32, v32, v33
    v_add_u32 v31, s24, v31
    s_mov_b32 s30, 2048
    v_mul_lo_u32 v31, v31, s30
    v_lshl_add_u32 v5, v32, 4, v31
    s_add_u32 s30, s31, 0
    s_min_u32 s30, s30, 23
    s_lshl_b32 s30, s30, 10
    s_add_u32 s40, s30, 16384
    v_lshlrev_b32 v30, 4, v0
    v_add_u32 v30, s30, v30
    s_mov_b32 s30, 2731
    v_mul_lo_u32 v31, v30, s30
    v_lshrrev_b32 v31, 20, v31
    s_mov_b32 s30, 384
    v_mul_lo_u32 v32, v31, s30
    v_sub_u32 v32, v30, v32
    v_lshrrev_b32 v32, 4, v32
    v_mov_b32 v33, 0
    v_bfe_u32 v34, v31, 1, 1
    v_lshl_or_b32 v33, v34, 1, v33
    v_bfe_u32 v34, v31, 3, 1
    v_lshl_or_b32 v33, v34, 2, v33
    v_xor_b32 v32, v32, v33
    v_min_u32 v32, 23, v32
    s_mov_b32 s30, 6144
    v_mul_lo_u32 v31, v31, s30
    v_lshl_add_u32 v31, v32, 4, v31
    s_lshl_b32 s30, s25, 1
    v_add_u32 v6, s30, v31
    s_add_u32 s30, s31, 4
    s_min_u32 s30, s30, 23
    s_lshl_b32 s30, s30, 10
    s_add_u32 s41, s30, 16384
    v_lshlrev_b32 v30, 4, v0
    v_add_u32 v30, s30, v30
    s_mov_b32 s30, 2731
    v_mul_lo_u32 v31, v30, s30
    v_lshrrev_b32 v31, 20, v31
    s_mov_b32 s30, 384
    v_mul_lo_u32 v32, v31, s30
    v_sub_u32 v32, v30, v32
    v_lshrrev_b32 v32, 4, v32
    v_mov_b32 v33, 0
    v_bfe_u32 v34, v31, 1, 1
    v_lshl_or_b32 v33, v34, 1, v33
    v_bfe_u32 v34, v31, 3, 1
    v_lshl_or_b32 v33, v34, 2, v33
    v_xor_b32 v32, v32, v33
    v_min_u32 v32, 23, v32
    s_mov_b32 s30, 6144
    v_mul_lo_u32 v31, v31, s30
    v_lshl_add_u32 v31, v32, 4, v31
    s_lshl_b32 s30, s25, 1
    v_add_u32 v7, s30, v31
    s_add_u32 s30, s31, 8
    s_min_u32 s30, s30, 23
    s_lshl_b32 s30, s30, 10
    s_add_u32 s42, s30, 16384
    v_lshlrev_b32 v30, 4, v0
    v_add_u32 v30, s30, v30
    s_mov_b32 s30, 2731
    v_mul_lo_u32 v31, v30, s30
    v_lshrrev_b32 v31, 20, v31
    s_mov_b32 s30, 384
    v_mul_lo_u32 v32, v31, s30
    v_sub_u32 v32, v30, v32
    v_lshrrev_b32 v32, 4, v32
    v_mov_b32 v33, 0
    v_bfe_u32 v34, v31, 1, 1
    v_lshl_or_b32 v33, v34, 1, v33
    v_bfe_u32 v34, v31, 3, 1
    v_lshl_or_b32 v33, v34, 2, v33
    v_xor_b32 v32, v32, v33
    v_min_u32 v32, 23, v32
    s_mov_b32 s30, 6144
    v_mul_lo_u32 v31, v31, s30
    v_lshl_add_u32 v31, v32, 4, v31
    s_lshl_b32 s30, s25, 1
    v_add_u32 v8, s30, v31
    s_add_u32 s30, s31, 12
    s_min_u32 s30, s30, 23
    s_lshl_b32 s30, s30, 10
    s_add_u32 s43, s30, 16384
    v_lshlrev_b32 v30, 4, v0
    v_add_u32 v30, s30, v30
    s_mov_b32 s30, 2731
    v_mul_lo_u32 v31, v30, s30
    v_lshrrev_b32 v31, 20, v31
    s_mov_b32 s30, 384
    v_mul_lo_u32 v32, v31, s30
    v_sub_u32 v32, v30, v32
    v_lshrrev_b32 v32, 4, v32
    v_mov_b32 v33, 0
    v_bfe_u32 v34, v31, 1, 1
    v_lshl_or_b32 v33, v34, 1, v33
    v_bfe_u32 v34, v31, 3, 1
    v_lshl_or_b32 v33, v34, 2, v33
    v_xor_b32 v32, v32, v33
    v_min_u32 v32, 23, v32
    s_mov_b32 s30, 6144
    v_mul_lo_u32 v31, v31, s30
    v_lshl_add_u32 v31, v32, 4, v31
    s_lshl_b32 s30, s25, 1
    v_add_u32 v9, s30, v31
    s_add_u32 s30, s31, 16
    s_min_u32 s30, s30, 23
    s_lshl_b32 s30, s30, 10
    s_add_u32 s44, s30, 16384
    v_lshlrev_b32 v30, 4, v0
    v_add_u32 v30, s30, v30
    s_mov_b32 s30, 2731
    v_mul_lo_u32 v31, v30, s30
    v_lshrrev_b32 v31, 20, v31
    s_mov_b32 s30, 384
    v_mul_lo_u32 v32, v31, s30
    v_sub_u32 v32, v30, v32
    v_lshrrev_b32 v32, 4, v32
    v_mov_b32 v33, 0
    v_bfe_u32 v34, v31, 1, 1
    v_lshl_or_b32 v33, v34, 1, v33
    v_bfe_u32 v34, v31, 3, 1
    v_lshl_or_b32 v33, v34, 2, v33
    v_xor_b32 v32, v32, v33
    v_min_u32 v32, 23, v32
    s_mov_b32 s30, 6144
    v_mul_lo_u32 v31, v31, s30
    v_lshl_add_u32 v31, v32, 4, v31
    s_lshl_b32 s30, s25, 1
    v_add_u32 v10, s30, v31
    s_add_u32 s30, s31, 20
    s_min_u32 s30, s30, 23
    s_lshl_b32 s30, s30, 10
    s_add_u32 s45, s30, 16384
    v_lshlrev_b32 v30, 4, v0
    v_add_u32 v30, s30, v30
    s_mov_b32 s30, 2731
    v_mul_lo_u32 v31, v30, s30
    v_lshrrev_b32 v31, 20, v31
    s_mov_b32 s30, 384
    v_mul_lo_u32 v32, v31, s30
    v_sub_u32 v32, v30, v32
    v_lshrrev_b32 v32, 4, v32
    v_mov_b32 v33, 0
    v_bfe_u32 v34, v31, 1, 1
    v_lshl_or_b32 v33, v34, 1, v33
    v_bfe_u32 v34, v31, 3, 1
    v_lshl_or_b32 v33, v34, 2, v33
    v_xor_b32 v32, v32, v33
    v_min_u32 v32, 23, v32
    s_mov_b32 s30, 6144
    v_mul_lo_u32 v31, v31, s30
    v_lshl_add_u32 v31, v32, 4, v31
    s_lshl_b32 s30, s25, 1
    v_add_u32 v11, s30, v31
    v_and_b32 v30, 15, v0
    v_lshrrev_b32 v31, 4, v0
    s_mul_i32 s30, s26, 64
    v_add_u32 v32, s30, v30
    v_bfe_u32 v33, v30, 1, 3
    v_add_u32 v34, 0, v31
    v_xor_b32 v34, v34, v33
    v_lshlrev_b32 v34, 4, v34
    v_mul_u32_u24 v12, 128, v32
    v_add_u32 v12, v12, v34
    v_add_u32 v13, 40960, v12
    v_add_u32 v14, 81920, v12
    v_add_u32 v34, 4, v31
    v_xor_b32 v34, v34, v33
    v_lshlrev_b32 v34, 4, v34
    v_mul_u32_u24 v15, 128, v32
    v_add_u32 v15, v15, v34
    v_add_u32 v16, 40960, v15
    v_add_u32 v17, 81920, v15
    v_bfe_u32 v30, v0, 2, 2
    v_lshl_add_u32 v30, v31, 3, v30
    v_and_b32 v32, 3, v0
    v_mov_b32 v33, 0
    v_bfe_u32 v34, v30, 1, 1
    v_lshl_or_b32 v33, v34, 1, v33
    v_bfe_u32 v34, v30, 3, 1
    v_lshl_or_b32 v33, v34, 2, v33
    s_mul_i32 s30, s27, 192
    s_add_u32 s30, s30, 0
    v_lshlrev_b32 v34, 3, v32
    v_add_u32 v34, s30, v34
    v_lshrrev_b32 v31, 4, v34
    v_xor_b32 v31, v31, v33
    v_and_b32 v34, 15, v34
    v_lshl_add_u32 v34, v31, 4, v34
    v_mul_u32_u24 v18, 384, v30
    v_add_u32 v18, v18, v34
    v_add_u32 v18, 16384, v18
    v_add_u32 v19, 40960, v18
    v_add_u32 v20, 81920, v18
    s_mul_i32 s30, s27, 192
    s_add_u32 s30, s30, 32
    v_lshlrev_b32 v34, 3, v32
    v_add_u32 v34, s30, v34
    v_lshrrev_b32 v31, 4, v34
    v_xor_b32 v31, v31, v33
    v_and_b32 v34, 15, v34
    v_lshl_add_u32 v34, v31, 4, v34
    v_mul_u32_u24 v21, 384, v30
    v_add_u32 v21, v21, v34
    v_add_u32 v21, 16384, v21
    v_add_u32 v22, 40960, v21
    v_add_u32 v23, 81920, v21
    s_mul_i32 s30, s27, 192
    s_add_u32 s30, s30, 64
    v_lshlrev_b32 v34, 3, v32
    v_add_u32 v34, s30, v34
    v_lshrrev_b32 v31, 4, v34
    v_xor_b32 v31, v31, v33
    v_and_b32 v34, 15, v34
    v_lshl_add_u32 v34, v31, 4, v34
    v_mul_u32_u24 v24, 384, v30
    v_add_u32 v24, v24, v34
    v_add_u32 v24, 16384, v24
    v_add_u32 v25, 40960, v24
    v_add_u32 v26, 81920, v24
    s_mul_i32 s30, s27, 192
    s_add_u32 s30, s30, 96
    v_lshlrev_b32 v34, 3, v32
    v_add_u32 v34, s30, v34
    v_lshrrev_b32 v31, 4, v34
    v_xor_b32 v31, v31, v33
    v_and_b32 v34, 15, v34
    v_lshl_add_u32 v34, v31, 4, v34
    v_mul_u32_u24 v27, 384, v30
    v_add_u32 v27, v27, v34
    v_add_u32 v27, 16384, v27
    v_add_u32 v28, 40960, v27
    v_add_u32 v29, 81920, v27
    s_add_u32 m0, s36, 0
    buffer_load_dwordx4 v2, s[4:7], s28 offen lds
    s_add_u32 m0, s37, 0
    buffer_load_dwordx4 v3, s[4:7], s28 offen lds
    s_add_u32 m0, s38, 0
    buffer_load_dwordx4 v4, s[4:7], s28 offen lds
    s_add_u32 m0, s39, 0
    buffer_load_dwordx4 v5, s[4:7], s28 offen lds
    s_add_u32 m0, s40, 0
    buffer_load_dwordx4 v6, s[8:11], s29 offen lds
    s_add_u32 m0, s41, 0
    buffer_load_dwordx4 v7, s[8:11], s29 offen lds
    s_add_u32 m0, s42, 0
    buffer_load_dwordx4 v8, s[8:11], s29 offen lds
    s_add_u32 m0, s43, 0
    buffer_load_dwordx4 v9, s[8:11], s29 offen lds
    s_add_u32 m0, s44, 0
    buffer_load_dwordx4 v10, s[8:11], s29 offen lds
    s_add_u32 m0, s45, 0
    buffer_load_dwordx4 v11, s[8:11], s29 offen lds
    s_add_u32 s28, s28, 128
    s_add_u32 s29, s29, 393216
    s_add_u32 m0, s36, 40960
    buffer_load_dwordx4 v2, s[4:7], s28 offen lds
    s_add_u32 m0, s37, 40960
    buffer_load_dwordx4 v3, s[4:7], s28 offen lds
    s_add_u32 m0, s38, 40960
    buffer_load_dwordx4 v4, s[4:7], s28 offen lds
    s_add_u32 m0, s39, 40960
    buffer_load_dwordx4 v5, s[4:7], s28 offen lds
    s_add_u32 m0, s40, 40960
    buffer_load_dwordx4 v6, s[8:11], s29 offen lds
    s_add_u32 m0, s41, 40960
    buffer_load_dwordx4 v7, s[8:11], s29 offen lds
    s_add_u32 m0, s42, 40960
    buffer_load_dwordx4 v8, s[8:11], s29 offen lds
    s_add_u32 m0, s43, 40960
    buffer_load_dwordx4 v9, s[8:11], s29 offen lds
    s_add_u32 m0, s44, 40960
    buffer_load_dwordx4 v10, s[8:11], s29 offen lds
    s_add_u32 m0, s45, 40960
    buffer_load_dwordx4 v11, s[8:11], s29 offen lds
    s_add_u32 s28, s28, 128
    s_add_u32 s29, s29, 393216
    s_add_u32 m0, s36, 81920
    buffer_load_dwordx4 v2, s[4:7], s28 offen lds
    s_add_u32 m0, s37, 81920
    buffer_load_dwordx4 v3, s[4:7], s28 offen lds
    s_add_u32 m0, s38, 81920
    buffer_load_dwordx4 v4, s[4:7], s28 offen lds
    s_add_u32 m0, s39, 81920
    buffer_load_dwordx4 v5, s[4:7], s28 offen lds
    s_add_u32 m0, s40, 81920
    buffer_load_dwordx4 v6, s[8:11], s29 offen lds
    s_add_u32 m0, s41, 81920
    buffer_load_dwordx4 v7, s[8:11], s29 offen lds
    s_add_u32 m0, s42, 81920
    buffer_load_dwordx4 v8, s[8:11], s29 offen lds
    s_add_u32 m0, s43, 81920
    buffer_load_dwordx4 v9, s[8:11], s29 offen lds
    s_add_u32 m0, s44, 81920
    buffer_load_dwordx4 v10, s[8:11], s29 offen lds
    s_add_u32 m0, s45, 81920
    buffer_load_dwordx4 v11, s[8:11], s29 offen lds
    s_add_u32 s28, s28, 128
    s_add_u32 s29, s29, 393216
    v_accvgpr_write_b32 a0, 0
    v_accvgpr_write_b32 a1, 0
    v_accvgpr_write_b32 a2, 0
    v_accvgpr_write_b32 a3, 0
    v_accvgpr_write_b32 a4, 0
    v_accvgpr_write_b32 a5, 0
    v_accvgpr_write_b32 a6, 0
    v_accvgpr_write_b32 a7, 0
    v_accvgpr_write_b32 a8, 0
    v_accvgpr_write_b32 a9, 0
    v_accvgpr_write_b32 a10, 0
    v_accvgpr_write_b32 a11, 0
    v_accvgpr_write_b32 a12, 0
    v_accvgpr_write_b32 a13, 0
    v_accvgpr_write_b32 a14, 0
    v_accvgpr_write_b32 a15, 0
    v_accvgpr_write_b32 a16, 0
    v_accvgpr_write_b32 a17, 0
    v_accvgpr_write_b32 a18, 0
    v_accvgpr_write_b32 a19, 0
    v_accvgpr_write_b32 a20, 0
    v_accvgpr_write_b32 a21, 0
    v_accvgpr_write_b32 a22, 0
    v_accvgpr_write_b32 a23, 0
    v_accvgpr_write_b32 a24, 0
    v_accvgpr_write_b32 a25, 0
    v_accvgpr_write_b32 a26, 0
    v_accvgpr_write_b32 a27, 0
    v_accvgpr_write_b32 a28, 0
    v_accvgpr_write_b32 a29, 0
    v_accvgpr_write_b32 a30, 0
    v_accvgpr_write_b32 a31, 0
    v_accvgpr_write_b32 a32, 0
    v_accvgpr_write_b32 a33, 0
    v_accvgpr_write_b32 a34, 0
    v_accvgpr_write_b32 a35, 0
    v_accvgpr_write_b32 a36, 0
    v_accvgpr_write_b32 a37, 0
    v_accvgpr_write_b32 a38, 0
    v_accvgpr_write_b32 a39, 0
    v_accvgpr_write_b32 a40, 0
    v_accvgpr_write_b32 a41, 0
    v_accvgpr_write_b32 a42, 0
    v_accvgpr_write_b32 a43, 0
    v_accvgpr_write_b32 a44, 0
    v_accvgpr_write_b32 a45, 0
    v_accvgpr_write_b32 a46, 0
    v_accvgpr_write_b32 a47, 0
    v_accvgpr_write_b32 a48, 0
    v_accvgpr_write_b32 a49, 0
    v_accvgpr_write_b32 a50, 0
    v_accvgpr_write_b32 a51, 0
    v_accvgpr_write_b32 a52, 0
    v_accvgpr_write_b32 a53, 0
    v_accvgpr_write_b32 a54, 0
    v_accvgpr_write_b32 a55, 0
    v_accvgpr_write_b32 a56, 0
    v_accvgpr_write_b32 a57, 0
    v_accvgpr_write_b32 a58, 0
    v_accvgpr_write_b32 a59, 0
    v_accvgpr_write_b32 a60, 0
    v_accvgpr_write_b32 a61, 0
    v_accvgpr_write_b32 a62, 0
    v_accvgpr_write_b32 a63, 0
    v_accvgpr_write_b32 a64, 0
    v_accvgpr_write_b32 a65, 0
    v_accvgpr_write_b32 a66, 0
    v_accvgpr_write_b32 a67, 0
    v_accvgpr_write_b32 a68, 0
    v_accvgpr_write_b32 a69, 0
    v_accvgpr_write_b32 a70, 0
    v_accvgpr_write_b32 a71, 0
    v_accvgpr_write_b32 a72, 0
    v_accvgpr_write_b32 a73, 0
    v_accvgpr_write_b32 a74, 0
    v_accvgpr_write_b32 a75, 0
    v_accvgpr_write_b32 a76, 0
    v_accvgpr_write_b32 a77, 0
    v_accvgpr_write_b32 a78, 0
    v_accvgpr_write_b32 a79, 0
    v_accvgpr_write_b32 a80, 0
    v_accvgpr_write_b32 a81, 0
    v_accvgpr_write_b32 a82, 0
    v_accvgpr_write_b32 a83, 0
    v_accvgpr_write_b32 a84, 0
    v_accvgpr_write_b32 a85, 0
    v_accvgpr_write_b32 a86, 0
    v_accvgpr_write_b32 a87, 0
    v_accvgpr_write_b32 a88, 0
    v_accvgpr_write_b32 a89, 0
    v_accvgpr_write_b32 a90, 0
    v_accvgpr_write_b32 a91, 0
    v_accvgpr_write_b32 a92, 0
    v_accvgpr_write_b32 a93, 0
    v_accvgpr_write_b32 a94, 0
    v_accvgpr_write_b32 a95, 0
    s_waitcnt vmcnt(20)
    s_barrier
    ds_read_b128 v[40:43], v12 offset:0
    ds_read_b128 v[44:47], v12 offset:2048
    ds_read_b128 v[48:51], v12 offset:4096
    ds_read_b128 v[52:55], v12 offset:6144
    ds_read_b64_tr_b16 v[56:57], v18 offset:0
    ds_read_b64_tr_b16 v[58:59], v18 offset:1536
    ds_read_b64_tr_b16 v[60:61], v21 offset:0
    ds_read_b64_tr_b16 v[62:63], v21 offset:1536
    ds_read_b64_tr_b16 v[64:65], v24 offset:0
    ds_read_b64_tr_b16 v[66:67], v24 offset:1536
    ds_read_b64_tr_b16 v[68:69], v27 offset:0
    ds_read_b64_tr_b16 v[70:71], v27 offset:1536
    ds_read_b64_tr_b16 v[72:73], v18 offset:128
    ds_read_b64_tr_b16 v[74:75], v18 offset:1664
    ds_read_b64_tr_b16 v[76:77], v21 offset:128
    ds_read_b64_tr_b16 v[78:79], v21 offset:1664
    s_waitcnt lgkmcnt(0)
    ds_read_b128 v[80:83], v15 offset:0
    v_mfma_f32_16x16x32_bf16 a[0:3], v[56:59], v[40:43], a[0:3]
    ds_read_b128 v[84:87], v15 offset:2048
    v_mfma_f32_16x16x32_bf16 a[24:27], v[56:59], v[44:47], a[24:27]
    ds_read_b128 v[88:91], v15 offset:4096
    v_mfma_f32_16x16x32_bf16 a[48:51], v[56:59], v[48:51], a[48:51]
    ds_read_b128 v[92:95], v15 offset:6144
    v_mfma_f32_16x16x32_bf16 a[72:75], v[56:59], v[52:55], a[72:75]
    ds_read_b64_tr_b16 v[96:97], v18 offset:12288
    v_mfma_f32_16x16x32_bf16 a[4:7], v[60:63], v[40:43], a[4:7]
    ds_read_b64_tr_b16 v[98:99], v18 offset:13824
    v_mfma_f32_16x16x32_bf16 a[28:31], v[60:63], v[44:47], a[28:31]
    ds_read_b64_tr_b16 v[100:101], v21 offset:12288
    v_mfma_f32_16x16x32_bf16 a[52:55], v[60:63], v[48:51], a[52:55]
    ds_read_b64_tr_b16 v[102:103], v21 offset:13824
    v_mfma_f32_16x16x32_bf16 a[76:79], v[60:63], v[52:55], a[76:79]
    ds_read_b64_tr_b16 v[104:105], v24 offset:12288
    v_mfma_f32_16x16x32_bf16 a[8:11], v[64:67], v[40:43], a[8:11]
    ds_read_b64_tr_b16 v[106:107], v24 offset:13824
    v_mfma_f32_16x16x32_bf16 a[32:35], v[64:67], v[44:47], a[32:35]
    ds_read_b64_tr_b16 v[108:109], v27 offset:12288
    v_mfma_f32_16x16x32_bf16 a[56:59], v[64:67], v[48:51], a[56:59]
    ds_read_b64_tr_b16 v[110:111], v27 offset:13824
    v_mfma_f32_16x16x32_bf16 a[80:83], v[64:67], v[52:55], a[80:83]
    ds_read_b64_tr_b16 v[112:113], v18 offset:12416
    v_mfma_f32_16x16x32_bf16 a[12:15], v[68:71], v[40:43], a[12:15]
    ds_read_b64_tr_b16 v[114:115], v18 offset:13952
    v_mfma_f32_16x16x32_bf16 a[36:39], v[68:71], v[44:47], a[36:39]
    ds_read_b64_tr_b16 v[116:117], v21 offset:12416
    v_mfma_f32_16x16x32_bf16 a[60:63], v[68:71], v[48:51], a[60:63]
    ds_read_b64_tr_b16 v[118:119], v21 offset:13952
    v_mfma_f32_16x16x32_bf16 a[84:87], v[68:71], v[52:55], a[84:87]
    v_mfma_f32_16x16x32_bf16 a[16:19], v[72:75], v[40:43], a[16:19]
    v_mfma_f32_16x16x32_bf16 a[40:43], v[72:75], v[44:47], a[40:43]
    v_mfma_f32_16x16x32_bf16 a[64:67], v[72:75], v[48:51], a[64:67]
    v_mfma_f32_16x16x32_bf16 a[88:91], v[72:75], v[52:55], a[88:91]
    v_mfma_f32_16x16x32_bf16 a[20:23], v[76:79], v[40:43], a[20:23]
    v_mfma_f32_16x16x32_bf16 a[44:47], v[76:79], v[44:47], a[44:47]
    v_mfma_f32_16x16x32_bf16 a[68:71], v[76:79], v[48:51], a[68:71]
    v_mfma_f32_16x16x32_bf16 a[92:95], v[76:79], v[52:55], a[92:95]
    s_waitcnt lgkmcnt(0)
    v_mfma_f32_16x16x32_bf16 a[0:3], v[96:99], v[80:83], a[0:3]
    v_mfma_f32_16x16x32_bf16 a[24:27], v[96:99], v[84:87], a[24:27]
    s_waitcnt vmcnt(10)
    s_barrier
    s_add_u32 m0, s36, 0
    buffer_load_dwordx4 v2, s[4:7], s28 offen lds
    s_add_u32 m0, s37, 0
    buffer_load_dwordx4 v3, s[4:7], s28 offen lds
    s_add_u32 m0, s38, 0
    buffer_load_dwordx4 v4, s[4:7], s28 offen lds
    s_add_u32 m0, s39, 0
    buffer_load_dwordx4 v5, s[4:7], s28 offen lds
    s_add_u32 m0, s40, 0
    buffer_load_dwordx4 v6, s[8:11], s29 offen lds
    s_add_u32 m0, s41, 0
    buffer_load_dwordx4 v7, s[8:11], s29 offen lds
    s_add_u32 m0, s42, 0
    buffer_load_dwordx4 v8, s[8:11], s29 offen lds
    s_add_u32 m0, s43, 0
    buffer_load_dwordx4 v9, s[8:11], s29 offen lds
    s_add_u32 m0, s44, 0
    buffer_load_dwordx4 v10, s[8:11], s29 offen lds
    s_add_u32 m0, s45, 0
    buffer_load_dwordx4 v11, s[8:11], s29 offen lds
    s_add_u32 s28, s28, 128
    s_add_u32 s29, s29, 393216
    ds_read_b128 v[40:43], v13 offset:0
    v_mfma_f32_16x16x32_bf16 a[48:51], v[96:99], v[88:91], a[48:51]
    ds_read_b128 v[44:47], v13 offset:2048
    v_mfma_f32_16x16x32_bf16 a[72:75], v[96:99], v[92:95], a[72:75]
    ds_read_b128 v[48:51], v13 offset:4096
    v_mfma_f32_16x16x32_bf16 a[4:7], v[100:103], v[80:83], a[4:7]
    ds_read_b128 v[52:55], v13 offset:6144
    v_mfma_f32_16x16x32_bf16 a[28:31], v[100:103], v[84:87], a[28:31]
    ds_read_b64_tr_b16 v[56:57], v19 offset:0
    v_mfma_f32_16x16x32_bf16 a[52:55], v[100:103], v[88:91], a[52:55]
    ds_read_b64_tr_b16 v[58:59], v19 offset:1536
    v_mfma_f32_16x16x32_bf16 a[76:79], v[100:103], v[92:95], a[76:79]
    ds_read_b64_tr_b16 v[60:61], v22 offset:0
    v_mfma_f32_16x16x32_bf16 a[8:11], v[104:107], v[80:83], a[8:11]
    ds_read_b64_tr_b16 v[62:63], v22 offset:1536
    v_mfma_f32_16x16x32_bf16 a[32:35], v[104:107], v[84:87], a[32:35]
    ds_read_b64_tr_b16 v[64:65], v25 offset:0
    v_mfma_f32_16x16x32_bf16 a[56:59], v[104:107], v[88:91], a[56:59]
    ds_read_b64_tr_b16 v[66:67], v25 offset:1536
    v_mfma_f32_16x16x32_bf16 a[80:83], v[104:107], v[92:95], a[80:83]
    ds_read_b64_tr_b16 v[68:69], v28 offset:0
    v_mfma_f32_16x16x32_bf16 a[12:15], v[108:111], v[80:83], a[12:15]
    ds_read_b64_tr_b16 v[70:71], v28 offset:1536
    v_mfma_f32_16x16x32_bf16 a[36:39], v[108:111], v[84:87], a[36:39]
    ds_read_b64_tr_b16 v[72:73], v19 offset:128
    v_mfma_f32_16x16x32_bf16 a[60:63], v[108:111], v[88:91], a[60:63]
    ds_read_b64_tr_b16 v[74:75], v19 offset:1664
    v_mfma_f32_16x16x32_bf16 a[84:87], v[108:111], v[92:95], a[84:87]
    ds_read_b64_tr_b16 v[76:77], v22 offset:128
    v_mfma_f32_16x16x32_bf16 a[16:19], v[112:115], v[80:83], a[16:19]
    ds_read_b64_tr_b16 v[78:79], v22 offset:1664
    v_mfma_f32_16x16x32_bf16 a[40:43], v[112:115], v[84:87], a[40:43]
    v_mfma_f32_16x16x32_bf16 a[64:67], v[112:115], v[88:91], a[64:67]
    v_mfma_f32_16x16x32_bf16 a[88:91], v[112:115], v[92:95], a[88:91]
    v_mfma_f32_16x16x32_bf16 a[20:23], v[116:119], v[80:83], a[20:23]
    v_mfma_f32_16x16x32_bf16 a[44:47], v[116:119], v[84:87], a[44:47]
    v_mfma_f32_16x16x32_bf16 a[68:71], v[116:119], v[88:91], a[68:71]
    v_mfma_f32_16x16x32_bf16 a[92:95], v[116:119], v[92:95], a[92:95]
    s_waitcnt lgkmcnt(0)
    ds_read_b128 v[80:83], v16 offset:0
    v_mfma_f32_16x16x32_bf16 a[0:3], v[56:59], v[40:43], a[0:3]
    ds_read_b128 v[84:87], v16 offset:2048
    v_mfma_f32_16x16x32_bf16 a[24:27], v[56:59], v[44:47], a[24:27]
    ds_read_b128 v[88:91], v16 offset:4096
    v_mfma_f32_16x16x32_bf16 a[48:51], v[56:59], v[48:51], a[48:51]
    ds_read_b128 v[92:95], v16 offset:6144
    v_mfma_f32_16x16x32_bf16 a[72:75], v[56:59], v[52:55], a[72:75]
    ds_read_b64_tr_b16 v[96:97], v19 offset:12288
    v_mfma_f32_16x16x32_bf16 a[4:7], v[60:63], v[40:43], a[4:7]
    ds_read_b64_tr_b16 v[98:99], v19 offset:13824
    v_mfma_f32_16x16x32_bf16 a[28:31], v[60:63], v[44:47], a[28:31]
    ds_read_b64_tr_b16 v[100:101], v22 offset:12288
    v_mfma_f32_16x16x32_bf16 a[52:55], v[60:63], v[48:51], a[52:55]
    ds_read_b64_tr_b16 v[102:103], v22 offset:13824
    v_mfma_f32_16x16x32_bf16 a[76:79], v[60:63], v[52:55], a[76:79]
    ds_read_b64_tr_b16 v[104:105], v25 offset:12288
    v_mfma_f32_16x16x32_bf16 a[8:11], v[64:67], v[40:43], a[8:11]
    ds_read_b64_tr_b16 v[106:107], v25 offset:13824
    v_mfma_f32_16x16x32_bf16 a[32:35], v[64:67], v[44:47], a[32:35]
    ds_read_b64_tr_b16 v[108:109], v28 offset:12288
    v_mfma_f32_16x16x32_bf16 a[56:59], v[64:67], v[48:51], a[56:59]
    ds_read_b64_tr_b16 v[110:111], v28 offset:13824
    v_mfma_f32_16x16x32_bf16 a[80:83], v[64:67], v[52:55], a[80:83]
    ds_read_b64_tr_b16 v[112:113], v19 offset:12416
    v_mfma_f32_16x16x32_bf16 a[12:15], v[68:71], v[40:43], a[12:15]
    ds_read_b64_tr_b16 v[114:115], v19 offset:13952
    v_mfma_f32_16x16x32_bf16 a[36:39], v[68:71], v[44:47], a[36:39]
    ds_read_b64_tr_b16 v[116:117], v22 offset:12416
    v_mfma_f32_16x16x32_bf16 a[60:63], v[68:71], v[48:51], a[60:63]
    ds_read_b64_tr_b16 v[118:119], v22 offset:13952
    v_mfma_f32_16x16x32_bf16 a[84:87], v[68:71], v[52:55], a[84:87]
    v_mfma_f32_16x16x32_bf16 a[16:19], v[72:75], v[40:43], a[16:19]
    v_mfma_f32_16x16x32_bf16 a[40:43], v[72:75], v[44:47], a[40:43]
    v_mfma_f32_16x16x32_bf16 a[64:67], v[72:75], v[48:51], a[64:67]
    v_mfma_f32_16x16x32_bf16 a[88:91], v[72:75], v[52:55], a[88:91]
    v_mfma_f32_16x16x32_bf16 a[20:23], v[76:79], v[40:43], a[20:23]
    v_mfma_f32_16x16x32_bf16 a[44:47], v[76:79], v[44:47], a[44:47]
    v_mfma_f32_16x16x32_bf16 a[68:71], v[76:79], v[48:51], a[68:71]
    v_mfma_f32_16x16x32_bf16 a[92:95], v[76:79], v[52:55], a[92:95]
    s_waitcnt lgkmcnt(0)
    v_mfma_f32_16x16x32_bf16 a[0:3], v[96:99], v[80:83], a[0:3]
    v_mfma_f32_16x16x32_bf16 a[24:27], v[96:99], v[84:87], a[24:27]
    s_waitcnt vmcnt(10)
    s_barrier
    s_add_u32 m0, s36, 40960
    buffer_load_dwordx4 v2, s[4:7], s28 offen lds
    s_add_u32 m0, s37, 40960
    buffer_load_dwordx4 v3, s[4:7], s28 offen lds
    s_add_u32 m0, s38, 40960
    buffer_load_dwordx4 v4, s[4:7], s28 offen lds
    s_add_u32 m0, s39, 40960
    buffer_load_dwordx4 v5, s[4:7], s28 offen lds
    s_add_u32 m0, s40, 40960
    buffer_load_dwordx4 v6, s[8:11], s29 offen lds
    s_add_u32 m0, s41, 40960
    buffer_load_dwordx4 v7, s[8:11], s29 offen lds
    s_add_u32 m0, s42, 40960
    buffer_load_dwordx4 v8, s[8:11], s29 offen lds
    s_add_u32 m0, s43, 40960
    buffer_load_dwordx4 v9, s[8:11], s29 offen lds
    s_add_u32 m0, s44, 40960
    buffer_load_dwordx4 v10, s[8:11], s29 offen lds
    s_add_u32 m0, s45, 40960
    buffer_load_dwordx4 v11, s[8:11], s29 offen lds
    s_add_u32 s28, s28, 128
    s_add_u32 s29, s29, 393216
    ds_read_b128 v[40:43], v14 offset:0
    v_mfma_f32_16x16x32_bf16 a[48:51], v[96:99], v[88:91], a[48:51]
    ds_read_b128 v[44:47], v14 offset:2048
    v_mfma_f32_16x16x32_bf16 a[72:75], v[96:99], v[92:95], a[72:75]
    ds_read_b128 v[48:51], v14 offset:4096
    v_mfma_f32_16x16x32_bf16 a[4:7], v[100:103], v[80:83], a[4:7]
    ds_read_b128 v[52:55], v14 offset:6144
    v_mfma_f32_16x16x32_bf16 a[28:31], v[100:103], v[84:87], a[28:31]
    ds_read_b64_tr_b16 v[56:57], v20 offset:0
    v_mfma_f32_16x16x32_bf16 a[52:55], v[100:103], v[88:91], a[52:55]
    ds_read_b64_tr_b16 v[58:59], v20 offset:1536
    v_mfma_f32_16x16x32_bf16 a[76:79], v[100:103], v[92:95], a[76:79]
    ds_read_b64_tr_b16 v[60:61], v23 offset:0
    v_mfma_f32_16x16x32_bf16 a[8:11], v[104:107], v[80:83], a[8:11]
    ds_read_b64_tr_b16 v[62:63], v23 offset:1536
    v_mfma_f32_16x16x32_bf16 a[32:35], v[104:107], v[84:87], a[32:35]
    ds_read_b64_tr_b16 v[64:65], v26 offset:0
    v_mfma_f32_16x16x32_bf16 a[56:59], v[104:107], v[88:91], a[56:59]
    ds_read_b64_tr_b16 v[66:67], v26 offset:1536
    v_mfma_f32_16x16x32_bf16 a[80:83], v[104:107], v[92:95], a[80:83]
    ds_read_b64_tr_b16 v[68:69], v29 offset:0
    v_mfma_f32_16x16x32_bf16 a[12:15], v[108:111], v[80:83], a[12:15]
    ds_read_b64_tr_b16 v[70:71], v29 offset:1536
    v_mfma_f32_16x16x32_bf16 a[36:39], v[108:111], v[84:87], a[36:39]
    ds_read_b64_tr_b16 v[72:73], v20 offset:128
    v_mfma_f32_16x16x32_bf16 a[60:63], v[108:111], v[88:91], a[60:63]
    ds_read_b64_tr_b16 v[74:75], v20 offset:1664
    v_mfma_f32_16x16x32_bf16 a[84:87], v[108:111], v[92:95], a[84:87]
    ds_read_b64_tr_b16 v[76:77], v23 offset:128
    v_mfma_f32_16x16x32_bf16 a[16:19], v[112:115], v[80:83], a[16:19]
    ds_read_b64_tr_b16 v[78:79], v23 offset:1664
    v_mfma_f32_16x16x32_bf16 a[40:43], v[112:115], v[84:87], a[40:43]
    v_mfma_f32_16x16x32_bf16 a[64:67], v[112:115], v[88:91], a[64:67]
    v_mfma_f32_16x16x32_bf16 a[88:91], v[112:115], v[92:95], a[88:91]
    v_mfma_f32_16x16x32_bf16 a[20:23], v[116:119], v[80:83], a[20:23]
    v_mfma_f32_16x16x32_bf16 a[44:47], v[116:119], v[84:87], a[44:47]
    v_mfma_f32_16x16x32_bf16 a[68:71], v[116:119], v[88:91], a[68:71]
    v_mfma_f32_16x16x32_bf16 a[92:95], v[116:119], v[92:95], a[92:95]
    s_waitcnt lgkmcnt(0)
    ds_read_b128 v[80:83], v17 offset:0
    v_mfma_f32_16x16x32_bf16 a[0:3], v[56:59], v[40:43], a[0:3]
    ds_read_b128 v[84:87], v17 offset:2048
    v_mfma_f32_16x16x32_bf16 a[24:27], v[56:59], v[44:47], a[24:27]
    ds_read_b128 v[88:91], v17 offset:4096
    v_mfma_f32_16x16x32_bf16 a[48:51], v[56:59], v[48:51], a[48:51]
    ds_read_b128 v[92:95], v17 offset:6144
    v_mfma_f32_16x16x32_bf16 a[72:75], v[56:59], v[52:55], a[72:75]
    ds_read_b64_tr_b16 v[96:97], v20 offset:12288
    v_mfma_f32_16x16x32_bf16 a[4:7], v[60:63], v[40:43], a[4:7]
    ds_read_b64_tr_b16 v[98:99], v20 offset:13824
    v_mfma_f32_16x16x32_bf16 a[28:31], v[60:63], v[44:47], a[28:31]
    ds_read_b64_tr_b16 v[100:101], v23 offset:12288
    v_mfma_f32_16x16x32_bf16 a[52:55], v[60:63], v[48:51], a[52:55]
    ds_read_b64_tr_b16 v[102:103], v23 offset:13824
    v_mfma_f32_16x16x32_bf16 a[76:79], v[60:63], v[52:55], a[76:79]
    ds_read_b64_tr_b16 v[104:105], v26 offset:12288
    v_mfma_f32_16x16x32_bf16 a[8:11], v[64:67], v[40:43], a[8:11]
    ds_read_b64_tr_b16 v[106:107], v26 offset:13824
    v_mfma_f32_16x16x32_bf16 a[32:35], v[64:67], v[44:47], a[32:35]
    ds_read_b64_tr_b16 v[108:109], v29 offset:12288
    v_mfma_f32_16x16x32_bf16 a[56:59], v[64:67], v[48:51], a[56:59]
    ds_read_b64_tr_b16 v[110:111], v29 offset:13824
    v_mfma_f32_16x16x32_bf16 a[80:83], v[64:67], v[52:55], a[80:83]
    ds_read_b64_tr_b16 v[112:113], v20 offset:12416
    v_mfma_f32_16x16x32_bf16 a[12:15], v[68:71], v[40:43], a[12:15]
    ds_read_b64_tr_b16 v[114:115], v20 offset:13952
    v_mfma_f32_16x16x32_bf16 a[36:39], v[68:71], v[44:47], a[36:39]
    ds_read_b64_tr_b16 v[116:117], v23 offset:12416
    v_mfma_f32_16x16x32_bf16 a[60:63], v[68:71], v[48:51], a[60:63]
    ds_read_b64_tr_b16 v[118:119], v23 offset:13952
    v_mfma_f32_16x16x32_bf16 a[84:87], v[68:71], v[52:55], a[84:87]
    v_mfma_f32_16x16x32_bf16 a[16:19], v[72:75], v[40:43], a[16:19]
    v_mfma_f32_16x16x32_bf16 a[40:43], v[72:75], v[44:47], a[40:43]
    v_mfma_f32_16x16x32_bf16 a[64:67], v[72:75], v[48:51], a[64:67]
    v_mfma_f32_16x16x32_bf16 a[88:91], v[72:75], v[52:55], a[88:91]
    v_mfma_f32_16x16x32_bf16 a[20:23], v[76:79], v[40:43], a[20:23]
    v_mfma_f32_16x16x32_bf16 a[44:47], v[76:79], v[44:47], a[44:47]
    v_mfma_f32_16x16x32_bf16 a[68:71], v[76:79], v[48:51], a[68:71]
    v_mfma_f32_16x16x32_bf16 a[92:95], v[76:79], v[52:55], a[92:95]
    s_waitcnt lgkmcnt(0)
    v_mfma_f32_16x16x32_bf16 a[0:3], v[96:99], v[80:83], a[0:3]
    v_mfma_f32_16x16x32_bf16 a[24:27], v[96:99], v[84:87], a[24:27]
    s_waitcnt vmcnt(10)
    s_barrier
    s_add_u32 m0, s36, 81920
    buffer_load_dwordx4 v2, s[4:7], s28 offen lds
    s_add_u32 m0, s37, 81920
    buffer_load_dwordx4 v3, s[4:7], s28 offen lds
    s_add_u32 m0, s38, 81920
    buffer_load_dwordx4 v4, s[4:7], s28 offen lds
    s_add_u32 m0, s39, 81920
    buffer_load_dwordx4 v5, s[4:7], s28 offen lds
    s_add_u32 m0, s40, 81920
    buffer_load_dwordx4 v6, s[8:11], s29 offen lds
    s_add_u32 m0, s41, 81920
    buffer_load_dwordx4 v7, s[8:11], s29 offen lds
    s_add_u32 m0, s42, 81920
    buffer_load_dwordx4 v8, s[8:11], s29 offen lds
    s_add_u32 m0, s43, 81920
    buffer_load_dwordx4 v9, s[8:11], s29 offen lds
    s_add_u32 m0, s44, 81920
    buffer_load_dwordx4 v10, s[8:11], s29 offen lds
    s_add_u32 m0, s45, 81920
    buffer_load_dwordx4 v11, s[8:11], s29 offen lds
    s_add_u32 s28, s28, 128
    s_add_u32 s29, s29, 393216
    ds_read_b128 v[40:43], v12 offset:0
    v_mfma_f32_16x16x32_bf16 a[48:51], v[96:99], v[88:91], a[48:51]
    ds_read_b128 v[44:47], v12 offset:2048
    v_mfma_f32_16x16x32_bf16 a[72:75], v[96:99], v[92:95], a[72:75]
    ds_read_b128 v[48:51], v12 offset:4096
    v_mfma_f32_16x16x32_bf16 a[4:7], v[100:103], v[80:83], a[4:7]
    ds_read_b128 v[52:55], v12 offset:6144
    v_mfma_f32_16x16x32_bf16 a[28:31], v[100:103], v[84:87], a[28:31]
    ds_read_b64_tr_b16 v[56:57], v18 offset:0
    v_mfma_f32_16x16x32_bf16 a[52:55], v[100:103], v[88:91], a[52:55]
    ds_read_b64_tr_b16 v[58:59], v18 offset:1536
    v_mfma_f32_16x16x32_bf16 a[76:79], v[100:103], v[92:95], a[76:79]
    ds_read_b64_tr_b16 v[60:61], v21 offset:0
    v_mfma_f32_16x16x32_bf16 a[8:11], v[104:107], v[80:83], a[8:11]
    ds_read_b64_tr_b16 v[62:63], v21 offset:1536
    v_mfma_f32_16x16x32_bf16 a[32:35], v[104:107], v[84:87], a[32:35]
    ds_read_b64_tr_b16 v[64:65], v24 offset:0
    v_mfma_f32_16x16x32_bf16 a[56:59], v[104:107], v[88:91], a[56:59]
    ds_read_b64_tr_b16 v[66:67], v24 offset:1536
    v_mfma_f32_16x16x32_bf16 a[80:83], v[104:107], v[92:95], a[80:83]
    ds_read_b64_tr_b16 v[68:69], v27 offset:0
    v_mfma_f32_16x16x32_bf16 a[12:15], v[108:111], v[80:83], a[12:15]
    ds_read_b64_tr_b16 v[70:71], v27 offset:1536
    v_mfma_f32_16x16x32_bf16 a[36:39], v[108:111], v[84:87], a[36:39]
    ds_read_b64_tr_b16 v[72:73], v18 offset:128
    v_mfma_f32_16x16x32_bf16 a[60:63], v[108:111], v[88:91], a[60:63]
    ds_read_b64_tr_b16 v[74:75], v18 offset:1664
    v_mfma_f32_16x16x32_bf16 a[84:87], v[108:111], v[92:95], a[84:87]
    ds_read_b64_tr_b16 v[76:77], v21 offset:128
    v_mfma_f32_16x16x32_bf16 a[16:19], v[112:115], v[80:83], a[16:19]
    ds_read_b64_tr_b16 v[78:79], v21 offset:1664
    v_mfma_f32_16x16x32_bf16 a[40:43], v[112:115], v[84:87], a[40:43]
    v_mfma_f32_16x16x32_bf16 a[64:67], v[112:115], v[88:91], a[64:67]
    v_mfma_f32_16x16x32_bf16 a[88:91], v[112:115], v[92:95], a[88:91]
    v_mfma_f32_16x16x32_bf16 a[20:23], v[116:119], v[80:83], a[20:23]
    v_mfma_f32_16x16x32_bf16 a[44:47], v[116:119], v[84:87], a[44:47]
    v_mfma_f32_16x16x32_bf16 a[68:71], v[116:119], v[88:91], a[68:71]
    v_mfma_f32_16x16x32_bf16 a[92:95], v[116:119], v[92:95], a[92:95]
    s_waitcnt lgkmcnt(0)
    ds_read_b128 v[80:83], v15 offset:0
    v_mfma_f32_16x16x32_bf16 a[0:3], v[56:59], v[40:43], a[0:3]
    ds_read_b128 v[84:87], v15 offset:2048
    v_mfma_f32_16x16x32_bf16 a[24:27], v[56:59], v[44:47], a[24:27]
    ds_read_b128 v[88:91], v15 offset:4096
    v_mfma_f32_16x16x32_bf16 a[48:51], v[56:59], v[48:51], a[48:51]
    ds_read_b128 v[92:95], v15 offset:6144
    v_mfma_f32_16x16x32_bf16 a[72:75], v[56:59], v[52:55], a[72:75]
    ds_read_b64_tr_b16 v[96:97], v18 offset:12288
    v_mfma_f32_16x16x32_bf16 a[4:7], v[60:63], v[40:43], a[4:7]
    ds_read_b64_tr_b16 v[98:99], v18 offset:13824
    v_mfma_f32_16x16x32_bf16 a[28:31], v[60:63], v[44:47], a[28:31]
    ds_read_b64_tr_b16 v[100:101], v21 offset:12288
    v_mfma_f32_16x16x32_bf16 a[52:55], v[60:63], v[48:51], a[52:55]
    ds_read_b64_tr_b16 v[102:103], v21 offset:13824
    v_mfma_f32_16x16x32_bf16 a[76:79], v[60:63], v[52:55], a[76:79]
    ds_read_b64_tr_b16 v[104:105], v24 offset:12288
    v_mfma_f32_16x16x32_bf16 a[8:11], v[64:67], v[40:43], a[8:11]
    ds_read_b64_tr_b16 v[106:107], v24 offset:13824
    v_mfma_f32_16x16x32_bf16 a[32:35], v[64:67], v[44:47], a[32:35]
    ds_read_b64_tr_b16 v[108:109], v27 offset:12288
    v_mfma_f32_16x16x32_bf16 a[56:59], v[64:67], v[48:51], a[56:59]
    ds_read_b64_tr_b16 v[110:111], v27 offset:13824
    v_mfma_f32_16x16x32_bf16 a[80:83], v[64:67], v[52:55], a[80:83]
    ds_read_b64_tr_b16 v[112:113], v18 offset:12416
    v_mfma_f32_16x16x32_bf16 a[12:15], v[68:71], v[40:43], a[12:15]
    ds_read_b64_tr_b16 v[114:115], v18 offset:13952
    v_mfma_f32_16x16x32_bf16 a[36:39], v[68:71], v[44:47], a[36:39]
    ds_read_b64_tr_b16 v[116:117], v21 offset:12416
    v_mfma_f32_16x16x32_bf16 a[60:63], v[68:71], v[48:51], a[60:63]
    ds_read_b64_tr_b16 v[118:119], v21 offset:13952
    v_mfma_f32_16x16x32_bf16 a[84:87], v[68:71], v[52:55], a[84:87]
    v_mfma_f32_16x16x32_bf16 a[16:19], v[72:75], v[40:43], a[16:19]
    v_mfma_f32_16x16x32_bf16 a[40:43], v[72:75], v[44:47], a[40:43]
    v_mfma_f32_16x16x32_bf16 a[64:67], v[72:75], v[48:51], a[64:67]
    v_mfma_f32_16x16x32_bf16 a[88:91], v[72:75], v[52:55], a[88:91]
    v_mfma_f32_16x16x32_bf16 a[20:23], v[76:79], v[40:43], a[20:23]
    v_mfma_f32_16x16x32_bf16 a[44:47], v[76:79], v[44:47], a[44:47]
    v_mfma_f32_16x16x32_bf16 a[68:71], v[76:79], v[48:51], a[68:71]
    v_mfma_f32_16x16x32_bf16 a[92:95], v[76:79], v[52:55], a[92:95]
    s_waitcnt lgkmcnt(0)
    v_mfma_f32_16x16x32_bf16 a[0:3], v[96:99], v[80:83], a[0:3]
    v_mfma_f32_16x16x32_bf16 a[24:27], v[96:99], v[84:87], a[24:27]
    s_waitcnt vmcnt(10)
    s_barrier
    s_add_u32 m0, s36, 0
    buffer_load_dwordx4 v2, s[4:7], s28 offen lds
    s_add_u32 m0, s37, 0
    buffer_load_dwordx4 v3, s[4:7], s28 offen lds
    s_add_u32 m0, s38, 0
    buffer_load_dwordx4 v4, s[4:7], s28 offen lds
    s_add_u32 m0, s39, 0
    buffer_load_dwordx4 v5, s[4:7], s28 offen lds
    s_add_u32 m0, s40, 0
    buffer_load_dwordx4 v6, s[8:11], s29 offen lds
    s_add_u32 m0, s41, 0
    buffer_load_dwordx4 v7, s[8:11], s29 offen lds
    s_add_u32 m0, s42, 0
    buffer_load_dwordx4 v8, s[8:11], s29 offen lds
    s_add_u32 m0, s43, 0
    buffer_load_dwordx4 v9, s[8:11], s29 offen lds
    s_add_u32 m0, s44, 0
    buffer_load_dwordx4 v10, s[8:11], s29 offen lds
    s_add_u32 m0, s45, 0
    buffer_load_dwordx4 v11, s[8:11], s29 offen lds
    s_add_u32 s28, s28, 128
    s_add_u32 s29, s29, 393216
    ds_read_b128 v[40:43], v13 offset:0
    v_mfma_f32_16x16x32_bf16 a[48:51], v[96:99], v[88:91], a[48:51]
    ds_read_b128 v[44:47], v13 offset:2048
    v_mfma_f32_16x16x32_bf16 a[72:75], v[96:99], v[92:95], a[72:75]
    ds_read_b128 v[48:51], v13 offset:4096
    v_mfma_f32_16x16x32_bf16 a[4:7], v[100:103], v[80:83], a[4:7]
    ds_read_b128 v[52:55], v13 offset:6144
    v_mfma_f32_16x16x32_bf16 a[28:31], v[100:103], v[84:87], a[28:31]
    ds_read_b64_tr_b16 v[56:57], v19 offset:0
    v_mfma_f32_16x16x32_bf16 a[52:55], v[100:103], v[88:91], a[52:55]
    ds_read_b64_tr_b16 v[58:59], v19 offset:1536
    v_mfma_f32_16x16x32_bf16 a[76:79], v[100:103], v[92:95], a[76:79]
    ds_read_b64_tr_b16 v[60:61], v22 offset:0
    v_mfma_f32_16x16x32_bf16 a[8:11], v[104:107], v[80:83], a[8:11]
    ds_read_b64_tr_b16 v[62:63], v22 offset:1536
    v_mfma_f32_16x16x32_bf16 a[32:35], v[104:107], v[84:87], a[32:35]
    ds_read_b64_tr_b16 v[64:65], v25 offset:0
    v_mfma_f32_16x16x32_bf16 a[56:59], v[104:107], v[88:91], a[56:59]
    ds_read_b64_tr_b16 v[66:67], v25 offset:1536
    v_mfma_f32_16x16x32_bf16 a[80:83], v[104:107], v[92:95], a[80:83]
    ds_read_b64_tr_b16 v[68:69], v28 offset:0
    v_mfma_f32_16x16x32_bf16 a[12:15], v[108:111], v[80:83], a[12:15]
    ds_read_b64_tr_b16 v[70:71], v28 offset:1536
    v_mfma_f32_16x16x32_bf16 a[36:39], v[108:111], v[84:87], a[36:39]
    ds_read_b64_tr_b16 v[72:73], v19 offset:128
    v_mfma_f32_16x16x32_bf16 a[60:63], v[108:111], v[88:91], a[60:63]
    ds_read_b64_tr_b16 v[74:75], v19 offset:1664
    v_mfma_f32_16x16x32_bf16 a[84:87], v[108:111], v[92:95], a[84:87]
    ds_read_b64_tr_b16 v[76:77], v22 offset:128
    v_mfma_f32_16x16x32_bf16 a[16:19], v[112:115], v[80:83], a[16:19]
    ds_read_b64_tr_b16 v[78:79], v22 offset:1664
    v_mfma_f32_16x16x32_bf16 a[40:43], v[112:115], v[84:87], a[40:43]
    v_mfma_f32_16x16x32_bf16 a[64:67], v[112:115], v[88:91], a[64:67]
    v_mfma_f32_16x16x32_bf16 a[88:91], v[112:115], v[92:95], a[88:91]
    v_mfma_f32_16x16x32_bf16 a[20:23], v[116:119], v[80:83], a[20:23]
    v_mfma_f32_16x16x32_bf16 a[44:47], v[116:119], v[84:87], a[44:47]
    v_mfma_f32_16x16x32_bf16 a[68:71], v[116:119], v[88:91], a[68:71]
    v_mfma_f32_16x16x32_bf16 a[92:95], v[116:119], v[92:95], a[92:95]
    s_waitcnt lgkmcnt(0)
    ds_read_b128 v[80:83], v16 offset:0
    v_mfma_f32_16x16x32_bf16 a[0:3], v[56:59], v[40:43], a[0:3]
    ds_read_b128 v[84:87], v16 offset:2048
    v_mfma_f32_16x16x32_bf16 a[24:27], v[56:59], v[44:47], a[24:27]
    ds_read_b128 v[88:91], v16 offset:4096
    v_mfma_f32_16x16x32_bf16 a[48:51], v[56:59], v[48:51], a[48:51]
    ds_read_b128 v[92:95], v16 offset:6144
    v_mfma_f32_16x16x32_bf16 a[72:75], v[56:59], v[52:55], a[72:75]
    ds_read_b64_tr_b16 v[96:97], v19 offset:12288
    v_mfma_f32_16x16x32_bf16 a[4:7], v[60:63], v[40:43], a[4:7]
    ds_read_b64_tr_b16 v[98:99], v19 offset:13824
    v_mfma_f32_16x16x32_bf16 a[28:31], v[60:63], v[44:47], a[28:31]
    ds_read_b64_tr_b16 v[100:101], v22 offset:12288
    v_mfma_f32_16x16x32_bf16 a[52:55], v[60:63], v[48:51], a[52:55]
    ds_read_b64_tr_b16 v[102:103], v22 offset:13824
    v_mfma_f32_16x16x32_bf16 a[76:79], v[60:63], v[52:55], a[76:79]
    ds_read_b64_tr_b16 v[104:105], v25 offset:12288
    v_mfma_f32_16x16x32_bf16 a[8:11], v[64:67], v[40:43], a[8:11]
    ds_read_b64_tr_b16 v[106:107], v25 offset:13824
    v_mfma_f32_16x16x32_bf16 a[32:35], v[64:67], v[44:47], a[32:35]
    ds_read_b64_tr_b16 v[108:109], v28 offset:12288
    v_mfma_f32_16x16x32_bf16 a[56:59], v[64:67], v[48:51], a[56:59]
    ds_read_b64_tr_b16 v[110:111], v28 offset:13824
    v_mfma_f32_16x16x32_bf16 a[80:83], v[64:67], v[52:55], a[80:83]
    ds_read_b64_tr_b16 v[112:113], v19 offset:12416
    v_mfma_f32_16x16x32_bf16 a[12:15], v[68:71], v[40:43], a[12:15]
    ds_read_b64_tr_b16 v[114:115], v19 offset:13952
    v_mfma_f32_16x16x32_bf16 a[36:39], v[68:71], v[44:47], a[36:39]
    ds_read_b64_tr_b16 v[116:117], v22 offset:12416
    v_mfma_f32_16x16x32_bf16 a[60:63], v[68:71], v[48:51], a[60:63]
    ds_read_b64_tr_b16 v[118:119], v22 offset:13952
    v_mfma_f32_16x16x32_bf16 a[84:87], v[68:71], v[52:55], a[84:87]
    v_mfma_f32_16x16x32_bf16 a[16:19], v[72:75], v[40:43], a[16:19]
    v_mfma_f32_16x16x32_bf16 a[40:43], v[72:75], v[44:47], a[40:43]
    v_mfma_f32_16x16x32_bf16 a[64:67], v[72:75], v[48:51], a[64:67]
    v_mfma_f32_16x16x32_bf16 a[88:91], v[72:75], v[52:55], a[88:91]
    v_mfma_f32_16x16x32_bf16 a[20:23], v[76:79], v[40:43], a[20:23]
    v_mfma_f32_16x16x32_bf16 a[44:47], v[76:79], v[44:47], a[44:47]
    v_mfma_f32_16x16x32_bf16 a[68:71], v[76:79], v[48:51], a[68:71]
    v_mfma_f32_16x16x32_bf16 a[92:95], v[76:79], v[52:55], a[92:95]
    s_waitcnt lgkmcnt(0)
    v_mfma_f32_16x16x32_bf16 a[0:3], v[96:99], v[80:83], a[0:3]
    v_mfma_f32_16x16x32_bf16 a[24:27], v[96:99], v[84:87], a[24:27]
    s_waitcnt vmcnt(10)
    s_barrier
    s_add_u32 m0, s36, 40960
    buffer_load_dwordx4 v2, s[4:7], s28 offen lds
    s_add_u32 m0, s37, 40960
    buffer_load_dwordx4 v3, s[4:7], s28 offen lds
    s_add_u32 m0, s38, 40960
    buffer_load_dwordx4 v4, s[4:7], s28 offen lds
    s_add_u32 m0, s39, 40960
    buffer_load_dwordx4 v5, s[4:7], s28 offen lds
    s_add_u32 m0, s40, 40960
    buffer_load_dwordx4 v6, s[8:11], s29 offen lds
    s_add_u32 m0, s41, 40960
    buffer_load_dwordx4 v7, s[8:11], s29 offen lds
    s_add_u32 m0, s42, 40960
    buffer_load_dwordx4 v8, s[8:11], s29 offen lds
    s_add_u32 m0, s43, 40960
    buffer_load_dwordx4 v9, s[8:11], s29 offen lds
    s_add_u32 m0, s44, 40960
    buffer_load_dwordx4 v10, s[8:11], s29 offen lds
    s_add_u32 m0, s45, 40960
    buffer_load_dwordx4 v11, s[8:11], s29 offen lds
    s_add_u32 s28, s28, 128
    s_add_u32 s29, s29, 393216
    ds_read_b128 v[40:43], v14 offset:0
    v_mfma_f32_16x16x32_bf16 a[48:51], v[96:99], v[88:91], a[48:51]
    ds_read_b128 v[44:47], v14 offset:2048
    v_mfma_f32_16x16x32_bf16 a[72:75], v[96:99], v[92:95], a[72:75]
    ds_read_b128 v[48:51], v14 offset:4096
    v_mfma_f32_16x16x32_bf16 a[4:7], v[100:103], v[80:83], a[4:7]
    ds_read_b128 v[52:55], v14 offset:6144
    v_mfma_f32_16x16x32_bf16 a[28:31], v[100:103], v[84:87], a[28:31]
    ds_read_b64_tr_b16 v[56:57], v20 offset:0
    v_mfma_f32_16x16x32_bf16 a[52:55], v[100:103], v[88:91], a[52:55]
    ds_read_b64_tr_b16 v[58:59], v20 offset:1536
    v_mfma_f32_16x16x32_bf16 a[76:79], v[100:103], v[92:95], a[76:79]
    ds_read_b64_tr_b16 v[60:61], v23 offset:0
    v_mfma_f32_16x16x32_bf16 a[8:11], v[104:107], v[80:83], a[8:11]
    ds_read_b64_tr_b16 v[62:63], v23 offset:1536
    v_mfma_f32_16x16x32_bf16 a[32:35], v[104:107], v[84:87], a[32:35]
    ds_read_b64_tr_b16 v[64:65], v26 offset:0
    v_mfma_f32_16x16x32_bf16 a[56:59], v[104:107], v[88:91], a[56:59]
    ds_read_b64_tr_b16 v[66:67], v26 offset:1536
    v_mfma_f32_16x16x32_bf16 a[80:83], v[104:107], v[92:95], a[80:83]
    ds_read_b64_tr_b16 v[68:69], v29 offset:0
    v_mfma_f32_16x16x32_bf16 a[12:15], v[108:111], v[80:83], a[12:15]
    ds_read_b64_tr_b16 v[70:71], v29 offset:1536
    v_mfma_f32_16x16x32_bf16 a[36:39], v[108:111], v[84:87], a[36:39]
    ds_read_b64_tr_b16 v[72:73], v20 offset:128
    v_mfma_f32_16x16x32_bf16 a[60:63], v[108:111], v[88:91], a[60:63]
    ds_read_b64_tr_b16 v[74:75], v20 offset:1664
    v_mfma_f32_16x16x32_bf16 a[84:87], v[108:111], v[92:95], a[84:87]
    ds_read_b64_tr_b16 v[76:77], v23 offset:128
    v_mfma_f32_16x16x32_bf16 a[16:19], v[112:115], v[80:83], a[16:19]
    ds_read_b64_tr_b16 v[78:79], v23 offset:1664
    v_mfma_f32_16x16x32_bf16 a[40:43], v[112:115], v[84:87], a[40:43]
    v_mfma_f32_16x16x32_bf16 a[64:67], v[112:115], v[88:91], a[64:67]
    v_mfma_f32_16x16x32_bf16 a[88:91], v[112:115], v[92:95], a[88:91]
    v_mfma_f32_16x16x32_bf16 a[20:23], v[116:119], v[80:83], a[20:23]
    v_mfma_f32_16x16x32_bf16 a[44:47], v[116:119], v[84:87], a[44:47]
    v_mfma_f32_16x16x32_bf16 a[68:71], v[116:119], v[88:91], a[68:71]
    v_mfma_f32_16x16x32_bf16 a[92:95], v[116:119], v[92:95], a[92:95]
    s_waitcnt lgkmcnt(0)
    ds_read_b128 v[80:83], v17 offset:0
    v_mfma_f32_16x16x32_bf16 a[0:3], v[56:59], v[40:43], a[0:3]
    ds_read_b128 v[84:87], v17 offset:2048
    v_mfma_f32_16x16x32_bf16 a[24:27], v[56:59], v[44:47], a[24:27]
    ds_read_b128 v[88:91], v17 offset:4096
    v_mfma_f32_16x16x32_bf16 a[48:51], v[56:59], v[48:51], a[48:51]
    ds_read_b128 v[92:95], v17 offset:6144
    v_mfma_f32_16x16x32_bf16 a[72:75], v[56:59], v[52:55], a[72:75]
    ds_read_b64_tr_b16 v[96:97], v20 offset:12288
    v_mfma_f32_16x16x32_bf16 a[4:7], v[60:63], v[40:43], a[4:7]
    ds_read_b64_tr_b16 v[98:99], v20 offset:13824
    v_mfma_f32_16x16x32_bf16 a[28:31], v[60:63], v[44:47], a[28:31]
    ds_read_b64_tr_b16 v[100:101], v23 offset:12288
    v_mfma_f32_16x16x32_bf16 a[52:55], v[60:63], v[48:51], a[52:55]
    ds_read_b64_tr_b16 v[102:103], v23 offset:13824
    v_mfma_f32_16x16x32_bf16 a[76:79], v[60:63], v[52:55], a[76:79]
    ds_read_b64_tr_b16 v[104:105], v26 offset:12288
    v_mfma_f32_16x16x32_bf16 a[8:11], v[64:67], v[40:43], a[8:11]
    ds_read_b64_tr_b16 v[106:107], v26 offset:13824
    v_mfma_f32_16x16x32_bf16 a[32:35], v[64:67], v[44:47], a[32:35]
    ds_read_b64_tr_b16 v[108:109], v29 offset:12288
    v_mfma_f32_16x16x32_bf16 a[56:59], v[64:67], v[48:51], a[56:59]
    ds_read_b64_tr_b16 v[110:111], v29 offset:13824
    v_mfma_f32_16x16x32_bf16 a[80:83], v[64:67], v[52:55], a[80:83]
    ds_read_b64_tr_b16 v[112:113], v20 offset:12416
    v_mfma_f32_16x16x32_bf16 a[12:15], v[68:71], v[40:43], a[12:15]
    ds_read_b64_tr_b16 v[114:115], v20 offset:13952
    v_mfma_f32_16x16x32_bf16 a[36:39], v[68:71], v[44:47], a[36:39]
    ds_read_b64_tr_b16 v[116:117], v23 offset:12416
    v_mfma_f32_16x16x32_bf16 a[60:63], v[68:71], v[48:51], a[60:63]
    ds_read_b64_tr_b16 v[118:119], v23 offset:13952
    v_mfma_f32_16x16x32_bf16 a[84:87], v[68:71], v[52:55], a[84:87]
    v_mfma_f32_16x16x32_bf16 a[16:19], v[72:75], v[40:43], a[16:19]
    v_mfma_f32_16x16x32_bf16 a[40:43], v[72:75], v[44:47], a[40:43]
    v_mfma_f32_16x16x32_bf16 a[64:67], v[72:75], v[48:51], a[64:67]
    v_mfma_f32_16x16x32_bf16 a[88:91], v[72:75], v[52:55], a[88:91]
    v_mfma_f32_16x16x32_bf16 a[20:23], v[76:79], v[40:43], a[20:23]
    v_mfma_f32_16x16x32_bf16 a[44:47], v[76:79], v[44:47], a[44:47]
    v_mfma_f32_16x16x32_bf16 a[68:71], v[76:79], v[48:51], a[68:71]
    v_mfma_f32_16x16x32_bf16 a[92:95], v[76:79], v[52:55], a[92:95]
    s_waitcnt lgkmcnt(0)
    v_mfma_f32_16x16x32_bf16 a[0:3], v[96:99], v[80:83], a[0:3]
    v_mfma_f32_16x16x32_bf16 a[24:27], v[96:99], v[84:87], a[24:27]
    s_waitcnt vmcnt(10)
    s_barrier
    s_add_u32 m0, s36, 81920
    buffer_load_dwordx4 v2, s[4:7], s28 offen lds
    s_add_u32 m0, s37, 81920
    buffer_load_dwordx4 v3, s[4:7], s28 offen lds
    s_add_u32 m0, s38, 81920
    buffer_load_dwordx4 v4, s[4:7], s28 offen lds
    s_add_u32 m0, s39, 81920
    buffer_load_dwordx4 v5, s[4:7], s28 offen lds
    s_add_u32 m0, s40, 81920
    buffer_load_dwordx4 v6, s[8:11], s29 offen lds
    s_add_u32 m0, s41, 81920
    buffer_load_dwordx4 v7, s[8:11], s29 offen lds
    s_add_u32 m0, s42, 81920
    buffer_load_dwordx4 v8, s[8:11], s29 offen lds
    s_add_u32 m0, s43, 81920
    buffer_load_dwordx4 v9, s[8:11], s29 offen lds
    s_add_u32 m0, s44, 81920
    buffer_load_dwordx4 v10, s[8:11], s29 offen lds
    s_add_u32 m0, s45, 81920
    buffer_load_dwordx4 v11, s[8:11], s29 offen lds
    s_add_u32 s28, s28, 128
    s_add_u32 s29, s29, 393216
    ds_read_b128 v[40:43], v12 offset:0
    v_mfma_f32_16x16x32_bf16 a[48:51], v[96:99], v[88:91], a[48:51]
    ds_read_b128 v[44:47], v12 offset:2048
    v_mfma_f32_16x16x32_bf16 a[72:75], v[96:99], v[92:95], a[72:75]
    ds_read_b128 v[48:51], v12 offset:4096
    v_mfma_f32_16x16x32_bf16 a[4:7], v[100:103], v[80:83], a[4:7]
    ds_read_b128 v[52:55], v12 offset:6144
    v_mfma_f32_16x16x32_bf16 a[28:31], v[100:103], v[84:87], a[28:31]
    ds_read_b64_tr_b16 v[56:57], v18 offset:0
    v_mfma_f32_16x16x32_bf16 a[52:55], v[100:103], v[88:91], a[52:55]
    ds_read_b64_tr_b16 v[58:59], v18 offset:1536
    v_mfma_f32_16x16x32_bf16 a[76:79], v[100:103], v[92:95], a[76:79]
    ds_read_b64_tr_b16 v[60:61], v21 offset:0
    v_mfma_f32_16x16x32_bf16 a[8:11], v[104:107], v[80:83], a[8:11]
    ds_read_b64_tr_b16 v[62:63], v21 offset:1536
    v_mfma_f32_16x16x32_bf16 a[32:35], v[104:107], v[84:87], a[32:35]
    ds_read_b64_tr_b16 v[64:65], v24 offset:0
    v_mfma_f32_16x16x32_bf16 a[56:59], v[104:107], v[88:91], a[56:59]
    ds_read_b64_tr_b16 v[66:67], v24 offset:1536
    v_mfma_f32_16x16x32_bf16 a[80:83], v[104:107], v[92:95], a[80:83]
    ds_read_b64_tr_b16 v[68:69], v27 offset:0
    v_mfma_f32_16x16x32_bf16 a[12:15], v[108:111], v[80:83], a[12:15]
    ds_read_b64_tr_b16 v[70:71], v27 offset:1536
    v_mfma_f32_16x16x32_bf16 a[36:39], v[108:111], v[84:87], a[36:39]
    ds_read_b64_tr_b16 v[72:73], v18 offset:128
    v_mfma_f32_16x16x32_bf16 a[60:63], v[108:111], v[88:91], a[60:63]
    ds_read_b64_tr_b16 v[74:75], v18 offset:1664
    v_mfma_f32_16x16x32_bf16 a[84:87], v[108:111], v[92:95], a[84:87]
    ds_read_b64_tr_b16 v[76:77], v21 offset:128
    v_mfma_f32_16x16x32_bf16 a[16:19], v[112:115], v[80:83], a[16:19]
    ds_read_b64_tr_b16 v[78:79], v21 offset:1664
    v_mfma_f32_16x16x32_bf16 a[40:43], v[112:115], v[84:87], a[40:43]
    v_mfma_f32_16x16x32_bf16 a[64:67], v[112:115], v[88:91], a[64:67]
    v_mfma_f32_16x16x32_bf16 a[88:91], v[112:115], v[92:95], a[88:91]
    v_mfma_f32_16x16x32_bf16 a[20:23], v[116:119], v[80:83], a[20:23]
    v_mfma_f32_16x16x32_bf16 a[44:47], v[116:119], v[84:87], a[44:47]
    v_mfma_f32_16x16x32_bf16 a[68:71], v[116:119], v[88:91], a[68:71]
    v_mfma_f32_16x16x32_bf16 a[92:95], v[116:119], v[92:95], a[92:95]
    s_waitcnt lgkmcnt(0)
    ds_read_b128 v[80:83], v15 offset:0
    v_mfma_f32_16x16x32_bf16 a[0:3], v[56:59], v[40:43], a[0:3]
    ds_read_b128 v[84:87], v15 offset:2048
    v_mfma_f32_16x16x32_bf16 a[24:27], v[56:59], v[44:47], a[24:27]
    ds_read_b128 v[88:91], v15 offset:4096
    v_mfma_f32_16x16x32_bf16 a[48:51], v[56:59], v[48:51], a[48:51]
    ds_read_b128 v[92:95], v15 offset:6144
    v_mfma_f32_16x16x32_bf16 a[72:75], v[56:59], v[52:55], a[72:75]
    ds_read_b64_tr_b16 v[96:97], v18 offset:12288
    v_mfma_f32_16x16x32_bf16 a[4:7], v[60:63], v[40:43], a[4:7]
    ds_read_b64_tr_b16 v[98:99], v18 offset:13824
    v_mfma_f32_16x16x32_bf16 a[28:31], v[60:63], v[44:47], a[28:31]
    ds_read_b64_tr_b16 v[100:101], v21 offset:12288
    v_mfma_f32_16x16x32_bf16 a[52:55], v[60:63], v[48:51], a[52:55]
    ds_read_b64_tr_b16 v[102:103], v21 offset:13824
    v_mfma_f32_16x16x32_bf16 a[76:79], v[60:63], v[52:55], a[76:79]
    ds_read_b64_tr_b16 v[104:105], v24 offset:12288
    v_mfma_f32_16x16x32_bf16 a[8:11], v[64:67], v[40:43], a[8:11]
    ds_read_b64_tr_b16 v[106:107], v24 offset:13824
    v_mfma_f32_16x16x32_bf16 a[32:35], v[64:67], v[44:47], a[32:35]
    ds_read_b64_tr_b16 v[108:109], v27 offset:12288
    v_mfma_f32_16x16x32_bf16 a[56:59], v[64:67], v[48:51], a[56:59]
    ds_read_b64_tr_b16 v[110:111], v27 offset:13824
    v_mfma_f32_16x16x32_bf16 a[80:83], v[64:67], v[52:55], a[80:83]
    ds_read_b64_tr_b16 v[112:113], v18 offset:12416
    v_mfma_f32_16x16x32_bf16 a[12:15], v[68:71], v[40:43], a[12:15]
    ds_read_b64_tr_b16 v[114:115], v18 offset:13952
    v_mfma_f32_16x16x32_bf16 a[36:39], v[68:71], v[44:47], a[36:39]
    ds_read_b64_tr_b16 v[116:117], v21 offset:12416
    v_mfma_f32_16x16x32_bf16 a[60:63], v[68:71], v[48:51], a[60:63]
    ds_read_b64_tr_b16 v[118:119], v21 offset:13952
    v_mfma_f32_16x16x32_bf16 a[84:87], v[68:71], v[52:55], a[84:87]
    v_mfma_f32_16x16x32_bf16 a[16:19], v[72:75], v[40:43], a[16:19]
    v_mfma_f32_16x16x32_bf16 a[40:43], v[72:75], v[44:47], a[40:43]
    v_mfma_f32_16x16x32_bf16 a[64:67], v[72:75], v[48:51], a[64:67]
    v_mfma_f32_16x16x32_bf16 a[88:91], v[72:75], v[52:55], a[88:91]
    v_mfma_f32_16x16x32_bf16 a[20:23], v[76:79], v[40:43], a[20:23]
    v_mfma_f32_16x16x32_bf16 a[44:47], v[76:79], v[44:47], a[44:47]
    v_mfma_f32_16x16x32_bf16 a[68:71], v[76:79], v[48:51], a[68:71]
    v_mfma_f32_16x16x32_bf16 a[92:95], v[76:79], v[52:55], a[92:95]
    s_waitcnt lgkmcnt(0)
    v_mfma_f32_16x16x32_bf16 a[0:3], v[96:99], v[80:83], a[0:3]
    v_mfma_f32_16x16x32_bf16 a[24:27], v[96:99], v[84:87], a[24:27]
    s_waitcnt vmcnt(10)
    s_barrier
    s_add_u32 m0, s36, 0
    buffer_load_dwordx4 v2, s[4:7], s28 offen lds
    s_add_u32 m0, s37, 0
    buffer_load_dwordx4 v3, s[4:7], s28 offen lds
    s_add_u32 m0, s38, 0
    buffer_load_dwordx4 v4, s[4:7], s28 offen lds
    s_add_u32 m0, s39, 0
    buffer_load_dwordx4 v5, s[4:7], s28 offen lds
    s_add_u32 m0, s40, 0
    buffer_load_dwordx4 v6, s[8:11], s29 offen lds
    s_add_u32 m0, s41, 0
    buffer_load_dwordx4 v7, s[8:11], s29 offen lds
    s_add_u32 m0, s42, 0
    buffer_load_dwordx4 v8, s[8:11], s29 offen lds
    s_add_u32 m0, s43, 0
    buffer_load_dwordx4 v9, s[8:11], s29 offen lds
    s_add_u32 m0, s44, 0
    buffer_load_dwordx4 v10, s[8:11], s29 offen lds
    s_add_u32 m0, s45, 0
    buffer_load_dwordx4 v11, s[8:11], s29 offen lds
    s_add_u32 s28, s28, 128
    s_add_u32 s29, s29, 393216
    ds_read_b128 v[40:43], v13 offset:0
    v_mfma_f32_16x16x32_bf16 a[48:51], v[96:99], v[88:91], a[48:51]
    ds_read_b128 v[44:47], v13 offset:2048
    v_mfma_f32_16x16x32_bf16 a[72:75], v[96:99], v[92:95], a[72:75]
    ds_read_b128 v[48:51], v13 offset:4096
    v_mfma_f32_16x16x32_bf16 a[4:7], v[100:103], v[80:83], a[4:7]
    ds_read_b128 v[52:55], v13 offset:6144
    v_mfma_f32_16x16x32_bf16 a[28:31], v[100:103], v[84:87], a[28:31]
    ds_read_b64_tr_b16 v[56:57], v19 offset:0
    v_mfma_f32_16x16x32_bf16 a[52:55], v[100:103], v[88:91], a[52:55]
    ds_read_b64_tr_b16 v[58:59], v19 offset:1536
    v_mfma_f32_16x16x32_bf16 a[76:79], v[100:103], v[92:95], a[76:79]
    ds_read_b64_tr_b16 v[60:61], v22 offset:0
    v_mfma_f32_16x16x32_bf16 a[8:11], v[104:107], v[80:83], a[8:11]
    ds_read_b64_tr_b16 v[62:63], v22 offset:1536
    v_mfma_f32_16x16x32_bf16 a[32:35], v[104:107], v[84:87], a[32:35]
    ds_read_b64_tr_b16 v[64:65], v25 offset:0
    v_mfma_f32_16x16x32_bf16 a[56:59], v[104:107], v[88:91], a[56:59]
    ds_read_b64_tr_b16 v[66:67], v25 offset:1536
    v_mfma_f32_16x16x32_bf16 a[80:83], v[104:107], v[92:95], a[80:83]
    ds_read_b64_tr_b16 v[68:69], v28 offset:0
    v_mfma_f32_16x16x32_bf16 a[12:15], v[108:111], v[80:83], a[12:15]
    ds_read_b64_tr_b16 v[70:71], v28 offset:1536
    v_mfma_f32_16x16x32_bf16 a[36:39], v[108:111], v[84:87], a[36:39]
    ds_read_b64_tr_b16 v[72:73], v19 offset:128
    v_mfma_f32_16x16x32_bf16 a[60:63], v[108:111], v[88:91], a[60:63]
    ds_read_b64_tr_b16 v[74:75], v19 offset:1664
    v_mfma_f32_16x16x32_bf16 a[84:87], v[108:111], v[92:95], a[84:87]
    ds_read_b64_tr_b16 v[76:77], v22 offset:128
    v_mfma_f32_16x16x32_bf16 a[16:19], v[112:115], v[80:83], a[16:19]
    ds_read_b64_tr_b16 v[78:79], v22 offset:1664
    v_mfma_f32_16x16x32_bf16 a[40:43], v[112:115], v[84:87], a[40:43]
    v_mfma_f32_16x16x32_bf16 a[64:67], v[112:115], v[88:91], a[64:67]
    v_mfma_f32_16x16x32_bf16 a[88:91], v[112:115], v[92:95], a[88:91]
    v_mfma_f32_16x16x32_bf16 a[20:23], v[116:119], v[80:83], a[20:23]
    v_mfma_f32_16x16x32_bf16 a[44:47], v[116:119], v[84:87], a[44:47]
    v_mfma_f32_16x16x32_bf16 a[68:71], v[116:119], v[88:91], a[68:71]
    v_mfma_f32_16x16x32_bf16 a[92:95], v[116:119], v[92:95], a[92:95]
    s_waitcnt lgkmcnt(0)
    ds_read_b128 v[80:83], v16 offset:0
    v_mfma_f32_16x16x32_bf16 a[0:3], v[56:59], v[40:43], a[0:3]
    ds_read_b128 v[84:87], v16 offset:2048
    v_mfma_f32_16x16x32_bf16 a[24:27], v[56:59], v[44:47], a[24:27]
    ds_read_b128 v[88:91], v16 offset:4096
    v_mfma_f32_16x16x32_bf16 a[48:51], v[56:59], v[48:51], a[48:51]
    ds_read_b128 v[92:95], v16 offset:6144
    v_mfma_f32_16x16x32_bf16 a[72:75], v[56:59], v[52:55], a[72:75]
    ds_read_b64_tr_b16 v[96:97], v19 offset:12288
    v_mfma_f32_16x16x32_bf16 a[4:7], v[60:63], v[40:43], a[4:7]
    ds_read_b64_tr_b16 v[98:99], v19 offset:13824
    v_mfma_f32_16x16x32_bf16 a[28:31], v[60:63], v[44:47], a[28:31]
    ds_read_b64_tr_b16 v[100:101], v22 offset:12288
    v_mfma_f32_16x16x32_bf16 a[52:55], v[60:63], v[48:51], a[52:55]
    ds_read_b64_tr_b16 v[102:103], v22 offset:13824
    v_mfma_f32_16x16x32_bf16 a[76:79], v[60:63], v[52:55], a[76:79]
    ds_read_b64_tr_b16 v[104:105], v25 offset:12288
    v_mfma_f32_16x16x32_bf16 a[8:11], v[64:67], v[40:43], a[8:11]
    ds_read_b64_tr_b16 v[106:107], v25 offset:13824
    v_mfma_f32_16x16x32_bf16 a[32:35], v[64:67], v[44:47], a[32:35]
    ds_read_b64_tr_b16 v[108:109], v28 offset:12288
    v_mfma_f32_16x16x32_bf16 a[56:59], v[64:67], v[48:51], a[56:59]
    ds_read_b64_tr_b16 v[110:111], v28 offset:13824
    v_mfma_f32_16x16x32_bf16 a[80:83], v[64:67], v[52:55], a[80:83]
    ds_read_b64_tr_b16 v[112:113], v19 offset:12416
    v_mfma_f32_16x16x32_bf16 a[12:15], v[68:71], v[40:43], a[12:15]
    ds_read_b64_tr_b16 v[114:115], v19 offset:13952
    v_mfma_f32_16x16x32_bf16 a[36:39], v[68:71], v[44:47], a[36:39]
    ds_read_b64_tr_b16 v[116:117], v22 offset:12416
    v_mfma_f32_16x16x32_bf16 a[60:63], v[68:71], v[48:51], a[60:63]
    ds_read_b64_tr_b16 v[118:119], v22 offset:13952
    v_mfma_f32_16x16x32_bf16 a[84:87], v[68:71], v[52:55], a[84:87]
    v_mfma_f32_16x16x32_bf16 a[16:19], v[72:75], v[40:43], a[16:19]
    v_mfma_f32_16x16x32_bf16 a[40:43], v[72:75], v[44:47], a[40:43]
    v_mfma_f32_16x16x32_bf16 a[64:67], v[72:75], v[48:51], a[64:67]
    v_mfma_f32_16x16x32_bf16 a[88:91], v[72:75], v[52:55], a[88:91]
    v_mfma_f32_16x16x32_bf16 a[20:23], v[76:79], v[40:43], a[20:23]
    v_mfma_f32_16x16x32_bf16 a[44:47], v[76:79], v[44:47], a[44:47]
    v_mfma_f32_16x16x32_bf16 a[68:71], v[76:79], v[48:51], a[68:71]
    v_mfma_f32_16x16x32_bf16 a[92:95], v[76:79], v[52:55], a[92:95]
    s_waitcnt lgkmcnt(0)
    v_mfma_f32_16x16x32_bf16 a[0:3], v[96:99], v[80:83], a[0:3]
    v_mfma_f32_16x16x32_bf16 a[24:27], v[96:99], v[84:87], a[24:27]
    s_waitcnt vmcnt(10)
    s_barrier
    s_add_u32 m0, s36, 40960
    buffer_load_dwordx4 v2, s[4:7], s28 offen lds
    s_add_u32 m0, s37, 40960
    buffer_load_dwordx4 v3, s[4:7], s28 offen lds
    s_add_u32 m0, s38, 40960
    buffer_load_dwordx4 v4, s[4:7], s28 offen lds
    s_add_u32 m0, s39, 40960
    buffer_load_dwordx4 v5, s[4:7], s28 offen lds
    s_add_u32 m0, s40, 40960
    buffer_load_dwordx4 v6, s[8:11], s29 offen lds
    s_add_u32 m0, s41, 40960
    buffer_load_dwordx4 v7, s[8:11], s29 offen lds
    s_add_u32 m0, s42, 40960
    buffer_load_dwordx4 v8, s[8:11], s29 offen lds
    s_add_u32 m0, s43, 40960
    buffer_load_dwordx4 v9, s[8:11], s29 offen lds
    s_add_u32 m0, s44, 40960
    buffer_load_dwordx4 v10, s[8:11], s29 offen lds
    s_add_u32 m0, s45, 40960
    buffer_load_dwordx4 v11, s[8:11], s29 offen lds
    s_add_u32 s28, s28, 128
    s_add_u32 s29, s29, 393216
    ds_read_b128 v[40:43], v14 offset:0
    v_mfma_f32_16x16x32_bf16 a[48:51], v[96:99], v[88:91], a[48:51]
    ds_read_b128 v[44:47], v14 offset:2048
    v_mfma_f32_16x16x32_bf16 a[72:75], v[96:99], v[92:95], a[72:75]
    ds_read_b128 v[48:51], v14 offset:4096
    v_mfma_f32_16x16x32_bf16 a[4:7], v[100:103], v[80:83], a[4:7]
    ds_read_b128 v[52:55], v14 offset:6144
    v_mfma_f32_16x16x32_bf16 a[28:31], v[100:103], v[84:87], a[28:31]
    ds_read_b64_tr_b16 v[56:57], v20 offset:0
    v_mfma_f32_16x16x32_bf16 a[52:55], v[100:103], v[88:91], a[52:55]
    ds_read_b64_tr_b16 v[58:59], v20 offset:1536
    v_mfma_f32_16x16x32_bf16 a[76:79], v[100:103], v[92:95], a[76:79]
    ds_read_b64_tr_b16 v[60:61], v23 offset:0
    v_mfma_f32_16x16x32_bf16 a[8:11], v[104:107], v[80:83], a[8:11]
    ds_read_b64_tr_b16 v[62:63], v23 offset:1536
    v_mfma_f32_16x16x32_bf16 a[32:35], v[104:107], v[84:87], a[32:35]
    ds_read_b64_tr_b16 v[64:65], v26 offset:0
    v_mfma_f32_16x16x32_bf16 a[56:59], v[104:107], v[88:91], a[56:59]
    ds_read_b64_tr_b16 v[66:67], v26 offset:1536
    v_mfma_f32_16x16x32_bf16 a[80:83], v[104:107], v[92:95], a[80:83]
    ds_read_b64_tr_b16 v[68:69], v29 offset:0
    v_mfma_f32_16x16x32_bf16 a[12:15], v[108:111], v[80:83], a[12:15]
    ds_read_b64_tr_b16 v[70:71], v29 offset:1536
    v_mfma_f32_16x16x32_bf16 a[36:39], v[108:111], v[84:87], a[36:39]
    ds_read_b64_tr_b16 v[72:73], v20 offset:128
    v_mfma_f32_16x16x32_bf16 a[60:63], v[108:111], v[88:91], a[60:63]
    ds_read_b64_tr_b16 v[74:75], v20 offset:1664
    v_mfma_f32_16x16x32_bf16 a[84:87], v[108:111], v[92:95], a[84:87]
    ds_read_b64_tr_b16 v[76:77], v23 offset:128
    v_mfma_f32_16x16x32_bf16 a[16:19], v[112:115], v[80:83], a[16:19]
    ds_read_b64_tr_b16 v[78:79], v23 offset:1664
    v_mfma_f32_16x16x32_bf16 a[40:43], v[112:115], v[84:87], a[40:43]
    v_mfma_f32_16x16x32_bf16 a[64:67], v[112:115], v[88:91], a[64:67]
    v_mfma_f32_16x16x32_bf16 a[88:91], v[112:115], v[92:95], a[88:91]
    v_mfma_f32_16x16x32_bf16 a[20:23], v[116:119], v[80:83], a[20:23]
    v_mfma_f32_16x16x32_bf16 a[44:47], v[116:119], v[84:87], a[44:47]
    v_mfma_f32_16x16x32_bf16 a[68:71], v[116:119], v[88:91], a[68:71]
    v_mfma_f32_16x16x32_bf16 a[92:95], v[116:119], v[92:95], a[92:95]
    s_waitcnt lgkmcnt(0)
    ds_read_b128 v[80:83], v17 offset:0
    v_mfma_f32_16x16x32_bf16 a[0:3], v[56:59], v[40:43], a[0:3]
    ds_read_b128 v[84:87], v17 offset:2048
    v_mfma_f32_16x16x32_bf16 a[24:27], v[56:59], v[44:47], a[24:27]
    ds_read_b128 v[88:91], v17 offset:4096
    v_mfma_f32_16x16x32_bf16 a[48:51], v[56:59], v[48:51], a[48:51]
    ds_read_b128 v[92:95], v17 offset:6144
    v_mfma_f32_16x16x32_bf16 a[72:75], v[56:59], v[52:55], a[72:75]
    ds_read_b64_tr_b16 v[96:97], v20 offset:12288
    v_mfma_f32_16x16x32_bf16 a[4:7], v[60:63], v[40:43], a[4:7]
    ds_read_b64_tr_b16 v[98:99], v20 offset:13824
    v_mfma_f32_16x16x32_bf16 a[28:31], v[60:63], v[44:47], a[28:31]
    ds_read_b64_tr_b16 v[100:101], v23 offset:12288
    v_mfma_f32_16x16x32_bf16 a[52:55], v[60:63], v[48:51], a[52:55]
    ds_read_b64_tr_b16 v[102:103], v23 offset:13824
    v_mfma_f32_16x16x32_bf16 a[76:79], v[60:63], v[52:55], a[76:79]
    ds_read_b64_tr_b16 v[104:105], v26 offset:12288
    v_mfma_f32_16x16x32_bf16 a[8:11], v[64:67], v[40:43], a[8:11]
    ds_read_b64_tr_b16 v[106:107], v26 offset:13824
    v_mfma_f32_16x16x32_bf16 a[32:35], v[64:67], v[44:47], a[32:35]
    ds_read_b64_tr_b16 v[108:109], v29 offset:12288
    v_mfma_f32_16x16x32_bf16 a[56:59], v[64:67], v[48:51], a[56:59]
    ds_read_b64_tr_b16 v[110:111], v29 offset:13824
    v_mfma_f32_16x16x32_bf16 a[80:83], v[64:67], v[52:55], a[80:83]
    ds_read_b64_tr_b16 v[112:113], v20 offset:12416
    v_mfma_f32_16x16x32_bf16 a[12:15], v[68:71], v[40:43], a[12:15]
    ds_read_b64_tr_b16 v[114:115], v20 offset:13952
    v_mfma_f32_16x16x32_bf16 a[36:39], v[68:71], v[44:47], a[36:39]
    ds_read_b64_tr_b16 v[116:117], v23 offset:12416
    v_mfma_f32_16x16x32_bf16 a[60:63], v[68:71], v[48:51], a[60:63]
    ds_read_b64_tr_b16 v[118:119], v23 offset:13952
    v_mfma_f32_16x16x32_bf16 a[84:87], v[68:71], v[52:55], a[84:87]
    v_mfma_f32_16x16x32_bf16 a[16:19], v[72:75], v[40:43], a[16:19]
    v_mfma_f32_16x16x32_bf16 a[40:43], v[72:75], v[44:47], a[40:43]
    v_mfma_f32_16x16x32_bf16 a[64:67], v[72:75], v[48:51], a[64:67]
    v_mfma_f32_16x16x32_bf16 a[88:91], v[72:75], v[52:55], a[88:91]
    v_mfma_f32_16x16x32_bf16 a[20:23], v[76:79], v[40:43], a[20:23]
    v_mfma_f32_16x16x32_bf16 a[44:47], v[76:79], v[44:47], a[44:47]
    v_mfma_f32_16x16x32_bf16 a[68:71], v[76:79], v[48:51], a[68:71]
    v_mfma_f32_16x16x32_bf16 a[92:95], v[76:79], v[52:55], a[92:95]
    s_waitcnt lgkmcnt(0)
    v_mfma_f32_16x16x32_bf16 a[0:3], v[96:99], v[80:83], a[0:3]
    v_mfma_f32_16x16x32_bf16 a[24:27], v[96:99], v[84:87], a[24:27]
    s_waitcnt vmcnt(10)
    s_barrier
    s_add_u32 m0, s36, 81920
    buffer_load_dwordx4 v2, s[4:7], s28 offen lds
    s_add_u32 m0, s37, 81920
    buffer_load_dwordx4 v3, s[4:7], s28 offen lds
    s_add_u32 m0, s38, 81920
    buffer_load_dwordx4 v4, s[4:7], s28 offen lds
    s_add_u32 m0, s39, 81920
    buffer_load_dwordx4 v5, s[4:7], s28 offen lds
    s_add_u32 m0, s40, 81920
    buffer_load_dwordx4 v6, s[8:11], s29 offen lds
    s_add_u32 m0, s41, 81920
    buffer_load_dwordx4 v7, s[8:11], s29 offen lds
    s_add_u32 m0, s42, 81920
    buffer_load_dwordx4 v8, s[8:11], s29 offen lds
    s_add_u32 m0, s43, 81920
    buffer_load_dwordx4 v9, s[8:11], s29 offen lds
    s_add_u32 m0, s44, 81920
    buffer_load_dwordx4 v10, s[8:11], s29 offen lds
    s_add_u32 m0, s45, 81920
    buffer_load_dwordx4 v11, s[8:11], s29 offen lds
    s_add_u32 s28, s28, 128
    s_add_u32 s29, s29, 393216
    ds_read_b128 v[40:43], v12 offset:0
    v_mfma_f32_16x16x32_bf16 a[48:51], v[96:99], v[88:91], a[48:51]
    ds_read_b128 v[44:47], v12 offset:2048
    v_mfma_f32_16x16x32_bf16 a[72:75], v[96:99], v[92:95], a[72:75]
    ds_read_b128 v[48:51], v12 offset:4096
    v_mfma_f32_16x16x32_bf16 a[4:7], v[100:103], v[80:83], a[4:7]
    ds_read_b128 v[52:55], v12 offset:6144
    v_mfma_f32_16x16x32_bf16 a[28:31], v[100:103], v[84:87], a[28:31]
    ds_read_b64_tr_b16 v[56:57], v18 offset:0
    v_mfma_f32_16x16x32_bf16 a[52:55], v[100:103], v[88:91], a[52:55]
    ds_read_b64_tr_b16 v[58:59], v18 offset:1536
    v_mfma_f32_16x16x32_bf16 a[76:79], v[100:103], v[92:95], a[76:79]
    ds_read_b64_tr_b16 v[60:61], v21 offset:0
    v_mfma_f32_16x16x32_bf16 a[8:11], v[104:107], v[80:83], a[8:11]
    ds_read_b64_tr_b16 v[62:63], v21 offset:1536
    v_mfma_f32_16x16x32_bf16 a[32:35], v[104:107], v[84:87], a[32:35]
    ds_read_b64_tr_b16 v[64:65], v24 offset:0
    v_mfma_f32_16x16x32_bf16 a[56:59], v[104:107], v[88:91], a[56:59]
    ds_read_b64_tr_b16 v[66:67], v24 offset:1536
    v_mfma_f32_16x16x32_bf16 a[80:83], v[104:107], v[92:95], a[80:83]
    ds_read_b64_tr_b16 v[68:69], v27 offset:0
    v_mfma_f32_16x16x32_bf16 a[12:15], v[108:111], v[80:83], a[12:15]
    ds_read_b64_tr_b16 v[70:71], v27 offset:1536
    v_mfma_f32_16x16x32_bf16 a[36:39], v[108:111], v[84:87], a[36:39]
    ds_read_b64_tr_b16 v[72:73], v18 offset:128
    v_mfma_f32_16x16x32_bf16 a[60:63], v[108:111], v[88:91], a[60:63]
    ds_read_b64_tr_b16 v[74:75], v18 offset:1664
    v_mfma_f32_16x16x32_bf16 a[84:87], v[108:111], v[92:95], a[84:87]
    ds_read_b64_tr_b16 v[76:77], v21 offset:128
    v_mfma_f32_16x16x32_bf16 a[16:19], v[112:115], v[80:83], a[16:19]
    ds_read_b64_tr_b16 v[78:79], v21 offset:1664
    v_mfma_f32_16x16x32_bf16 a[40:43], v[112:115], v[84:87], a[40:43]
    v_mfma_f32_16x16x32_bf16 a[64:67], v[112:115], v[88:91], a[64:67]
    v_mfma_f32_16x16x32_bf16 a[88:91], v[112:115], v[92:95], a[88:91]
    v_mfma_f32_16x16x32_bf16 a[20:23], v[116:119], v[80:83], a[20:23]
    v_mfma_f32_16x16x32_bf16 a[44:47], v[116:119], v[84:87], a[44:47]
    v_mfma_f32_16x16x32_bf16 a[68:71], v[116:119], v[88:91], a[68:71]
    v_mfma_f32_16x16x32_bf16 a[92:95], v[116:119], v[92:95], a[92:95]
    s_waitcnt lgkmcnt(0)
    ds_read_b128 v[80:83], v15 offset:0
    v_mfma_f32_16x16x32_bf16 a[0:3], v[56:59], v[40:43], a[0:3]
    ds_read_b128 v[84:87], v15 offset:2048
    v_mfma_f32_16x16x32_bf16 a[24:27], v[56:59], v[44:47], a[24:27]
    ds_read_b128 v[88:91], v15 offset:4096
    v_mfma_f32_16x16x32_bf16 a[48:51], v[56:59], v[48:51], a[48:51]
    ds_read_b128 v[92:95], v15 offset:6144
    v_mfma_f32_16x16x32_bf16 a[72:75], v[56:59], v[52:55], a[72:75]
    ds_read_b64_tr_b16 v[96:97], v18 offset:12288
    v_mfma_f32_16x16x32_bf16 a[4:7], v[60:63], v[40:43], a[4:7]
    ds_read_b64_tr_b16 v[98:99], v18 offset:13824
    v_mfma_f32_16x16x32_bf16 a[28:31], v[60:63], v[44:47], a[28:31]
    ds_read_b64_tr_b16 v[100:101], v21 offset:12288
    v_mfma_f32_16x16x32_bf16 a[52:55], v[60:63], v[48:51], a[52:55]
    ds_read_b64_tr_b16 v[102:103], v21 offset:13824
    v_mfma_f32_16x16x32_bf16 a[76:79], v[60:63], v[52:55], a[76:79]
    ds_read_b64_tr_b16 v[104:105], v24 offset:12288
    v_mfma_f32_16x16x32_bf16 a[8:11], v[64:67], v[40:43], a[8:11]
    ds_read_b64_tr_b16 v[106:107], v24 offset:13824
    v_mfma_f32_16x16x32_bf16 a[32:35], v[64:67], v[44:47], a[32:35]
    ds_read_b64_tr_b16 v[108:109], v27 offset:12288
    v_mfma_f32_16x16x32_bf16 a[56:59], v[64:67], v[48:51], a[56:59]
    ds_read_b64_tr_b16 v[110:111], v27 offset:13824
    v_mfma_f32_16x16x32_bf16 a[80:83], v[64:67], v[52:55], a[80:83]
    ds_read_b64_tr_b16 v[112:113], v18 offset:12416
    v_mfma_f32_16x16x32_bf16 a[12:15], v[68:71], v[40:43], a[12:15]
    ds_read_b64_tr_b16 v[114:115], v18 offset:13952
    v_mfma_f32_16x16x32_bf16 a[36:39], v[68:71], v[44:47], a[36:39]
    ds_read_b64_tr_b16 v[116:117], v21 offset:12416
    v_mfma_f32_16x16x32_bf16 a[60:63], v[68:71], v[48:51], a[60:63]
    ds_read_b64_tr_b16 v[118:119], v21 offset:13952
    v_mfma_f32_16x16x32_bf16 a[84:87], v[68:71], v[52:55], a[84:87]
    v_mfma_f32_16x16x32_bf16 a[16:19], v[72:75], v[40:43], a[16:19]
    v_mfma_f32_16x16x32_bf16 a[40:43], v[72:75], v[44:47], a[40:43]
    v_mfma_f32_16x16x32_bf16 a[64:67], v[72:75], v[48:51], a[64:67]
    v_mfma_f32_16x16x32_bf16 a[88:91], v[72:75], v[52:55], a[88:91]
    v_mfma_f32_16x16x32_bf16 a[20:23], v[76:79], v[40:43], a[20:23]
    v_mfma_f32_16x16x32_bf16 a[44:47], v[76:79], v[44:47], a[44:47]
    v_mfma_f32_16x16x32_bf16 a[68:71], v[76:79], v[48:51], a[68:71]
    v_mfma_f32_16x16x32_bf16 a[92:95], v[76:79], v[52:55], a[92:95]
    s_waitcnt lgkmcnt(0)
    v_mfma_f32_16x16x32_bf16 a[0:3], v[96:99], v[80:83], a[0:3]
    v_mfma_f32_16x16x32_bf16 a[24:27], v[96:99], v[84:87], a[24:27]
    s_waitcnt vmcnt(10)
    s_barrier
    s_add_u32 m0, s36, 0
    buffer_load_dwordx4 v2, s[4:7], s28 offen lds
    s_add_u32 m0, s37, 0
    buffer_load_dwordx4 v3, s[4:7], s28 offen lds
    s_add_u32 m0, s38, 0
    buffer_load_dwordx4 v4, s[4:7], s28 offen lds
    s_add_u32 m0, s39, 0
    buffer_load_dwordx4 v5, s[4:7], s28 offen lds
    s_add_u32 m0, s40, 0
    buffer_load_dwordx4 v6, s[8:11], s29 offen lds
    s_add_u32 m0, s41, 0
    buffer_load_dwordx4 v7, s[8:11], s29 offen lds
    s_add_u32 m0, s42, 0
    buffer_load_dwordx4 v8, s[8:11], s29 offen lds
    s_add_u32 m0, s43, 0
    buffer_load_dwordx4 v9, s[8:11], s29 offen lds
    s_add_u32 m0, s44, 0
    buffer_load_dwordx4 v10, s[8:11], s29 offen lds
    s_add_u32 m0, s45, 0
    buffer_load_dwordx4 v11, s[8:11], s29 offen lds
    s_add_u32 s28, s28, 128
    s_add_u32 s29, s29, 393216
    ds_read_b128 v[40:43], v13 offset:0
    v_mfma_f32_16x16x32_bf16 a[48:51], v[96:99], v[88:91], a[48:51]
    ds_read_b128 v[44:47], v13 offset:2048
    v_mfma_f32_16x16x32_bf16 a[72:75], v[96:99], v[92:95], a[72:75]
    ds_read_b128 v[48:51], v13 offset:4096
    v_mfma_f32_16x16x32_bf16 a[4:7], v[100:103], v[80:83], a[4:7]
    ds_read_b128 v[52:55], v13 offset:6144
    v_mfma_f32_16x16x32_bf16 a[28:31], v[100:103], v[84:87], a[28:31]
    ds_read_b64_tr_b16 v[56:57], v19 offset:0
    v_mfma_f32_16x16x32_bf16 a[52:55], v[100:103], v[88:91], a[52:55]
    ds_read_b64_tr_b16 v[58:59], v19 offset:1536
    v_mfma_f32_16x16x32_bf16 a[76:79], v[100:103], v[92:95], a[76:79]
    ds_read_b64_tr_b16 v[60:61], v22 offset:0
    v_mfma_f32_16x16x32_bf16 a[8:11], v[104:107], v[80:83], a[8:11]
    ds_read_b64_tr_b16 v[62:63], v22 offset:1536
    v_mfma_f32_16x16x32_bf16 a[32:35], v[104:107], v[84:87], a[32:35]
    ds_read_b64_tr_b16 v[64:65], v25 offset:0
    v_mfma_f32_16x16x32_bf16 a[56:59], v[104:107], v[88:91], a[56:59]
    ds_read_b64_tr_b16 v[66:67], v25 offset:1536
    v_mfma_f32_16x16x32_bf16 a[80:83], v[104:107], v[92:95], a[80:83]
    ds_read_b64_tr_b16 v[68:69], v28 offset:0
    v_mfma_f32_16x16x32_bf16 a[12:15], v[108:111], v[80:83], a[12:15]
    ds_read_b64_tr_b16 v[70:71], v28 offset:1536
    v_mfma_f32_16x16x32_bf16 a[36:39], v[108:111], v[84:87], a[36:39]
    ds_read_b64_tr_b16 v[72:73], v19 offset:128
    v_mfma_f32_16x16x32_bf16 a[60:63], v[108:111], v[88:91], a[60:63]
    ds_read_b64_tr_b16 v[74:75], v19 offset:1664
    v_mfma_f32_16x16x32_bf16 a[84:87], v[108:111], v[92:95], a[84:87]
    ds_read_b64_tr_b16 v[76:77], v22 offset:128
    v_mfma_f32_16x16x32_bf16 a[16:19], v[112:115], v[80:83], a[16:19]
    ds_read_b64_tr_b16 v[78:79], v22 offset:1664
    v_mfma_f32_16x16x32_bf16 a[40:43], v[112:115], v[84:87], a[40:43]
    v_mfma_f32_16x16x32_bf16 a[64:67], v[112:115], v[88:91], a[64:67]
    v_mfma_f32_16x16x32_bf16 a[88:91], v[112:115], v[92:95], a[88:91]
    v_mfma_f32_16x16x32_bf16 a[20:23], v[116:119], v[80:83], a[20:23]
    v_mfma_f32_16x16x32_bf16 a[44:47], v[116:119], v[84:87], a[44:47]
    v_mfma_f32_16x16x32_bf16 a[68:71], v[116:119], v[88:91], a[68:71]
    v_mfma_f32_16x16x32_bf16 a[92:95], v[116:119], v[92:95], a[92:95]
    s_waitcnt lgkmcnt(0)
    ds_read_b128 v[80:83], v16 offset:0
    v_mfma_f32_16x16x32_bf16 a[0:3], v[56:59], v[40:43], a[0:3]
    ds_read_b128 v[84:87], v16 offset:2048
    v_mfma_f32_16x16x32_bf16 a[24:27], v[56:59], v[44:47], a[24:27]
    ds_read_b128 v[88:91], v16 offset:4096
    v_mfma_f32_16x16x32_bf16 a[48:51], v[56:59], v[48:51], a[48:51]
    ds_read_b128 v[92:95], v16 offset:6144
    v_mfma_f32_16x16x32_bf16 a[72:75], v[56:59], v[52:55], a[72:75]
    ds_read_b64_tr_b16 v[96:97], v19 offset:12288
    v_mfma_f32_16x16x32_bf16 a[4:7], v[60:63], v[40:43], a[4:7]
    ds_read_b64_tr_b16 v[98:99], v19 offset:13824
    v_mfma_f32_16x16x32_bf16 a[28:31], v[60:63], v[44:47], a[28:31]
    ds_read_b64_tr_b16 v[100:101], v22 offset:12288
    v_mfma_f32_16x16x32_bf16 a[52:55], v[60:63], v[48:51], a[52:55]
    ds_read_b64_tr_b16 v[102:103], v22 offset:13824
    v_mfma_f32_16x16x32_bf16 a[76:79], v[60:63], v[52:55], a[76:79]
    ds_read_b64_tr_b16 v[104:105], v25 offset:12288
    v_mfma_f32_16x16x32_bf16 a[8:11], v[64:67], v[40:43], a[8:11]
    ds_read_b64_tr_b16 v[106:107], v25 offset:13824
    v_mfma_f32_16x16x32_bf16 a[32:35], v[64:67], v[44:47], a[32:35]
    ds_read_b64_tr_b16 v[108:109], v28 offset:12288
    v_mfma_f32_16x16x32_bf16 a[56:59], v[64:67], v[48:51], a[56:59]
    ds_read_b64_tr_b16 v[110:111], v28 offset:13824
    v_mfma_f32_16x16x32_bf16 a[80:83], v[64:67], v[52:55], a[80:83]
    ds_read_b64_tr_b16 v[112:113], v19 offset:12416
    v_mfma_f32_16x16x32_bf16 a[12:15], v[68:71], v[40:43], a[12:15]
    ds_read_b64_tr_b16 v[114:115], v19 offset:13952
    v_mfma_f32_16x16x32_bf16 a[36:39], v[68:71], v[44:47], a[36:39]
    ds_read_b64_tr_b16 v[116:117], v22 offset:12416
    v_mfma_f32_16x16x32_bf16 a[60:63], v[68:71], v[48:51], a[60:63]
    ds_read_b64_tr_b16 v[118:119], v22 offset:13952
    v_mfma_f32_16x16x32_bf16 a[84:87], v[68:71], v[52:55], a[84:87]
    v_mfma_f32_16x16x32_bf16 a[16:19], v[72:75], v[40:43], a[16:19]
    v_mfma_f32_16x16x32_bf16 a[40:43], v[72:75], v[44:47], a[40:43]
    v_mfma_f32_16x16x32_bf16 a[64:67], v[72:75], v[48:51], a[64:67]
    v_mfma_f32_16x16x32_bf16 a[88:91], v[72:75], v[52:55], a[88:91]
    v_mfma_f32_16x16x32_bf16 a[20:23], v[76:79], v[40:43], a[20:23]
    v_mfma_f32_16x16x32_bf16 a[44:47], v[76:79], v[44:47], a[44:47]
    v_mfma_f32_16x16x32_bf16 a[68:71], v[76:79], v[48:51], a[68:71]
    v_mfma_f32_16x16x32_bf16 a[92:95], v[76:79], v[52:55], a[92:95]
    s_waitcnt lgkmcnt(0)
    v_mfma_f32_16x16x32_bf16 a[0:3], v[96:99], v[80:83], a[0:3]
    v_mfma_f32_16x16x32_bf16 a[24:27], v[96:99], v[84:87], a[24:27]
    s_waitcnt vmcnt(10)
    s_barrier
    s_add_u32 m0, s36, 40960
    buffer_load_dwordx4 v2, s[4:7], s28 offen lds
    s_add_u32 m0, s37, 40960
    buffer_load_dwordx4 v3, s[4:7], s28 offen lds
    s_add_u32 m0, s38, 40960
    buffer_load_dwordx4 v4, s[4:7], s28 offen lds
    s_add_u32 m0, s39, 40960
    buffer_load_dwordx4 v5, s[4:7], s28 offen lds
    s_add_u32 m0, s40, 40960
    buffer_load_dwordx4 v6, s[8:11], s29 offen lds
    s_add_u32 m0, s41, 40960
    buffer_load_dwordx4 v7, s[8:11], s29 offen lds
    s_add_u32 m0, s42, 40960
    buffer_load_dwordx4 v8, s[8:11], s29 offen lds
    s_add_u32 m0, s43, 40960
    buffer_load_dwordx4 v9, s[8:11], s29 offen lds
    s_add_u32 m0, s44, 40960
    buffer_load_dwordx4 v10, s[8:11], s29 offen lds
    s_add_u32 m0, s45, 40960
    buffer_load_dwordx4 v11, s[8:11], s29 offen lds
    s_add_u32 s28, s28, 128
    s_add_u32 s29, s29, 393216
    ds_read_b128 v[40:43], v14 offset:0
    v_mfma_f32_16x16x32_bf16 a[48:51], v[96:99], v[88:91], a[48:51]
    ds_read_b128 v[44:47], v14 offset:2048
    v_mfma_f32_16x16x32_bf16 a[72:75], v[96:99], v[92:95], a[72:75]
    ds_read_b128 v[48:51], v14 offset:4096
    v_mfma_f32_16x16x32_bf16 a[4:7], v[100:103], v[80:83], a[4:7]
    ds_read_b128 v[52:55], v14 offset:6144
    v_mfma_f32_16x16x32_bf16 a[28:31], v[100:103], v[84:87], a[28:31]
    ds_read_b64_tr_b16 v[56:57], v20 offset:0
    v_mfma_f32_16x16x32_bf16 a[52:55], v[100:103], v[88:91], a[52:55]
    ds_read_b64_tr_b16 v[58:59], v20 offset:1536
    v_mfma_f32_16x16x32_bf16 a[76:79], v[100:103], v[92:95], a[76:79]
    ds_read_b64_tr_b16 v[60:61], v23 offset:0
    v_mfma_f32_16x16x32_bf16 a[8:11], v[104:107], v[80:83], a[8:11]
    ds_read_b64_tr_b16 v[62:63], v23 offset:1536
    v_mfma_f32_16x16x32_bf16 a[32:35], v[104:107], v[84:87], a[32:35]
    ds_read_b64_tr_b16 v[64:65], v26 offset:0
    v_mfma_f32_16x16x32_bf16 a[56:59], v[104:107], v[88:91], a[56:59]
    ds_read_b64_tr_b16 v[66:67], v26 offset:1536
    v_mfma_f32_16x16x32_bf16 a[80:83], v[104:107], v[92:95], a[80:83]
    ds_read_b64_tr_b16 v[68:69], v29 offset:0
    v_mfma_f32_16x16x32_bf16 a[12:15], v[108:111], v[80:83], a[12:15]
    ds_read_b64_tr_b16 v[70:71], v29 offset:1536
    v_mfma_f32_16x16x32_bf16 a[36:39], v[108:111], v[84:87], a[36:39]
    ds_read_b64_tr_b16 v[72:73], v20 offset:128
    v_mfma_f32_16x16x32_bf16 a[60:63], v[108:111], v[88:91], a[60:63]
    ds_read_b64_tr_b16 v[74:75], v20 offset:1664
    v_mfma_f32_16x16x32_bf16 a[84:87], v[108:111], v[92:95], a[84:87]
    ds_read_b64_tr_b16 v[76:77], v23 offset:128
    v_mfma_f32_16x16x32_bf16 a[16:19], v[112:115], v[80:83], a[16:19]
    ds_read_b64_tr_b16 v[78:79], v23 offset:1664
    v_mfma_f32_16x16x32_bf16 a[40:43], v[112:115], v[84:87], a[40:43]
    v_mfma_f32_16x16x32_bf16 a[64:67], v[112:115], v[88:91], a[64:67]
    v_mfma_f32_16x16x32_bf16 a[88:91], v[112:115], v[92:95], a[88:91]
    v_mfma_f32_16x16x32_bf16 a[20:23], v[116:119], v[80:83], a[20:23]
    v_mfma_f32_16x16x32_bf16 a[44:47], v[116:119], v[84:87], a[44:47]
    v_mfma_f32_16x16x32_bf16 a[68:71], v[116:119], v[88:91], a[68:71]
    v_mfma_f32_16x16x32_bf16 a[92:95], v[116:119], v[92:95], a[92:95]
    s_waitcnt lgkmcnt(0)
    ds_read_b128 v[80:83], v17 offset:0
    v_mfma_f32_16x16x32_bf16 a[0:3], v[56:59], v[40:43], a[0:3]
    ds_read_b128 v[84:87], v17 offset:2048
    v_mfma_f32_16x16x32_bf16 a[24:27], v[56:59], v[44:47], a[24:27]
    ds_read_b128 v[88:91], v17 offset:4096
    v_mfma_f32_16x16x32_bf16 a[48:51], v[56:59], v[48:51], a[48:51]
    ds_read_b128 v[92:95], v17 offset:6144
    v_mfma_f32_16x16x32_bf16 a[72:75], v[56:59], v[52:55], a[72:75]
    ds_read_b64_tr_b16 v[96:97], v20 offset:12288
    v_mfma_f32_16x16x32_bf16 a[4:7], v[60:63], v[40:43], a[4:7]
    ds_read_b64_tr_b16 v[98:99], v20 offset:13824
    v_mfma_f32_16x16x32_bf16 a[28:31], v[60:63], v[44:47], a[28:31]
    ds_read_b64_tr_b16 v[100:101], v23 offset:12288
    v_mfma_f32_16x16x32_bf16 a[52:55], v[60:63], v[48:51], a[52:55]
    ds_read_b64_tr_b16 v[102:103], v23 offset:13824
    v_mfma_f32_16x16x32_bf16 a[76:79], v[60:63], v[52:55], a[76:79]
    ds_read_b64_tr_b16 v[104:105], v26 offset:12288
    v_mfma_f32_16x16x32_bf16 a[8:11], v[64:67], v[40:43], a[8:11]
    ds_read_b64_tr_b16 v[106:107], v26 offset:13824
    v_mfma_f32_16x16x32_bf16 a[32:35], v[64:67], v[44:47], a[32:35]
    ds_read_b64_tr_b16 v[108:109], v29 offset:12288
    v_mfma_f32_16x16x32_bf16 a[56:59], v[64:67], v[48:51], a[56:59]
    ds_read_b64_tr_b16 v[110:111], v29 offset:13824
    v_mfma_f32_16x16x32_bf16 a[80:83], v[64:67], v[52:55], a[80:83]
    ds_read_b64_tr_b16 v[112:113], v20 offset:12416
    v_mfma_f32_16x16x32_bf16 a[12:15], v[68:71], v[40:43], a[12:15]
    ds_read_b64_tr_b16 v[114:115], v20 offset:13952
    v_mfma_f32_16x16x32_bf16 a[36:39], v[68:71], v[44:47], a[36:39]
    ds_read_b64_tr_b16 v[116:117], v23 offset:12416
    v_mfma_f32_16x16x32_bf16 a[60:63], v[68:71], v[48:51], a[60:63]
    ds_read_b64_tr_b16 v[118:119], v23 offset:13952
    v_mfma_f32_16x16x32_bf16 a[84:87], v[68:71], v[52:55], a[84:87]
    v_mfma_f32_16x16x32_bf16 a[16:19], v[72:75], v[40:43], a[16:19]
    v_mfma_f32_16x16x32_bf16 a[40:43], v[72:75], v[44:47], a[40:43]
    v_mfma_f32_16x16x32_bf16 a[64:67], v[72:75], v[48:51], a[64:67]
    v_mfma_f32_16x16x32_bf16 a[88:91], v[72:75], v[52:55], a[88:91]
    v_mfma_f32_16x16x32_bf16 a[20:23], v[76:79], v[40:43], a[20:23]
    v_mfma_f32_16x16x32_bf16 a[44:47], v[76:79], v[44:47], a[44:47]
    v_mfma_f32_16x16x32_bf16 a[68:71], v[76:79], v[48:51], a[68:71]
    v_mfma_f32_16x16x32_bf16 a[92:95], v[76:79], v[52:55], a[92:95]
    s_waitcnt lgkmcnt(0)
    v_mfma_f32_16x16x32_bf16 a[0:3], v[96:99], v[80:83], a[0:3]
    v_mfma_f32_16x16x32_bf16 a[24:27], v[96:99], v[84:87], a[24:27]
    s_waitcnt vmcnt(10)
    s_barrier
    s_add_u32 m0, s36, 81920
    buffer_load_dwordx4 v2, s[4:7], s28 offen lds
    s_add_u32 m0, s37, 81920
    buffer_load_dwordx4 v3, s[4:7], s28 offen lds
    s_add_u32 m0, s38, 81920
    buffer_load_dwordx4 v4, s[4:7], s28 offen lds
    s_add_u32 m0, s39, 81920
    buffer_load_dwordx4 v5, s[4:7], s28 offen lds
    s_add_u32 m0, s40, 81920
    buffer_load_dwordx4 v6, s[8:11], s29 offen lds
    s_add_u32 m0, s41, 81920
    buffer_load_dwordx4 v7, s[8:11], s29 offen lds
    s_add_u32 m0, s42, 81920
    buffer_load_dwordx4 v8, s[8:11], s29 offen lds
    s_add_u32 m0, s43, 81920
    buffer_load_dwordx4 v9, s[8:11], s29 offen lds
    s_add_u32 m0, s44, 81920
    buffer_load_dwordx4 v10, s[8:11], s29 offen lds
    s_add_u32 m0, s45, 81920
    buffer_load_dwordx4 v11, s[8:11], s29 offen lds
    s_add_u32 s28, s28, 128
    s_add_u32 s29, s29, 393216
    ds_read_b128 v[40:43], v12 offset:0
    v_mfma_f32_16x16x32_bf16 a[48:51], v[96:99], v[88:91], a[48:51]
    ds_read_b128 v[44:47], v12 offset:2048
    v_mfma_f32_16x16x32_bf16 a[72:75], v[96:99], v[92:95], a[72:75]
    ds_read_b128 v[48:51], v12 offset:4096
    v_mfma_f32_16x16x32_bf16 a[4:7], v[100:103], v[80:83], a[4:7]
    ds_read_b128 v[52:55], v12 offset:6144
    v_mfma_f32_16x16x32_bf16 a[28:31], v[100:103], v[84:87], a[28:31]
    ds_read_b64_tr_b16 v[56:57], v18 offset:0
    v_mfma_f32_16x16x32_bf16 a[52:55], v[100:103], v[88:91], a[52:55]
    ds_read_b64_tr_b16 v[58:59], v18 offset:1536
    v_mfma_f32_16x16x32_bf16 a[76:79], v[100:103], v[92:95], a[76:79]
    ds_read_b64_tr_b16 v[60:61], v21 offset:0
    v_mfma_f32_16x16x32_bf16 a[8:11], v[104:107], v[80:83], a[8:11]
    ds_read_b64_tr_b16 v[62:63], v21 offset:1536
    v_mfma_f32_16x16x32_bf16 a[32:35], v[104:107], v[84:87], a[32:35]
    ds_read_b64_tr_b16 v[64:65], v24 offset:0
    v_mfma_f32_16x16x32_bf16 a[56:59], v[104:107], v[88:91], a[56:59]
    ds_read_b64_tr_b16 v[66:67], v24 offset:1536
    v_mfma_f32_16x16x32_bf16 a[80:83], v[104:107], v[92:95], a[80:83]
    ds_read_b64_tr_b16 v[68:69], v27 offset:0
    v_mfma_f32_16x16x32_bf16 a[12:15], v[108:111], v[80:83], a[12:15]
    ds_read_b64_tr_b16 v[70:71], v27 offset:1536
    v_mfma_f32_16x16x32_bf16 a[36:39], v[108:111], v[84:87], a[36:39]
    ds_read_b64_tr_b16 v[72:73], v18 offset:128
    v_mfma_f32_16x16x32_bf16 a[60:63], v[108:111], v[88:91], a[60:63]
    ds_read_b64_tr_b16 v[74:75], v18 offset:1664
    v_mfma_f32_16x16x32_bf16 a[84:87], v[108:111], v[92:95], a[84:87]
    ds_read_b64_tr_b16 v[76:77], v21 offset:128
    v_mfma_f32_16x16x32_bf16 a[16:19], v[112:115], v[80:83], a[16:19]
    ds_read_b64_tr_b16 v[78:79], v21 offset:1664
    v_mfma_f32_16x16x32_bf16 a[40:43], v[112:115], v[84:87], a[40:43]
    v_mfma_f32_16x16x32_bf16 a[64:67], v[112:115], v[88:91], a[64:67]
    v_mfma_f32_16x16x32_bf16 a[88:91], v[112:115], v[92:95], a[88:91]
    v_mfma_f32_16x16x32_bf16 a[20:23], v[116:119], v[80:83], a[20:23]
    v_mfma_f32_16x16x32_bf16 a[44:47], v[116:119], v[84:87], a[44:47]
    v_mfma_f32_16x16x32_bf16 a[68:71], v[116:119], v[88:91], a[68:71]
    v_mfma_f32_16x16x32_bf16 a[92:95], v[116:119], v[92:95], a[92:95]
    s_waitcnt lgkmcnt(0)
    ds_read_b128 v[80:83], v15 offset:0
    v_mfma_f32_16x16x32_bf16 a[0:3], v[56:59], v[40:43], a[0:3]
    ds_read_b128 v[84:87], v15 offset:2048
    v_mfma_f32_16x16x32_bf16 a[24:27], v[56:59], v[44:47], a[24:27]
    ds_read_b128 v[88:91], v15 offset:4096
    v_mfma_f32_16x16x32_bf16 a[48:51], v[56:59], v[48:51], a[48:51]
    ds_read_b128 v[92:95], v15 offset:6144
    v_mfma_f32_16x16x32_bf16 a[72:75], v[56:59], v[52:55], a[72:75]
    ds_read_b64_tr_b16 v[96:97], v18 offset:12288
    v_mfma_f32_16x16x32_bf16 a[4:7], v[60:63], v[40:43], a[4:7]
    ds_read_b64_tr_b16 v[98:99], v18 offset:13824
    v_mfma_f32_16x16x32_bf16 a[28:31], v[60:63], v[44:47], a[28:31]
    ds_read_b64_tr_b16 v[100:101], v21 offset:12288
    v_mfma_f32_16x16x32_bf16 a[52:55], v[60:63], v[48:51], a[52:55]
    ds_read_b64_tr_b16 v[102:103], v21 offset:13824
    v_mfma_f32_16x16x32_bf16 a[76:79], v[60:63], v[52:55], a[76:79]
    ds_read_b64_tr_b16 v[104:105], v24 offset:12288
    v_mfma_f32_16x16x32_bf16 a[8:11], v[64:67], v[40:43], a[8:11]
    ds_read_b64_tr_b16 v[106:107], v24 offset:13824
    v_mfma_f32_16x16x32_bf16 a[32:35], v[64:67], v[44:47], a[32:35]
    ds_read_b64_tr_b16 v[108:109], v27 offset:12288
    v_mfma_f32_16x16x32_bf16 a[56:59], v[64:67], v[48:51], a[56:59]
    ds_read_b64_tr_b16 v[110:111], v27 offset:13824
    v_mfma_f32_16x16x32_bf16 a[80:83], v[64:67], v[52:55], a[80:83]
    ds_read_b64_tr_b16 v[112:113], v18 offset:12416
    v_mfma_f32_16x16x32_bf16 a[12:15], v[68:71], v[40:43], a[12:15]
    ds_read_b64_tr_b16 v[114:115], v18 offset:13952
    v_mfma_f32_16x16x32_bf16 a[36:39], v[68:71], v[44:47], a[36:39]
    ds_read_b64_tr_b16 v[116:117], v21 offset:12416
    v_mfma_f32_16x16x32_bf16 a[60:63], v[68:71], v[48:51], a[60:63]
    ds_read_b64_tr_b16 v[118:119], v21 offset:13952
    v_mfma_f32_16x16x32_bf16 a[84:87], v[68:71], v[52:55], a[84:87]
    v_mfma_f32_16x16x32_bf16 a[16:19], v[72:75], v[40:43], a[16:19]
    v_mfma_f32_16x16x32_bf16 a[40:43], v[72:75], v[44:47], a[40:43]
    v_mfma_f32_16x16x32_bf16 a[64:67], v[72:75], v[48:51], a[64:67]
    v_mfma_f32_16x16x32_bf16 a[88:91], v[72:75], v[52:55], a[88:91]
    v_mfma_f32_16x16x32_bf16 a[20:23], v[76:79], v[40:43], a[20:23]
    v_mfma_f32_16x16x32_bf16 a[44:47], v[76:79], v[44:47], a[44:47]
    v_mfma_f32_16x16x32_bf16 a[68:71], v[76:79], v[48:51], a[68:71]
    v_mfma_f32_16x16x32_bf16 a[92:95], v[76:79], v[52:55], a[92:95]
    s_waitcnt lgkmcnt(0)
    v_mfma_f32_16x16x32_bf16 a[0:3], v[96:99], v[80:83], a[0:3]
    v_mfma_f32_16x16x32_bf16 a[24:27], v[96:99], v[84:87], a[24:27]
    s_waitcnt vmcnt(10)
    s_barrier
    s_add_u32 m0, s36, 0
    buffer_load_dwordx4 v2, s[4:7], s28 offen lds
    s_add_u32 m0, s37, 0
    buffer_load_dwordx4 v3, s[4:7], s28 offen lds
    s_add_u32 m0, s38, 0
    buffer_load_dwordx4 v4, s[4:7], s28 offen lds
    s_add_u32 m0, s39, 0
    buffer_load_dwordx4 v5, s[4:7], s28 offen lds
    s_add_u32 m0, s40, 0
    buffer_load_dwordx4 v6, s[8:11], s29 offen lds
    s_add_u32 m0, s41, 0
    buffer_load_dwordx4 v7, s[8:11], s29 offen lds
    s_add_u32 m0, s42, 0
    buffer_load_dwordx4 v8, s[8:11], s29 offen lds
    s_add_u32 m0, s43, 0
    buffer_load_dwordx4 v9, s[8:11], s29 offen lds
    s_add_u32 m0, s44, 0
    buffer_load_dwordx4 v10, s[8:11], s29 offen lds
    s_add_u32 m0, s45, 0
    buffer_load_dwordx4 v11, s[8:11], s29 offen lds
    s_add_u32 s28, s28, 128
    s_add_u32 s29, s29, 393216
    ds_read_b128 v[40:43], v13 offset:0
    v_mfma_f32_16x16x32_bf16 a[48:51], v[96:99], v[88:91], a[48:51]
    ds_read_b128 v[44:47], v13 offset:2048
    v_mfma_f32_16x16x32_bf16 a[72:75], v[96:99], v[92:95], a[72:75]
    ds_read_b128 v[48:51], v13 offset:4096
    v_mfma_f32_16x16x32_bf16 a[4:7], v[100:103], v[80:83], a[4:7]
    ds_read_b128 v[52:55], v13 offset:6144
    v_mfma_f32_16x16x32_bf16 a[28:31], v[100:103], v[84:87], a[28:31]
    ds_read_b64_tr_b16 v[56:57], v19 offset:0
    v_mfma_f32_16x16x32_bf16 a[52:55], v[100:103], v[88:91], a[52:55]
    ds_read_b64_tr_b16 v[58:59], v19 offset:1536
    v_mfma_f32_16x16x32_bf16 a[76:79], v[100:103], v[92:95], a[76:79]
    ds_read_b64_tr_b16 v[60:61], v22 offset:0
    v_mfma_f32_16x16x32_bf16 a[8:11], v[104:107], v[80:83], a[8:11]
    ds_read_b64_tr_b16 v[62:63], v22 offset:1536
    v_mfma_f32_16x16x32_bf16 a[32:35], v[104:107], v[84:87], a[32:35]
    ds_read_b64_tr_b16 v[64:65], v25 offset:0
    v_mfma_f32_16x16x32_bf16 a[56:59], v[104:107], v[88:91], a[56:59]
    ds_read_b64_tr_b16 v[66:67], v25 offset:1536
    v_mfma_f32_16x16x32_bf16 a[80:83], v[104:107], v[92:95], a[80:83]
    ds_read_b64_tr_b16 v[68:69], v28 offset:0
    v_mfma_f32_16x16x32_bf16 a[12:15], v[108:111], v[80:83], a[12:15]
    ds_read_b64_tr_b16 v[70:71], v28 offset:1536
    v_mfma_f32_16x16x32_bf16 a[36:39], v[108:111], v[84:87], a[36:39]
    ds_read_b64_tr_b16 v[72:73], v19 offset:128
    v_mfma_f32_16x16x32_bf16 a[60:63], v[108:111], v[88:91], a[60:63]
    ds_read_b64_tr_b16 v[74:75], v19 offset:1664
    v_mfma_f32_16x16x32_bf16 a[84:87], v[108:111], v[92:95], a[84:87]
    ds_read_b64_tr_b16 v[76:77], v22 offset:128
    v_mfma_f32_16x16x32_bf16 a[16:19], v[112:115], v[80:83], a[16:19]
    ds_read_b64_tr_b16 v[78:79], v22 offset:1664
    v_mfma_f32_16x16x32_bf16 a[40:43], v[112:115], v[84:87], a[40:43]
    v_mfma_f32_16x16x32_bf16 a[64:67], v[112:115], v[88:91], a[64:67]
    v_mfma_f32_16x16x32_bf16 a[88:91], v[112:115], v[92:95], a[88:91]
    v_mfma_f32_16x16x32_bf16 a[20:23], v[116:119], v[80:83], a[20:23]
    v_mfma_f32_16x16x32_bf16 a[44:47], v[116:119], v[84:87], a[44:47]
    v_mfma_f32_16x16x32_bf16 a[68:71], v[116:119], v[88:91], a[68:71]
    v_mfma_f32_16x16x32_bf16 a[92:95], v[116:119], v[92:95], a[92:95]
    s_waitcnt lgkmcnt(0)
    ds_read_b128 v[80:83], v16 offset:0
    v_mfma_f32_16x16x32_bf16 a[0:3], v[56:59], v[40:43], a[0:3]
    ds_read_b128 v[84:87], v16 offset:2048
    v_mfma_f32_16x16x32_bf16 a[24:27], v[56:59], v[44:47], a[24:27]
    ds_read_b128 v[88:91], v16 offset:4096
    v_mfma_f32_16x16x32_bf16 a[48:51], v[56:59], v[48:51], a[48:51]
    ds_read_b128 v[92:95], v16 offset:6144
    v_mfma_f32_16x16x32_bf16 a[72:75], v[56:59], v[52:55], a[72:75]
    ds_read_b64_tr_b16 v[96:97], v19 offset:12288
    v_mfma_f32_16x16x32_bf16 a[4:7], v[60:63], v[40:43], a[4:7]
    ds_read_b64_tr_b16 v[98:99], v19 offset:13824
    v_mfma_f32_16x16x32_bf16 a[28:31], v[60:63], v[44:47], a[28:31]
    ds_read_b64_tr_b16 v[100:101], v22 offset:12288
    v_mfma_f32_16x16x32_bf16 a[52:55], v[60:63], v[48:51], a[52:55]
    ds_read_b64_tr_b16 v[102:103], v22 offset:13824
    v_mfma_f32_16x16x32_bf16 a[76:79], v[60:63], v[52:55], a[76:79]
    ds_read_b64_tr_b16 v[104:105], v25 offset:12288
    v_mfma_f32_16x16x32_bf16 a[8:11], v[64:67], v[40:43], a[8:11]
    ds_read_b64_tr_b16 v[106:107], v25 offset:13824
    v_mfma_f32_16x16x32_bf16 a[32:35], v[64:67], v[44:47], a[32:35]
    ds_read_b64_tr_b16 v[108:109], v28 offset:12288
    v_mfma_f32_16x16x32_bf16 a[56:59], v[64:67], v[48:51], a[56:59]
    ds_read_b64_tr_b16 v[110:111], v28 offset:13824
    v_mfma_f32_16x16x32_bf16 a[80:83], v[64:67], v[52:55], a[80:83]
    ds_read_b64_tr_b16 v[112:113], v19 offset:12416
    v_mfma_f32_16x16x32_bf16 a[12:15], v[68:71], v[40:43], a[12:15]
    ds_read_b64_tr_b16 v[114:115], v19 offset:13952
    v_mfma_f32_16x16x32_bf16 a[36:39], v[68:71], v[44:47], a[36:39]
    ds_read_b64_tr_b16 v[116:117], v22 offset:12416
    v_mfma_f32_16x16x32_bf16 a[60:63], v[68:71], v[48:51], a[60:63]
    ds_read_b64_tr_b16 v[118:119], v22 offset:13952
    v_mfma_f32_16x16x32_bf16 a[84:87], v[68:71], v[52:55], a[84:87]
    v_mfma_f32_16x16x32_bf16 a[16:19], v[72:75], v[40:43], a[16:19]
    v_mfma_f32_16x16x32_bf16 a[40:43], v[72:75], v[44:47], a[40:43]
    v_mfma_f32_16x16x32_bf16 a[64:67], v[72:75], v[48:51], a[64:67]
    v_mfma_f32_16x16x32_bf16 a[88:91], v[72:75], v[52:55], a[88:91]
    v_mfma_f32_16x16x32_bf16 a[20:23], v[76:79], v[40:43], a[20:23]
    v_mfma_f32_16x16x32_bf16 a[44:47], v[76:79], v[44:47], a[44:47]
    v_mfma_f32_16x16x32_bf16 a[68:71], v[76:79], v[48:51], a[68:71]
    v_mfma_f32_16x16x32_bf16 a[92:95], v[76:79], v[52:55], a[92:95]
    s_waitcnt lgkmcnt(0)
    v_mfma_f32_16x16x32_bf16 a[0:3], v[96:99], v[80:83], a[0:3]
    v_mfma_f32_16x16x32_bf16 a[24:27], v[96:99], v[84:87], a[24:27]
    s_waitcnt vmcnt(10)
    s_barrier
    ds_read_b128 v[40:43], v14 offset:0
    v_mfma_f32_16x16x32_bf16 a[48:51], v[96:99], v[88:91], a[48:51]
    ds_read_b128 v[44:47], v14 offset:2048
    v_mfma_f32_16x16x32_bf16 a[72:75], v[96:99], v[92:95], a[72:75]
    ds_read_b128 v[48:51], v14 offset:4096
    v_mfma_f32_16x16x32_bf16 a[4:7], v[100:103], v[80:83], a[4:7]
    ds_read_b128 v[52:55], v14 offset:6144
    v_mfma_f32_16x16x32_bf16 a[28:31], v[100:103], v[84:87], a[28:31]
    ds_read_b64_tr_b16 v[56:57], v20 offset:0
    v_mfma_f32_16x16x32_bf16 a[52:55], v[100:103], v[88:91], a[52:55]
    ds_read_b64_tr_b16 v[58:59], v20 offset:1536
    v_mfma_f32_16x16x32_bf16 a[76:79], v[100:103], v[92:95], a[76:79]
    ds_read_b64_tr_b16 v[60:61], v23 offset:0
    v_mfma_f32_16x16x32_bf16 a[8:11], v[104:107], v[80:83], a[8:11]
    ds_read_b64_tr_b16 v[62:63], v23 offset:1536
    v_mfma_f32_16x16x32_bf16 a[32:35], v[104:107], v[84:87], a[32:35]
    ds_read_b64_tr_b16 v[64:65], v26 offset:0
    v_mfma_f32_16x16x32_bf16 a[56:59], v[104:107], v[88:91], a[56:59]
    ds_read_b64_tr_b16 v[66:67], v26 offset:1536
    v_mfma_f32_16x16x32_bf16 a[80:83], v[104:107], v[92:95], a[80:83]
    ds_read_b64_tr_b16 v[68:69], v29 offset:0
    v_mfma_f32_16x16x32_bf16 a[12:15], v[108:111], v[80:83], a[12:15]
    ds_read_b64_tr_b16 v[70:71], v29 offset:1536
    v_mfma_f32_16x16x32_bf16 a[36:39], v[108:111], v[84:87], a[36:39]
    ds_read_b64_tr_b16 v[72:73], v20 offset:128
    v_mfma_f32_16x16x32_bf16 a[60:63], v[108:111], v[88:91], a[60:63]
    ds_read_b64_tr_b16 v[74:75], v20 offset:1664
    v_mfma_f32_16x16x32_bf16 a[84:87], v[108:111], v[92:95], a[84:87]
    ds_read_b64_tr_b16 v[76:77], v23 offset:128
    v_mfma_f32_16x16x32_bf16 a[16:19], v[112:115], v[80:83], a[16:19]
    ds_read_b64_tr_b16 v[78:79], v23 offset:1664
    v_mfma_f32_16x16x32_bf16 a[40:43], v[112:115], v[84:87], a[40:43]
    v_mfma_f32_16x16x32_bf16 a[64:67], v[112:115], v[88:91], a[64:67]
    v_mfma_f32_16x16x32_bf16 a[88:91], v[112:115], v[92:95], a[88:91]
    v_mfma_f32_16x16x32_bf16 a[20:23], v[116:119], v[80:83], a[20:23]
    v_mfma_f32_16x16x32_bf16 a[44:47], v[116:119], v[84:87], a[44:47]
    v_mfma_f32_16x16x32_bf16 a[68:71], v[116:119], v[88:91], a[68:71]
    v_mfma_f32_16x16x32_bf16 a[92:95], v[116:119], v[92:95], a[92:95]
    s_waitcnt lgkmcnt(0)
    ds_read_b128 v[80:83], v17 offset:0
    v_mfma_f32_16x16x32_bf16 a[0:3], v[56:59], v[40:43], a[0:3]
    ds_read_b128 v[84:87], v17 offset:2048
    v_mfma_f32_16x16x32_bf16 a[24:27], v[56:59], v[44:47], a[24:27]
    ds_read_b128 v[88:91], v17 offset:4096
    v_mfma_f32_16x16x32_bf16 a[48:51], v[56:59], v[48:51], a[48:51]
    ds_read_b128 v[92:95], v17 offset:6144
    v_mfma_f32_16x16x32_bf16 a[72:75], v[56:59], v[52:55], a[72:75]
    ds_read_b64_tr_b16 v[96:97], v20 offset:12288
    v_mfma_f32_16x16x32_bf16 a[4:7], v[60:63], v[40:43], a[4:7]
    ds_read_b64_tr_b16 v[98:99], v20 offset:13824
    v_mfma_f32_16x16x32_bf16 a[28:31], v[60:63], v[44:47], a[28:31]
    ds_read_b64_tr_b16 v[100:101], v23 offset:12288
    v_mfma_f32_16x16x32_bf16 a[52:55], v[60:63], v[48:51], a[52:55]
    ds_read_b64_tr_b16 v[102:103], v23 offset:13824
    v_mfma_f32_16x16x32_bf16 a[76:79], v[60:63], v[52:55], a[76:79]
    ds_read_b64_tr_b16 v[104:105], v26 offset:12288
    v_mfma_f32_16x16x32_bf16 a[8:11], v[64:67], v[40:43], a[8:11]
    ds_read_b64_tr_b16 v[106:107], v26 offset:13824
    v_mfma_f32_16x16x32_bf16 a[32:35], v[64:67], v[44:47], a[32:35]
    ds_read_b64_tr_b16 v[108:109], v29 offset:12288
    v_mfma_f32_16x16x32_bf16 a[56:59], v[64:67], v[48:51], a[56:59]
    ds_read_b64_tr_b16 v[110:111], v29 offset:13824
    v_mfma_f32_16x16x32_bf16 a[80:83], v[64:67], v[52:55], a[80:83]
    ds_read_b64_tr_b16 v[112:113], v20 offset:12416
    v_mfma_f32_16x16x32_bf16 a[12:15], v[68:71], v[40:43], a[12:15]
    ds_read_b64_tr_b16 v[114:115], v20 offset:13952
    v_mfma_f32_16x16x32_bf16 a[36:39], v[68:71], v[44:47], a[36:39]
    ds_read_b64_tr_b16 v[116:117], v23 offset:12416
    v_mfma_f32_16x16x32_bf16 a[60:63], v[68:71], v[48:51], a[60:63]
    ds_read_b64_tr_b16 v[118:119], v23 offset:13952
    v_mfma_f32_16x16x32_bf16 a[84:87], v[68:71], v[52:55], a[84:87]
    v_mfma_f32_16x16x32_bf16 a[16:19], v[72:75], v[40:43], a[16:19]
    v_mfma_f32_16x16x32_bf16 a[40:43], v[72:75], v[44:47], a[40:43]
    v_mfma_f32_16x16x32_bf16 a[64:67], v[72:75], v[48:51], a[64:67]
    v_mfma_f32_16x16x32_bf16 a[88:91], v[72:75], v[52:55], a[88:91]
    v_mfma_f32_16x16x32_bf16 a[20:23], v[76:79], v[40:43], a[20:23]
    v_mfma_f32_16x16x32_bf16 a[44:47], v[76:79], v[44:47], a[44:47]
    v_mfma_f32_16x16x32_bf16 a[68:71], v[76:79], v[48:51], a[68:71]
    v_mfma_f32_16x16x32_bf16 a[92:95], v[76:79], v[52:55], a[92:95]
    s_waitcnt lgkmcnt(0)
    v_mfma_f32_16x16x32_bf16 a[0:3], v[96:99], v[80:83], a[0:3]
    v_mfma_f32_16x16x32_bf16 a[24:27], v[96:99], v[84:87], a[24:27]
    s_waitcnt vmcnt(0)
    s_barrier
    ds_read_b128 v[40:43], v12 offset:0
    v_mfma_f32_16x16x32_bf16 a[48:51], v[96:99], v[88:91], a[48:51]
    ds_read_b128 v[44:47], v12 offset:2048
    v_mfma_f32_16x16x32_bf16 a[72:75], v[96:99], v[92:95], a[72:75]
    ds_read_b128 v[48:51], v12 offset:4096
    v_mfma_f32_16x16x32_bf16 a[4:7], v[100:103], v[80:83], a[4:7]
    ds_read_b128 v[52:55], v12 offset:6144
    v_mfma_f32_16x16x32_bf16 a[28:31], v[100:103], v[84:87], a[28:31]
    ds_read_b64_tr_b16 v[56:57], v18 offset:0
    v_mfma_f32_16x16x32_bf16 a[52:55], v[100:103], v[88:91], a[52:55]
    ds_read_b64_tr_b16 v[58:59], v18 offset:1536
    v_mfma_f32_16x16x32_bf16 a[76:79], v[100:103], v[92:95], a[76:79]
    ds_read_b64_tr_b16 v[60:61], v21 offset:0
    v_mfma_f32_16x16x32_bf16 a[8:11], v[104:107], v[80:83], a[8:11]
    ds_read_b64_tr_b16 v[62:63], v21 offset:1536
    v_mfma_f32_16x16x32_bf16 a[32:35], v[104:107], v[84:87], a[32:35]
    ds_read_b64_tr_b16 v[64:65], v24 offset:0
    v_mfma_f32_16x16x32_bf16 a[56:59], v[104:107], v[88:91], a[56:59]
    ds_read_b64_tr_b16 v[66:67], v24 offset:1536
    v_mfma_f32_16x16x32_bf16 a[80:83], v[104:107], v[92:95], a[80:83]
    ds_read_b64_tr_b16 v[68:69], v27 offset:0
    v_mfma_f32_16x16x32_bf16 a[12:15], v[108:111], v[80:83], a[12:15]
    ds_read_b64_tr_b16 v[70:71], v27 offset:1536
    v_mfma_f32_16x16x32_bf16 a[36:39], v[108:111], v[84:87], a[36:39]
    ds_read_b64_tr_b16 v[72:73], v18 offset:128
    v_mfma_f32_16x16x32_bf16 a[60:63], v[108:111], v[88:91], a[60:63]
    ds_read_b64_tr_b16 v[74:75], v18 offset:1664
    v_mfma_f32_16x16x32_bf16 a[84:87], v[108:111], v[92:95], a[84:87]
    ds_read_b64_tr_b16 v[76:77], v21 offset:128
    v_mfma_f32_16x16x32_bf16 a[16:19], v[112:115], v[80:83], a[16:19]
    ds_read_b64_tr_b16 v[78:79], v21 offset:1664
    v_mfma_f32_16x16x32_bf16 a[40:43], v[112:115], v[84:87], a[40:43]
    v_mfma_f32_16x16x32_bf16 a[64:67], v[112:115], v[88:91], a[64:67]
    v_mfma_f32_16x16x32_bf16 a[88:91], v[112:115], v[92:95], a[88:91]
    v_mfma_f32_16x16x32_bf16 a[20:23], v[116:119], v[80:83], a[20:23]
    v_mfma_f32_16x16x32_bf16 a[44:47], v[116:119], v[84:87], a[44:47]
    v_mfma_f32_16x16x32_bf16 a[68:71], v[116:119], v[88:91], a[68:71]
    v_mfma_f32_16x16x32_bf16 a[92:95], v[116:119], v[92:95], a[92:95]
    s_waitcnt lgkmcnt(0)
    ds_read_b128 v[80:83], v15 offset:0
    v_mfma_f32_16x16x32_bf16 a[0:3], v[56:59], v[40:43], a[0:3]
    ds_read_b128 v[84:87], v15 offset:2048
    v_mfma_f32_16x16x32_bf16 a[24:27], v[56:59], v[44:47], a[24:27]
    ds_read_b128 v[88:91], v15 offset:4096
    v_mfma_f32_16x16x32_bf16 a[48:51], v[56:59], v[48:51], a[48:51]
    ds_read_b128 v[92:95], v15 offset:6144
    v_mfma_f32_16x16x32_bf16 a[72:75], v[56:59], v[52:55], a[72:75]
    ds_read_b64_tr_b16 v[96:97], v18 offset:12288
    v_mfma_f32_16x16x32_bf16 a[4:7], v[60:63], v[40:43], a[4:7]
    ds_read_b64_tr_b16 v[98:99], v18 offset:13824
    v_mfma_f32_16x16x32_bf16 a[28:31], v[60:63], v[44:47], a[28:31]
    ds_read_b64_tr_b16 v[100:101], v21 offset:12288
    v_mfma_f32_16x16x32_bf16 a[52:55], v[60:63], v[48:51], a[52:55]
    ds_read_b64_tr_b16 v[102:103], v21 offset:13824
    v_mfma_f32_16x16x32_bf16 a[76:79], v[60:63], v[52:55], a[76:79]
    ds_read_b64_tr_b16 v[104:105], v24 offset:12288
    v_mfma_f32_16x16x32_bf16 a[8:11], v[64:67], v[40:43], a[8:11]
    ds_read_b64_tr_b16 v[106:107], v24 offset:13824
    v_mfma_f32_16x16x32_bf16 a[32:35], v[64:67], v[44:47], a[32:35]
    ds_read_b64_tr_b16 v[108:109], v27 offset:12288
    v_mfma_f32_16x16x32_bf16 a[56:59], v[64:67], v[48:51], a[56:59]
    ds_read_b64_tr_b16 v[110:111], v27 offset:13824
    v_mfma_f32_16x16x32_bf16 a[80:83], v[64:67], v[52:55], a[80:83]
    ds_read_b64_tr_b16 v[112:113], v18 offset:12416
    v_mfma_f32_16x16x32_bf16 a[12:15], v[68:71], v[40:43], a[12:15]
    ds_read_b64_tr_b16 v[114:115], v18 offset:13952
    v_mfma_f32_16x16x32_bf16 a[36:39], v[68:71], v[44:47], a[36:39]
    ds_read_b64_tr_b16 v[116:117], v21 offset:12416
    v_mfma_f32_16x16x32_bf16 a[60:63], v[68:71], v[48:51], a[60:63]
    ds_read_b64_tr_b16 v[118:119], v21 offset:13952
    v_mfma_f32_16x16x32_bf16 a[84:87], v[68:71], v[52:55], a[84:87]
    v_mfma_f32_16x16x32_bf16 a[16:19], v[72:75], v[40:43], a[16:19]
    v_mfma_f32_16x16x32_bf16 a[40:43], v[72:75], v[44:47], a[40:43]
    v_mfma_f32_16x16x32_bf16 a[64:67], v[72:75], v[48:51], a[64:67]
    v_mfma_f32_16x16x32_bf16 a[88:91], v[72:75], v[52:55], a[88:91]
    v_mfma_f32_16x16x32_bf16 a[20:23], v[76:79], v[40:43], a[20:23]
    v_mfma_f32_16x16x32_bf16 a[44:47], v[76:79], v[44:47], a[44:47]
    v_mfma_f32_16x16x32_bf16 a[68:71], v[76:79], v[48:51], a[68:71]
    v_mfma_f32_16x16x32_bf16 a[92:95], v[76:79], v[52:55], a[92:95]
    s_waitcnt lgkmcnt(0)
    v_mfma_f32_16x16x32_bf16 a[0:3], v[96:99], v[80:83], a[0:3]
    v_mfma_f32_16x16x32_bf16 a[24:27], v[96:99], v[84:87], a[24:27]
    v_mfma_f32_16x16x32_bf16 a[48:51], v[96:99], v[88:91], a[48:51]
    v_mfma_f32_16x16x32_bf16 a[72:75], v[96:99], v[92:95], a[72:75]
    v_mfma_f32_16x16x32_bf16 a[4:7], v[100:103], v[80:83], a[4:7]
    v_mfma_f32_16x16x32_bf16 a[28:31], v[100:103], v[84:87], a[28:31]
    v_mfma_f32_16x16x32_bf16 a[52:55], v[100:103], v[88:91], a[52:55]
    v_mfma_f32_16x16x32_bf16 a[76:79], v[100:103], v[92:95], a[76:79]
    v_mfma_f32_16x16x32_bf16 a[8:11], v[104:107], v[80:83], a[8:11]
    v_mfma_f32_16x16x32_bf16 a[32:35], v[104:107], v[84:87], a[32:35]
    v_mfma_f32_16x16x32_bf16 a[56:59], v[104:107], v[88:91], a[56:59]
    v_mfma_f32_16x16x32_bf16 a[80:83], v[104:107], v[92:95], a[80:83]
    v_mfma_f32_16x16x32_bf16 a[12:15], v[108:111], v[80:83], a[12:15]
    v_mfma_f32_16x16x32_bf16 a[36:39], v[108:111], v[84:87], a[36:39]
    v_mfma_f32_16x16x32_bf16 a[60:63], v[108:111], v[88:91], a[60:63]
    v_mfma_f32_16x16x32_bf16 a[84:87], v[108:111], v[92:95], a[84:87]
    v_mfma_f32_16x16x32_bf16 a[16:19], v[112:115], v[80:83], a[16:19]
    v_mfma_f32_16x16x32_bf16 a[40:43], v[112:115], v[84:87], a[40:43]
    v_mfma_f32_16x16x32_bf16 a[64:67], v[112:115], v[88:91], a[64:67]
    v_mfma_f32_16x16x32_bf16 a[88:91], v[112:115], v[92:95], a[88:91]
    v_mfma_f32_16x16x32_bf16 a[20:23], v[116:119], v[80:83], a[20:23]
    v_mfma_f32_16x16x32_bf16 a[44:47], v[116:119], v[84:87], a[44:47]
    v_mfma_f32_16x16x32_bf16 a[68:71], v[116:119], v[88:91], a[68:71]
    v_mfma_f32_16x16x32_bf16 a[92:95], v[116:119], v[92:95], a[92:95]
    s_nop 7
    s_nop 7
    s_barrier
    v_and_b32 v30, 15, v0
    v_lshrrev_b32 v31, 4, v0
    s_mul_i32 s30, s26, 64
    v_add_u32 v30, s30, v30
    v_mul_u32_u24 v30, 784, v30
    s_mul_i32 s30, s27, 384
    v_lshl_add_u32 v30, v31, 4, v30
    v_add_u32 v32, s30, v30
    v_accvgpr_read_b32 v40, a0
    v_accvgpr_read_b32 v41, a1
    v_accvgpr_read_b32 v42, a2
    v_accvgpr_read_b32 v43, a3
    ds_write_b128 v32, v[40:43] offset:0
    v_accvgpr_read_b32 v56, a4
    v_accvgpr_read_b32 v57, a5
    v_accvgpr_read_b32 v58, a6
    v_accvgpr_read_b32 v59, a7
    ds_write_b128 v32, v[56:59] offset:64
    v_accvgpr_read_b32 v40, a8
    v_accvgpr_read_b32 v41, a9
    v_accvgpr_read_b32 v42, a10
    v_accvgpr_read_b32 v43, a11
    ds_write_b128 v32, v[40:43] offset:128
    v_accvgpr_read_b32 v56, a12
    v_accvgpr_read_b32 v57, a13
    v_accvgpr_read_b32 v58, a14
    v_accvgpr_read_b32 v59, a15
    ds_write_b128 v32, v[56:59] offset:192
    v_accvgpr_read_b32 v40, a16
    v_accvgpr_read_b32 v41, a17
    v_accvgpr_read_b32 v42, a18
    v_accvgpr_read_b32 v43, a19
    ds_write_b128 v32, v[40:43] offset:256
    v_accvgpr_read_b32 v56, a20
    v_accvgpr_read_b32 v57, a21
    v_accvgpr_read_b32 v58, a22
    v_accvgpr_read_b32 v59, a23
    ds_write_b128 v32, v[56:59] offset:320
    v_accvgpr_read_b32 v40, a24
    v_accvgpr_read_b32 v41, a25
    v_accvgpr_read_b32 v42, a26
    v_accvgpr_read_b32 v43, a27
    ds_write_b128 v32, v[40:43] offset:12544
    v_accvgpr_read_b32 v56, a28
    v_accvgpr_read_b32 v57, a29
    v_accvgpr_read_b32 v58, a30
    v_accvgpr_read_b32 v59, a31
    ds_write_b128 v32, v[56:59] offset:12608
    v_accvgpr_read_b32 v40, a32
    v_accvgpr_read_b32 v41, a33
    v_accvgpr_read_b32 v42, a34
    v_accvgpr_read_b32 v43, a35
    ds_write_b128 v32, v[40:43] offset:12672
    v_accvgpr_read_b32 v56, a36
    v_accvgpr_read_b32 v57, a37
    v_accvgpr_read_b32 v58, a38
    v_accvgpr_read_b32 v59, a39
    ds_write_b128 v32, v[56:59] offset:12736
    v_accvgpr_read_b32 v40, a40
    v_accvgpr_read_b32 v41, a41
    v_accvgpr_read_b32 v42, a42
    v_accvgpr_read_b32 v43, a43
    ds_write_b128 v32, v[40:43] offset:12800
    v_accvgpr_read_b32 v56, a44
    v_accvgpr_read_b32 v57, a45
    v_accvgpr_read_b32 v58, a46
    v_accvgpr_read_b32 v59, a47
    ds_write_b128 v32, v[56:59] offset:12864
    v_accvgpr_read_b32 v40, a48
    v_accvgpr_read_b32 v41, a49
    v_accvgpr_read_b32 v42, a50
    v_accvgpr_read_b32 v43, a51
    ds_write_b128 v32, v[40:43] offset:25088
    v_accvgpr_read_b32 v56, a52
    v_accvgpr_read_b32 v57, a53
    v_accvgpr_read_b32 v58, a54
    v_accvgpr_read_b32 v59, a55
    ds_write_b128 v32, v[56:59] offset:25152
    v_accvgpr_read_b32 v40, a56
    v_accvgpr_read_b32 v41, a57
    v_accvgpr_read_b32 v42, a58
    v_accvgpr_read_b32 v43, a59
    ds_write_b128 v32, v[40:43] offset:25216
    v_accvgpr_read_b32 v56, a60
    v_accvgpr_read_b32 v57, a61
    v_accvgpr_read_b32 v58, a62
    v_accvgpr_read_b32 v59, a63
    ds_write_b128 v32, v[56:59] offset:25280
    v_accvgpr_read_b32 v40, a64
    v_accvgpr_read_b32 v41, a65
    v_accvgpr_read_b32 v42, a66
    v_accvgpr_read_b32 v43, a67
    ds_write_b128 v32, v[40:43] offset:25344
    v_accvgpr_read_b32 v56, a68
    v_accvgpr_read_b32 v57, a69
    v_accvgpr_read_b32 v58, a70
    v_accvgpr_read_b32 v59, a71
    ds_write_b128 v32, v[56:59] offset:25408
    v_accvgpr_read_b32 v40, a72
    v_accvgpr_read_b32 v41, a73
    v_accvgpr_read_b32 v42, a74
    v_accvgpr_read_b32 v43, a75
    ds_write_b128 v32, v[40:43] offset:37632
    v_accvgpr_read_b32 v56, a76
    v_accvgpr_read_b32 v57, a77
    v_accvgpr_read_b32 v58, a78
    v_accvgpr_read_b32 v59, a79
    ds_write_b128 v32, v[56:59] offset:37696
    v_accvgpr_read_b32 v40, a80
    v_accvgpr_read_b32 v41, a81
    v_accvgpr_read_b32 v42, a82
    v_accvgpr_read_b32 v43, a83
    ds_write_b128 v32, v[40:43] offset:37760
    v_accvgpr_read_b32 v56, a84
    v_accvgpr_read_b32 v57, a85
    v_accvgpr_read_b32 v58, a86
    v_accvgpr_read_b32 v59, a87
    ds_write_b128 v32, v[56:59] offset:37824
    v_accvgpr_read_b32 v40, a88
    v_accvgpr_read_b32 v41, a89
    v_accvgpr_read_b32 v42, a90
    v_accvgpr_read_b32 v43, a91
    ds_write_b128 v32, v[40:43] offset:37888
    v_accvgpr_read_b32 v56, a92
    v_accvgpr_read_b32 v57, a93
    v_accvgpr_read_b32 v58, a94
    v_accvgpr_read_b32 v59, a95
    ds_write_b128 v32, v[56:59] offset:37952
    s_waitcnt lgkmcnt(0)
    s_barrier
    s_lshl_b32 s30, s31, 6
    v_add_u32 v33, s30, v0
    v_add_u32 v30, 0, v33
    s_mov_b32 s30, 43691
    v_mul_lo_u32 v31, v30, s30
    v_lshrrev_b32 v31, 20, v31
    v_mul_u32_u24 v32, 24, v31
    v_sub_u32 v32, v30, v32
    v_mul_u32_u24 v30, 784, v31
    v_lshl_add_u32 v30, v32, 5, v30
    ds_read_b128 v[40:43], v30
    ds_read_b128 v[44:47], v30 offset:16
    v_add_u32 v31, s24, v31
    s_mov_b32 s30, 6144
    v_mul_lo_u32 v31, v31, s30
    v_lshl_add_u32 v31, v32, 4, v31
    s_lshl_b32 s30, s25, 1
    v_add_u32 v52, s30, v31
    v_add_u32 v30, 256, v33
    s_mov_b32 s30, 43691
    v_mul_lo_u32 v31, v30, s30
    v_lshrrev_b32 v31, 20, v31
    v_mul_u32_u24 v32, 24, v31
    v_sub_u32 v32, v30, v32
    v_mul_u32_u24 v30, 784, v31
    v_lshl_add_u32 v30, v32, 5, v30
    ds_read_b128 v[56:59], v30
    ds_read_b128 v[60:63], v30 offset:16
    v_add_u32 v31, s24, v31
    s_mov_b32 s30, 6144
    v_mul_lo_u32 v31, v31, s30
    v_lshl_add_u32 v31, v32, 4, v31
    s_lshl_b32 s30, s25, 1
    v_add_u32 v68, s30, v31
    v_add_u32 v30, 512, v33
    s_mov_b32 s30, 43691
    v_mul_lo_u32 v31, v30, s30
    v_lshrrev_b32 v31, 20, v31
    v_mul_u32_u24 v32, 24, v31
    v_sub_u32 v32, v30, v32
    v_mul_u32_u24 v30, 784, v31
    v_lshl_add_u32 v30, v32, 5, v30
    ds_read_b128 v[72:75], v30
    ds_read_b128 v[76:79], v30 offset:16
    v_add_u32 v31, s24, v31
    s_mov_b32 s30, 6144
    v_mul_lo_u32 v31, v31, s30
    v_lshl_add_u32 v31, v32, 4, v31
    s_lshl_b32 s30, s25, 1
    v_add_u32 v84, s30, v31
    v_add_u32 v30, 768, v33
    s_mov_b32 s30, 43691
    v_mul_lo_u32 v31, v30, s30
    v_lshrrev_b32 v31, 20, v31
    v_mul_u32_u24 v32, 24, v31
    v_sub_u32 v32, v30, v32
    v_mul_u32_u24 v30, 784, v31
    v_lshl_add_u32 v30, v32, 5, v30
    ds_read_b128 v[88:91], v30
    ds_read_b128 v[92:95], v30 offset:16
    v_add_u32 v31, s24, v31
    s_mov_b32 s30, 6144
    v_mul_lo_u32 v31, v31, s30
    v_lshl_add_u32 v31, v32, 4, v31
    s_lshl_b32 s30, s25, 1
    v_add_u32 v100, s30, v31
    s_waitcnt vmcnt(0) lgkmcnt(0)
    v_cvt_pk_bf16_f32 v48, v40, v41
    v_cvt_pk_bf16_f32 v49, v42, v43
    v_cvt_pk_bf16_f32 v50, v44, v45
    v_cvt_pk_bf16_f32 v51, v46, v47
    buffer_store_dwordx4 v[48:51], v52, s[16:19], 0 offen
    v_cvt_pk_bf16_f32 v64, v56, v57
    v_cvt_pk_bf16_f32 v65, v58, v59
    v_cvt_pk_bf16_f32 v66, v60, v61
    v_cvt_pk_bf16_f32 v67, v62, v63
    buffer_store_dwordx4 v[64:67], v68, s[16:19], 0 offen
    v_cvt_pk_bf16_f32 v80, v72, v73
    v_cvt_pk_bf16_f32 v81, v74, v75
    v_cvt_pk_bf16_f32 v82, v76, v77
    v_cvt_pk_bf16_f32 v83, v78, v79
    buffer_store_dwordx4 v[80:83], v84, s[16:19], 0 offen
    v_cvt_pk_bf16_f32 v96, v88, v89
    v_cvt_pk_bf16_f32 v97, v90, v91
    v_cvt_pk_bf16_f32 v98, v92, v93
    v_cvt_pk_bf16_f32 v99, v94, v95
    buffer_store_dwordx4 v[96:99], v100, s[16:19], 0 offen
    s_nop 1
    v_add_u32 v30, 1024, v33
    s_mov_b32 s30, 43691
    v_mul_lo_u32 v31, v30, s30
    v_lshrrev_b32 v31, 20, v31
    v_mul_u32_u24 v32, 24, v31
    v_sub_u32 v32, v30, v32
    v_mul_u32_u24 v30, 784, v31
    v_lshl_add_u32 v30, v32, 5, v30
    ds_read_b128 v[40:43], v30
    ds_read_b128 v[44:47], v30 offset:16
    v_add_u32 v31, s24, v31
    s_mov_b32 s30, 6144
    v_mul_lo_u32 v31, v31, s30
    v_lshl_add_u32 v31, v32, 4, v31
    s_lshl_b32 s30, s25, 1
    v_add_u32 v52, s30, v31
    v_add_u32 v30, 1280, v33
    s_mov_b32 s30, 43691
    v_mul_lo_u32 v31, v30, s30
    v_lshrrev_b32 v31, 20, v31
    v_mul_u32_u24 v32, 24, v31
    v_sub_u32 v32, v30, v32
    v_mul_u32_u24 v30, 784, v31
    v_lshl_add_u32 v30, v32, 5, v30
    ds_read_b128 v[56:59], v30
    ds_read_b128 v[60:63], v30 offset:16
    v_add_u32 v31, s24, v31
    s_mov_b32 s30, 6144
    v_mul_lo_u32 v31, v31, s30
    v_lshl_add_u32 v31, v32, 4, v31
    s_lshl_b32 s30, s25, 1
    v_add_u32 v68, s30, v31
    v_add_u32 v30, 1536, v33
    s_mov_b32 s30, 43691
    v_mul_lo_u32 v31, v30, s30
    v_lshrrev_b32 v31, 20, v31
    v_mul_u32_u24 v32, 24, v31
    v_sub_u32 v32, v30, v32
    v_mul_u32_u24 v30, 784, v31
    v_lshl_add_u32 v30, v32, 5, v30
    ds_read_b128 v[72:75], v30
    ds_read_b128 v[76:79], v30 offset:16
    v_add_u32 v31, s24, v31
    s_mov_b32 s30, 6144
    v_mul_lo_u32 v31, v31, s30
    v_lshl_add_u32 v31, v32, 4, v31
    s_lshl_b32 s30, s25, 1
    v_add_u32 v84, s30, v31
    v_add_u32 v30, 1792, v33
    s_mov_b32 s30, 43691
    v_mul_lo_u32 v31, v30, s30
    v_lshrrev_b32 v31, 20, v31
    v_mul_u32_u24 v32, 24, v31
    v_sub_u32 v32, v30, v32
    v_mul_u32_u24 v30, 784, v31
    v_lshl_add_u32 v30, v32, 5, v30
    ds_read_b128 v[88:91], v30
    ds_read_b128 v[92:95], v30 offset:16
    v_add_u32 v31, s24, v31
    s_mov_b32 s30, 6144
    v_mul_lo_u32 v31, v31, s30
    v_lshl_add_u32 v31, v32, 4, v31
    s_lshl_b32 s30, s25, 1
    v_add_u32 v100, s30, v31
    s_waitcnt vmcnt(0) lgkmcnt(0)
    v_cvt_pk_bf16_f32 v48, v40, v41
    v_cvt_pk_bf16_f32 v49, v42, v43
    v_cvt_pk_bf16_f32 v50, v44, v45
    v_cvt_pk_bf16_f32 v51, v46, v47
    buffer_store_dwordx4 v[48:51], v52, s[16:19], 0 offen
    v_cvt_pk_bf16_f32 v64, v56, v57
    v_cvt_pk_bf16_f32 v65, v58, v59
    v_cvt_pk_bf16_f32 v66, v60, v61
    v_cvt_pk_bf16_f32 v67, v62, v63
    buffer_store_dwordx4 v[64:67], v68, s[16:19], 0 offen
    v_cvt_pk_bf16_f32 v80, v72, v73
    v_cvt_pk_bf16_f32 v81, v74, v75
    v_cvt_pk_bf16_f32 v82, v76, v77
    v_cvt_pk_bf16_f32 v83, v78, v79
    buffer_store_dwordx4 v[80:83], v84, s[16:19], 0 offen
    v_cvt_pk_bf16_f32 v96, v88, v89
    v_cvt_pk_bf16_f32 v97, v90, v91
    v_cvt_pk_bf16_f32 v98, v92, v93
    v_cvt_pk_bf16_f32 v99, v94, v95
    buffer_store_dwordx4 v[96:99], v100, s[16:19], 0 offen
    s_nop 1
    v_add_u32 v30, 2048, v33
    s_mov_b32 s30, 43691
    v_mul_lo_u32 v31, v30, s30
    v_lshrrev_b32 v31, 20, v31
    v_mul_u32_u24 v32, 24, v31
    v_sub_u32 v32, v30, v32
    v_mul_u32_u24 v30, 784, v31
    v_lshl_add_u32 v30, v32, 5, v30
    ds_read_b128 v[40:43], v30
    ds_read_b128 v[44:47], v30 offset:16
    v_add_u32 v31, s24, v31
    s_mov_b32 s30, 6144
    v_mul_lo_u32 v31, v31, s30
    v_lshl_add_u32 v31, v32, 4, v31
    s_lshl_b32 s30, s25, 1
    v_add_u32 v52, s30, v31
    v_add_u32 v30, 2304, v33
    s_mov_b32 s30, 43691
    v_mul_lo_u32 v31, v30, s30
    v_lshrrev_b32 v31, 20, v31
    v_mul_u32_u24 v32, 24, v31
    v_sub_u32 v32, v30, v32
    v_mul_u32_u24 v30, 784, v31
    v_lshl_add_u32 v30, v32, 5, v30
    ds_read_b128 v[56:59], v30
    ds_read_b128 v[60:63], v30 offset:16
    v_add_u32 v31, s24, v31
    s_mov_b32 s30, 6144
    v_mul_lo_u32 v31, v31, s30
    v_lshl_add_u32 v31, v32, 4, v31
    s_lshl_b32 s30, s25, 1
    v_add_u32 v68, s30, v31
    v_add_u32 v30, 2560, v33
    s_mov_b32 s30, 43691
    v_mul_lo_u32 v31, v30, s30
    v_lshrrev_b32 v31, 20, v31
    v_mul_u32_u24 v32, 24, v31
    v_sub_u32 v32, v30, v32
    v_mul_u32_u24 v30, 784, v31
    v_lshl_add_u32 v30, v32, 5, v30
    ds_read_b128 v[72:75], v30
    ds_read_b128 v[76:79], v30 offset:16
    v_add_u32 v31, s24, v31
    s_mov_b32 s30, 6144
    v_mul_lo_u32 v31, v31, s30
    v_lshl_add_u32 v31, v32, 4, v31
    s_lshl_b32 s30, s25, 1
    v_add_u32 v84, s30, v31
    v_add_u32 v30, 2816, v33
    s_mov_b32 s30, 43691
    v_mul_lo_u32 v31, v30, s30
    v_lshrrev_b32 v31, 20, v31
    v_mul_u32_u24 v32, 24, v31
    v_sub_u32 v32, v30, v32
    v_mul_u32_u24 v30, 784, v31
    v_lshl_add_u32 v30, v32, 5, v30
    ds_read_b128 v[88:91], v30
    ds_read_b128 v[92:95], v30 offset:16
    v_add_u32 v31, s24, v31
    s_mov_b32 s30, 6144
    v_mul_lo_u32 v31, v31, s30
    v_lshl_add_u32 v31, v32, 4, v31
    s_lshl_b32 s30, s25, 1
    v_add_u32 v100, s30, v31
    s_waitcnt vmcnt(0) lgkmcnt(0)
    v_cvt_pk_bf16_f32 v48, v40, v41
    v_cvt_pk_bf16_f32 v49, v42, v43
    v_cvt_pk_bf16_f32 v50, v44, v45
    v_cvt_pk_bf16_f32 v51, v46, v47
    buffer_store_dwordx4 v[48:51], v52, s[16:19], 0 offen
    v_cvt_pk_bf16_f32 v64, v56, v57
    v_cvt_pk_bf16_f32 v65, v58, v59
    v_cvt_pk_bf16_f32 v66, v60, v61
    v_cvt_pk_bf16_f32 v67, v62, v63
    buffer_store_dwordx4 v[64:67], v68, s[16:19], 0 offen
    v_cvt_pk_bf16_f32 v80, v72, v73
    v_cvt_pk_bf16_f32 v81, v74, v75
    v_cvt_pk_bf16_f32 v82, v76, v77
    v_cvt_pk_bf16_f32 v83, v78, v79
    buffer_store_dwordx4 v[80:83], v84, s[16:19], 0 offen
    v_cvt_pk_bf16_f32 v96, v88, v89
    v_cvt_pk_bf16_f32 v97, v90, v91
    v_cvt_pk_bf16_f32 v98, v92, v93
    v_cvt_pk_bf16_f32 v99, v94, v95
    buffer_store_dwordx4 v[96:99], v100, s[16:19], 0 offen
    s_nop 1
L_qkv_kernel_end:
    s_endpgm
.section .rodata,"a"
.p2align 6
.amdhsa_kernel qkv_kernel
  .amdhsa_next_free_vgpr 216
  .amdhsa_next_free_sgpr 102
  .amdhsa_accum_offset 120
  .amdhsa_group_segment_fixed_size 0
  .amdhsa_kernarg_size 80
  .amdhsa_user_sgpr_count 2
  .amdhsa_user_sgpr_kernarg_segment_ptr 1
  .amdhsa_system_sgpr_workgroup_id_x 1
.end_amdhsa_kernel
.text
.globl attn_kernel
.p2align 8
.type attn_kernel,@function
attn_kernel:
    s_cmp_ge_u32 s2, 512
    s_cbranch_scc1 L_attn_kernel_end
    s_load_dwordx2 s[4:5], s[0:1], 72
    s_load_dwordx2 s[8:9], s[0:1], 72
    v_lshrrev_b32 v1, 6, v0
    s_nop 0
    v_readfirstlane_b32 s14, v1
    v_and_b32 v0, 63, v0
    s_lshr_b32 s12, s2, 3
    s_lshl_b32 s12, s12, 5
    s_and_b32 s13, s2, 7
    s_lshl_b32 s13, s13, 2
    s_nop 2
    s_add_u32 s13, s13, s14
    s_waitcnt lgkmcnt(0)
    s_add_u32 s4, s4, 4194304
    s_addc_u32 s5, s5, 0
    s_mov_b32 s6, 12582912
    s_mov_b32 s7, 0x00020000
    s_add_u32 s8, s8, 16777216
    s_addc_u32 s9, s9, 0
    s_mov_b32 s10, 4194304
    s_mov_b32 s11, 0x00020000
    v_and_b32 v1, 31, v0
    v_lshrrev_b32 v2, 5, v0
    s_sub_u32 s15, s12, 256
    v_add_u32 v4, s12, v1
    s_mov_b32 s20, 6144
    v_mul_lo_u32 v4, v4, s20
    s_lshl_b32 s20, s13, 6
    v_lshl_add_u32 v4, v2, 4, v4
    v_add_u32 v4, s20, v4
    buffer_load_dwordx4 v[12:15], v4, s[4:7], 0 offen
    buffer_load_dwordx4 v[16:19], v4, s[4:7], 0 offen offset:32
    v_add_u32 v6, s15, v1
    s_mov_b32 s23, 6144
    s_lshl_b32 s20, s13, 6
    s_add_u32 s20, s20, 2048
    v_lshlrev_b32 v10, 4, v2
    v_add_u32 v10, s20, v10
    v_add_u32 v5, 0, v6
    v_max_i32 v5, 0, v5
    v_mul_lo_u32 v5, v5, s23
    v_add_u32 v5, v5, v10
    buffer_load_dwordx4 v[80:83], v5, s[4:7], 0 offen
    buffer_load_dwordx4 v[84:87], v5, s[4:7], 0 offen offset:32
    v_add_u32 v5, 32, v6
    v_max_i32 v5, 0, v5
    v_mul_lo_u32 v5, v5, s23
    v_add_u32 v5, v5, v10
    buffer_load_dwordx4 v[96:99], v5, s[4:7], 0 offen
    buffer_load_dwordx4 v[100:103], v5, s[4:7], 0 offen offset:32
    v_add_u32 v5, 64, v6
    v_max_i32 v5, 0, v5
    v_mul_lo_u32 v5, v5, s23
    v_add_u32 v5, v5, v10
    buffer_load_dwordx4 v[112:115], v5, s[4:7], 0 offen
    buffer_load_dwordx4 v[116:119], v5, s[4:7], 0 offen offset:32
    v_add_u32 v5, 96, v6
    v_max_i32 v5, 0, v5
    v_mul_lo_u32 v5, v5, s23
    v_add_u32 v5, v5, v10
    buffer_load_dwordx4 v[128:131], v5, s[4:7], 0 offen
    buffer_load_dwordx4 v[132:135], v5, s[4:7], 0 offen offset:32
    v_add_u32 v5, 128, v6
    v_max_i32 v5, 0, v5
    v_mul_lo_u32 v5, v5, s23
    v_add_u32 v5, v5, v10
    buffer_load_dwordx4 v[144:147], v5, s[4:7], 0 offen
    buffer_load_dwordx4 v[148:151], v5, s[4:7], 0 offen offset:32
    v_add_u32 v5, 160, v6
    v_max_i32 v5, 0, v5
    v_mul_lo_u32 v5, v5, s23
    v_add_u32 v5, v5, v10
    buffer_load_dwordx4 v[160:163], v5, s[4:7], 0 offen
    buffer_load_dwordx4 v[164:167], v5, s[4:7], 0 offen offset:32
    v_add_u32 v5, 192, v6
    v_max_i32 v5, 0, v5
    v_mul_lo_u32 v5, v5, s23
    v_add_u32 v5, v5, v10
    buffer_load_dwordx4 v[176:179], v5, s[4:7], 0 offen
    buffer_load_dwordx4 v[180:183], v5, s[4:7], 0 offen offset:32
    v_add_u32 v5, 224, v6
    v_max_i32 v5, 0, v5
    v_mul_lo_u32 v5, v5, s23
    v_add_u32 v5, v5, v10
    buffer_load_dwordx4 v[192:195], v5, s[4:7], 0 offen
    buffer_load_dwordx4 v[196:199], v5, s[4:7], 0 offen offset:32
    v_add_u32 v5, 256, v6
    v_max_i32 v5, 0, v5
    v_mul_lo_u32 v5, v5, s23
    v_add_u32 v5, v5, v10
    buffer_load_dwordx4 v[20:23], v5, s[4:7], 0 offen
    buffer_load_dwordx4 v[24:27], v5, s[4:7], 0 offen offset:32
    v_lshrrev_b32 v3, 2, v0
    v_add_u32 v3, s15, v3
    v_and_b32 v4, 3, v0
    v_lshlrev_b32 v4, 4, v4
    s_lshl_b32 s20, s13, 6
    s_add_u32 s20, s20, 4096
    v_add_u32 v4, s20, v4
    s_mov_b32 s20, 6144
    s_mul_i32 s21, s14, 18432
    s_add_u32 m0, s21, 0
    v_add_u32 v5, 0, v3
    v_max_i32 v5, 0, v5
    v_mul_lo_u32 v5, v5, s20
    v_add_u32 v5, v5, v4
    buffer_load_dwordx4 v5, s[4:7], 0 offen lds
    s_add_u32 m0, s21, 1024
    v_add_u32 v5, 16, v3
    v_max_i32 v5, 0, v5
    v_mul_lo_u32 v5, v5, s20
    v_add_u32 v5, v5, v4
    buffer_load_dwordx4 v5, s[4:7], 0 offen lds
    s_add_u32 m0, s21, 2048
    v_add_u32 v5, 32, v3
    v_max_i32 v5, 0, v5
    v_mul_lo_u32 v5, v5, s20
    v_add_u32 v5, v5, v4
    buffer_load_dwordx4 v5, s[4:7], 0 offen lds
    s_add_u32 m0, s21, 3072
    v_add_u32 v5, 48, v3
    v_max_i32 v5, 0, v5
    v_mul_lo_u32 v5, v5, s20
    v_add_u32 v5, v5, v4
    buffer_load_dwordx4 v5, s[4:7], 0 offen lds
    s_add_u32 m0, s21, 4096
    v_add_u32 v5, 64, v3
    v_max_i32 v5, 0, v5
    v_mul_lo_u32 v5, v5, s20
    v_add_u32 v5, v5, v4
    buffer_load_dwordx4 v5, s[4:7], 0 offen lds
    s_add_u32 m0, s21, 5120
    v_add_u32 v5, 80, v3
    v_max_i32 v5, 0, v5
    v_mul_lo_u32 v5, v5, s20
    v_add_u32 v5, v5, v4
    buffer_load_dwordx4 v5, s[4:7], 0 offen lds
    s_add_u32 m0, s21, 6144
    v_add_u32 v5, 96, v3
    v_max_i32 v5, 0, v5
    v_mul_lo_u32 v5, v5, s20
    v_add_u32 v5, v5, v4
    buffer_load_dwordx4 v5, s[4:7], 0 offen lds
    s_add_u32 m0, s21, 7168
    v_add_u32 v5, 112, v3
    v_max_i32 v5, 0, v5
    v_mul_lo_u32 v5, v5, s20
    v_add_u32 v5, v5, v4
    buffer_load_dwordx4 v5, s[4:7], 0 offen lds
    s_add_u32 m0, s21, 8192
    v_add_u32 v5, 128, v3
    v_max_i32 v5, 0, v5
    v_mul_lo_u32 v5, v5, s20
    v_add_u32 v5, v5, v4
    buffer_load_dwordx4 v5, s[4:7], 0 offen lds
    s_add_u32 m0, s21, 9216
    v_add_u32 v5, 144, v3
    v_max_i32 v5, 0, v5
    v_mul_lo_u32 v5, v5, s20
    v_add_u32 v5, v5, v4
    buffer_load_dwordx4 v5, s[4:7], 0 offen lds
    s_add_u32 m0, s21, 10240
    v_add_u32 v5, 160, v3
    v_max_i32 v5, 0, v5
    v_mul_lo_u32 v5, v5, s20
    v_add_u32 v5, v5, v4
    buffer_load_dwordx4 v5, s[4:7], 0 offen lds
    s_add_u32 m0, s21, 11264
    v_add_u32 v5, 176, v3
    v_max_i32 v5, 0, v5
    v_mul_lo_u32 v5, v5, s20
    v_add_u32 v5, v5, v4
    buffer_load_dwordx4 v5, s[4:7], 0 offen lds
    s_add_u32 m0, s21, 12288
    v_add_u32 v5, 192, v3
    v_max_i32 v5, 0, v5
    v_mul_lo_u32 v5, v5, s20
    v_add_u32 v5, v5, v4
    buffer_load_dwordx4 v5, s[4:7], 0 offen lds
    s_add_u32 m0, s21, 13312
    v_add_u32 v5, 208, v3
    v_max_i32 v5, 0, v5
    v_mul_lo_u32 v5, v5, s20
    v_add_u32 v5, v5, v4
    buffer_load_dwordx4 v5, s[4:7], 0 offen lds
    s_add_u32 m0, s21, 14336
    v_add_u32 v5, 224, v3
    v_max_i32 v5, 0, v5
    v_mul_lo_u32 v5, v5, s20
    v_add_u32 v5, v5, v4
    buffer_load_dwordx4 v5, s[4:7], 0 offen lds
    s_add_u32 m0, s21, 15360
    v_add_u32 v5, 240, v3
    v_max_i32 v5, 0, v5
    v_mul_lo_u32 v5, v5, s20
    v_add_u32 v5, v5, v4
    buffer_load_dwordx4 v5, s[4:7], 0 offen lds
    s_add_u32 m0, s21, 16384
    v_add_u32 v5, 256, v3
    v_max_i32 v5, 0, v5
    v_mul_lo_u32 v5, v5, s20
    v_add_u32 v5, v5, v4
    buffer_load_dwordx4 v5, s[4:7], 0 offen lds
    s_add_u32 m0, s21, 17408
    v_add_u32 v5, 272, v3
    v_max_i32 v5, 0, v5
    v_mul_lo_u32 v5, v5, s20
    v_add_u32 v5, v5, v4
    buffer_load_dwordx4 v5, s[4:7], 0 offen lds
    v_mov_b32 v64, 0
    v_mov_b32 v65, 0
    v_mov_b32 v66, 0
    v_mov_b32 v67, 0
    v_mov_b32 v68, 0
    v_mov_b32 v69, 0
    v_mov_b32 v70, 0
    v_mov_b32 v71, 0
    v_mov_b32 v72, 0
    v_mov_b32 v73, 0
    v_mov_b32 v74, 0
    v_mov_b32 v75, 0
    v_mov_b32 v76, 0
    v_mov_b32 v77, 0
    v_mov_b32 v78, 0
    v_mov_b32 v79, 0
    s_waitcnt vmcnt(34)
    v_mfma_f32_32x32x16_bf16 v[64:79], v[80:83], v[12:15], v[64:79]
    v_mfma_f32_32x32x16_bf16 v[64:79], v[84:87], v[16:19], v[64:79]
    v_mov_b32 v80, 0
    v_mov_b32 v81, 0
    v_mov_b32 v82, 0
    v_mov_b32 v83, 0
    v_mov_b32 v84, 0
    v_mov_b32 v85, 0
    v_mov_b32 v86, 0
    v_mov_b32 v87, 0
    v_mov_b32 v88, 0
    v_mov_b32 v89, 0
    v_mov_b32 v90, 0
    v_mov_b32 v91, 0
    v_mov_b32 v92, 0
    v_mov_b32 v93, 0
    v_mov_b32 v94, 0
    v_mov_b32 v95, 0
    s_waitcnt vmcnt(32)
    v_mfma_f32_32x32x16_bf16 v[80:95], v[96:99], v[12:15], v[80:95]
    v_mfma_f32_32x32x16_bf16 v[80:95], v[100:103], v[16:19], v[80:95]
    v_mov_b32 v96, 0
    v_mov_b32 v97, 0
    v_mov_b32 v98, 0
    v_mov_b32 v99, 0
    v_mov_b32 v100, 0
    v_mov_b32 v101, 0
    v_mov_b32 v102, 0
    v_mov_b32 v103, 0
    v_mov_b32 v104, 0
    v_mov_b32 v105, 0
    v_mov_b32 v106, 0
    v_mov_b32 v107, 0
    v_mov_b32 v108, 0
    v_mov_b32 v109, 0
    v_mov_b32 v110, 0
    v_mov_b32 v111, 0
    s_waitcnt vmcnt(30)
    v_mfma_f32_32x32x16_bf16 v[96:111], v[112:115], v[12:15], v[96:111]
    v_mfma_f32_32x32x16_bf16 v[96:111], v[116:119], v[16:19], v[96:111]
    v_mov_b32 v112, 0
    v_mov_b32 v113, 0
    v_mov_b32 v114, 0
    v_mov_b32 v115, 0
    v_mov_b32 v116, 0
    v_mov_b32 v117, 0
    v_mov_b32 v118, 0
    v_mov_b32 v119, 0
    v_mov_b32 v120, 0
    v_mov_b32 v121, 0
    v_mov_b32 v122, 0
    v_mov_b32 v123, 0
    v_mov_b32 v124, 0
    v_mov_b32 v125, 0
    v_mov_b32 v126, 0
    v_mov_b32 v127, 0
    s_waitcnt vmcnt(28)
    v_mfma_f32_32x32x16_bf16 v[112:127], v[128:131], v[12:15], v[112:127]
    v_mfma_f32_32x32x16_bf16 v[112:127], v[132:135], v[16:19], v[112:127]
    v_mov_b32 v128, 0
    v_mov_b32 v129, 0
    v_mov_b32 v130, 0
    v_mov_b32 v131, 0
    v_mov_b32 v132, 0
    v_mov_b32 v133, 0
    v_mov_b32 v134, 0
    v_mov_b32 v135, 0
    v_mov_b32 v136, 0
    v_mov_b32 v137, 0
    v_mov_b32 v138, 0
    v_mov_b32 v139, 0
    v_mov_b32 v140, 0
    v_mov_b32 v141, 0
    v_mov_b32 v142, 0
    v_mov_b32 v143, 0
    s_waitcnt vmcnt(26)
    v_mfma_f32_32x32x16_bf16 v[128:143], v[144:147], v[12:15], v[128:143]
    v_mfma_f32_32x32x16_bf16 v[128:143], v[148:151], v[16:19], v[128:143]
    v_mov_b32 v144, 0
    v_mov_b32 v145, 0
    v_mov_b32 v146, 0
    v_mov_b32 v147, 0
    v_mov_b32 v148, 0
    v_mov_b32 v149, 0
    v_mov_b32 v150, 0
    v_mov_b32 v151, 0
    v_mov_b32 v152, 0
    v_mov_b32 v153, 0
    v_mov_b32 v154, 0
    v_mov_b32 v155, 0
    v_mov_b32 v156, 0
    v_mov_b32 v157, 0
    v_mov_b32 v158, 0
    v_mov_b32 v159, 0
    s_waitcnt vmcnt(24)
    v_mfma_f32_32x32x16_bf16 v[144:159], v[160:163], v[12:15], v[144:159]
    v_mfma_f32_32x32x16_bf16 v[144:159], v[164:167], v[16:19], v[144:159]
    v_mov_b32 v160, 0
    v_mov_b32 v161, 0
    v_mov_b32 v162, 0
    v_mov_b32 v163, 0
    v_mov_b32 v164, 0
    v_mov_b32 v165, 0
    v_mov_b32 v166, 0
    v_mov_b32 v167, 0
    v_mov_b32 v168, 0
    v_mov_b32 v169, 0
    v_mov_b32 v170, 0
    v_mov_b32 v171, 0
    v_mov_b32 v172, 0
    v_mov_b32 v173, 0
    v_mov_b32 v174, 0
    v_mov_b32 v175, 0
    s_waitcnt vmcnt(22)
    v_mfma_f32_32x32x16_bf16 v[160:175], v[176:179], v[12:15], v[160:175]
    v_mfma_f32_32x32x16_bf16 v[160:175], v[180:183], v[16:19], v[160:175]
    v_mov_b32 v176, 0
    v_mov_b32 v177, 0
    v_mov_b32 v178, 0
    v_mov_b32 v179, 0
    v_mov_b32 v180, 0
    v_mov_b32 v181, 0
    v_mov_b32 v182, 0
    v_mov_b32 v183, 0
    v_mov_b32 v184, 0
    v_mov_b32 v185, 0
    v_mov_b32 v186, 0
    v_mov_b32 v187, 0
    v_mov_b32 v188, 0
    v_mov_b32 v189, 0
    v_mov_b32 v190, 0
    v_mov_b32 v191, 0
    s_waitcnt vmcnt(20)
    v_mfma_f32_32x32x16_bf16 v[176:191], v[192:195], v[12:15], v[176:191]
    v_mfma_f32_32x32x16_bf16 v[176:191], v[196:199], v[16:19], v[176:191]
    v_mov_b32 v192, 0
    v_mov_b32 v193, 0
    v_mov_b32 v194, 0
    v_mov_b32 v195, 0
    v_mov_b32 v196, 0
    v_mov_b32 v197, 0
    v_mov_b32 v198, 0
    v_mov_b32 v199, 0
    v_mov_b32 v200, 0
    v_mov_b32 v201, 0
    v_mov_b32 v202, 0
    v_mov_b32 v203, 0
    v_mov_b32 v204, 0
    v_mov_b32 v205, 0
    v_mov_b32 v206, 0
    v_mov_b32 v207, 0
    s_waitcnt vmcnt(18)
    v_mfma_f32_32x32x16_bf16 v[192:207], v[20:23], v[12:15], v[192:207]
    v_mfma_f32_32x32x16_bf16 v[192:207], v[24:27], v[16:19], v[192:207]
    s_nop 15
    s_nop 3
    v_lshlrev_b32 v3, 2, v2
    v_mov_b32 v5, 0xf149f2ca
    v_add_u32 v4, 0, v3
    v_cmp_gt_u32 vcc, v4, v1
    s_nop 1
    v_cndmask_b32 v64, v5, v64, vcc
    v_cndmask_b32 v192, v192, v5, vcc
    v_add_u32 v4, 1, v3
    v_cmp_gt_u32 vcc, v4, v1
    s_nop 1
    v_cndmask_b32 v65, v5, v65, vcc
    v_cndmask_b32 v193, v193, v5, vcc
    v_add_u32 v4, 2, v3
    v_cmp_gt_u32 vcc, v4, v1
    s_nop 1
    v_cndmask_b32 v66, v5, v66, vcc
    v_cndmask_b32 v194, v194, v5, vcc
    v_add_u32 v4, 3, v3
    v_cmp_gt_u32 vcc, v4, v1
    s_nop 1
    v_cndmask_b32 v67, v5, v67, vcc
    v_cndmask_b32 v195, v195, v5, vcc
    v_add_u32 v4, 8, v3
    v_cmp_gt_u32 vcc, v4, v1
    s_nop 1
    v_cndmask_b32 v68, v5, v68, vcc
    v_cndmask_b32 v196, v196, v5, vcc
    v_add_u32 v4, 9, v3
    v_cmp_gt_u32 vcc, v4, v1
    s_nop 1
    v_cndmask_b32 v69, v5, v69, vcc
    v_cndmask_b32 v197, v197, v5, vcc
    v_add_u32 v4, 10, v3
    v_cmp_gt_u32 vcc, v4, v1
    s_nop 1
    v_cndmask_b32 v70, v5, v70, vcc
    v_cndmask_b32 v198, v198, v5, vcc
    v_add_u32 v4, 11, v3
    v_cmp_gt_u32 vcc, v4, v1
    s_nop 1
    v_cndmask_b32 v71, v5, v71, vcc
    v_cndmask_b32 v199, v199, v5, vcc
    v_add_u32 v4, 16, v3
    v_cmp_gt_u32 vcc, v4, v1
    s_nop 1
    v_cndmask_b32 v72, v5, v72, vcc
    v_cndmask_b32 v200, v200, v5, vcc
    v_add_u32 v4, 17, v3
    v_cmp_gt_u32 vcc, v4, v1
    s_nop 1
    v_cndmask_b32 v73, v5, v73, vcc
    v_cndmask_b32 v201, v201, v5, vcc
    v_add_u32 v4, 18, v3
    v_cmp_gt_u32 vcc, v4, v1
    s_nop 1
    v_cndmask_b32 v74, v5, v74, vcc
    v_cndmask_b32 v202, v202, v5, vcc
    v_add_u32 v4, 19, v3
    v_cmp_gt_u32 vcc, v4, v1
    s_nop 1
    v_cndmask_b32 v75, v5, v75, vcc
    v_cndmask_b32 v203, v203, v5, vcc
    v_add_u32 v4, 24, v3
    v_cmp_gt_u32 vcc, v4, v1
    s_nop 1
    v_cndmask_b32 v76, v5, v76, vcc
    v_cndmask_b32 v204, v204, v5, vcc
    v_add_u32 v4, 25, v3
    v_cmp_gt_u32 vcc, v4, v1
    s_nop 1
    v_cndmask_b32 v77, v5, v77, vcc
    v_cndmask_b32 v205, v205, v5, vcc
    v_add_u32 v4, 26, v3
    v_cmp_gt_u32 vcc, v4, v1
    s_nop 1
    v_cndmask_b32 v78, v5, v78, vcc
    v_cndmask_b32 v206, v206, v5, vcc
    v_add_u32 v4, 27, v3
    v_cmp_gt_u32 vcc, v4, v1
    s_nop 1
    v_cndmask_b32 v79, v5, v79, vcc
    v_cndmask_b32 v207, v207, v5, vcc
    s_cmp_ge_u32 s12, 256
    s_cbranch_scc1 L_attn_kernel_ok0
    v_mov_b32 v64, 0xf149f2ca
    v_mov_b32 v65, 0xf149f2ca
    v_mov_b32 v66, 0xf149f2ca
    v_mov_b32 v67, 0xf149f2ca
    v_mov_b32 v68, 0xf149f2ca
    v_mov_b32 v69, 0xf149f2ca
    v_mov_b32 v70, 0xf149f2ca
    v_mov_b32 v71, 0xf149f2ca
    v_mov_b32 v72, 0xf149f2ca
    v_mov_b32 v73, 0xf149f2ca
    v_mov_b32 v74, 0xf149f2ca
    v_mov_b32 v75, 0xf149f2ca
    v_mov_b32 v76, 0xf149f2ca
    v_mov_b32 v77, 0xf149f2ca
    v_mov_b32 v78, 0xf149f2ca
    v_mov_b32 v79, 0xf149f2ca
L_attn_kernel_ok0:
    s_cmp_ge_u32 s12, 224
    s_cbranch_scc1 L_attn_kernel_ok1
    v_mov_b32 v80, 0xf149f2ca
    v_mov_b32 v81, 0xf149f2ca
    v_mov_b32 v82, 0xf149f2ca
    v_mov_b32 v83, 0xf149f2ca
    v_mov_b32 v84, 0xf149f2ca
    v_mov_b32 v85, 0xf149f2ca
    v_mov_b32 v86, 0xf149f2ca
    v_mov_b32 v87, 0xf149f2ca
    v_mov_b32 v88, 0xf149f2ca
    v_mov_b32 v89, 0xf149f2ca
    v_mov_b32 v90, 0xf149f2ca
    v_mov_b32 v91, 0xf149f2ca
    v_mov_b32 v92, 0xf149f2ca
    v_mov_b32 v93, 0xf149f2ca
    v_mov_b32 v94, 0xf149f2ca
    v_mov_b32 v95, 0xf149f2ca
L_attn_kernel_ok1:
    s_cmp_ge_u32 s12, 192
    s_cbranch_scc1 L_attn_kernel_ok2
    v_mov_b32 v96, 0xf149f2ca
    v_mov_b32 v97, 0xf149f2ca
    v_mov_b32 v98, 0xf149f2ca
    v_mov_b32 v99, 0xf149f2ca
    v_mov_b32 v100, 0xf149f2ca
    v_mov_b32 v101, 0xf149f2ca
    v_mov_b32 v102, 0xf149f2ca
    v_mov_b32 v103, 0xf149f2ca
    v_mov_b32 v104, 0xf149f2ca
    v_mov_b32 v105, 0xf149f2ca
    v_mov_b32 v106, 0xf149f2ca
    v_mov_b32 v107, 0xf149f2ca
    v_mov_b32 v108, 0xf149f2ca
    v_mov_b32 v109, 0xf149f2ca
    v_mov_b32 v110, 0xf149f2ca
    v_mov_b32 v111, 0xf149f2ca
L_attn_kernel_ok2:
    s_cmp_ge_u32 s12, 160
    s_cbranch_scc1 L_attn_kernel_ok3
    v_mov_b32 v112, 0xf149f2ca
    v_mov_b32 v113, 0xf149f2ca
    v_mov_b32 v114, 0xf149f2ca
    v_mov_b32 v115, 0xf149f2ca
    v_mov_b32 v116, 0xf149f2ca
    v_mov_b32 v117, 0xf149f2ca
    v_mov_b32 v118, 0xf149f2ca
    v_mov_b32 v119, 0xf149f2ca
    v_mov_b32 v120, 0xf149f2ca
    v_mov_b32 v121, 0xf149f2ca
    v_mov_b32 v122, 0xf149f2ca
    v_mov_b32 v123, 0xf149f2ca
    v_mov_b32 v124, 0xf149f2ca
    v_mov_b32 v125, 0xf149f2ca
    v_mov_b32 v126, 0xf149f2ca
    v_mov_b32 v127, 0xf149f2ca
L_attn_kernel_ok3:
    s_cmp_ge_u32 s12, 128
    s_cbranch_scc1 L_attn_kernel_ok4
    v_mov_b32 v128, 0xf149f2ca
    v_mov_b32 v129, 0xf149f2ca
    v_mov_b32 v130, 0xf149f2ca
    v_mov_b32 v131, 0xf149f2ca
    v_mov_b32 v132, 0xf149f2ca
    v_mov_b32 v133, 0xf149f2ca
    v_mov_b32 v134, 0xf149f2ca
    v_mov_b32 v135, 0xf149f2ca
    v_mov_b32 v136, 0xf149f2ca
    v_mov_b32 v137, 0xf149f2ca
    v_mov_b32 v138, 0xf149f2ca
    v_mov_b32 v139, 0xf149f2ca
    v_mov_b32 v140, 0xf149f2ca
    v_mov_b32 v141, 0xf149f2ca
    v_mov_b32 v142, 0xf149f2ca
    v_mov_b32 v143, 0xf149f2ca
L_attn_kernel_ok4:
    s_cmp_ge_u32 s12, 96
    s_cbranch_scc1 L_attn_kernel_ok5
    v_mov_b32 v144, 0xf149f2ca
    v_mov_b32 v145, 0xf149f2ca
    v_mov_b32 v146, 0xf149f2ca
    v_mov_b32 v147, 0xf149f2ca
    v_mov_b32 v148, 0xf149f2ca
    v_mov_b32 v149, 0xf149f2ca
    v_mov_b32 v150, 0xf149f2ca
    v_mov_b32 v151, 0xf149f2ca
    v_mov_b32 v152, 0xf149f2ca
    v_mov_b32 v153, 0xf149f2ca
    v_mov_b32 v154, 0xf149f2ca
    v_mov_b32 v155, 0xf149f2ca
    v_mov_b32 v156, 0xf149f2ca
    v_mov_b32 v157, 0xf149f2ca
    v_mov_b32 v158, 0xf149f2ca
    v_mov_b32 v159, 0xf149f2ca
L_attn_kernel_ok5:
    s_cmp_ge_u32 s12, 64
    s_cbranch_scc1 L_attn_kernel_ok6
    v_mov_b32 v160, 0xf149f2ca
    v_mov_b32 v161, 0xf149f2ca
    v_mov_b32 v162, 0xf149f2ca
    v_mov_b32 v163, 0xf149f2ca
    v_mov_b32 v164, 0xf149f2ca
    v_mov_b32 v165, 0xf149f2ca
    v_mov_b32 v166, 0xf149f2ca
    v_mov_b32 v167, 0xf149f2ca
    v_mov_b32 v168, 0xf149f2ca
    v_mov_b32 v169, 0xf149f2ca
    v_mov_b32 v170, 0xf149f2ca
    v_mov_b32 v171, 0xf149f2ca
    v_mov_b32 v172, 0xf149f2ca
    v_mov_b32 v173, 0xf149f2ca
    v_mov_b32 v174, 0xf149f2ca
    v_mov_b32 v175, 0xf149f2ca
L_attn_kernel_ok6:
    s_cmp_ge_u32 s12, 32
    s_cbranch_scc1 L_attn_kernel_ok7
    v_mov_b32 v176, 0xf149f2ca
    v_mov_b32 v177, 0xf149f2ca
    v_mov_b32 v178, 0xf149f2ca
    v_mov_b32 v179, 0xf149f2ca
    v_mov_b32 v180, 0xf149f2ca
    v_mov_b32 v181, 0xf149f2ca
    v_mov_b32 v182, 0xf149f2ca
    v_mov_b32 v183, 0xf149f2ca
    v_mov_b32 v184, 0xf149f2ca
    v_mov_b32 v185, 0xf149f2ca
    v_mov_b32 v186, 0xf149f2ca
    v_mov_b32 v187, 0xf149f2ca
    v_mov_b32 v188, 0xf149f2ca
    v_mov_b32 v189, 0xf149f2ca
    v_mov_b32 v190, 0xf149f2ca
    v_mov_b32 v191, 0xf149f2ca
L_attn_kernel_ok7:
    v_max3_f32 v8, v64, v65, v66
    v_max3_f32 v8, v8, v67, v68
    v_max3_f32 v8, v8, v69, v70
    v_max3_f32 v8, v8, v71, v72
    v_max3_f32 v8, v8, v73, v74
    v_max3_f32 v8, v8, v75, v76
    v_max3_f32 v8, v8, v77, v78
    v_max3_f32 v8, v8, v79, v80
    v_max3_f32 v8, v8, v81, v82
    v_max3_f32 v8, v8, v83, v84
    v_max3_f32 v8, v8, v85, v86
    v_max3_f32 v8, v8, v87, v88
    v_max3_f32 v8, v8, v89, v90
    v_max3_f32 v8, v8, v91, v92
    v_max3_f32 v8, v8, v93, v94
    v_max3_f32 v8, v8, v95, v96
    v_max3_f32 v8, v8, v97, v98
    v_max3_f32 v8, v8, v99, v100
    v_max3_f32 v8, v8, v101, v102
    v_max3_f32 v8, v8, v103, v104
    v_max3_f32 v8, v8, v105, v106
    v_max3_f32 v8, v8, v107, v108
    v_max3_f32 v8, v8, v109, v110
    v_max3_f32 v8, v8, v111, v112
    v_max3_f32 v8, v8, v113, v114
    v_max3_f32 v8, v8, v115, v116
    v_max3_f32 v8, v8, v117, v118
    v_max3_f32 v8, v8, v119, v120
    v_max3_f32 v8, v8, v121, v122
    v_max3_f32 v8, v8, v123, v124
    v_max3_f32 v8, v8, v125, v126
    v_max3_f32 v8, v8, v127, v128
    v_max3_f32 v8, v8, v129, v130
    v_max3_f32 v8, v8, v131, v132
    v_max3_f32 v8, v8, v133, v134
    v_max3_f32 v8, v8, v135, v136
    v_max3_f32 v8, v8, v137, v138
    v_max3_f32 v8, v8, v139, v140
    v_max3_f32 v8, v8, v141, v142
    v_max3_f32 v8, v8, v143, v144
    v_max3_f32 v8, v8, v145, v146
    v_max3_f32 v8, v8, v147, v148
    v_max3_f32 v8, v8, v149, v150
    v_max3_f32 v8, v8, v151, v152
    v_max3_f32 v8, v8, v153, v154
    v_max3_f32 v8, v8, v155, v156
    v_max3_f32 v8, v8, v157, v158
    v_max3_f32 v8, v8, v159, v160
    v_max3_f32 v8, v8, v161, v162
    v_max3_f32 v8, v8, v163, v164
    v_max3_f32 v8, v8, v165, v166
    v_max3_f32 v8, v8, v167, v168
    v_max3_f32 v8, v8, v169, v170
    v_max3_f32 v8, v8, v171, v172
    v_max3_f32 v8, v8, v173, v174
    v_max3_f32 v8, v8, v175, v176
    v_max3_f32 v8, v8, v177, v178
    v_max3_f32 v8, v8, v179, v180
    v_max3_f32 v8, v8, v181, v182
    v_max3_f32 v8, v8, v183, v184
    v_max3_f32 v8, v8, v185, v186
    v_max3_f32 v8, v8, v187, v188
    v_max3_f32 v8, v8, v189, v190
    v_max3_f32 v8, v8, v191, v192
    v_max3_f32 v8, v8, v193, v194
    v_max3_f32 v8, v8, v195, v196
    v_max3_f32 v8, v8, v197, v198
    v_max3_f32 v8, v8, v199, v200
    v_max3_f32 v8, v8, v201, v202
    v_max3_f32 v8, v8, v203, v204
    v_max3_f32 v8, v8, v205, v206
    v_max_f32 v8, v8, v207
    v_mov_b32 v10, v8
    s_nop 1
    v_permlane32_swap_b32 v8, v10
    s_nop 1
    v_max_f32 v8, v8, v10
    s_mov_b32 s20, 0.25503486164919736
    v_mul_f32 v8, s20, v8
    v_sub_f32 v8, 0, v8
    v_fma_f32 v64, v64, s20, v8
    v_fma_f32 v65, v65, s20, v8
    v_fma_f32 v66, v66, s20, v8
    v_fma_f32 v67, v67, s20, v8
    v_fma_f32 v68, v68, s20, v8
    v_fma_f32 v69, v69, s20, v8
    v_fma_f32 v70, v70, s20, v8
    v_fma_f32 v71, v71, s20, v8
    v_fma_f32 v72, v72, s20, v8
    v_fma_f32 v73, v73, s20, v8
    v_fma_f32 v74, v74, s20, v8
    v_fma_f32 v75, v75, s20, v8
    v_fma_f32 v76, v76, s20, v8
    v_fma_f32 v77, v77, s20, v8
    v_fma_f32 v78, v78, s20, v8
    v_fma_f32 v79, v79, s20, v8
    v_fma_f32 v80, v80, s20, v8
    v_fma_f32 v81, v81, s20, v8
    v_fma_f32 v82, v82, s20, v8
    v_fma_f32 v83, v83, s20, v8
    v_fma_f32 v84, v84, s20, v8
    v_fma_f32 v85, v85, s20, v8
    v_fma_f32 v86, v86, s20, v8
    v_fma_f32 v87, v87, s20, v8
    v_fma_f32 v88, v88, s20, v8
    v_fma_f32 v89, v89, s20, v8
    v_fma_f32 v90, v90, s20, v8
    v_fma_f32 v91, v91, s20, v8
    v_fma_f32 v92, v92, s20, v8
    v_fma_f32 v93, v93, s20, v8
    v_fma_f32 v94, v94, s20, v8
    v_fma_f32 v95, v95, s20, v8
    v_fma_f32 v96, v96, s20, v8
    v_fma_f32 v97, v97, s20, v8
    v_fma_f32 v98, v98, s20, v8
    v_fma_f32 v99, v99, s20, v8
    v_fma_f32 v100, v100, s20, v8
    v_fma_f32 v101, v101, s20, v8
    v_fma_f32 v102, v102, s20, v8
    v_fma_f32 v103, v103, s20, v8
    v_fma_f32 v104, v104, s20, v8
    v_fma_f32 v105, v105, s20, v8
    v_fma_f32 v106, v106, s20, v8
    v_fma_f32 v107, v107, s20, v8
    v_fma_f32 v108, v108, s20, v8
    v_fma_f32 v109, v109, s20, v8
    v_fma_f32 v110, v110, s20, v8
    v_fma_f32 v111, v111, s20, v8
    v_fma_f32 v112, v112, s20, v8
    v_fma_f32 v113, v113, s20, v8
    v_fma_f32 v114, v114, s20, v8
    v_fma_f32 v115, v115, s20, v8
    v_fma_f32 v116, v116, s20, v8
    v_fma_f32 v117, v117, s20, v8
    v_fma_f32 v118, v118, s20, v8
    v_fma_f32 v119, v119, s20, v8
    v_fma_f32 v120, v120, s20, v8
    v_fma_f32 v121, v121, s20, v8
    v_fma_f32 v122, v122, s20, v8
    v_fma_f32 v123, v123, s20, v8
    v_fma_f32 v124, v124, s20, v8
    v_fma_f32 v125, v125, s20, v8
    v_fma_f32 v126, v126, s20, v8
    v_fma_f32 v127, v127, s20, v8
    v_fma_f32 v128, v128, s20, v8
    v_fma_f32 v129, v129, s20, v8
    v_fma_f32 v130, v130, s20, v8
    v_fma_f32 v131, v131, s20, v8
    v_fma_f32 v132, v132, s20, v8
    v_fma_f32 v133, v133, s20, v8
    v_fma_f32 v134, v134, s20, v8
    v_fma_f32 v135, v135, s20, v8
    v_fma_f32 v136, v136, s20, v8
    v_fma_f32 v137, v137, s20, v8
    v_fma_f32 v138, v138, s20, v8
    v_fma_f32 v139, v139, s20, v8
    v_fma_f32 v140, v140, s20, v8
    v_fma_f32 v141, v141, s20, v8
    v_fma_f32 v142, v142, s20, v8
    v_fma_f32 v143, v143, s20, v8
    v_fma_f32 v144, v144, s20, v8
    v_fma_f32 v145, v145, s20, v8
    v_fma_f32 v146, v146, s20, v8
    v_fma_f32 v147, v147, s20, v8
    v_fma_f32 v148, v148, s20, v8
    v_fma_f32 v149, v149, s20, v8
    v_fma_f32 v150, v150, s20, v8
    v_fma_f32 v151, v151, s20, v8
    v_fma_f32 v152, v152, s20, v8
    v_fma_f32 v153, v153, s20, v8
    v_fma_f32 v154, v154, s20, v8
    v_fma_f32 v155, v155, s20, v8
    v_fma_f32 v156, v156, s20, v8
    v_fma_f32 v157, v157, s20, v8
    v_fma_f32 v158, v158, s20, v8
    v_fma_f32 v159, v159, s20, v8
    v_fma_f32 v160, v160, s20, v8
    v_fma_f32 v161, v161, s20, v8
    v_fma_f32 v162, v162, s20, v8
    v_fma_f32 v163, v163, s20, v8
    v_fma_f32 v164, v164, s20, v8
    v_fma_f32 v165, v165, s20, v8
    v_fma_f32 v166, v166, s20, v8
    v_fma_f32 v167, v167, s20, v8
    v_fma_f32 v168, v168, s20, v8
    v_fma_f32 v169, v169, s20, v8
    v_fma_f32 v170, v170, s20, v8
    v_fma_f32 v171, v171, s20, v8
    v_fma_f32 v172, v172, s20, v8
    v_fma_f32 v173, v173, s20, v8
    v_fma_f32 v174, v174, s20, v8
    v_fma_f32 v175, v175, s20, v8
    v_fma_f32 v176, v176, s20, v8
    v_fma_f32 v177, v177, s20, v8
    v_fma_f32 v178, v178, s20, v8
    v_fma_f32 v179, v179, s20, v8
    v_fma_f32 v180, v180, s20, v8
    v_fma_f32 v181, v181, s20, v8
    v_fma_f32 v182, v182, s20, v8
    v_fma_f32 v183, v183, s20, v8
    v_fma_f32 v184, v184, s20, v8
    v_fma_f32 v185, v185, s20, v8
    v_fma_f32 v186, v186, s20, v8
    v_fma_f32 v187, v187, s20, v8
    v_fma_f32 v188, v188, s20, v8
    v_fma_f32 v189, v189, s20, v8
    v_fma_f32 v190, v190, s20, v8
    v_fma_f32 v191, v191, s20, v8
    v_fma_f32 v192, v192, s20, v8
    v_fma_f32 v193, v193, s20, v8
    v_fma_f32 v194, v194, s20, v8
    v_fma_f32 v195, v195, s20, v8
    v_fma_f32 v196, v196, s20, v8
    v_fma_f32 v197, v197, s20, v8
    v_fma_f32 v198, v198, s20, v8
    v_fma_f32 v199, v199, s20, v8
    v_fma_f32 v200, v200, s20, v8
    v_fma_f32 v201, v201, s20, v8
    v_fma_f32 v202, v202, s20, v8
    v_fma_f32 v203, v203, s20, v8
    v_fma_f32 v204, v204, s20, v8
    v_fma_f32 v205, v205, s20, v8
    v_fma_f32 v206, v206, s20, v8
    v_fma_f32 v207, v207, s20, v8
    v_exp_f32 v64, v64
    v_exp_f32 v65, v65
    v_exp_f32 v66, v66
    v_exp_f32 v67, v67
    v_exp_f32 v68, v68
    v_exp_f32 v69, v69
    v_exp_f32 v70, v70
    v_exp_f32 v71, v71
    v_exp_f32 v72, v72
    v_exp_f32 v73, v73
    v_exp_f32 v74, v74
    v_exp_f32 v75, v75
    v_exp_f32 v76, v76
    v_exp_f32 v77, v77
    v_exp_f32 v78, v78
    v_exp_f32 v79, v79
    v_exp_f32 v80, v80
    v_exp_f32 v81, v81
    v_exp_f32 v82, v82
    v_exp_f32 v83, v83
    v_exp_f32 v84, v84
    v_exp_f32 v85, v85
    v_exp_f32 v86, v86
    v_exp_f32 v87, v87
    v_exp_f32 v88, v88
    v_exp_f32 v89, v89
    v_exp_f32 v90, v90
    v_exp_f32 v91, v91
    v_exp_f32 v92, v92
    v_exp_f32 v93, v93
    v_exp_f32 v94, v94
    v_exp_f32 v95, v95
    v_exp_f32 v96, v96
    v_exp_f32 v97, v97
    v_exp_f32 v98, v98
    v_exp_f32 v99, v99
    v_exp_f32 v100, v100
    v_exp_f32 v101, v101
    v_exp_f32 v102, v102
    v_exp_f32 v103, v103
    v_exp_f32 v104, v104
    v_exp_f32 v105, v105
    v_exp_f32 v106, v106
    v_exp_f32 v107, v107
    v_exp_f32 v108, v108
    v_exp_f32 v109, v109
    v_exp_f32 v110, v110
    v_exp_f32 v111, v111
    v_exp_f32 v112, v112
    v_exp_f32 v113, v113
    v_exp_f32 v114, v114
    v_exp_f32 v115, v115
    v_exp_f32 v116, v116
    v_exp_f32 v117, v117
    v_exp_f32 v118, v118
    v_exp_f32 v119, v119
    v_exp_f32 v120, v120
    v_exp_f32 v121, v121
    v_exp_f32 v122, v122
    v_exp_f32 v123, v123
    v_exp_f32 v124, v124
    v_exp_f32 v125, v125
    v_exp_f32 v126, v126
    v_exp_f32 v127, v127
    v_exp_f32 v128, v128
    v_exp_f32 v129, v129
    v_exp_f32 v130, v130
    v_exp_f32 v131, v131
    v_exp_f32 v132, v132
    v_exp_f32 v133, v133
    v_exp_f32 v134, v134
    v_exp_f32 v135, v135
    v_exp_f32 v136, v136
    v_exp_f32 v137, v137
    v_exp_f32 v138, v138
    v_exp_f32 v139, v139
    v_exp_f32 v140, v140
    v_exp_f32 v141, v141
    v_exp_f32 v142, v142
    v_exp_f32 v143, v143
    v_exp_f32 v144, v144
    v_exp_f32 v145, v145
    v_exp_f32 v146, v146
    v_exp_f32 v147, v147
    v_exp_f32 v148, v148
    v_exp_f32 v149, v149
    v_exp_f32 v150, v150
    v_exp_f32 v151, v151
    v_exp_f32 v152, v152
    v_exp_f32 v153, v153
    v_exp_f32 v154, v154
    v_exp_f32 v155, v155
    v_exp_f32 v156, v156
    v_exp_f32 v157, v157
    v_exp_f32 v158, v158
    v_exp_f32 v159, v159
    v_exp_f32 v160, v160
    v_exp_f32 v161, v161
    v_exp_f32 v162, v162
    v_exp_f32 v163, v163
    v_exp_f32 v164, v164
    v_exp_f32 v165, v165
    v_exp_f32 v166, v166
    v_exp_f32 v167, v167
    v_exp_f32 v168, v168
    v_exp_f32 v169, v169
    v_exp_f32 v170, v170
    v_exp_f32 v171, v171
    v_exp_f32 v172, v172
    v_exp_f32 v173, v173
    v_exp_f32 v174, v174
    v_exp_f32 v175, v175
    v_exp_f32 v176, v176
    v_exp_f32 v177, v177
    v_exp_f32 v178, v178
    v_exp_f32 v179, v179
    v_exp_f32 v180, v180
    v_exp_f32 v181, v181
    v_exp_f32 v182, v182
    v_exp_f32 v183, v183
    v_exp_f32 v184, v184
    v_exp_f32 v185, v185
    v_exp_f32 v186, v186
    v_exp_f32 v187, v187
    v_exp_f32 v188, v188
    v_exp_f32 v189, v189
    v_exp_f32 v190, v190
    v_exp_f32 v191, v191
    v_exp_f32 v192, v192
    v_exp_f32 v193, v193
    v_exp_f32 v194, v194
    v_exp_f32 v195, v195
    v_exp_f32 v196, v196
    v_exp_f32 v197, v197
    v_exp_f32 v198, v198
    v_exp_f32 v199, v199
    v_exp_f32 v200, v200
    v_exp_f32 v201, v201
    v_exp_f32 v202, v202
    v_exp_f32 v203, v203
    v_exp_f32 v204, v204
    v_exp_f32 v205, v205
    v_exp_f32 v206, v206
    v_exp_f32 v207, v207
    s_nop 0
    v_add_f32 v9, v64, v65
    v_add_f32 v9, v9, v66
    v_add_f32 v9, v9, v67
    v_add_f32 v9, v9, v68
    v_add_f32 v9, v9, v69
    v_add_f32 v9, v9, v70
    v_add_f32 v9, v9, v71
    v_add_f32 v9, v9, v72
    v_add_f32 v9, v9, v73
    v_add_f32 v9, v9, v74
    v_add_f32 v9, v9, v75
    v_add_f32 v9, v9, v76
    v_add_f32 v9, v9, v77
    v_add_f32 v9, v9, v78
    v_add_f32 v9, v9, v79
    v_add_f32 v9, v9, v80
    v_add_f32 v9, v9, v81
    v_add_f32 v9, v9, v82
    v_add_f32 v9, v9, v83
    v_add_f32 v9, v9, v84
    v_add_f32 v9, v9, v85
    v_add_f32 v9, v9, v86
    v_add_f32 v9, v9, v87
    v_add_f32 v9, v9, v88
    v_add_f32 v9, v9, v89
    v_add_f32 v9, v9, v90
    v_add_f32 v9, v9, v91
    v_add_f32 v9, v9, v92
    v_add_f32 v9, v9, v93
    v_add_f32 v9, v9, v94
    v_add_f32 v9, v9, v95
    v_add_f32 v9, v9, v96
    v_add_f32 v9, v9, v97
    v_add_f32 v9, v9, v98
    v_add_f32 v9, v9, v99
    v_add_f32 v9, v9, v100
    v_add_f32 v9, v9, v101
    v_add_f32 v9, v9, v102
    v_add_f32 v9, v9, v103
    v_add_f32 v9, v9, v104
    v_add_f32 v9, v9, v105
    v_add_f32 v9, v9, v106
    v_add_f32 v9, v9, v107
    v_add_f32 v9, v9, v108
    v_add_f32 v9, v9, v109
    v_add_f32 v9, v9, v110
    v_add_f32 v9, v9, v111
    v_add_f32 v9, v9, v112
    v_add_f32 v9, v9, v113
    v_add_f32 v9, v9, v114
    v_add_f32 v9, v9, v115
    v_add_f32 v9, v9, v116
    v_add_f32 v9, v9, v117
    v_add_f32 v9, v9, v118
    v_add_f32 v9, v9, v119
    v_add_f32 v9, v9, v120
    v_add_f32 v9, v9, v121
    v_add_f32 v9, v9, v122
    v_add_f32 v9, v9, v123
    v_add_f32 v9, v9, v124
    v_add_f32 v9, v9, v125
    v_add_f32 v9, v9, v126
    v_add_f32 v9, v9, v127
    v_add_f32 v9, v9, v128
    v_add_f32 v9, v9, v129
    v_add_f32 v9, v9, v130
    v_add_f32 v9, v9, v131
    v_add_f32 v9, v9, v132
    v_add_f32 v9, v9, v133
    v_add_f32 v9, v9, v134
    v_add_f32 v9, v9, v135
    v_add_f32 v9, v9, v136
    v_add_f32 v9, v9, v137
    v_add_f32 v9, v9, v138
    v_add_f32 v9, v9, v139
    v_add_f32 v9, v9, v140
    v_add_f32 v9, v9, v141
    v_add_f32 v9, v9, v142
    v_add_f32 v9, v9, v143
    v_add_f32 v9, v9, v144
    v_add_f32 v9, v9, v145
    v_add_f32 v9, v9, v146
    v_add_f32 v9, v9, v147
    v_add_f32 v9, v9, v148
    v_add_f32 v9, v9, v149
    v_add_f32 v9, v9, v150
    v_add_f32 v9, v9, v151
    v_add_f32 v9, v9, v152
    v_add_f32 v9, v9, v153
    v_add_f32 v9, v9, v154
    v_add_f32 v9, v9, v155
    v_add_f32 v9, v9, v156
    v_add_f32 v9, v9, v157
    v_add_f32 v9, v9, v158
    v_add_f32 v9, v9, v159
    v_add_f32 v9, v9, v160
    v_add_f32 v9, v9, v161
    v_add_f32 v9, v9, v162
    v_add_f32 v9, v9, v163
    v_add_f32 v9, v9, v164
    v_add_f32 v9, v9, v165
    v_add_f32 v9, v9, v166
    v_add_f32 v9, v9, v167
    v_add_f32 v9, v9, v168
    v_add_f32 v9, v9, v169
    v_add_f32 v9, v9, v170
    v_add_f32 v9, v9, v171
    v_add_f32 v9, v9, v172
    v_add_f32 v9, v9, v173
    v_add_f32 v9, v9, v174
    v_add_f32 v9, v9, v175
    v_add_f32 v9, v9, v176
    v_add_f32 v9, v9, v177
    v_add_f32 v9, v9, v178
    v_add_f32 v9, v9, v179
    v_add_f32 v9, v9, v180
    v_add_f32 v9, v9, v181
    v_add_f32 v9, v9, v182
    v_add_f32 v9, v9, v183
    v_add_f32 v9, v9, v184
    v_add_f32 v9, v9, v185
    v_add_f32 v9, v9, v186
    v_add_f32 v9, v9, v187
    v_add_f32 v9, v9, v188
    v_add_f32 v9, v9, v189
    v_add_f32 v9, v9, v190
    v_add_f32 v9, v9, v191
    v_add_f32 v9, v9, v192
    v_add_f32 v9, v9, v193
    v_add_f32 v9, v9, v194
    v_add_f32 v9, v9, v195
    v_add_f32 v9, v9, v196
    v_add_f32 v9, v9, v197
    v_add_f32 v9, v9, v198
    v_add_f32 v9, v9, v199
    v_add_f32 v9, v9, v200
    v_add_f32 v9, v9, v201
    v_add_f32 v9, v9, v202
    v_add_f32 v9, v9, v203
    v_add_f32 v9, v9, v204
    v_add_f32 v9, v9, v205
    v_add_f32 v9, v9, v206
    v_add_f32 v9, v9, v207
    v_mov_b32 v10, v9
    s_nop 1
    v_permlane32_swap_b32 v9, v10
    s_nop 1
    v_add_f32 v9, v9, v10
    v_rcp_f32 v9, v9
    v_cvt_pk_bf16_f32 v64, v64, v65
    v_cvt_pk_bf16_f32 v65, v66, v67
    v_cvt_pk_bf16_f32 v66, v68, v69
    v_cvt_pk_bf16_f32 v67, v70, v71
    v_cvt_pk_bf16_f32 v68, v72, v73
    v_cvt_pk_bf16_f32 v69, v74, v75
    v_cvt_pk_bf16_f32 v70, v76, v77
    v_cvt_pk_bf16_f32 v71, v78, v79
    v_cvt_pk_bf16_f32 v72, v80, v81
    v_cvt_pk_bf16_f32 v73, v82, v83
    v_cvt_pk_bf16_f32 v74, v84, v85
    v_cvt_pk_bf16_f32 v75, v86, v87
    v_cvt_pk_bf16_f32 v76, v88, v89
    v_cvt_pk_bf16_f32 v77, v90, v91
    v_cvt_pk_bf16_f32 v78, v92, v93
    v_cvt_pk_bf16_f32 v79, v94, v95
    v_cvt_pk_bf16_f32 v80, v96, v97
    v_cvt_pk_bf16_f32 v81, v98, v99
    v_cvt_pk_bf16_f32 v82, v100, v101
    v_cvt_pk_bf16_f32 v83, v102, v103
    v_cvt_pk_bf16_f32 v84, v104, v105
    v_cvt_pk_bf16_f32 v85, v106, v107
    v_cvt_pk_bf16_f32 v86, v108, v109
    v_cvt_pk_bf16_f32 v87, v110, v111
    v_cvt_pk_bf16_f32 v88, v112, v113
    v_cvt_pk_bf16_f32 v89, v114, v115
    v_cvt_pk_bf16_f32 v90, v116, v117
    v_cvt_pk_bf16_f32 v91, v118, v119
    v_cvt_pk_bf16_f32 v92, v120, v121
    v_cvt_pk_bf16_f32 v93, v122, v123
    v_cvt_pk_bf16_f32 v94, v124, v125
    v_cvt_pk_bf16_f32 v95, v126, v127
    v_cvt_pk_bf16_f32 v96, v128, v129
    v_cvt_pk_bf16_f32 v97, v130, v131
    v_cvt_pk_bf16_f32 v98, v132, v133
    v_cvt_pk_bf16_f32 v99, v134, v135
    v_cvt_pk_bf16_f32 v100, v136, v137
    v_cvt_pk_bf16_f32 v101, v138, v139
    v_cvt_pk_bf16_f32 v102, v140, v141
    v_cvt_pk_bf16_f32 v103, v142, v143
    v_cvt_pk_bf16_f32 v104, v144, v145
    v_cvt_pk_bf16_f32 v105, v146, v147
    v_cvt_pk_bf16_f32 v106, v148, v149
    v_cvt_pk_bf16_f32 v107, v150, v151
    v_cvt_pk_bf16_f32 v108, v152, v153
    v_cvt_pk_bf16_f32 v109, v154, v155
    v_cvt_pk_bf16_f32 v110, v156, v157
    v_cvt_pk_bf16_f32 v111, v158, v159
    v_cvt_pk_bf16_f32 v112, v160, v161
    v_cvt_pk_bf16_f32 v113, v162, v163
    v_cvt_pk_bf16_f32 v114, v164, v165
    v_cvt_pk_bf16_f32 v115, v166, v167
    v_cvt_pk_bf16_f32 v116, v168, v169
    v_cvt_pk_bf16_f32 v117, v170, v171
    v_cvt_pk_bf16_f32 v118, v172, v173
    v_cvt_pk_bf16_f32 v119, v174, v175
    v_cvt_pk_bf16_f32 v120, v176, v177
    v_cvt_pk_bf16_f32 v121, v178, v179
    v_cvt_pk_bf16_f32 v122, v180, v181
    v_cvt_pk_bf16_f32 v123, v182, v183
    v_cvt_pk_bf16_f32 v124, v184, v185
    v_cvt_pk_bf16_f32 v125, v186, v187
    v_cvt_pk_bf16_f32 v126, v188, v189
    v_cvt_pk_bf16_f32 v127, v190, v191
    v_cvt_pk_bf16_f32 v128, v192, v193
    v_cvt_pk_bf16_f32 v129, v194, v195
    v_cvt_pk_bf16_f32 v130, v196, v197
    v_cvt_pk_bf16_f32 v131, v198, v199
    v_cvt_pk_bf16_f32 v132, v200, v201
    v_cvt_pk_bf16_f32 v133, v202, v203
    v_cvt_pk_bf16_f32 v134, v204, v205
    v_cvt_pk_bf16_f32 v135, v206, v207
    v_bfe_u32 v3, v0, 2, 2
    v_lshl_add_u32 v3, v2, 2, v3
    v_lshlrev_b32 v3, 6, v3
    v_bfe_u32 v4, v0, 4, 1
    v_lshl_add_u32 v3, v4, 5, v3
    v_and_b32 v4, 3, v0
    v_lshl_add_u32 v3, v4, 3, v3
    v_add_u32 v7, s21, v3
    s_waitcnt vmcnt(0)
    v_mov_b32 v28, 0
    v_mov_b32 v29, 0
    v_mov_b32 v30, 0
    v_mov_b32 v31, 0
    v_mov_b32 v32, 0
    v_mov_b32 v33, 0
    v_mov_b32 v34, 0
    v_mov_b32 v35, 0
    v_mov_b32 v36, 0
    v_mov_b32 v37, 0
    v_mov_b32 v38, 0
    v_mov_b32 v39, 0
    v_mov_b32 v40, 0
    v_mov_b32 v41, 0
    v_mov_b32 v42, 0
    v_mov_b32 v43, 0
    ds_read_b64_tr_b16 v[144:145], v7 offset:0
    ds_read_b64_tr_b16 v[146:147], v7 offset:512
    ds_read_b64_tr_b16 v[148:149], v7 offset:1024
    ds_read_b64_tr_b16 v[150:151], v7 offset:1536
    ds_read_b64_tr_b16 v[152:153], v7 offset:2048
    ds_read_b64_tr_b16 v[154:155], v7 offset:2560
    ds_read_b64_tr_b16 v[156:157], v7 offset:3072
    ds_read_b64_tr_b16 v[158:159], v7 offset:3584
    s_waitcnt lgkmcnt(6)
    v_mfma_f32_32x32x16_bf16 v[28:43], v[144:147], v[64:67], v[28:43]
    ds_read_b64_tr_b16 v[144:145], v7 offset:4096
    ds_read_b64_tr_b16 v[146:147], v7 offset:4608
    s_waitcnt lgkmcnt(6)
    v_mfma_f32_32x32x16_bf16 v[28:43], v[148:151], v[68:71], v[28:43]
    ds_read_b64_tr_b16 v[148:149], v7 offset:5120
    ds_read_b64_tr_b16 v[150:151], v7 offset:5632
    s_waitcnt lgkmcnt(6)
    v_mfma_f32_32x32x16_bf16 v[28:43], v[152:155], v[72:75], v[28:43]
    ds_read_b64_tr_b16 v[152:153], v7 offset:6144
    ds_read_b64_tr_b16 v[154:155], v7 offset:6656
    s_waitcnt lgkmcnt(6)
    v_mfma_f32_32x32x16_bf16 v[28:43], v[156:159], v[76:79], v[28:43]
    ds_read_b64_tr_b16 v[156:157], v7 offset:7168
    ds_read_b64_tr_b16 v[158:159], v7 offset:7680
    s_waitcnt lgkmcnt(6)
    v_mfma_f32_32x32x16_bf16 v[28:43], v[144:147], v[80:83], v[28:43]
    ds_read_b64_tr_b16 v[144:145], v7 offset:8192
    ds_read_b64_tr_b16 v[146:147], v7 offset:8704
    s_waitcnt lgkmcnt(6)
    v_mfma_f32_32x32x16_bf16 v[28:43], v[148:151], v[84:87], v[28:43]
    ds_read_b64_tr_b16 v[148:149], v7 offset:9216
    ds_read_b64_tr_b16 v[150:151], v7 offset:9728
    s_waitcnt lgkmcnt(6)
    v_mfma_f32_32x32x16_bf16 v[28:43], v[152:155], v[88:91], v[28:43]
    ds_read_b64_tr_b16 v[152:153], v7 offset:10240
    ds_read_b64_tr_b16 v[154:155], v7 offset:10752
    s_waitcnt lgkmcnt(6)
    v_mfma_f32_32x32x16_bf16 v[28:43], v[156:159], v[92:95], v[28:43]
    ds_read_b64_tr_b16 v[156:157], v7 offset:11264
    ds_read_b64_tr_b16 v[158:159], v7 offset:11776
    s_waitcnt lgkmcnt(6)
    v_mfma_f32_32x32x16_bf16 v[28:43], v[144:147], v[96:99], v[28:43]
    ds_read_b64_tr_b16 v[144:145], v7 offset:12288
    ds_read_b64_tr_b16 v[146:147], v7 offset:12800
    s_waitcnt lgkmcnt(6)
    v_mfma_f32_32x32x16_bf16 v[28:43], v[148:151], v[100:103], v[28:43]
    ds_read_b64_tr_b16 v[148:149], v7 offset:13312
    ds_read_b64_tr_b16 v[150:151], v7 offset:13824
    s_waitcnt lgkmcnt(6)
    v_mfma_f32_32x32x16_bf16 v[28:43], v[152:155], v[104:107], v[28:43]
    ds_read_b64_tr_b16 v[152:153], v7 offset:14336
    ds_read_b64_tr_b16 v[154:155], v7 offset:14848
    s_waitcnt lgkmcnt(6)
    v_mfma_f32_32x32x16_bf16 v[28:43], v[156:159], v[108:111], v[28:43]
    ds_read_b64_tr_b16 v[156:157], v7 offset:15360
    ds_read_b64_tr_b16 v[158:159], v7 offset:15872
    s_waitcnt lgkmcnt(6)
    v_mfma_f32_32x32x16_bf16 v[28:43], v[144:147], v[112:115], v[28:43]
    ds_read_b64_tr_b16 v[144:145], v7 offset:16384
    ds_read_b64_tr_b16 v[146:147], v7 offset:16896
    s_waitcnt lgkmcnt(6)
    v_mfma_f32_32x32x16_bf16 v[28:43], v[148:151], v[116:119], v[28:43]
    ds_read_b64_tr_b16 v[148:149], v7 offset:17408
    ds_read_b64_tr_b16 v[150:151], v7 offset:17920
    s_waitcnt lgkmcnt(6)
    v_mfma_f32_32x32x16_bf16 v[28:43], v[152:155], v[120:123], v[28:43]
    s_waitcnt lgkmcnt(4)
    v_mfma_f32_32x32x16_bf16 v[28:43], v[156:159], v[124:127], v[28:43]
    s_waitcnt lgkmcnt(2)
    v_mfma_f32_32x32x16_bf16 v[28:43], v[144:147], v[128:131], v[28:43]
    s_waitcnt lgkmcnt(0)
    v_mfma_f32_32x32x16_bf16 v[28:43], v[148:151], v[132:135], v[28:43]
    s_nop 15
    s_nop 3
    v_add_u32 v4, s12, v1
    v_lshlrev_b32 v4, 11, v4
    s_lshl_b32 s20, s13, 6
    v_lshl_add_u32 v4, v2, 3, v4
    v_add_u32 v4, s20, v4
    v_mul_f32 v28, v28, v9
    v_mul_f32 v29, v29, v9
    v_mul_f32 v30, v30, v9
    v_mul_f32 v31, v31, v9
    v_cvt_pk_bf16_f32 v12, v28, v29
    v_cvt_pk_bf16_f32 v13, v30, v31
    buffer_store_dwordx2 v[12:13], v4, s[8:11], 0 offen offset:0
    v_mul_f32 v32, v32, v9
    v_mul_f32 v33, v33, v9
    v_mul_f32 v34, v34, v9
    v_mul_f32 v35, v35, v9
    v_cvt_pk_bf16_f32 v14, v32, v33
    v_cvt_pk_bf16_f32 v15, v34, v35
    buffer_store_dwordx2 v[14:15], v4, s[8:11], 0 offen offset:16
    v_mul_f32 v36, v36, v9
    v_mul_f32 v37, v37, v9
    v_mul_f32 v38, v38, v9
    v_mul_f32 v39, v39, v9
    v_cvt_pk_bf16_f32 v16, v36, v37
    v_cvt_pk_bf16_f32 v17, v38, v39
    buffer_store_dwordx2 v[16:17], v4, s[8:11], 0 offen offset:32
    v_mul_f32 v40, v40, v9
    v_mul_f32 v41, v41, v9
    v_mul_f32 v42, v42, v9
    v_mul_f32 v43, v43, v9
    v_cvt_pk_bf16_f32 v18, v40, v41
    v_cvt_pk_bf16_f32 v19, v42, v43
    buffer_store_dwordx2 v[18:19], v4, s[8:11], 0 offen offset:48
L_attn_kernel_end:
    s_endpgm
.section .rodata,"a"
.p2align 6
.amdhsa_kernel attn_kernel
  .amdhsa_next_free_vgpr 208
  .amdhsa_next_free_sgpr 96
  .amdhsa_accum_offset 208
  .amdhsa_group_segment_fixed_size 0
  .amdhsa_kernarg_size 80
  .amdhsa_user_sgpr_count 2
  .amdhsa_user_sgpr_kernarg_segment_ptr 1
  .amdhsa_system_sgpr_workgroup_id_x 1
.end_amdhsa_kernel
.text
.globl wo_kernel
.p2align 8
.type wo_kernel,@function
wo_kernel:
    s_cmp_ge_u32 s2, 256
    s_cbranch_scc1 L_wo_kernel_end
    s_load_dwordx2 s[4:5], s[0:1], 72
    s_load_dwordx2 s[8:9], s[0:1], 16
    s_load_dwordx2 s[16:17], s[0:1], 72
    s_load_dwordx2 s[20:21], s[0:1], 0
    s_and_b32 s30, s2, 7
    s_lshr_b32 s31, s2, 3
    s_and_b32 s33, s31, 0
    s_lshr_b32 s31, s31, 0
    s_mul_i32 s34, s30, 32
    s_add_u32 s34, s34, s31
    s_and_b32 s24, s31, 3
    s_lshr_b32 s25, s31, 2
    s_lshr_b32 s31, s30, 1
    s_mul_i32 s31, s31, 4
    s_add_u32 s24, s24, s31
    s_and_b32 s31, s30, 1
    s_mul_i32 s31, s31, 8
    s_add_u32 s25, s25, s31
    s_mul_i32 s24, s24, 128
    s_mul_i32 s25, s25, 64
    v_lshrrev_b32 v1, 6, v0
    s_nop 0
    v_readfirstlane_b32 s31, v1
    v_and_b32 v0, 63, v0
    s_nop 3
    s_lshr_b32 s26, s31, 0
    s_and_b32 s27, s31, 0
    s_mul_i32 s60, s33, 2048
    s_mul_i32 s61, s33, 2097152
    s_add_u32 s62, s60, 2048
    s_lshr_b32 s30, s2, 3
    s_mul_i32 s30, s30, 0
    s_mul_hi_u32 s28, s30, 268435456
    s_mul_i32 s28, s28, 16
    s_sub_u32 s30, s30, s28
    s_mul_i32 s28, s30, 128
    s_add_u32 s28, s28, s60
    s_mul_i32 s29, s30, 131072
    s_add_u32 s29, s29, s61
    s_waitcnt lgkmcnt(0)
    s_add_u32 s4, s4, 16777216
    s_addc_u32 s5, s5, 0
    s_mov_b32 s6, 4194304
    s_mov_b32 s7, 0x00020000
    s_mov_b32 s10, 2097152
    s_mov_b32 s11, 0x00020000
    s_add_u32 s16, s16, 20971520
    s_addc_u32 s17, s17, 0
    s_mov_b32 s18, 4194304
    s_mov_b32 s19, 0x00020000
    s_mov_b32 s22, 4194304
    s_mov_b32 s23, 0x00020000
    s_add_u32 s30, s31, 0
    s_min_u32 s30, s30, 15
    s_lshl_b32 s30, s30, 10
    s_add_u32 s36, s30, 0
    v_lshlrev_b32 v32, 4, v0
    v_add_u32 v32, s30, v32
    s_mov_b32 s30, 8192
    v_mul_lo_u32 v33, v32, s30
    v_lshrrev_b32 v33, 20, v33
    s_mov_b32 s30, 128
    v_mul_lo_u32 v34, v33, s30
    v_sub_u32 v34, v32, v34
    v_lshrrev_b32 v34, 4, v34
    v_bfe_u32 v35, v33, 1, 3
    v_xor_b32 v34, v34, v35
    v_add_u32 v33, s24, v33
    s_mov_b32 s30, 2048
    v_mul_lo_u32 v33, v33, s30
    v_lshl_add_u32 v2, v34, 4, v33
    s_add_u32 s30, s31, 4
    s_min_u32 s30, s30, 15
    s_lshl_b32 s30, s30, 10
    s_add_u32 s37, s30, 0
    v_lshlrev_b32 v32, 4, v0
    v_add_u32 v32, s30, v32
    s_mov_b32 s30, 8192
    v_mul_lo_u32 v33, v32, s30
    v_lshrrev_b32 v33, 20, v33
    s_mov_b32 s30, 128
    v_mul_lo_u32 v34, v33, s30
    v_sub_u32 v34, v32, v34
    v_lshrrev_b32 v34, 4, v34
    v_bfe_u32 v35, v33, 1, 3
    v_xor_b32 v34, v34, v35
    v_add_u32 v33, s24, v33
    s_mov_b32 s30, 2048
    v_mul_lo_u32 v33, v33, s30
    v_lshl_add_u32 v3, v34, 4, v33
    s_add_u32 s30, s31, 8
    s_min_u32 s30, s30, 15
    s_lshl_b32 s30, s30, 10
    s_add_u32 s38, s30, 0
    v_lshlrev_b32 v32, 4, v0
    v_add_u32 v32, s30, v32
    s_mov_b32 s30, 8192
    v_mul_lo_u32 v33, v32, s30
    v_lshrrev_b32 v33, 20, v33
    s_mov_b32 s30, 128
    v_mul_lo_u32 v34, v33, s30
    v_sub_u32 v34, v32, v34
    v_lshrrev_b32 v34, 4, v34
    v_bfe_u32 v35, v33, 1, 3
    v_xor_b32 v34, v34, v35
    v_add_u32 v33, s24, v33
    s_mov_b32 s30, 2048
    v_mul_lo_u32 v33, v33, s30
    v_lshl_add_u32 v4, v34, 4, v33
    s_add_u32 s30, s31, 12
    s_min_u32 s30, s30, 15
    s_lshl_b32 s30, s30, 10
    s_add_u32 s39, s30, 0
    v_lshlrev_b32 v32, 4, v0
    v_add_u32 v32, s30, v32
    s_mov_b32 s30, 8192
    v_mul_lo_u32 v33, v32, s30
    v_lshrrev_b32 v33, 20, v33
    s_mov_b32 s30, 128
    v_mul_lo_u32 v34, v33, s30
    v_sub_u32 v34, v32, v34
    v_lshrrev_b32 v34, 4, v34
    v_bfe_u32 v35, v33, 1, 3
    v_xor_b32 v34, v34, v35
    v_add_u32 v33, s24, v33
    s_mov_b32 s30, 2048
    v_mul_lo_u32 v33, v33, s30
    v_lshl_add_u32 v5, v34, 4, v33
    s_add_u32 s30, s31, 0
    s_min_u32 s30, s30, 7
    s_lshl_b32 s30, s30, 10
    s_add_u32 s40, s30, 16384
    v_lshlrev_b32 v32, 4, v0
    v_add_u32 v32, s30, v32
    s_mov_b32 s30, 8192
    v_mul_lo_u32 v33, v32, s30
    v_lshrrev_b32 v33, 20, v33
    s_mov_b32 s30, 128
    v_mul_lo_u32 v34, v33, s30
    v_sub_u32 v34, v32, v34
    v_lshrrev_b32 v34, 4, v34
    v_mov_b32 v35, 0
    v_bfe_u32 v36, v33, 1, 1
    v_lshl_or_b32 v35, v36, 1, v35
    v_bfe_u32 v36, v33, 3, 1
    v_lshl_or_b32 v35, v36, 2, v35
    v_xor_b32 v34, v34, v35
    v_min_u32 v34, 7, v34
    s_mov_b32 s30, 2048
    v_mul_lo_u32 v33, v33, s30
    v_lshl_add_u32 v33, v34, 4, v33
    s_lshl_b32 s30, s25, 1
    v_add_u32 v6, s30, v33
    s_add_u32 s30, s31, 4
    s_min_u32 s30, s30, 7
    s_lshl_b32 s30, s30, 10
    s_add_u32 s41, s30, 16384
    v_lshlrev_b32 v32, 4, v0
    v_add_u32 v32, s30, v32
    s_mov_b32 s30, 8192
    v_mul_lo_u32 v33, v32, s30
    v_lshrrev_b32 v33, 20, v33
    s_mov_b32 s30, 128
    v_mul_lo_u32 v34, v33, s30
    v_sub_u32 v34, v32, v34
    v_lshrrev_b32 v34, 4, v34
    v_mov_b32 v35, 0
    v_bfe_u32 v36, v33, 1, 1
    v_lshl_or_b32 v35, v36, 1, v35
    v_bfe_u32 v36, v33, 3, 1
    v_lshl_or_b32 v35, v36, 2, v35
    v_xor_b32 v34, v34, v35
    v_min_u32 v34, 7, v34
    s_mov_b32 s30, 2048
    v_mul_lo_u32 v33, v33, s30
    v_lshl_add_u32 v33, v34, 4, v33
    s_lshl_b32 s30, s25, 1
    v_add_u32 v7, s30, v33
    v_and_b32 v32, 15, v0
    v_lshrrev_b32 v33, 4, v0
    s_mul_i32 s30, s26, 32
    v_add_u32 v34, s30, v32
    v_bfe_u32 v35, v32, 1, 3
    v_add_u32 v36, 0, v33
    v_xor_b32 v36, v36, v35
    v_lshlrev_b32 v36, 4, v36
    v_mul_u32_u24 v8, 128, v34
    v_add_u32 v8, v8, v36
    v_add_u32 v9, 24576, v8
    v_add_u32 v10, 49152, v8
    v_add_u32 v11, 73728, v8
    v_add_u32 v36, 4, v33
    v_xor_b32 v36, v36, v35
    v_lshlrev_b32 v36, 4, v36
    v_mul_u32_u24 v12, 128, v34
    v_add_u32 v12, v12, v36
    v_add_u32 v13, 24576, v12
    v_add_u32 v14, 49152, v12
    v_add_u32 v15, 73728, v12
    v_bfe_u32 v32, v0, 2, 2
    v_lshl_add_u32 v32, v33, 3, v32
    v_and_b32 v34, 3, v0
    v_mov_b32 v35, 0
    v_bfe_u32 v36, v32, 1, 1
    v_lshl_or_b32 v35, v36, 1, v35
    v_bfe_u32 v36, v32, 3, 1
    v_lshl_or_b32 v35, v36, 2, v35
    s_mul_i32 s30, s27, 128
    s_add_u32 s30, s30, 0
    v_lshlrev_b32 v36, 3, v34
    v_add_u32 v36, s30, v36
    v_lshrrev_b32 v33, 4, v36
    v_xor_b32 v33, v33, v35
    v_and_b32 v36, 15, v36
    v_lshl_add_u32 v36, v33, 4, v36
    v_mul_u32_u24 v16, 128, v32
    v_add_u32 v16, v16, v36
    v_add_u32 v16, 16384, v16
    v_add_u32 v17, 24576, v16
    v_add_u32 v18, 49152, v16
    v_add_u32 v19, 73728, v16
    s_mul_i32 s30, s27, 128
    s_add_u32 s30, s30, 32
    v_lshlrev_b32 v36, 3, v34
    v_add_u32 v36, s30, v36
    v_lshrrev_b32 v33, 4, v36
    v_xor_b32 v33, v33, v35
    v_and_b32 v36, 15, v36
    v_lshl_add_u32 v36, v33, 4, v36
    v_mul_u32_u24 v20, 128, v32
    v_add_u32 v20, v20, v36
    v_add_u32 v20, 16384, v20
    v_add_u32 v21, 24576, v20
    v_add_u32 v22, 49152, v20
    v_add_u32 v23, 73728, v20
    s_mul_i32 s30, s27, 128
    s_add_u32 s30, s30, 64
    v_lshlrev_b32 v36, 3, v34
    v_add_u32 v36, s30, v36
    v_lshrrev_b32 v33, 4, v36
    v_xor_b32 v33, v33, v35
    v_and_b32 v36, 15, v36
    v_lshl_add_u32 v36, v33, 4, v36
    v_mul_u32_u24 v24, 128, v32
    v_add_u32 v24, v24, v36
    v_add_u32 v24, 16384, v24
    v_add_u32 v25, 24576, v24
    v_add_u32 v26, 49152, v24
    v_add_u32 v27, 73728, v24
    s_mul_i32 s30, s27, 128
    s_add_u32 s30, s30, 96
    v_lshlrev_b32 v36, 3, v34
    v_add_u32 v36, s30, v36
    v_lshrrev_b32 v33, 4, v36
    v_xor_b32 v33, v33, v35
    v_and_b32 v36, 15, v36
    v_lshl_add_u32 v36, v33, 4, v36
    v_mul_u32_u24 v28, 128, v32
    v_add_u32 v28, v28, v36
    v_add_u32 v28, 16384, v28
    v_add_u32 v29, 24576, v28
    v_add_u32 v30, 49152, v28
    v_add_u32 v31, 73728, v28
    s_add_u32 m0, s36, 0
    buffer_load_dwordx4 v2, s[4:7], s28 offen lds
    s_add_u32 m0, s37, 0
    buffer_load_dwordx4 v3, s[4:7], s28 offen lds
    s_add_u32 m0, s38, 0
    buffer_load_dwordx4 v4, s[4:7], s28 offen lds
    s_add_u32 m0, s39, 0
    buffer_load_dwordx4 v5, s[4:7], s28 offen lds
    s_add_u32 m0, s40, 0
    buffer_load_dwordx4 v6, s[8:11], s29 offen lds
    s_add_u32 m0, s41, 0
    buffer_load_dwordx4 v7, s[8:11], s29 offen lds
    s_add_u32 s28, s28, 128
    s_add_u32 s29, s29, 131072
    s_add_u32 m0, s36, 24576
    buffer_load_dwordx4 v2, s[4:7], s28 offen lds
    s_add_u32 m0, s37, 24576
    buffer_load_dwordx4 v3, s[4:7], s28 offen lds
    s_add_u32 m0, s38, 24576
    buffer_load_dwordx4 v4, s[4:7], s28 offen lds
    s_add_u32 m0, s39, 24576
    buffer_load_dwordx4 v5, s[4:7], s28 offen lds
    s_add_u32 m0, s40, 24576
    buffer_load_dwordx4 v6, s[8:11], s29 offen lds
    s_add_u32 m0, s41, 24576
    buffer_load_dwordx4 v7, s[8:11], s29 offen lds
    s_add_u32 s28, s28, 128
    s_add_u32 s29, s29, 131072
    s_add_u32 m0, s36, 49152
    buffer_load_dwordx4 v2, s[4:7], s28 offen lds
    s_add_u32 m0, s37, 49152
    buffer_load_dwordx4 v3, s[4:7], s28 offen lds
    s_add_u32 m0, s38, 49152
    buffer_load_dwordx4 v4, s[4:7], s28 offen lds
    s_add_u32 m0, s39, 49152
    buffer_load_dwordx4 v5, s[4:7], s28 offen lds
    s_add_u32 m0, s40, 49152
    buffer_load_dwordx4 v6, s[8:11], s29 offen lds
    s_add_u32 m0, s41, 49152
    buffer_load_dwordx4 v7, s[8:11], s29 offen lds
    s_add_u32 s28, s28, 128
    s_add_u32 s29, s29, 131072
    s_add_u32 m0, s36, 73728
    buffer_load_dwordx4 v2, s[4:7], s28 offen lds
    s_add_u32 m0, s37, 73728
    buffer_load_dwordx4 v3, s[4:7], s28 offen lds
    s_add_u32 m0, s38, 73728
    buffer_load_dwordx4 v4, s[4:7], s28 offen lds
    s_add_u32 m0, s39, 73728
    buffer_load_dwordx4 v5, s[4:7], s28 offen lds
    s_add_u32 m0, s40, 73728
    buffer_load_dwordx4 v6, s[8:11], s29 offen lds
    s_add_u32 m0, s41, 73728
    buffer_load_dwordx4 v7, s[8:11], s29 offen lds
    s_add_u32 s28, s28, 128
    s_add_u32 s29, s29, 131072
    v_accvgpr_write_b32 a0, 0
    v_accvgpr_write_b32 a1, 0
    v_accvgpr_write_b32 a2, 0
    v_accvgpr_write_b32 a3, 0
    v_accvgpr_write_b32 a4, 0
    v_accvgpr_write_b32 a5, 0
    v_accvgpr_write_b32 a6, 0
    v_accvgpr_write_b32 a7, 0
    v_accvgpr_write_b32 a8, 0
    v_accvgpr_write_b32 a9, 0
    v_accvgpr_write_b32 a10, 0
    v_accvgpr_write_b32 a11, 0
    v_accvgpr_write_b32 a12, 0
    v_accvgpr_write_b32 a13, 0
    v_accvgpr_write_b32 a14, 0
    v_accvgpr_write_b32 a15, 0
    v_accvgpr_write_b32 a16, 0
    v_accvgpr_write_b32 a17, 0
    v_accvgpr_write_b32 a18, 0
    v_accvgpr_write_b32 a19, 0
    v_accvgpr_write_b32 a20, 0
    v_accvgpr_write_b32 a21, 0
    v_accvgpr_write_b32 a22, 0
    v_accvgpr_write_b32 a23, 0
    v_accvgpr_write_b32 a24, 0
    v_accvgpr_write_b32 a25, 0
    v_accvgpr_write_b32 a26, 0
    v_accvgpr_write_b32 a27, 0
    v_accvgpr_write_b32 a28, 0
    v_accvgpr_write_b32 a29, 0
    v_accvgpr_write_b32 a30, 0
    v_accvgpr_write_b32 a31, 0
    s_waitcnt vmcnt(18)
    s_barrier
    ds_read_b128 v[40:43], v8 offset:0
    ds_read_b128 v[44:47], v8 offset:2048
    ds_read_b64_tr_b16 v[48:49], v16 offset:0
    ds_read_b64_tr_b16 v[50:51], v16 offset:512
    ds_read_b64_tr_b16 v[52:53], v20 offset:0
    ds_read_b64_tr_b16 v[54:55], v20 offset:512
    ds_read_b64_tr_b16 v[56:57], v24 offset:0
    ds_read_b64_tr_b16 v[58:59], v24 offset:512
    ds_read_b64_tr_b16 v[60:61], v28 offset:0
    ds_read_b64_tr_b16 v[62:63], v28 offset:512
    s_waitcnt lgkmcnt(0)
    ds_read_b128 v[64:67], v12 offset:0
    v_mfma_f32_16x16x32_bf16 a[0:3], v[48:51], v[40:43], a[0:3]
    ds_read_b128 v[68:71], v12 offset:2048
    v_mfma_f32_16x16x32_bf16 a[16:19], v[48:51], v[44:47], a[16:19]
    ds_read_b64_tr_b16 v[72:73], v16 offset:4096
    v_mfma_f32_16x16x32_bf16 a[4:7], v[52:55], v[40:43], a[4:7]
    ds_read_b64_tr_b16 v[74:75], v16 offset:4608
    v_mfma_f32_16x16x32_bf16 a[20:23], v[52:55], v[44:47], a[20:23]
    ds_read_b64_tr_b16 v[76:77], v20 offset:4096
    v_mfma_f32_16x16x32_bf16 a[8:11], v[56:59], v[40:43], a[8:11]
    ds_read_b64_tr_b16 v[78:79], v20 offset:4608
    v_mfma_f32_16x16x32_bf16 a[24:27], v[56:59], v[44:47], a[24:27]
    ds_read_b64_tr_b16 v[80:81], v24 offset:4096
    v_mfma_f32_16x16x32_bf16 a[12:15], v[60:63], v[40:43], a[12:15]
    ds_read_b64_tr_b16 v[82:83], v24 offset:4608
    v_mfma_f32_16x16x32_bf16 a[28:31], v[60:63], v[44:47], a[28:31]
    ds_read_b64_tr_b16 v[84:85], v28 offset:4096
    ds_read_b64_tr_b16 v[86:87], v28 offset:4608
    s_waitcnt lgkmcnt(0)
    v_mfma_f32_16x16x32_bf16 a[0:3], v[72:75], v[64:67], a[0:3]
    v_mfma_f32_16x16x32_bf16 a[16:19], v[72:75], v[68:71], a[16:19]
    s_waitcnt vmcnt(12)
    s_barrier
    s_add_u32 m0, s36, 0
    buffer_load_dwordx4 v2, s[4:7], s28 offen lds
    s_add_u32 m0, s37, 0
    buffer_load_dwordx4 v3, s[4:7], s28 offen lds
    s_add_u32 m0, s38, 0
    buffer_load_dwordx4 v4, s[4:7], s28 offen lds
    s_add_u32 m0, s39, 0
    buffer_load_dwordx4 v5, s[4:7], s28 offen lds
    s_add_u32 m0, s40, 0
    buffer_load_dwordx4 v6, s[8:11], s29 offen lds
    s_add_u32 m0, s41, 0
    buffer_load_dwordx4 v7, s[8:11], s29 offen lds
    s_add_u32 s28, s28, 128
    s_add_u32 s29, s29, 131072
    ds_read_b128 v[40:43], v9 offset:0
    v_mfma_f32_16x16x32_bf16 a[4:7], v[76:79], v[64:67], a[4:7]
    ds_read_b128 v[44:47], v9 offset:2048
    v_mfma_f32_16x16x32_bf16 a[20:23], v[76:79], v[68:71], a[20:23]
    ds_read_b64_tr_b16 v[48:49], v17 offset:0
    v_mfma_f32_16x16x32_bf16 a[8:11], v[80:83], v[64:67], a[8:11]
    ds_read_b64_tr_b16 v[50:51], v17 offset:512
    v_mfma_f32_16x16x32_bf16 a[24:27], v[80:83], v[68:71], a[24:27]
    ds_read_b64_tr_b16 v[52:53], v21 offset:0
    v_mfma_f32_16x16x32_bf16 a[12:15], v[84:87], v[64:67], a[12:15]
    ds_read_b64_tr_b16 v[54:55], v21 offset:512
    v_mfma_f32_16x16x32_bf16 a[28:31], v[84:87], v[68:71], a[28:31]
    ds_read_b64_tr_b16 v[56:57], v25 offset:0
    ds_read_b64_tr_b16 v[58:59], v25 offset:512
    ds_read_b64_tr_b16 v[60:61], v29 offset:0
    ds_read_b64_tr_b16 v[62:63], v29 offset:512
    s_waitcnt lgkmcnt(0)
    ds_read_b128 v[64:67], v13 offset:0
    v_mfma_f32_16x16x32_bf16 a[0:3], v[48:51], v[40:43], a[0:3]
    ds_read_b128 v[68:71], v13 offset:2048
    v_mfma_f32_16x16x32_bf16 a[16:19], v[48:51], v[44:47], a[16:19]
    ds_read_b64_tr_b16 v[72:73], v17 offset:4096
    v_mfma_f32_16x16x32_bf16 a[4:7], v[52:55], v[40:43], a[4:7]
    ds_read_b64_tr_b16 v[74:75], v17 offset:4608
    v_mfma_f32_16x16x32_bf16 a[20:23], v[52:55], v[44:47], a[20:23]
    ds_read_b64_tr_b16 v[76:77], v21 offset:4096
    v_mfma_f32_16x16x32_bf16 a[8:11], v[56:59], v[40:43], a[8:11]
    ds_read_b64_tr_b16 v[78:79], v21 offset:4608
    v_mfma_f32_16x16x32_bf16 a[24:27], v[56:59], v[44:47], a[24:27]
    ds_read_b64_tr_b16 v[80:81], v25 offset:4096
    v_mfma_f32_16x16x32_bf16 a[12:15], v[60:63], v[40:43], a[12:15]
    ds_read_b64_tr_b16 v[82:83], v25 offset:4608
    v_mfma_f32_16x16x32_bf16 a[28:31], v[60:63], v[44:47], a[28:31]
    ds_read_b64_tr_b16 v[84:85], v29 offset:4096
    ds_read_b64_tr_b16 v[86:87], v29 offset:4608
    s_waitcnt lgkmcnt(0)
    v_mfma_f32_16x16x32_bf16 a[0:3], v[72:75], v[64:67], a[0:3]
    v_mfma_f32_16x16x32_bf16 a[16:19], v[72:75], v[68:71], a[16:19]
    s_waitcnt vmcnt(12)
    s_barrier
    s_add_u32 m0, s36, 24576
    buffer_load_dwordx4 v2, s[4:7], s28 offen lds
    s_add_u32 m0, s37, 24576
    buffer_load_dwordx4 v3, s[4:7], s28 offen lds
    s_add_u32 m0, s38, 24576
    buffer_load_dwordx4 v4, s[4:7], s28 offen lds
    s_add_u32 m0, s39, 24576
    buffer_load_dwordx4 v5, s[4:7], s28 offen lds
    s_add_u32 m0, s40, 24576
    buffer_load_dwordx4 v6, s[8:11], s29 offen lds
    s_add_u32 m0, s41, 24576
    buffer_load_dwordx4 v7, s[8:11], s29 offen lds
    s_add_u32 s28, s28, 128
    s_add_u32 s29, s29, 131072
    ds_read_b128 v[40:43], v10 offset:0
    v_mfma_f32_16x16x32_bf16 a[4:7], v[76:79], v[64:67], a[4:7]
    ds_read_b128 v[44:47], v10 offset:2048
    v_mfma_f32_16x16x32_bf16 a[20:23], v[76:79], v[68:71], a[20:23]
    ds_read_b64_tr_b16 v[48:49], v18 offset:0
    v_mfma_f32_16x16x32_bf16 a[8:11], v[80:83], v[64:67], a[8:11]
    ds_read_b64_tr_b16 v[50:51], v18 offset:512
    v_mfma_f32_16x16x32_bf16 a[24:27], v[80:83], v[68:71], a[24:27]
    ds_read_b64_tr_b16 v[52:53], v22 offset:0
    v_mfma_f32_16x16x32_bf16 a[12:15], v[84:87], v[64:67], a[12:15]
    ds_read_b64_tr_b16 v[54:55], v22 offset:512
    v_mfma_f32_16x16x32_bf16 a[28:31], v[84:87], v[68:71], a[28:31]
    ds_read_b64_tr_b16 v[56:57], v26 offset:0
    ds_read_b64_tr_b16 v[58:59], v26 offset:512
    ds_read_b64_tr_b16 v[60:61], v30 offset:0
    ds_read_b64_tr_b16 v[62:63], v30 offset:512
    s_waitcnt lgkmcnt(0)
    ds_read_b128 v[64:67], v14 offset:0
    v_mfma_f32_16x16x32_bf16 a[0:3], v[48:51], v[40:43], a[0:3]
    ds_read_b128 v[68:71], v14 offset:2048
    v_mfma_f32_16x16x32_bf16 a[16:19], v[48:51], v[44:47], a[16:19]
    ds_read_b64_tr_b16 v[72:73], v18 offset:4096
    v_mfma_f32_16x16x32_bf16 a[4:7], v[52:55], v[40:43], a[4:7]
    ds_read_b64_tr_b16 v[74:75], v18 offset:4608
    v_mfma_f32_16x16x32_bf16 a[20:23], v[52:55], v[44:47], a[20:23]
    ds_read_b64_tr_b16 v[76:77], v22 offset:4096
    v_mfma_f32_16x16x32_bf16 a[8:11], v[56:59], v[40:43], a[8:11]
    ds_read_b64_tr_b16 v[78:79], v22 offset:4608
    v_mfma_f32_16x16x32_bf16 a[24:27], v[56:59], v[44:47], a[24:27]
    ds_read_b64_tr_b16 v[80:81], v26 offset:4096
    v_mfma_f32_16x16x32_bf16 a[12:15], v[60:63], v[40:43], a[12:15]
    ds_read_b64_tr_b16 v[82:83], v26 offset:4608
    v_mfma_f32_16x16x32_bf16 a[28:31], v[60:63], v[44:47], a[28:31]
    ds_read_b64_tr_b16 v[84:85], v30 offset:4096
    ds_read_b64_tr_b16 v[86:87], v30 offset:4608
    s_waitcnt lgkmcnt(0)
    v_mfma_f32_16x16x32_bf16 a[0:3], v[72:75], v[64:67], a[0:3]
    v_mfma_f32_16x16x32_bf16 a[16:19], v[72:75], v[68:71], a[16:19]
    s_waitcnt vmcnt(12)
    s_barrier
    s_add_u32 m0, s36, 49152
    buffer_load_dwordx4 v2, s[4:7], s28 offen lds
    s_add_u32 m0, s37, 49152
    buffer_load_dwordx4 v3, s[4:7], s28 offen lds
    s_add_u32 m0, s38, 49152
    buffer_load_dwordx4 v4, s[4:7], s28 offen lds
    s_add_u32 m0, s39, 49152
    buffer_load_dwordx4 v5, s[4:7], s28 offen lds
    s_add_u32 m0, s40, 49152
    buffer_load_dwordx4 v6, s[8:11], s29 offen lds
    s_add_u32 m0, s41, 49152
    buffer_load_dwordx4 v7, s[8:11], s29 offen lds
    s_add_u32 s28, s28, 128
    s_add_u32 s29, s29, 131072
    ds_read_b128 v[40:43], v11 offset:0
    v_mfma_f32_16x16x32_bf16 a[4:7], v[76:79], v[64:67], a[4:7]
    ds_read_b128 v[44:47], v11 offset:2048
    v_mfma_f32_16x16x32_bf16 a[20:23], v[76:79], v[68:71], a[20:23]
    ds_read_b64_tr_b16 v[48:49], v19 offset:0
    v_mfma_f32_16x16x32_bf16 a[8:11], v[80:83], v[64:67], a[8:11]
    ds_read_b64_tr_b16 v[50:51], v19 offset:512
    v_mfma_f32_16x16x32_bf16 a[24:27], v[80:83], v[68:71], a[24:27]
    ds_read_b64_tr_b16 v[52:53], v23 offset:0
    v_mfma_f32_16x16x32_bf16 a[12:15], v[84:87], v[64:67], a[12:15]
    ds_read_b64_tr_b16 v[54:55], v23 offset:512
    v_mfma_f32_16x16x32_bf16 a[28:31], v[84:87], v[68:71], a[28:31]
    ds_read_b64_tr_b16 v[56:57], v27 offset:0
    ds_read_b64_tr_b16 v[58:59], v27 offset:512
    ds_read_b64_tr_b16 v[60:61], v31 offset:0
    ds_read_b64_tr_b16 v[62:63], v31 offset:512
    s_waitcnt lgkmcnt(0)
    ds_read_b128 v[64:67], v15 offset:0
    v_mfma_f32_16x16x32_bf16 a[0:3], v[48:51], v[40:43], a[0:3]
    ds_read_b128 v[68:71], v15 offset:2048
    v_mfma_f32_16x16x32_bf16 a[16:19], v[48:51], v[44:47], a[16:19]
    ds_read_b64_tr_b16 v[72:73], v19 offset:4096
    v_mfma_f32_16x16x32_bf16 a[4:7], v[52:55], v[40:43], a[4:7]
    ds_read_b64_tr_b16 v[74:75], v19 offset:4608
    v_mfma_f32_16x16x32_bf16 a[20:23], v[52:55], v[44:47], a[20:23]
    ds_read_b64_tr_b16 v[76:77], v23 offset:4096
    v_mfma_f32_16x16x32_bf16 a[8:11], v[56:59], v[40:43], a[8:11]
    ds_read_b64_tr_b16 v[78:79], v23 offset:4608
    v_mfma_f32_16x16x32_bf16 a[24:27], v[56:59], v[44:47], a[24:27]
    ds_read_b64_tr_b16 v[80:81], v27 offset:4096
    v_mfma_f32_16x16x32_bf16 a[12:15], v[60:63], v[40:43], a[12:15]
    ds_read_b64_tr_b16 v[82:83], v27 offset:4608
    v_mfma_f32_16x16x32_bf16 a[28:31], v[60:63], v[44:47], a[28:31]
    ds_read_b64_tr_b16 v[84:85], v31 offset:4096
    ds_read_b64_tr_b16 v[86:87], v31 offset:4608
    s_waitcnt lgkmcnt(0)
    v_mfma_f32_16x16x32_bf16 a[0:3], v[72:75], v[64:67], a[0:3]
    v_mfma_f32_16x16x32_bf16 a[16:19], v[72:75], v[68:71], a[16:19]
    s_waitcnt vmcnt(12)
    s_barrier
    s_add_u32 m0, s36, 73728
    buffer_load_dwordx4 v2, s[4:7], s28 offen lds
    s_add_u32 m0, s37, 73728
    buffer_load_dwordx4 v3, s[4:7], s28 offen lds
    s_add_u32 m0, s38, 73728
    buffer_load_dwordx4 v4, s[4:7], s28 offen lds
    s_add_u32 m0, s39, 73728
    buffer_load_dwordx4 v5, s[4:7], s28 offen lds
    s_add_u32 m0, s40, 73728
    buffer_load_dwordx4 v6, s[8:11], s29 offen lds
    s_add_u32 m0, s41, 73728
    buffer_load_dwordx4 v7, s[8:11], s29 offen lds
    s_add_u32 s28, s28, 128
    s_add_u32 s29, s29, 131072
    ds_read_b128 v[40:43], v8 offset:0
    v_mfma_f32_16x16x32_bf16 a[4:7], v[76:79], v[64:67], a[4:7]
    ds_read_b128 v[44:47], v8 offset:2048
    v_mfma_f32_16x16x32_bf16 a[20:23], v[76:79], v[68:71], a[20:23]
    ds_read_b64_tr_b16 v[48:49], v16 offset:0
    v_mfma_f32_16x16x32_bf16 a[8:11], v[80:83], v[64:67], a[8:11]
    ds_read_b64_tr_b16 v[50:51], v16 offset:512
    v_mfma_f32_16x16x32_bf16 a[24:27], v[80:83], v[68:71], a[24:27]
    ds_read_b64_tr_b16 v[52:53], v20 offset:0
    v_mfma_f32_16x16x32_bf16 a[12:15], v[84:87], v[64:67], a[12:15]
    ds_read_b64_tr_b16 v[54:55], v20 offset:512
    v_mfma_f32_16x16x32_bf16 a[28:31], v[84:87], v[68:71], a[28:31]
    ds_read_b64_tr_b16 v[56:57], v24 offset:0
    ds_read_b64_tr_b16 v[58:59], v24 offset:512
    ds_read_b64_tr_b16 v[60:61], v28 offset:0
    ds_read_b64_tr_b16 v[62:63], v28 offset:512
    s_waitcnt lgkmcnt(0)
    ds_read_b128 v[64:67], v12 offset:0
    v_mfma_f32_16x16x32_bf16 a[0:3], v[48:51], v[40:43], a[0:3]
    ds_read_b128 v[68:71], v12 offset:2048
    v_mfma_f32_16x16x32_bf16 a[16:19], v[48:51], v[44:47], a[16:19]
    ds_read_b64_tr_b16 v[72:73], v16 offset:4096
    v_mfma_f32_16x16x32_bf16 a[4:7], v[52:55], v[40:43], a[4:7]
    ds_read_b64_tr_b16 v[74:75], v16 offset:4608
    v_mfma_f32_16x16x32_bf16 a[20:23], v[52:55], v[44:47], a[20:23]
    ds_read_b64_tr_b16 v[76:77], v20 offset:4096
    v_mfma_f32_16x16x32_bf16 a[8:11], v[56:59], v[40:43], a[8:11]
    ds_read_b64_tr_b16 v[78:79], v20 offset:4608
    v_mfma_f32_16x16x32_bf16 a[24:27], v[56:59], v[44:47], a[24:27]
    ds_read_b64_tr_b16 v[80:81], v24 offset:4096
    v_mfma_f32_16x16x32_bf16 a[12:15], v[60:63], v[40:43], a[12:15]
    ds_read_b64_tr_b16 v[82:83], v24 offset:4608
    v_mfma_f32_16x16x32_bf16 a[28:31], v[60:63], v[44:47], a[28:31]
    ds_read_b64_tr_b16 v[84:85], v28 offset:4096
    ds_read_b64_tr_b16 v[86:87], v28 offset:4608
    s_waitcnt lgkmcnt(0)
    v_mfma_f32_16x16x32_bf16 a[0:3], v[72:75], v[64:67], a[0:3]
    v_mfma_f32_16x16x32_bf16 a[16:19], v[72:75], v[68:71], a[16:19]
    s_waitcnt vmcnt(12)
    s_barrier
    s_add_u32 m0, s36, 0
    buffer_load_dwordx4 v2, s[4:7], s28 offen lds
    s_add_u32 m0, s37, 0
    buffer_load_dwordx4 v3, s[4:7], s28 offen lds
    s_add_u32 m0, s38, 0
    buffer_load_dwordx4 v4, s[4:7], s28 offen lds
    s_add_u32 m0, s39, 0
    buffer_load_dwordx4 v5, s[4:7], s28 offen lds
    s_add_u32 m0, s40, 0
    buffer_load_dwordx4 v6, s[8:11], s29 offen lds
    s_add_u32 m0, s41, 0
    buffer_load_dwordx4 v7, s[8:11], s29 offen lds
    s_add_u32 s28, s28, 128
    s_add_u32 s29, s29, 131072
    ds_read_b128 v[40:43], v9 offset:0
    v_mfma_f32_16x16x32_bf16 a[4:7], v[76:79], v[64:67], a[4:7]
    ds_read_b128 v[44:47], v9 offset:2048
    v_mfma_f32_16x16x32_bf16 a[20:23], v[76:79], v[68:71], a[20:23]
    ds_read_b64_tr_b16 v[48:49], v17 offset:0
    v_mfma_f32_16x16x32_bf16 a[8:11], v[80:83], v[64:67], a[8:11]
    ds_read_b64_tr_b16 v[50:51], v17 offset:512
    v_mfma_f32_16x16x32_bf16 a[24:27], v[80:83], v[68:71], a[24:27]
    ds_read_b64_tr_b16 v[52:53], v21 offset:0
    v_mfma_f32_16x16x32_bf16 a[12:15], v[84:87], v[64:67], a[12:15]
    ds_read_b64_tr_b16 v[54:55], v21 offset:512
    v_mfma_f32_16x16x32_bf16 a[28:31], v[84:87], v[68:71], a[28:31]
    ds_read_b64_tr_b16 v[56:57], v25 offset:0
    ds_read_b64_tr_b16 v[58:59], v25 offset:512
    ds_read_b64_tr_b16 v[60:61], v29 offset:0
    ds_read_b64_tr_b16 v[62:63], v29 offset:512
    s_waitcnt lgkmcnt(0)
    ds_read_b128 v[64:67], v13 offset:0
    v_mfma_f32_16x16x32_bf16 a[0:3], v[48:51], v[40:43], a[0:3]
    ds_read_b128 v[68:71], v13 offset:2048
    v_mfma_f32_16x16x32_bf16 a[16:19], v[48:51], v[44:47], a[16:19]
    ds_read_b64_tr_b16 v[72:73], v17 offset:4096
    v_mfma_f32_16x16x32_bf16 a[4:7], v[52:55], v[40:43], a[4:7]
    ds_read_b64_tr_b16 v[74:75], v17 offset:4608
    v_mfma_f32_16x16x32_bf16 a[20:23], v[52:55], v[44:47], a[20:23]
    ds_read_b64_tr_b16 v[76:77], v21 offset:4096
    v_mfma_f32_16x16x32_bf16 a[8:11], v[56:59], v[40:43], a[8:11]
    ds_read_b64_tr_b16 v[78:79], v21 offset:4608
    v_mfma_f32_16x16x32_bf16 a[24:27], v[56:59], v[44:47], a[24:27]
    ds_read_b64_tr_b16 v[80:81], v25 offset:4096
    v_mfma_f32_16x16x32_bf16 a[12:15], v[60:63], v[40:43], a[12:15]
    ds_read_b64_tr_b16 v[82:83], v25 offset:4608
    v_mfma_f32_16x16x32_bf16 a[28:31], v[60:63], v[44:47], a[28:31]
    ds_read_b64_tr_b16 v[84:85], v29 offset:4096
    ds_read_b64_tr_b16 v[86:87], v29 offset:4608
    s_waitcnt lgkmcnt(0)
    v_mfma_f32_16x16x32_bf16 a[0:3], v[72:75], v[64:67], a[0:3]
    v_mfma_f32_16x16x32_bf16 a[16:19], v[72:75], v[68:71], a[16:19]
    s_waitcnt vmcnt(12)
    s_barrier
    s_add_u32 m0, s36, 24576
    buffer_load_dwordx4 v2, s[4:7], s28 offen lds
    s_add_u32 m0, s37, 24576
    buffer_load_dwordx4 v3, s[4:7], s28 offen lds
    s_add_u32 m0, s38, 24576
    buffer_load_dwordx4 v4, s[4:7], s28 offen lds
    s_add_u32 m0, s39, 24576
    buffer_load_dwordx4 v5, s[4:7], s28 offen lds
    s_add_u32 m0, s40, 24576
    buffer_load_dwordx4 v6, s[8:11], s29 offen lds
    s_add_u32 m0, s41, 24576
    buffer_load_dwordx4 v7, s[8:11], s29 offen lds
    s_add_u32 s28, s28, 128
    s_add_u32 s29, s29, 131072
    ds_read_b128 v[40:43], v10 offset:0
    v_mfma_f32_16x16x32_bf16 a[4:7], v[76:79], v[64:67], a[4:7]
    ds_read_b128 v[44:47], v10 offset:2048
    v_mfma_f32_16x16x32_bf16 a[20:23], v[76:79], v[68:71], a[20:23]
    ds_read_b64_tr_b16 v[48:49], v18 offset:0
    v_mfma_f32_16x16x32_bf16 a[8:11], v[80:83], v[64:67], a[8:11]
    ds_read_b64_tr_b16 v[50:51], v18 offset:512
    v_mfma_f32_16x16x32_bf16 a[24:27], v[80:83], v[68:71], a[24:27]
    ds_read_b64_tr_b16 v[52:53], v22 offset:0
    v_mfma_f32_16x16x32_bf16 a[12:15], v[84:87], v[64:67], a[12:15]
    ds_read_b64_tr_b16 v[54:55], v22 offset:512
    v_mfma_f32_16x16x32_bf16 a[28:31], v[84:87], v[68:71], a[28:31]
    ds_read_b64_tr_b16 v[56:57], v26 offset:0
    ds_read_b64_tr_b16 v[58:59], v26 offset:512
    ds_read_b64_tr_b16 v[60:61], v30 offset:0
    ds_read_b64_tr_b16 v[62:63], v30 offset:512
    s_waitcnt lgkmcnt(0)
    ds_read_b128 v[64:67], v14 offset:0
    v_mfma_f32_16x16x32_bf16 a[0:3], v[48:51], v[40:43], a[0:3]
    ds_read_b128 v[68:71], v14 offset:2048
    v_mfma_f32_16x16x32_bf16 a[16:19], v[48:51], v[44:47], a[16:19]
    ds_read_b64_tr_b16 v[72:73], v18 offset:4096
    v_mfma_f32_16x16x32_bf16 a[4:7], v[52:55], v[40:43], a[4:7]
    ds_read_b64_tr_b16 v[74:75], v18 offset:4608
    v_mfma_f32_16x16x32_bf16 a[20:23], v[52:55], v[44:47], a[20:23]
    ds_read_b64_tr_b16 v[76:77], v22 offset:4096
    v_mfma_f32_16x16x32_bf16 a[8:11], v[56:59], v[40:43], a[8:11]
    ds_read_b64_tr_b16 v[78:79], v22 offset:4608
    v_mfma_f32_16x16x32_bf16 a[24:27], v[56:59], v[44:47], a[24:27]
    ds_read_b64_tr_b16 v[80:81], v26 offset:4096
    v_mfma_f32_16x16x32_bf16 a[12:15], v[60:63], v[40:43], a[12:15]
    ds_read_b64_tr_b16 v[82:83], v26 offset:4608
    v_mfma_f32_16x16x32_bf16 a[28:31], v[60:63], v[44:47], a[28:31]
    ds_read_b64_tr_b16 v[84:85], v30 offset:4096
    ds_read_b64_tr_b16 v[86:87], v30 offset:4608
    s_waitcnt lgkmcnt(0)
    v_mfma_f32_16x16x32_bf16 a[0:3], v[72:75], v[64:67], a[0:3]
    v_mfma_f32_16x16x32_bf16 a[16:19], v[72:75], v[68:71], a[16:19]
    s_waitcnt vmcnt(12)
    s_barrier
    s_add_u32 m0, s36, 49152
    buffer_load_dwordx4 v2, s[4:7], s28 offen lds
    s_add_u32 m0, s37, 49152
    buffer_load_dwordx4 v3, s[4:7], s28 offen lds
    s_add_u32 m0, s38, 49152
    buffer_load_dwordx4 v4, s[4:7], s28 offen lds
    s_add_u32 m0, s39, 49152
    buffer_load_dwordx4 v5, s[4:7], s28 offen lds
    s_add_u32 m0, s40, 49152
    buffer_load_dwordx4 v6, s[8:11], s29 offen lds
    s_add_u32 m0, s41, 49152
    buffer_load_dwordx4 v7, s[8:11], s29 offen lds
    s_add_u32 s28, s28, 128
    s_add_u32 s29, s29, 131072
    ds_read_b128 v[40:43], v11 offset:0
    v_mfma_f32_16x16x32_bf16 a[4:7], v[76:79], v[64:67], a[4:7]
    ds_read_b128 v[44:47], v11 offset:2048
    v_mfma_f32_16x16x32_bf16 a[20:23], v[76:79], v[68:71], a[20:23]
    ds_read_b64_tr_b16 v[48:49], v19 offset:0
    v_mfma_f32_16x16x32_bf16 a[8:11], v[80:83], v[64:67], a[8:11]
    ds_read_b64_tr_b16 v[50:51], v19 offset:512
    v_mfma_f32_16x16x32_bf16 a[24:27], v[80:83], v[68:71], a[24:27]
    ds_read_b64_tr_b16 v[52:53], v23 offset:0
    v_mfma_f32_16x16x32_bf16 a[12:15], v[84:87], v[64:67], a[12:15]
    ds_read_b64_tr_b16 v[54:55], v23 offset:512
    v_mfma_f32_16x16x32_bf16 a[28:31], v[84:87], v[68:71], a[28:31]
    ds_read_b64_tr_b16 v[56:57], v27 offset:0
    ds_read_b64_tr_b16 v[58:59], v27 offset:512
    ds_read_b64_tr_b16 v[60:61], v31 offset:0
    ds_read_b64_tr_b16 v[62:63], v31 offset:512
    s_waitcnt lgkmcnt(0)
    ds_read_b128 v[64:67], v15 offset:0
    v_mfma_f32_16x16x32_bf16 a[0:3], v[48:51], v[40:43], a[0:3]
    ds_read_b128 v[68:71], v15 offset:2048
    v_mfma_f32_16x16x32_bf16 a[16:19], v[48:51], v[44:47], a[16:19]
    ds_read_b64_tr_b16 v[72:73], v19 offset:4096
    v_mfma_f32_16x16x32_bf16 a[4:7], v[52:55], v[40:43], a[4:7]
    ds_read_b64_tr_b16 v[74:75], v19 offset:4608
    v_mfma_f32_16x16x32_bf16 a[20:23], v[52:55], v[44:47], a[20:23]
    ds_read_b64_tr_b16 v[76:77], v23 offset:4096
    v_mfma_f32_16x16x32_bf16 a[8:11], v[56:59], v[40:43], a[8:11]
    ds_read_b64_tr_b16 v[78:79], v23 offset:4608
    v_mfma_f32_16x16x32_bf16 a[24:27], v[56:59], v[44:47], a[24:27]
    ds_read_b64_tr_b16 v[80:81], v27 offset:4096
    v_mfma_f32_16x16x32_bf16 a[12:15], v[60:63], v[40:43], a[12:15]
    ds_read_b64_tr_b16 v[82:83], v27 offset:4608
    v_mfma_f32_16x16x32_bf16 a[28:31], v[60:63], v[44:47], a[28:31]
    ds_read_b64_tr_b16 v[84:85], v31 offset:4096
    ds_read_b64_tr_b16 v[86:87], v31 offset:4608
    s_waitcnt lgkmcnt(0)
    v_mfma_f32_16x16x32_bf16 a[0:3], v[72:75], v[64:67], a[0:3]
    v_mfma_f32_16x16x32_bf16 a[16:19], v[72:75], v[68:71], a[16:19]
    s_waitcnt vmcnt(12)
    s_barrier
    s_add_u32 m0, s36, 73728
    buffer_load_dwordx4 v2, s[4:7], s28 offen lds
    s_add_u32 m0, s37, 73728
    buffer_load_dwordx4 v3, s[4:7], s28 offen lds
    s_add_u32 m0, s38, 73728
    buffer_load_dwordx4 v4, s[4:7], s28 offen lds
    s_add_u32 m0, s39, 73728
    buffer_load_dwordx4 v5, s[4:7], s28 offen lds
    s_add_u32 m0, s40, 73728
    buffer_load_dwordx4 v6, s[8:11], s29 offen lds
    s_add_u32 m0, s41, 73728
    buffer_load_dwordx4 v7, s[8:11], s29 offen lds
    s_add_u32 s28, s28, 128
    s_add_u32 s29, s29, 131072
    ds_read_b128 v[40:43], v8 offset:0
    v_mfma_f32_16x16x32_bf16 a[4:7], v[76:79], v[64:67], a[4:7]
    ds_read_b128 v[44:47], v8 offset:2048
    v_mfma_f32_16x16x32_bf16 a[20:23], v[76:79], v[68:71], a[20:23]
    ds_read_b64_tr_b16 v[48:49], v16 offset:0
    v_mfma_f32_16x16x32_bf16 a[8:11], v[80:83], v[64:67], a[8:11]
    ds_read_b64_tr_b16 v[50:51], v16 offset:512
    v_mfma_f32_16x16x32_bf16 a[24:27], v[80:83], v[68:71], a[24:27]
    ds_read_b64_tr_b16 v[52:53], v20 offset:0
    v_mfma_f32_16x16x32_bf16 a[12:15], v[84:87], v[64:67], a[12:15]
    ds_read_b64_tr_b16 v[54:55], v20 offset:512
    v_mfma_f32_16x16x32_bf16 a[28:31], v[84:87], v[68:71], a[28:31]
    ds_read_b64_tr_b16 v[56:57], v24 offset:0
    ds_read_b64_tr_b16 v[58:59], v24 offset:512
    ds_read_b64_tr_b16 v[60:61], v28 offset:0
    ds_read_b64_tr_b16 v[62:63], v28 offset:512
    s_waitcnt lgkmcnt(0)
    ds_read_b128 v[64:67], v12 offset:0
    v_mfma_f32_16x16x32_bf16 a[0:3], v[48:51], v[40:43], a[0:3]
    ds_read_b128 v[68:71], v12 offset:2048
    v_mfma_f32_16x16x32_bf16 a[16:19], v[48:51], v[44:47], a[16:19]
    ds_read_b64_tr_b16 v[72:73], v16 offset:4096
    v_mfma_f32_16x16x32_bf16 a[4:7], v[52:55], v[40:43], a[4:7]
    ds_read_b64_tr_b16 v[74:75], v16 offset:4608
    v_mfma_f32_16x16x32_bf16 a[20:23], v[52:55], v[44:47], a[20:23]
    ds_read_b64_tr_b16 v[76:77], v20 offset:4096
    v_mfma_f32_16x16x32_bf16 a[8:11], v[56:59], v[40:43], a[8:11]
    ds_read_b64_tr_b16 v[78:79], v20 offset:4608
    v_mfma_f32_16x16x32_bf16 a[24:27], v[56:59], v[44:47], a[24:27]
    ds_read_b64_tr_b16 v[80:81], v24 offset:4096
    v_mfma_f32_16x16x32_bf16 a[12:15], v[60:63], v[40:43], a[12:15]
    ds_read_b64_tr_b16 v[82:83], v24 offset:4608
    v_mfma_f32_16x16x32_bf16 a[28:31], v[60:63], v[44:47], a[28:31]
    ds_read_b64_tr_b16 v[84:85], v28 offset:4096
    ds_read_b64_tr_b16 v[86:87], v28 offset:4608
    s_waitcnt lgkmcnt(0)
    v_mfma_f32_16x16x32_bf16 a[0:3], v[72:75], v[64:67], a[0:3]
    v_mfma_f32_16x16x32_bf16 a[16:19], v[72:75], v[68:71], a[16:19]
    s_waitcnt vmcnt(12)
    s_barrier
    s_add_u32 m0, s36, 0
    buffer_load_dwordx4 v2, s[4:7], s28 offen lds
    s_add_u32 m0, s37, 0
    buffer_load_dwordx4 v3, s[4:7], s28 offen lds
    s_add_u32 m0, s38, 0
    buffer_load_dwordx4 v4, s[4:7], s28 offen lds
    s_add_u32 m0, s39, 0
    buffer_load_dwordx4 v5, s[4:7], s28 offen lds
    s_add_u32 m0, s40, 0
    buffer_load_dwordx4 v6, s[8:11], s29 offen lds
    s_add_u32 m0, s41, 0
    buffer_load_dwordx4 v7, s[8:11], s29 offen lds
    s_add_u32 s28, s28, 128
    s_add_u32 s29, s29, 131072
    ds_read_b128 v[40:43], v9 offset:0
    v_mfma_f32_16x16x32_bf16 a[4:7], v[76:79], v[64:67], a[4:7]
    ds_read_b128 v[44:47], v9 offset:2048
    v_mfma_f32_16x16x32_bf16 a[20:23], v[76:79], v[68:71], a[20:23]
    ds_read_b64_tr_b16 v[48:49], v17 offset:0
    v_mfma_f32_16x16x32_bf16 a[8:11], v[80:83], v[64:67], a[8:11]
    ds_read_b64_tr_b16 v[50:51], v17 offset:512
    v_mfma_f32_16x16x32_bf16 a[24:27], v[80:83], v[68:71], a[24:27]
    ds_read_b64_tr_b16 v[52:53], v21 offset:0
    v_mfma_f32_16x16x32_bf16 a[12:15], v[84:87], v[64:67], a[12:15]
    ds_read_b64_tr_b16 v[54:55], v21 offset:512
    v_mfma_f32_16x16x32_bf16 a[28:31], v[84:87], v[68:71], a[28:31]
    ds_read_b64_tr_b16 v[56:57], v25 offset:0
    ds_read_b64_tr_b16 v[58:59], v25 offset:512
    ds_read_b64_tr_b16 v[60:61], v29 offset:0
    ds_read_b64_tr_b16 v[62:63], v29 offset:512
    s_waitcnt lgkmcnt(0)
    ds_read_b128 v[64:67], v13 offset:0
    v_mfma_f32_16x16x32_bf16 a[0:3], v[48:51], v[40:43], a[0:3]
    ds_read_b128 v[68:71], v13 offset:2048
    v_mfma_f32_16x16x32_bf16 a[16:19], v[48:51], v[44:47], a[16:19]
    ds_read_b64_tr_b16 v[72:73], v17 offset:4096
    v_mfma_f32_16x16x32_bf16 a[4:7], v[52:55], v[40:43], a[4:7]
    ds_read_b64_tr_b16 v[74:75], v17 offset:4608
    v_mfma_f32_16x16x32_bf16 a[20:23], v[52:55], v[44:47], a[20:23]
    ds_read_b64_tr_b16 v[76:77], v21 offset:4096
    v_mfma_f32_16x16x32_bf16 a[8:11], v[56:59], v[40:43], a[8:11]
    ds_read_b64_tr_b16 v[78:79], v21 offset:4608
    v_mfma_f32_16x16x32_bf16 a[24:27], v[56:59], v[44:47], a[24:27]
    ds_read_b64_tr_b16 v[80:81], v25 offset:4096
    v_mfma_f32_16x16x32_bf16 a[12:15], v[60:63], v[40:43], a[12:15]
    ds_read_b64_tr_b16 v[82:83], v25 offset:4608
    v_mfma_f32_16x16x32_bf16 a[28:31], v[60:63], v[44:47], a[28:31]
    ds_read_b64_tr_b16 v[84:85], v29 offset:4096
    ds_read_b64_tr_b16 v[86:87], v29 offset:4608
    s_waitcnt lgkmcnt(0)
    v_mfma_f32_16x16x32_bf16 a[0:3], v[72:75], v[64:67], a[0:3]
    v_mfma_f32_16x16x32_bf16 a[16:19], v[72:75], v[68:71], a[16:19]
    s_waitcnt vmcnt(12)
    s_barrier
    s_add_u32 m0, s36, 24576
    buffer_load_dwordx4 v2, s[4:7], s28 offen lds
    s_add_u32 m0, s37, 24576
    buffer_load_dwordx4 v3, s[4:7], s28 offen lds
    s_add_u32 m0, s38, 24576
    buffer_load_dwordx4 v4, s[4:7], s28 offen lds
    s_add_u32 m0, s39, 24576
    buffer_load_dwordx4 v5, s[4:7], s28 offen lds
    s_add_u32 m0, s40, 24576
    buffer_load_dwordx4 v6, s[8:11], s29 offen lds
    s_add_u32 m0, s41, 24576
    buffer_load_dwordx4 v7, s[8:11], s29 offen lds
    s_add_u32 s28, s28, 128
    s_add_u32 s29, s29, 131072
    ds_read_b128 v[40:43], v10 offset:0
    v_mfma_f32_16x16x32_bf16 a[4:7], v[76:79], v[64:67], a[4:7]
    ds_read_b128 v[44:47], v10 offset:2048
    v_mfma_f32_16x16x32_bf16 a[20:23], v[76:79], v[68:71], a[20:23]
    ds_read_b64_tr_b16 v[48:49], v18 offset:0
    v_mfma_f32_16x16x32_bf16 a[8:11], v[80:83], v[64:67], a[8:11]
    ds_read_b64_tr_b16 v[50:51], v18 offset:512
    v_mfma_f32_16x16x32_bf16 a[24:27], v[80:83], v[68:71], a[24:27]
    ds_read_b64_tr_b16 v[52:53], v22 offset:0
    v_mfma_f32_16x16x32_bf16 a[12:15], v[84:87], v[64:67], a[12:15]
    ds_read_b64_tr_b16 v[54:55], v22 offset:512
    v_mfma_f32_16x16x32_bf16 a[28:31], v[84:87], v[68:71], a[28:31]
    ds_read_b64_tr_b16 v[56:57], v26 offset:0
    ds_read_b64_tr_b16 v[58:59], v26 offset:512
    ds_read_b64_tr_b16 v[60:61], v30 offset:0
    ds_read_b64_tr_b16 v[62:63], v30 offset:512
    s_waitcnt lgkmcnt(0)
    ds_read_b128 v[64:67], v14 offset:0
    v_mfma_f32_16x16x32_bf16 a[0:3], v[48:51], v[40:43], a[0:3]
    ds_read_b128 v[68:71], v14 offset:2048
    v_mfma_f32_16x16x32_bf16 a[16:19], v[48:51], v[44:47], a[16:19]
    ds_read_b64_tr_b16 v[72:73], v18 offset:4096
    v_mfma_f32_16x16x32_bf16 a[4:7], v[52:55], v[40:43], a[4:7]
    ds_read_b64_tr_b16 v[74:75], v18 offset:4608
    v_mfma_f32_16x16x32_bf16 a[20:23], v[52:55], v[44:47], a[20:23]
    ds_read_b64_tr_b16 v[76:77], v22 offset:4096
    v_mfma_f32_16x16x32_bf16 a[8:11], v[56:59], v[40:43], a[8:11]
    ds_read_b64_tr_b16 v[78:79], v22 offset:4608
    v_mfma_f32_16x16x32_bf16 a[24:27], v[56:59], v[44:47], a[24:27]
    ds_read_b64_tr_b16 v[80:81], v26 offset:4096
    v_mfma_f32_16x16x32_bf16 a[12:15], v[60:63], v[40:43], a[12:15]
    ds_read_b64_tr_b16 v[82:83], v26 offset:4608
    v_mfma_f32_16x16x32_bf16 a[28:31], v[60:63], v[44:47], a[28:31]
    ds_read_b64_tr_b16 v[84:85], v30 offset:4096
    ds_read_b64_tr_b16 v[86:87], v30 offset:4608
    s_waitcnt lgkmcnt(0)
    v_mfma_f32_16x16x32_bf16 a[0:3], v[72:75], v[64:67], a[0:3]
    v_mfma_f32_16x16x32_bf16 a[16:19], v[72:75], v[68:71], a[16:19]
    s_waitcnt vmcnt(12)
    s_barrier
    s_add_u32 m0, s36, 49152
    buffer_load_dwordx4 v2, s[4:7], s28 offen lds
    s_add_u32 m0, s37, 49152
    buffer_load_dwordx4 v3, s[4:7], s28 offen lds
    s_add_u32 m0, s38, 49152
    buffer_load_dwordx4 v4, s[4:7], s28 offen lds
    s_add_u32 m0, s39, 49152
    buffer_load_dwordx4 v5, s[4:7], s28 offen lds
    s_add_u32 m0, s40, 49152
    buffer_load_dwordx4 v6, s[8:11], s29 offen lds
    s_add_u32 m0, s41, 49152
    buffer_load_dwordx4 v7, s[8:11], s29 offen lds
    s_add_u32 s28, s28, 128
    s_add_u32 s29, s29, 131072
    ds_read_b128 v[40:43], v11 offset:0
    v_mfma_f32_16x16x32_bf16 a[4:7], v[76:79], v[64:67], a[4:7]
    ds_read_b128 v[44:47], v11 offset:2048
    v_mfma_f32_16x16x32_bf16 a[20:23], v[76:79], v[68:71], a[20:23]
    ds_read_b64_tr_b16 v[48:49], v19 offset:0
    v_mfma_f32_16x16x32_bf16 a[8:11], v[80:83], v[64:67], a[8:11]
    ds_read_b64_tr_b16 v[50:51], v19 offset:512
    v_mfma_f32_16x16x32_bf16 a[24:27], v[80:83], v[68:71], a[24:27]
    ds_read_b64_tr_b16 v[52:53], v23 offset:0
    v_mfma_f32_16x16x32_bf16 a[12:15], v[84:87], v[64:67], a[12:15]
    ds_read_b64_tr_b16 v[54:55], v23 offset:512
    v_mfma_f32_16x16x32_bf16 a[28:31], v[84:87], v[68:71], a[28:31]
    ds_read_b64_tr_b16 v[56:57], v27 offset:0
    ds_read_b64_tr_b16 v[58:59], v27 offset:512
    ds_read_b64_tr_b16 v[60:61], v31 offset:0
    ds_read_b64_tr_b16 v[62:63], v31 offset:512
    s_waitcnt lgkmcnt(0)
    ds_read_b128 v[64:67], v15 offset:0
    v_mfma_f32_16x16x32_bf16 a[0:3], v[48:51], v[40:43], a[0:3]
    ds_read_b128 v[68:71], v15 offset:2048
    v_mfma_f32_16x16x32_bf16 a[16:19], v[48:51], v[44:47], a[16:19]
    ds_read_b64_tr_b16 v[72:73], v19 offset:4096
    v_mfma_f32_16x16x32_bf16 a[4:7], v[52:55], v[40:43], a[4:7]
    ds_read_b64_tr_b16 v[74:75], v19 offset:4608
    v_mfma_f32_16x16x32_bf16 a[20:23], v[52:55], v[44:47], a[20:23]
    ds_read_b64_tr_b16 v[76:77], v23 offset:4096
    v_mfma_f32_16x16x32_bf16 a[8:11], v[56:59], v[40:43], a[8:11]
    ds_read_b64_tr_b16 v[78:79], v23 offset:4608
    v_mfma_f32_16x16x32_bf16 a[24:27], v[56:59], v[44:47], a[24:27]
    ds_read_b64_tr_b16 v[80:81], v27 offset:4096
    v_mfma_f32_16x16x32_bf16 a[12:15], v[60:63], v[40:43], a[12:15]
    ds_read_b64_tr_b16 v[82:83], v27 offset:4608
    v_mfma_f32_16x16x32_bf16 a[28:31], v[60:63], v[44:47], a[28:31]
    ds_read_b64_tr_b16 v[84:85], v31 offset:4096
    ds_read_b64_tr_b16 v[86:87], v31 offset:4608
    s_waitcnt lgkmcnt(0)
    v_mfma_f32_16x16x32_bf16 a[0:3], v[72:75], v[64:67], a[0:3]
    v_mfma_f32_16x16x32_bf16 a[16:19], v[72:75], v[68:71], a[16:19]
    s_waitcnt vmcnt(12)
    s_barrier
    s_add_u32 m0, s36, 73728
    buffer_load_dwordx4 v2, s[4:7], s28 offen lds
    s_add_u32 m0, s37, 73728
    buffer_load_dwordx4 v3, s[4:7], s28 offen lds
    s_add_u32 m0, s38, 73728
    buffer_load_dwordx4 v4, s[4:7], s28 offen lds
    s_add_u32 m0, s39, 73728
    buffer_load_dwordx4 v5, s[4:7], s28 offen lds
    s_add_u32 m0, s40, 73728
    buffer_load_dwordx4 v6, s[8:11], s29 offen lds
    s_add_u32 m0, s41, 73728
    buffer_load_dwordx4 v7, s[8:11], s29 offen lds
    s_add_u32 s28, s28, 128
    s_add_u32 s29, s29, 131072
    ds_read_b128 v[40:43], v8 offset:0
    v_mfma_f32_16x16x32_bf16 a[4:7], v[76:79], v[64:67], a[4:7]
    ds_read_b128 v[44:47], v8 offset:2048
    v_mfma_f32_16x16x32_bf16 a[20:23], v[76:79], v[68:71], a[20:23]
    ds_read_b64_tr_b16 v[48:49], v16 offset:0
    v_mfma_f32_16x16x32_bf16 a[8:11], v[80:83], v[64:67], a[8:11]
    ds_read_b64_tr_b16 v[50:51], v16 offset:512
    v_mfma_f32_16x16x32_bf16 a[24:27], v[80:83], v[68:71], a[24:27]
    ds_read_b64_tr_b16 v[52:53], v20 offset:0
    v_mfma_f32_16x16x32_bf16 a[12:15], v[84:87], v[64:67], a[12:15]
    ds_read_b64_tr_b16 v[54:55], v20 offset:512
    v_mfma_f32_16x16x32_bf16 a[28:31], v[84:87], v[68:71], a[28:31]
    ds_read_b64_tr_b16 v[56:57], v24 offset:0
    ds_read_b64_tr_b16 v[58:59], v24 offset:512
    ds_read_b64_tr_b16 v[60:61], v28 offset:0
    ds_read_b64_tr_b16 v[62:63], v28 offset:512
    s_waitcnt lgkmcnt(0)
    ds_read_b128 v[64:67], v12 offset:0
    v_mfma_f32_16x16x32_bf16 a[0:3], v[48:51], v[40:43], a[0:3]
    ds_read_b128 v[68:71], v12 offset:2048
    v_mfma_f32_16x16x32_bf16 a[16:19], v[48:51], v[44:47], a[16:19]
    ds_read_b64_tr_b16 v[72:73], v16 offset:4096
    v_mfma_f32_16x16x32_bf16 a[4:7], v[52:55], v[40:43], a[4:7]
    ds_read_b64_tr_b16 v[74:75], v16 offset:4608
    v_mfma_f32_16x16x32_bf16 a[20:23], v[52:55], v[44:47], a[20:23]
    ds_read_b64_tr_b16 v[76:77], v20 offset:4096
    v_mfma_f32_16x16x32_bf16 a[8:11], v[56:59], v[40:43], a[8:11]
    ds_read_b64_tr_b16 v[78:79], v20 offset:4608
    v_mfma_f32_16x16x32_bf16 a[24:27], v[56:59], v[44:47], a[24:27]
    ds_read_b64_tr_b16 v[80:81], v24 offset:4096
    v_mfma_f32_16x16x32_bf16 a[12:15], v[60:63], v[40:43], a[12:15]
    ds_read_b64_tr_b16 v[82:83], v24 offset:4608
    v_mfma_f32_16x16x32_bf16 a[28:31], v[60:63], v[44:47], a[28:31]
    ds_read_b64_tr_b16 v[84:85], v28 offset:4096
    ds_read_b64_tr_b16 v[86:87], v28 offset:4608
    s_waitcnt lgkmcnt(0)
    v_mfma_f32_16x16x32_bf16 a[0:3], v[72:75], v[64:67], a[0:3]
    v_mfma_f32_16x16x32_bf16 a[16:19], v[72:75], v[68:71], a[16:19]
    s_waitcnt vmcnt(12)
    s_barrier
    ds_read_b128 v[40:43], v9 offset:0
    v_mfma_f32_16x16x32_bf16 a[4:7], v[76:79], v[64:67], a[4:7]
    ds_read_b128 v[44:47], v9 offset:2048
    v_mfma_f32_16x16x32_bf16 a[20:23], v[76:79], v[68:71], a[20:23]
    ds_read_b64_tr_b16 v[48:49], v17 offset:0
    v_mfma_f32_16x16x32_bf16 a[8:11], v[80:83], v[64:67], a[8:11]
    ds_read_b64_tr_b16 v[50:51], v17 offset:512
    v_mfma_f32_16x16x32_bf16 a[24:27], v[80:83], v[68:71], a[24:27]
    ds_read_b64_tr_b16 v[52:53], v21 offset:0
    v_mfma_f32_16x16x32_bf16 a[12:15], v[84:87], v[64:67], a[12:15]
    ds_read_b64_tr_b16 v[54:55], v21 offset:512
    v_mfma_f32_16x16x32_bf16 a[28:31], v[84:87], v[68:71], a[28:31]
    ds_read_b64_tr_b16 v[56:57], v25 offset:0
    ds_read_b64_tr_b16 v[58:59], v25 offset:512
    ds_read_b64_tr_b16 v[60:61], v29 offset:0
    ds_read_b64_tr_b16 v[62:63], v29 offset:512
    s_waitcnt lgkmcnt(0)
    ds_read_b128 v[64:67], v13 offset:0
    v_mfma_f32_16x16x32_bf16 a[0:3], v[48:51], v[40:43], a[0:3]
    ds_read_b128 v[68:71], v13 offset:2048
    v_mfma_f32_16x16x32_bf16 a[16:19], v[48:51], v[44:47], a[16:19]
    ds_read_b64_tr_b16 v[72:73], v17 offset:4096
    v_mfma_f32_16x16x32_bf16 a[4:7], v[52:55], v[40:43], a[4:7]
    ds_read_b64_tr_b16 v[74:75], v17 offset:4608
    v_mfma_f32_16x16x32_bf16 a[20:23], v[52:55], v[44:47], a[20:23]
    ds_read_b64_tr_b16 v[76:77], v21 offset:4096
    v_mfma_f32_16x16x32_bf16 a[8:11], v[56:59], v[40:43], a[8:11]
    ds_read_b64_tr_b16 v[78:79], v21 offset:4608
    v_mfma_f32_16x16x32_bf16 a[24:27], v[56:59], v[44:47], a[24:27]
    ds_read_b64_tr_b16 v[80:81], v25 offset:4096
    v_mfma_f32_16x16x32_bf16 a[12:15], v[60:63], v[40:43], a[12:15]
    ds_read_b64_tr_b16 v[82:83], v25 offset:4608
    v_mfma_f32_16x16x32_bf16 a[28:31], v[60:63], v[44:47], a[28:31]
    ds_read_b64_tr_b16 v[84:85], v29 offset:4096
    ds_read_b64_tr_b16 v[86:87], v29 offset:4608
    s_waitcnt lgkmcnt(0)
    v_mfma_f32_16x16x32_bf16 a[0:3], v[72:75], v[64:67], a[0:3]
    v_mfma_f32_16x16x32_bf16 a[16:19], v[72:75], v[68:71], a[16:19]
    s_waitcnt vmcnt(6)
    s_barrier
    ds_read_b128 v[40:43], v10 offset:0
    v_mfma_f32_16x16x32_bf16 a[4:7], v[76:79], v[64:67], a[4:7]
    ds_read_b128 v[44:47], v10 offset:2048
    v_mfma_f32_16x16x32_bf16 a[20:23], v[76:79], v[68:71], a[20:23]
    ds_read_b64_tr_b16 v[48:49], v18 offset:0
    v_mfma_f32_16x16x32_bf16 a[8:11], v[80:83], v[64:67], a[8:11]
    ds_read_b64_tr_b16 v[50:51], v18 offset:512
    v_mfma_f32_16x16x32_bf16 a[24:27], v[80:83], v[68:71], a[24:27]
    ds_read_b64_tr_b16 v[52:53], v22 offset:0
    v_mfma_f32_16x16x32_bf16 a[12:15], v[84:87], v[64:67], a[12:15]
    ds_read_b64_tr_b16 v[54:55], v22 offset:512
    v_mfma_f32_16x16x32_bf16 a[28:31], v[84:87], v[68:71], a[28:31]
    ds_read_b64_tr_b16 v[56:57], v26 offset:0
    ds_read_b64_tr_b16 v[58:59], v26 offset:512
    ds_read_b64_tr_b16 v[60:61], v30 offset:0
    ds_read_b64_tr_b16 v[62:63], v30 offset:512
    s_waitcnt lgkmcnt(0)
    ds_read_b128 v[64:67], v14 offset:0
    v_mfma_f32_16x16x32_bf16 a[0:3], v[48:51], v[40:43], a[0:3]
    ds_read_b128 v[68:71], v14 offset:2048
    v_mfma_f32_16x16x32_bf16 a[16:19], v[48:51], v[44:47], a[16:19]
    ds_read_b64_tr_b16 v[72:73], v18 offset:4096
    v_mfma_f32_16x16x32_bf16 a[4:7], v[52:55], v[40:43], a[4:7]
    ds_read_b64_tr_b16 v[74:75], v18 offset:4608
    v_mfma_f32_16x16x32_bf16 a[20:23], v[52:55], v[44:47], a[20:23]
    ds_read_b64_tr_b16 v[76:77], v22 offset:4096
    v_mfma_f32_16x16x32_bf16 a[8:11], v[56:59], v[40:43], a[8:11]
    ds_read_b64_tr_b16 v[78:79], v22 offset:4608
    v_mfma_f32_16x16x32_bf16 a[24:27], v[56:59], v[44:47], a[24:27]
    ds_read_b64_tr_b16 v[80:81], v26 offset:4096
    v_mfma_f32_16x16x32_bf16 a[12:15], v[60:63], v[40:43], a[12:15]
    ds_read_b64_tr_b16 v[82:83], v26 offset:4608
    v_mfma_f32_16x16x32_bf16 a[28:31], v[60:63], v[44:47], a[28:31]
    ds_read_b64_tr_b16 v[84:85], v30 offset:4096
    ds_read_b64_tr_b16 v[86:87], v30 offset:4608
    s_waitcnt lgkmcnt(0)
    v_mfma_f32_16x16x32_bf16 a[0:3], v[72:75], v[64:67], a[0:3]
    v_mfma_f32_16x16x32_bf16 a[16:19], v[72:75], v[68:71], a[16:19]
    s_waitcnt vmcnt(0)
    s_barrier
    ds_read_b128 v[40:43], v11 offset:0
    v_mfma_f32_16x16x32_bf16 a[4:7], v[76:79], v[64:67], a[4:7]
    ds_read_b128 v[44:47], v11 offset:2048
    v_mfma_f32_16x16x32_bf16 a[20:23], v[76:79], v[68:71], a[20:23]
    ds_read_b64_tr_b16 v[48:49], v19 offset:0
    v_mfma_f32_16x16x32_bf16 a[8:11], v[80:83], v[64:67], a[8:11]
    ds_read_b64_tr_b16 v[50:51], v19 offset:512
    v_mfma_f32_16x16x32_bf16 a[24:27], v[80:83], v[68:71], a[24:27]
    ds_read_b64_tr_b16 v[52:53], v23 offset:0
    v_mfma_f32_16x16x32_bf16 a[12:15], v[84:87], v[64:67], a[12:15]
    ds_read_b64_tr_b16 v[54:55], v23 offset:512
    v_mfma_f32_16x16x32_bf16 a[28:31], v[84:87], v[68:71], a[28:31]
    ds_read_b64_tr_b16 v[56:57], v27 offset:0
    ds_read_b64_tr_b16 v[58:59], v27 offset:512
    ds_read_b64_tr_b16 v[60:61], v31 offset:0
    ds_read_b64_tr_b16 v[62:63], v31 offset:512
    s_waitcnt lgkmcnt(0)
    ds_read_b128 v[64:67], v15 offset:0
    v_mfma_f32_16x16x32_bf16 a[0:3], v[48:51], v[40:43], a[0:3]
    ds_read_b128 v[68:71], v15 offset:2048
    v_mfma_f32_16x16x32_bf16 a[16:19], v[48:51], v[44:47], a[16:19]
    ds_read_b64_tr_b16 v[72:73], v19 offset:4096
    v_mfma_f32_16x16x32_bf16 a[4:7], v[52:55], v[40:43], a[4:7]
    ds_read_b64_tr_b16 v[74:75], v19 offset:4608
    v_mfma_f32_16x16x32_bf16 a[20:23], v[52:55], v[44:47], a[20:23]
    ds_read_b64_tr_b16 v[76:77], v23 offset:4096
    v_mfma_f32_16x16x32_bf16 a[8:11], v[56:59], v[40:43], a[8:11]
    ds_read_b64_tr_b16 v[78:79], v23 offset:4608
    v_mfma_f32_16x16x32_bf16 a[24:27], v[56:59], v[44:47], a[24:27]
    ds_read_b64_tr_b16 v[80:81], v27 offset:4096
    v_mfma_f32_16x16x32_bf16 a[12:15], v[60:63], v[40:43], a[12:15]
    ds_read_b64_tr_b16 v[82:83], v27 offset:4608
    v_mfma_f32_16x16x32_bf16 a[28:31], v[60:63], v[44:47], a[28:31]
    ds_read_b64_tr_b16 v[84:85], v31 offset:4096
    ds_read_b64_tr_b16 v[86:87], v31 offset:4608
    s_waitcnt lgkmcnt(0)
    v_mfma_f32_16x16x32_bf16 a[0:3], v[72:75], v[64:67], a[0:3]
    v_mfma_f32_16x16x32_bf16 a[16:19], v[72:75], v[68:71], a[16:19]
    v_mfma_f32_16x16x32_bf16 a[4:7], v[76:79], v[64:67], a[4:7]
    v_mfma_f32_16x16x32_bf16 a[20:23], v[76:79], v[68:71], a[20:23]
    v_mfma_f32_16x16x32_bf16 a[8:11], v[80:83], v[64:67], a[8:11]
    v_mfma_f32_16x16x32_bf16 a[24:27], v[80:83], v[68:71], a[24:27]
    v_mfma_f32_16x16x32_bf16 a[12:15], v[84:87], v[64:67], a[12:15]
    v_mfma_f32_16x16x32_bf16 a[28:31], v[84:87], v[68:71], a[28:31]
    s_nop 7
    s_nop 7
    s_barrier
    v_and_b32 v32, 15, v0
    v_lshrrev_b32 v33, 4, v0
    s_mul_i32 s30, s26, 32
    v_add_u32 v32, s30, v32
    v_mul_u32_u24 v32, 272, v32
    s_mul_i32 s30, s27, 256
    v_lshl_add_u32 v32, v33, 4, v32
    v_add_u32 v34, s30, v32
    v_accvgpr_read_b32 v40, a0
    v_accvgpr_read_b32 v41, a1
    v_accvgpr_read_b32 v42, a2
    v_accvgpr_read_b32 v43, a3
    ds_write_b128 v34, v[40:43] offset:0
    v_accvgpr_read_b32 v56, a4
    v_accvgpr_read_b32 v57, a5
    v_accvgpr_read_b32 v58, a6
    v_accvgpr_read_b32 v59, a7
    ds_write_b128 v34, v[56:59] offset:64
    v_accvgpr_read_b32 v40, a8
    v_accvgpr_read_b32 v41, a9
    v_accvgpr_read_b32 v42, a10
    v_accvgpr_read_b32 v43, a11
    ds_write_b128 v34, v[40:43] offset:128
    v_accvgpr_read_b32 v56, a12
    v_accvgpr_read_b32 v57, a13
    v_accvgpr_read_b32 v58, a14
    v_accvgpr_read_b32 v59, a15
    ds_write_b128 v34, v[56:59] offset:192
    v_accvgpr_read_b32 v40, a16
    v_accvgpr_read_b32 v41, a17
    v_accvgpr_read_b32 v42, a18
    v_accvgpr_read_b32 v43, a19
    ds_write_b128 v34, v[40:43] offset:4352
    v_accvgpr_read_b32 v56, a20
    v_accvgpr_read_b32 v57, a21
    v_accvgpr_read_b32 v58, a22
    v_accvgpr_read_b32 v59, a23
    ds_write_b128 v34, v[56:59] offset:4416
    v_accvgpr_read_b32 v40, a24
    v_accvgpr_read_b32 v41, a25
    v_accvgpr_read_b32 v42, a26
    v_accvgpr_read_b32 v43, a27
    ds_write_b128 v34, v[40:43] offset:4480
    v_accvgpr_read_b32 v56, a28
    v_accvgpr_read_b32 v57, a29
    v_accvgpr_read_b32 v58, a30
    v_accvgpr_read_b32 v59, a31
    ds_write_b128 v34, v[56:59] offset:4544
    s_waitcnt lgkmcnt(0)
    s_barrier
    s_lshl_b32 s30, s31, 6
    v_add_u32 v35, s30, v0
    v_add_u32 v32, 0, v35
    s_mov_b32 s30, 131072
    v_mul_lo_u32 v33, v32, s30
    v_lshrrev_b32 v33, 20, v33
    v_mul_u32_u24 v34, 8, v33
    v_sub_u32 v34, v32, v34
    v_mul_u32_u24 v32, 272, v33
    v_lshl_add_u32 v32, v34, 5, v32
    ds_read_b128 v[40:43], v32
    ds_read_b128 v[44:47], v32 offset:16
    v_add_u32 v33, s24, v33
    s_mov_b32 s30, 2048
    v_mul_lo_u32 v33, v33, s30
    v_lshl_add_u32 v33, v34, 4, v33
    s_lshl_b32 s30, s25, 1
    v_add_u32 v52, s30, v33
    buffer_load_dwordx4 v[48:51], v52, s[20:23], 0 offen
    v_add_u32 v32, 256, v35
    s_mov_b32 s30, 131072
    v_mul_lo_u32 v33, v32, s30
    v_lshrrev_b32 v33, 20, v33
    v_mul_u32_u24 v34, 8, v33
    v_sub_u32 v34, v32, v34
    v_mul_u32_u24 v32, 272, v33
    v_lshl_add_u32 v32, v34, 5, v32
    ds_read_b128 v[56:59], v32
    ds_read_b128 v[60:63], v32 offset:16
    v_add_u32 v33, s24, v33
    s_mov_b32 s30, 2048
    v_mul_lo_u32 v33, v33, s30
    v_lshl_add_u32 v33, v34, 4, v33
    s_lshl_b32 s30, s25, 1
    v_add_u32 v68, s30, v33
    buffer_load_dwordx4 v[64:67], v68, s[20:23], 0 offen
    v_add_u32 v32, 512, v35
    s_mov_b32 s30, 131072
    v_mul_lo_u32 v33, v32, s30
    v_lshrrev_b32 v33, 20, v33
    v_mul_u32_u24 v34, 8, v33
    v_sub_u32 v34, v32, v34
    v_mul_u32_u24 v32, 272, v33
    v_lshl_add_u32 v32, v34, 5, v32
    ds_read_b128 v[72:75], v32
    ds_read_b128 v[76:79], v32 offset:16
    v_add_u32 v33, s24, v33
    s_mov_b32 s30, 2048
    v_mul_lo_u32 v33, v33, s30
    v_lshl_add_u32 v33, v34, 4, v33
    s_lshl_b32 s30, s25, 1
    v_add_u32 v84, s30, v33
    buffer_load_dwordx4 v[80:83], v84, s[20:23], 0 offen
    v_add_u32 v32, 768, v35
    s_mov_b32 s30, 131072
    v_mul_lo_u32 v33, v32, s30
    v_lshrrev_b32 v33, 20, v33
    v_mul_u32_u24 v34, 8, v33
    v_sub_u32 v34, v32, v34
    v_mul_u32_u24 v32, 272, v33
    v_lshl_add_u32 v32, v34, 5, v32
    ds_read_b128 v[88:91], v32
    ds_read_b128 v[92:95], v32 offset:16
    v_add_u32 v33, s24, v33
    s_mov_b32 s30, 2048
    v_mul_lo_u32 v33, v33, s30
    v_lshl_add_u32 v33, v34, 4, v33
    s_lshl_b32 s30, s25, 1
    v_add_u32 v100, s30, v33
    buffer_load_dwordx4 v[96:99], v100, s[20:23], 0 offen
    s_waitcnt vmcnt(0) lgkmcnt(0)
    v_lshlrev_b32 v32, 16, v48
    v_and_b32 v33, 0xffff0000, v48
    v_add_f32 v40, v40, v32
    v_add_f32 v41, v41, v33
    v_lshlrev_b32 v32, 16, v49
    v_and_b32 v33, 0xffff0000, v49
    v_add_f32 v42, v42, v32
    v_add_f32 v43, v43, v33
    v_lshlrev_b32 v32, 16, v50
    v_and_b32 v33, 0xffff0000, v50
    v_add_f32 v44, v44, v32
    v_add_f32 v45, v45, v33
    v_lshlrev_b32 v32, 16, v51
    v_and_b32 v33, 0xffff0000, v51
    v_add_f32 v46, v46, v32
    v_add_f32 v47, v47, v33
    v_cvt_pk_bf16_f32 v48, v40, v41
    v_cvt_pk_bf16_f32 v49, v42, v43
    v_cvt_pk_bf16_f32 v50, v44, v45
    v_cvt_pk_bf16_f32 v51, v46, v47
    buffer_store_dwordx4 v[48:51], v52, s[16:19], 0 offen
    v_lshlrev_b32 v32, 16, v64
    v_and_b32 v33, 0xffff0000, v64
    v_add_f32 v56, v56, v32
    v_add_f32 v57, v57, v33
    v_lshlrev_b32 v32, 16, v65
    v_and_b32 v33, 0xffff0000, v65
    v_add_f32 v58, v58, v32
    v_add_f32 v59, v59, v33
    v_lshlrev_b32 v32, 16, v66
    v_and_b32 v33, 0xffff0000, v66
    v_add_f32 v60, v60, v32
    v_add_f32 v61, v61, v33
    v_lshlrev_b32 v32, 16, v67
    v_and_b32 v33, 0xffff0000, v67
    v_add_f32 v62, v62, v32
    v_add_f32 v63, v63, v33
    v_cvt_pk_bf16_f32 v64, v56, v57
    v_cvt_pk_bf16_f32 v65, v58, v59
    v_cvt_pk_bf16_f32 v66, v60, v61
    v_cvt_pk_bf16_f32 v67, v62, v63
    buffer_store_dwordx4 v[64:67], v68, s[16:19], 0 offen
    v_lshlrev_b32 v32, 16, v80
    v_and_b32 v33, 0xffff0000, v80
    v_add_f32 v72, v72, v32
    v_add_f32 v73, v73, v33
    v_lshlrev_b32 v32, 16, v81
    v_and_b32 v33, 0xffff0000, v81
    v_add_f32 v74, v74, v32
    v_add_f32 v75, v75, v33
    v_lshlrev_b32 v32, 16, v82
    v_and_b32 v33, 0xffff0000, v82
    v_add_f32 v76, v76, v32
    v_add_f32 v77, v77, v33
    v_lshlrev_b32 v32, 16, v83
    v_and_b32 v33, 0xffff0000, v83
    v_add_f32 v78, v78, v32
    v_add_f32 v79, v79, v33
    v_cvt_pk_bf16_f32 v80, v72, v73
    v_cvt_pk_bf16_f32 v81, v74, v75
    v_cvt_pk_bf16_f32 v82, v76, v77
    v_cvt_pk_bf16_f32 v83, v78, v79
    buffer_store_dwordx4 v[80:83], v84, s[16:19], 0 offen
    v_lshlrev_b32 v32, 16, v96
    v_and_b32 v33, 0xffff0000, v96
    v_add_f32 v88, v88, v32
    v_add_f32 v89, v89, v33
    v_lshlrev_b32 v32, 16, v97
    v_and_b32 v33, 0xffff0000, v97
    v_add_f32 v90, v90, v32
    v_add_f32 v91, v91, v33
    v_lshlrev_b32 v32, 16, v98
    v_and_b32 v33, 0xffff0000, v98
    v_add_f32 v92, v92, v32
    v_add_f32 v93, v93, v33
    v_lshlrev_b32 v32, 16, v99
    v_and_b32 v33, 0xffff0000, v99
    v_add_f32 v94, v94, v32
    v_add_f32 v95, v95, v33
    v_cvt_pk_bf16_f32 v96, v88, v89
    v_cvt_pk_bf16_f32 v97, v90, v91
    v_cvt_pk_bf16_f32 v98, v92, v93
    v_cvt_pk_bf16_f32 v99, v94, v95
    buffer_store_dwordx4 v[96:99], v100, s[16:19], 0 offen
    s_nop 1
L_wo_kernel_end:
    s_endpgm
.section .rodata,"a"
.p2align 6
.amdhsa_kernel wo_kernel
  .amdhsa_next_free_vgpr 136
  .amdhsa_next_free_sgpr 102
  .amdhsa_accum_offset 104
  .amdhsa_group_segment_fixed_size 0
  .amdhsa_kernarg_size 80
  .amdhsa_user_sgpr_count 2
  .amdhsa_user_sgpr_kernarg_segment_ptr 1
  .amdhsa_system_sgpr_workgroup_id_x 1
.end_amdhsa_kernel
.text
.globl ln2_kernel
.p2align 8
.type ln2_kernel,@function
ln2_kernel:
    s_cmp_ge_u32 s2, 512
    s_cbranch_scc1 L_ln2_kernel_end
    s_load_dwordx2 s[4:5], s[0:1], 72
    s_load_dwordx2 s[8:9], s[0:1], 72
    s_waitcnt lgkmcnt(0)
    s_add_u32 s4, s4, 20971520
    s_addc_u32 s5, s5, 0
    s_mov_b32 s6, 4194304
    s_mov_b32 s7, 0x00020000
    s_add_u32 s8, s8, 25165824
    s_addc_u32 s9, s9, 0
    s_mov_b32 s10, 4194304
    s_mov_b32 s11, 0x00020000
    v_lshrrev_b32 v1, 6, v0
    v_and_b32 v2, 63, v0
    s_lshl_b32 s3, s2, 2
    v_add_u32 v1, s3, v1
    v_lshlrev_b32 v1, 11, v1
    v_lshl_add_u32 v1, v2, 4, v1
    buffer_load_dwordx4 v[4:7], v1, s[4:7], 0 offen
    buffer_load_dwordx4 v[8:11], v1, s[4:7], 0 offen offset:1024
    s_waitcnt vmcnt(0)
    v_lshlrev_b32 v16, 16, v4
    v_and_b32 v17, 0xffff0000, v4
    v_lshlrev_b32 v18, 16, v5
    v_and_b32 v19, 0xffff0000, v5
    v_lshlrev_b32 v20, 16, v6
    v_and_b32 v21, 0xffff0000, v6
    v_lshlrev_b32 v22, 16, v7
    v_and_b32 v23, 0xffff0000, v7
    v_lshlrev_b32 v24, 16, v8
    v_and_b32 v25, 0xffff0000, v8
    v_lshlrev_b32 v26, 16, v9
    v_and_b32 v27, 0xffff0000, v9
    v_lshlrev_b32 v28, 16, v10
    v_and_b32 v29, 0xffff0000, v10
    v_lshlrev_b32 v30, 16, v11
    v_and_b32 v31, 0xffff0000, v11
    v_add_f32 v12, v16, v17
    v_add_f32 v12, v12, v18
    v_add_f32 v12, v12, v19
    v_add_f32 v12, v12, v20
    v_add_f32 v12, v12, v21
    v_add_f32 v12, v12, v22
    v_add_f32 v12, v12, v23
    v_add_f32 v12, v12, v24
    v_add_f32 v12, v12, v25
    v_add_f32 v12, v12, v26
    v_add_f32 v12, v12, v27
    v_add_f32 v12, v12, v28
    v_add_f32 v12, v12, v29
    v_add_f32 v12, v12, v30
    v_add_f32 v12, v12, v31
    ds_swizzle_b32 v13, v12 offset:0x41f
    s_waitcnt lgkmcnt(0)
    v_add_f32 v12, v12, v13
    ds_swizzle_b32 v13, v12 offset:0x81f
    s_waitcnt lgkmcnt(0)
    v_add_f32 v12, v12, v13
    ds_swizzle_b32 v13, v12 offset:0x101f
    s_waitcnt lgkmcnt(0)
    v_add_f32 v12, v12, v13
    ds_swizzle_b32 v13, v12 offset:0x201f
    s_waitcnt lgkmcnt(0)
    v_add_f32 v12, v12, v13
    ds_swizzle_b32 v13, v12 offset:0x401f
    s_waitcnt lgkmcnt(0)
    v_add_f32 v12, v12, v13
    s_nop 1
    v_readlane_b32 s20, v12, 0
    v_readlane_b32 s21, v12, 32
    s_nop 3
    v_mov_b32 v12, s20
    v_add_f32 v12, s21, v12
    v_mul_f32 v12, 0.0009765625, v12
    v_sub_f32 v16, v16, v12
    v_sub_f32 v17, v17, v12
    v_sub_f32 v18, v18, v12
    v_sub_f32 v19, v19, v12
    v_sub_f32 v20, v20, v12
    v_sub_f32 v21, v21, v12
    v_sub_f32 v22, v22, v12
    v_sub_f32 v23, v23, v12
    v_sub_f32 v24, v24, v12
    v_sub_f32 v25, v25, v12
    v_sub_f32 v26, v26, v12
    v_sub_f32 v27, v27, v12
    v_sub_f32 v28, v28, v12
    v_sub_f32 v29, v29, v12
    v_sub_f32 v30, v30, v12
    v_sub_f32 v31, v31, v12
    v_mul_f32 v14, v16, v16
    v_fmac_f32 v14, v17, v17
    v_fmac_f32 v14, v18, v18
    v_fmac_f32 v14, v19, v19
    v_fmac_f32 v14, v20, v20
    v_fmac_f32 v14, v21, v21
    v_fmac_f32 v14, v22, v22
    v_fmac_f32 v14, v23, v23
    v_fmac_f32 v14, v24, v24
    v_fmac_f32 v14, v25, v25
    v_fmac_f32 v14, v26, v26
    v_fmac_f32 v14, v27, v27
    v_fmac_f32 v14, v28, v28
    v_fmac_f32 v14, v29, v29
    v_fmac_f32 v14, v30, v30
    v_fmac_f32 v14, v31, v31
    ds_swizzle_b32 v13, v14 offset:0x41f
    s_waitcnt lgkmcnt(0)
    v_add_f32 v14, v14, v13
    ds_swizzle_b32 v13, v14 offset:0x81f
    s_waitcnt lgkmcnt(0)
    v_add_f32 v14, v14, v13
    ds_swizzle_b32 v13, v14 offset:0x101f
    s_waitcnt lgkmcnt(0)
    v_add_f32 v14, v14, v13
    ds_swizzle_b32 v13, v14 offset:0x201f
    s_waitcnt lgkmcnt(0)
    v_add_f32 v14, v14, v13
    ds_swizzle_b32 v13, v14 offset:0x401f
    s_waitcnt lgkmcnt(0)
    v_add_f32 v14, v14, v13
    s_nop 1
    v_readlane_b32 s20, v14, 0
    v_readlane_b32 s21, v14, 32
    s_nop 3
    v_mov_b32 v14, s20
    v_add_f32 v14, s21, v14
    v_mov_b32 v15, 0x3727c5ac
    v_fmac_f32 v15, 0.0009765625, v14
    v_rsq_f32 v15, v15
    s_nop 0
    v_mul_f32 v16, v16, v15
    v_mul_f32 v17, v17, v15
    v_mul_f32 v18, v18, v15
    v_mul_f32 v19, v19, v15
    v_mul_f32 v20, v20, v15
    v_mul_f32 v21, v21, v15
    v_mul_f32 v22, v22, v15
    v_mul_f32 v23, v23, v15
    v_mul_f32 v24, v24, v15
    v_mul_f32 v25, v25, v15
    v_mul_f32 v26, v26, v15
    v_mul_f32 v27, v27, v15
    v_mul_f32 v28, v28, v15
    v_mul_f32 v29, v29, v15
    v_mul_f32 v30, v30, v15
    v_mul_f32 v31, v31, v15
    v_cvt_pk_bf16_f32 v4, v16, v17
    v_cvt_pk_bf16_f32 v5, v18, v19
    v_cvt_pk_bf16_f32 v6, v20, v21
    v_cvt_pk_bf16_f32 v7, v22, v23
    v_cvt_pk_bf16_f32 v8, v24, v25
    v_cvt_pk_bf16_f32 v9, v26, v27
    v_cvt_pk_bf16_f32 v10, v28, v29
    v_cvt_pk_bf16_f32 v11, v30, v31
    buffer_store_dwordx4 v[4:7], v1, s[8:11], 0 offen
    buffer_store_dwordx4 v[8:11], v1, s[8:11], 0 offen offset:1024
L_ln2_kernel_end:
    s_endpgm
.section .rodata,"a"
.p2align 6
.amdhsa_kernel ln2_kernel
  .amdhsa_next_free_vgpr 32
  .amdhsa_next_free_sgpr 96
  .amdhsa_accum_offset 32
  .amdhsa_group_segment_fixed_size 0
  .amdhsa_kernarg_size 80
  .amdhsa_user_sgpr_count 2
  .amdhsa_user_sgpr_kernarg_segment_ptr 1
  .amdhsa_system_sgpr_workgroup_id_x 1
.end_amdhsa_kernel
.text
.globl gu_kernel
.p2align 8
.type gu_kernel,@function
gu_kernel:
    s_cmp_ge_u32 s2, 256
    s_cbranch_scc1 L_gu_kernel_end
    s_load_dwordx2 s[4:5], s[0:1], 72
    s_load_dwordx2 s[8:9], s[0:1], 32
    s_load_dwordx2 s[12:13], s[0:1], 40
    s_load_dwordx2 s[16:17], s[0:1], 72
    s_and_b32 s30, s2, 7
    s_lshr_b32 s31, s2, 3
    s_and_b32 s33, s31, 0
    s_lshr_b32 s31, s31, 0
    s_mul_i32 s34, s30, 32
    s_add_u32 s34, s34, s31
    s_and_b32 s24, s31, 3
    s_lshr_b32 s25, s31, 2
    s_lshr_b32 s31, s30, 2
    s_mul_i32 s31, s31, 4
    s_add_u32 s24, s24, s31
    s_and_b32 s31, s30, 3
    s_mul_i32 s31, s31, 8
    s_add_u32 s25, s25, s31
    s_mul_i32 s24, s24, 256
    s_mul_i32 s25, s25, 112
    v_lshrrev_b32 v1, 6, v0
    s_nop 0
    v_readfirstlane_b32 s31, v1
    v_and_b32 v0, 63, v0
    s_nop 3
    s_lshr_b32 s26, s31, 0
    s_and_b32 s27, s31, 0
    s_mul_i32 s60, s33, 2048
    s_mul_i32 s61, s33, 7340032
    s_add_u32 s62, s60, 2048
    s_lshr_b32 s30, s2, 3
    s_mul_i32 s30, s30, 0
    s_mul_hi_u32 s28, s30, 134217728
    s_mul_i32 s28, s28, 32
    s_sub_u32 s30, s30, s28
    s_mul_i32 s28, s30, 64
    s_add_u32 s28, s28, s60
    s_mul_i32 s29, s30, 229376
    s_add_u32 s29, s29, s61
    s_waitcnt lgkmcnt(0)
    s_add_u32 s4, s4, 25165824
    s_addc_u32 s5, s5, 0
    s_mov_b32 s6, 4194304
    s_mov_b32 s7, 0x00020000
    s_mov_b32 s10, 7340032
    s_mov_b32 s11, 0x00020000
    s_mov_b32 s14, 7340032
    s_mov_b32 s15, 0x00020000
    s_add_u32 s16, s16, 29360128
    s_addc_u32 s17, s17, 0
    s_mov_b32 s18, 14680064
    s_mov_b32 s19, 0x00020000
    s_add_u32 s30, s31, 0
    s_min_u32 s30, s30, 15
    s_lshl_b32 s30, s30, 10
    s_add_u32 s36, s30, 0
    v_lshlrev_b32 v42, 4, v0
    v_add_u32 v42, s30, v42
    s_mov_b32 s30, 16384
    v_mul_lo_u32 v43, v42, s30
    v_lshrrev_b32 v43, 20, v43
    s_mov_b32 s30, 64
    v_mul_lo_u32 v44, v43, s30
    v_sub_u32 v44, v42, v44
    v_lshrrev_b32 v44, 4, v44
    v_bfe_u32 v45, v43, 3, 1
    v_lshlrev_b32 v45, 1, v45
    v_xor_b32 v44, v44, v45
    v_add_u32 v43, s24, v43
    s_mov_b32 s30, 2048
    v_mul_lo_u32 v43, v43, s30
    v_lshl_add_u32 v2, v44, 4, v43
    s_add_u32 s30, s31, 4
    s_min_u32 s30, s30, 15
    s_lshl_b32 s30, s30, 10
    s_add_u32 s37, s30, 0
    v_lshlrev_b32 v42, 4, v0
    v_add_u32 v42, s30, v42
    s_mov_b32 s30, 16384
    v_mul_lo_u32 v43, v42, s30
    v_lshrrev_b32 v43, 20, v43
    s_mov_b32 s30, 64
    v_mul_lo_u32 v44, v43, s30
    v_sub_u32 v44, v42, v44
    v_lshrrev_b32 v44, 4, v44
    v_bfe_u32 v45, v43, 3, 1
    v_lshlrev_b32 v45, 1, v45
    v_xor_b32 v44, v44, v45
    v_add_u32 v43, s24, v43
    s_mov_b32 s30, 2048
    v_mul_lo_u32 v43, v43, s30
    v_lshl_add_u32 v3, v44, 4, v43
    s_add_u32 s30, s31, 8
    s_min_u32 s30, s30, 15
    s_lshl_b32 s30, s30, 10
    s_add_u32 s38, s30, 0
    v_lshlrev_b32 v42, 4, v0
    v_add_u32 v42, s30, v42
    s_mov_b32 s30, 16384
    v_mul_lo_u32 v43, v42, s30
    v_lshrrev_b32 v43, 20, v43
    s_mov_b32 s30, 64
    v_mul_lo_u32 v44, v43, s30
    v_sub_u32 v44, v42, v44
    v_lshrrev_b32 v44, 4, v44
    v_bfe_u32 v45, v43, 3, 1
    v_lshlrev_b32 v45, 1, v45
    v_xor_b32 v44, v44, v45
    v_add_u32 v43, s24, v43
    s_mov_b32 s30, 2048
    v_mul_lo_u32 v43, v43, s30
    v_lshl_add_u32 v4, v44, 4, v43
    s_add_u32 s30, s31, 12
    s_min_u32 s30, s30, 15
    s_lshl_b32 s30, s30, 10
    s_add_u32 s39, s30, 0
    v_lshlrev_b32 v42, 4, v0
    v_add_u32 v42, s30, v42
    s_mov_b32 s30, 16384
    v_mul_lo_u32 v43, v42, s30
    v_lshrrev_b32 v43, 20, v43
    s_mov_b32 s30, 64
    v_mul_lo_u32 v44, v43, s30
    v_sub_u32 v44, v42, v44
    v_lshrrev_b32 v44, 4, v44
    v_bfe_u32 v45, v43, 3, 1
    v_lshlrev_b32 v45, 1, v45
    v_xor_b32 v44, v44, v45
    v_add_u32 v43, s24, v43
    s_mov_b32 s30, 2048
    v_mul_lo_u32 v43, v43, s30
    v_lshl_add_u32 v5, v44, 4, v43
    s_add_u32 s30, s31, 0
    s_min_u32 s30, s30, 7
    s_lshl_b32 s30, s30, 10
    s_add_u32 s40, s30, 16384
    v_lshlrev_b32 v42, 4, v0
    v_add_u32 v42, s30, v42
    s_mov_b32 s30, 4096
    v_mul_lo_u32 v43, v42, s30
    v_lshrrev_b32 v43, 20, v43
    s_mov_b32 s30, 256
    v_mul_lo_u32 v44, v43, s30
    v_sub_u32 v44, v42, v44
    v_lshrrev_b32 v44, 4, v44
    v_mov_b32 v45, 0
    v_bfe_u32 v46, v43, 0, 1
    v_lshl_or_b32 v45, v46, 1, v45
    v_bfe_u32 v46, v43, 1, 1
    v_lshl_or_b32 v45, v46, 2, v45
    v_bfe_u32 v46, v43, 3, 1
    v_lshl_or_b32 v45, v46, 3, v45
    v_xor_b32 v44, v44, v45
    v_min_u32 v44, 13, v44
    s_mov_b32 s30, 7168
    v_mul_lo_u32 v43, v43, s30
    v_lshl_add_u32 v43, v44, 4, v43
    s_lshl_b32 s30, s25, 1
    v_add_u32 v6, s30, v43
    s_add_u32 s30, s31, 4
    s_min_u32 s30, s30, 7
    s_lshl_b32 s30, s30, 10
    s_add_u32 s41, s30, 16384
    v_lshlrev_b32 v42, 4, v0
    v_add_u32 v42, s30, v42
    s_mov_b32 s30, 4096
    v_mul_lo_u32 v43, v42, s30
    v_lshrrev_b32 v43, 20, v43
    s_mov_b32 s30, 256
    v_mul_lo_u32 v44, v43, s30
    v_sub_u32 v44, v42, v44
    v_lshrrev_b32 v44, 4, v44
    v_mov_b32 v45, 0
    v_bfe_u32 v46, v43, 0, 1
    v_lshl_or_b32 v45, v46, 1, v45
    v_bfe_u32 v46, v43, 1, 1
    v_lshl_or_b32 v45, v46, 2, v45
    v_bfe_u32 v46, v43, 3, 1
    v_lshl_or_b32 v45, v46, 3, v45
    v_xor_b32 v44, v44, v45
    v_min_u32 v44, 13, v44
    s_mov_b32 s30, 7168
    v_mul_lo_u32 v43, v43, s30
    v_lshl_add_u32 v43, v44, 4, v43
    s_lshl_b32 s30, s25, 1
    v_add_u32 v7, s30, v43
    s_add_u32 s30, s31, 0
    s_min_u32 s30, s30, 7
    s_lshl_b32 s30, s30, 10
    s_add_u32 s42, s30, 24576
    v_lshlrev_b32 v42, 4, v0
    v_add_u32 v42, s30, v42
    s_mov_b32 s30, 4096
    v_mul_lo_u32 v43, v42, s30
    v_lshrrev_b32 v43, 20, v43
    s_mov_b32 s30, 256
    v_mul_lo_u32 v44, v43, s30
    v_sub_u32 v44, v42, v44
    v_lshrrev_b32 v44, 4, v44
    v_mov_b32 v45, 0
    v_bfe_u32 v46, v43, 0, 1
    v_lshl_or_b32 v45, v46, 1, v45
    v_bfe_u32 v46, v43, 1, 1
    v_lshl_or_b32 v45, v46, 2, v45
    v_bfe_u32 v46, v43, 3, 1
    v_lshl_or_b32 v45, v46, 3, v45
    v_xor_b32 v44, v44, v45
    v_min_u32 v44, 13, v44
    s_mov_b32 s30, 7168
    v_mul_lo_u32 v43, v43, s30
    v_lshl_add_u32 v43, v44, 4, v43
    s_lshl_b32 s30, s25, 1
    v_add_u32 v8, s30, v43
    s_add_u32 s30, s31, 4
    s_min_u32 s30, s30, 7
    s_lshl_b32 s30, s30, 10
    s_add_u32 s43, s30, 24576
    v_lshlrev_b32 v42, 4, v0
    v_add_u32 v42, s30, v42
    s_mov_b32 s30, 4096
    v_mul_lo_u32 v43, v42, s30
    v_lshrrev_b32 v43, 20, v43
    s_mov_b32 s30, 256
    v_mul_lo_u32 v44, v43, s30
    v_sub_u32 v44, v42, v44
    v_lshrrev_b32 v44, 4, v44
    v_mov_b32 v45, 0
    v_bfe_u32 v46, v43, 0, 1
    v_lshl_or_b32 v45, v46, 1, v45
    v_bfe_u32 v46, v43, 1, 1
    v_lshl_or_b32 v45, v46, 2, v45
    v_bfe_u32 v46, v43, 3, 1
    v_lshl_or_b32 v45, v46, 3, v45
    v_xor_b32 v44, v44, v45
    v_min_u32 v44, 13, v44
    s_mov_b32 s30, 7168
    v_mul_lo_u32 v43, v43, s30
    v_lshl_add_u32 v43, v44, 4, v43
    s_lshl_b32 s30, s25, 1
    v_add_u32 v9, s30, v43
    v_and_b32 v42, 15, v0
    v_lshrrev_b32 v43, 4, v0
    s_mul_i32 s30, s26, 64
    v_add_u32 v44, s30, v42
    v_bfe_u32 v45, v42, 3, 1
    v_lshlrev_b32 v45, 1, v45
    v_add_u32 v46, 0, v43
    v_xor_b32 v46, v46, v45
    v_lshlrev_b32 v46, 4, v46
    v_mul_u32_u24 v10, 64, v44
    v_add_u32 v10, v10, v46
    v_add_u32 v11, 32768, v10
    v_add_u32 v12, 65536, v10
    v_add_u32 v13, 98304, v10
    v_bfe_u32 v42, v0, 2, 2
    v_lshl_add_u32 v42, v43, 3, v42
    v_and_b32 v44, 3, v0
    v_mov_b32 v45, 0
    v_bfe_u32 v46, v42, 0, 1
    v_lshl_or_b32 v45, v46, 1, v45
    v_bfe_u32 v46, v42, 1, 1
    v_lshl_or_b32 v45, v46, 2, v45
    v_bfe_u32 v46, v42, 3, 1
    v_lshl_or_b32 v45, v46, 3, v45
    s_mul_i32 s30, s27, 224
    s_add_u32 s30, s30, 0
    v_lshlrev_b32 v46, 3, v44
    v_add_u32 v46, s30, v46
    v_lshrrev_b32 v43, 4, v46
    v_xor_b32 v43, v43, v45
    v_and_b32 v46, 15, v46
    v_lshl_add_u32 v46, v43, 4, v46
    v_mul_u32_u24 v14, 256, v42
    v_add_u32 v14, v14, v46
    v_add_u32 v14, 16384, v14
    v_add_u32 v15, 32768, v14
    v_add_u32 v16, 65536, v14
    v_add_u32 v17, 98304, v14
    s_mul_i32 s30, s27, 224
    s_add_u32 s30, s30, 32
    v_lshlrev_b32 v46, 3, v44
    v_add_u32 v46, s30, v46
    v_lshrrev_b32 v43, 4, v46
    v_xor_b32 v43, v43, v45
    v_and_b32 v46, 15, v46
    v_lshl_add_u32 v46, v43, 4, v46
    v_mul_u32_u24 v18, 256, v42
    v_add_u32 v18, v18, v46
    v_add_u32 v18, 16384, v18
    v_add_u32 v19, 32768, v18
    v_add_u32 v20, 65536, v18
    v_add_u32 v21, 98304, v18
    s_mul_i32 s30, s27, 224
    s_add_u32 s30, s30, 64
    v_lshlrev_b32 v46, 3, v44
    v_add_u32 v46, s30, v46
    v_lshrrev_b32 v43, 4, v46
    v_xor_b32 v43, v43, v45
    v_and_b32 v46, 15, v46
    v_lshl_add_u32 v46, v43, 4, v46
    v_mul_u32_u24 v22, 256, v42
    v_add_u32 v22, v22, v46
    v_add_u32 v22, 16384, v22
    v_add_u32 v23, 32768, v22
    v_add_u32 v24, 65536, v22
    v_add_u32 v25, 98304, v22
    s_mul_i32 s30, s27, 224
    s_add_u32 s30, s30, 96
    v_lshlrev_b32 v46, 3, v44
    v_add_u32 v46, s30, v46
    v_lshrrev_b32 v43, 4, v46
    v_xor_b32 v43, v43, v45
    v_and_b32 v46, 15, v46
    v_lshl_add_u32 v46, v43, 4, v46
    v_mul_u32_u24 v26, 256, v42
    v_add_u32 v26, v26, v46
    v_add_u32 v26, 16384, v26
    v_add_u32 v27, 32768, v26
    v_add_u32 v28, 65536, v26
    v_add_u32 v29, 98304, v26
    s_mul_i32 s30, s27, 224
    s_add_u32 s30, s30, 128
    v_lshlrev_b32 v46, 3, v44
    v_add_u32 v46, s30, v46
    v_lshrrev_b32 v43, 4, v46
    v_xor_b32 v43, v43, v45
    v_and_b32 v46, 15, v46
    v_lshl_add_u32 v46, v43, 4, v46
    v_mul_u32_u24 v30, 256, v42
    v_add_u32 v30, v30, v46
    v_add_u32 v30, 16384, v30
    v_add_u32 v31, 32768, v30
    v_add_u32 v32, 65536, v30
    v_add_u32 v33, 98304, v30
    s_mul_i32 s30, s27, 224
    s_add_u32 s30, s30, 160
    v_lshlrev_b32 v46, 3, v44
    v_add_u32 v46, s30, v46
    v_lshrrev_b32 v43, 4, v46
    v_xor_b32 v43, v43, v45
    v_and_b32 v46, 15, v46
    v_lshl_add_u32 v46, v43, 4, v46
    v_mul_u32_u24 v34, 256, v42
    v_add_u32 v34, v34, v46
    v_add_u32 v34, 16384, v34
    v_add_u32 v35, 32768, v34
    v_add_u32 v36, 65536, v34
    v_add_u32 v37, 98304, v34
    s_mul_i32 s30, s27, 224
    s_add_u32 s30, s30, 192
    v_lshlrev_b32 v46, 3, v44
    v_add_u32 v46, s30, v46
    v_lshrrev_b32 v43, 4, v46
    v_xor_b32 v43, v43, v45
    v_and_b32 v46, 15, v46
    v_lshl_add_u32 v46, v43, 4, v46
    v_mul_u32_u24 v38, 256, v42
    v_add_u32 v38, v38, v46
    v_add_u32 v38, 16384, v38
    v_add_u32 v39, 32768, v38
    v_add_u32 v40, 65536, v38
    v_add_u32 v41, 98304, v38
    s_add_u32 m0, s36, 0
    buffer_load_dwordx4 v2, s[4:7], s28 offen lds
    s_add_u32 m0, s37, 0
    buffer_load_dwordx4 v3, s[4:7], s28 offen lds
    s_add_u32 m0, s38, 0
    buffer_load_dwordx4 v4, s[4:7], s28 offen lds
    s_add_u32 m0, s39, 0
    buffer_load_dwordx4 v5, s[4:7], s28 offen lds
    s_add_u32 m0, s40, 0
    buffer_load_dwordx4 v6, s[8:11], s29 offen lds
    s_add_u32 m0, s41, 0
    buffer_load_dwordx4 v7, s[8:11], s29 offen lds
    s_add_u32 m0, s42, 0
    buffer_load_dwordx4 v8, s[12:15], s29 offen lds
    s_add_u32 m0, s43, 0
    buffer_load_dwordx4 v9, s[12:15], s29 offen lds
    s_add_u32 s28, s28, 64
    s_add_u32 s29, s29, 229376
    s_add_u32 m0, s36, 32768
    buffer_load_dwordx4 v2, s[4:7], s28 offen lds
    s_add_u32 m0, s37, 32768
    buffer_load_dwordx4 v3, s[4:7], s28 offen lds
    s_add_u32 m0, s38, 32768
    buffer_load_dwordx4 v4, s[4:7], s28 offen lds
    s_add_u32 m0, s39, 32768
    buffer_load_dwordx4 v5, s[4:7], s28 offen lds
    s_add_u32 m0, s40, 32768
    buffer_load_dwordx4 v6, s[8:11], s29 offen lds
    s_add_u32 m0, s41, 32768
    buffer_load_dwordx4 v7, s[8:11], s29 offen lds
    s_add_u32 m0, s42, 32768
    buffer_load_dwordx4 v8, s[12:15], s29 offen lds
    s_add_u32 m0, s43, 32768
    buffer_load_dwordx4 v9, s[12:15], s29 offen lds
    s_add_u32 s28, s28, 64
    s_add_u32 s29, s29, 229376
    s_add_u32 m0, s36, 65536
    buffer_load_dwordx4 v2, s[4:7], s28 offen lds
    s_add_u32 m0, s37, 65536
    buffer_load_dwordx4 v3, s[4:7], s28 offen lds
    s_add_u32 m0, s38, 65536
    buffer_load_dwordx4 v4, s[4:7], s28 offen lds
    s_add_u32 m0, s39, 65536
    buffer_load_dwordx4 v5, s[4:7], s28 offen lds
    s_add_u32 m0, s40, 65536
    buffer_load_dwordx4 v6, s[8:11], s29 offen lds
    s_add_u32 m0, s41, 65536
    buffer_load_dwordx4 v7, s[8:11], s29 offen lds
    s_add_u32 m0, s42, 65536
    buffer_load_dwordx4 v8, s[12:15], s29 offen lds
    s_add_u32 m0, s43, 65536
    buffer_load_dwordx4 v9, s[12:15], s29 offen lds
    s_add_u32 s28, s28, 64
    s_add_u32 s29, s29, 229376
    s_add_u32 m0, s36, 98304
    buffer_load_dwordx4 v2, s[4:7], s28 offen lds
    s_add_u32 m0, s37, 98304
    buffer_load_dwordx4 v3, s[4:7], s28 offen lds
    s_add_u32 m0, s38, 98304
    buffer_load_dwordx4 v4, s[4:7], s28 offen lds
    s_add_u32 m0, s39, 98304
    buffer_load_dwordx4 v5, s[4:7], s28 offen lds
    s_add_u32 m0, s40, 98304
    buffer_load_dwordx4 v6, s[8:11], s29 offen lds
    s_add_u32 m0, s41, 98304
    buffer_load_dwordx4 v7, s[8:11], s29 offen lds
    s_add_u32 m0, s42, 98304
    buffer_load_dwordx4 v8, s[12:15], s29 offen lds
    s_add_u32 m0, s43, 98304
    buffer_load_dwordx4 v9, s[12:15], s29 offen lds
    s_add_u32 s28, s28, 64
    s_add_u32 s29, s29, 229376
    v_accvgpr_write_b32 a0, 0
    v_accvgpr_write_b32 a1, 0
    v_accvgpr_write_b32 a2, 0
    v_accvgpr_write_b32 a3, 0
    v_accvgpr_write_b32 a4, 0
    v_accvgpr_write_b32 a5, 0
    v_accvgpr_write_b32 a6, 0
    v_accvgpr_write_b32 a7, 0
    v_accvgpr_write_b32 a8, 0
    v_accvgpr_write_b32 a9, 0
    v_accvgpr_write_b32 a10, 0
    v_accvgpr_write_b32 a11, 0
    v_accvgpr_write_b32 a12, 0
    v_accvgpr_write_b32 a13, 0
    v_accvgpr_write_b32 a14, 0
    v_accvgpr_write_b32 a15, 0
    v_accvgpr_write_b32 a16, 0
    v_accvgpr_write_b32 a17, 0
    v_accvgpr_write_b32 a18, 0
    v_accvgpr_write_b32 a19, 0
    v_accvgpr_write_b32 a20, 0
    v_accvgpr_write_b32 a21, 0
    v_accvgpr_write_b32 a22, 0
    v_accvgpr_write_b32 a23, 0
    v_accvgpr_write_b32 a24, 0
    v_accvgpr_write_b32 a25, 0
    v_accvgpr_write_b32 a26, 0
    v_accvgpr_write_b32 a27, 0
    v_accvgpr_write_b32 a28, 0
    v_accvgpr_write_b32 a29, 0
    v_accvgpr_write_b32 a30, 0
    v_accvgpr_write_b32 a31, 0
    v_accvgpr_write_b32 a32, 0
    v_accvgpr_write_b32 a33, 0
    v_accvgpr_write_b32 a34, 0
    v_accvgpr_write_b32 a35, 0
    v_accvgpr_write_b32 a36, 0
    v_accvgpr_write_b32 a37, 0
    v_accvgpr_write_b32 a38, 0
    v_accvgpr_write_b32 a39, 0
    v_accvgpr_write_b32 a40, 0
    v_accvgpr_write_b32 a41, 0
    v_accvgpr_write_b32 a42, 0
    v_accvgpr_write_b32 a43, 0
    v_accvgpr_write_b32 a44, 0
    v_accvgpr_write_b32 a45, 0
    v_accvgpr_write_b32 a46, 0
    v_accvgpr_write_b32 a47, 0
    v_accvgpr_write_b32 a48, 0
    v_accvgpr_write_b32 a49, 0
    v_accvgpr_write_b32 a50, 0
    v_accvgpr_write_b32 a51, 0
    v_accvgpr_write_b32 a52, 0
    v_accvgpr_write_b32 a53, 0
    v_accvgpr_write_b32 a54, 0
    v_accvgpr_write_b32 a55, 0
    v_accvgpr_write_b32 a56, 0
    v_accvgpr_write_b32 a57, 0
    v_accvgpr_write_b32 a58, 0
    v_accvgpr_write_b32 a59, 0
    v_accvgpr_write_b32 a60, 0
    v_accvgpr_write_b32 a61, 0
    v_accvgpr_write_b32 a62, 0
    v_accvgpr_write_b32 a63, 0
    v_accvgpr_write_b32 a64, 0
    v_accvgpr_write_b32 a65, 0
    v_accvgpr_write_b32 a66, 0
    v_accvgpr_write_b32 a67, 0
    v_accvgpr_write_b32 a68, 0
    v_accvgpr_write_b32 a69, 0
    v_accvgpr_write_b32 a70, 0
    v_accvgpr_write_b32 a71, 0
    v_accvgpr_write_b32 a72, 0
    v_accvgpr_write_b32 a73, 0
    v_accvgpr_write_b32 a74, 0
    v_accvgpr_write_b32 a75, 0
    v_accvgpr_write_b32 a76, 0
    v_accvgpr_write_b32 a77, 0
    v_accvgpr_write_b32 a78, 0
    v_accvgpr_write_b32 a79, 0
    v_accvgpr_write_b32 a80, 0
    v_accvgpr_write_b32 a81, 0
    v_accvgpr_write_b32 a82, 0
    v_accvgpr_write_b32 a83, 0
    v_accvgpr_write_b32 a84, 0
    v_accvgpr_write_b32 a85, 0
    v_accvgpr_write_b32 a86, 0
    v_accvgpr_write_b32 a87, 0
    v_accvgpr_write_b32 a88, 0
    v_accvgpr_write_b32 a89, 0
    v_accvgpr_write_b32 a90, 0
    v_accvgpr_write_b32 a91, 0
    v_accvgpr_write_b32 a92, 0
    v_accvgpr_write_b32 a93, 0
    v_accvgpr_write_b32 a94, 0
    v_accvgpr_write_b32 a95, 0
    v_accvgpr_write_b32 a96, 0
    v_accvgpr_write_b32 a97, 0
    v_accvgpr_write_b32 a98, 0
    v_accvgpr_write_b32 a99, 0
    v_accvgpr_write_b32 a100, 0
    v_accvgpr_write_b32 a101, 0
    v_accvgpr_write_b32 a102, 0
    v_accvgpr_write_b32 a103, 0
    v_accvgpr_write_b32 a104, 0
    v_accvgpr_write_b32 a105, 0
    v_accvgpr_write_b32 a106, 0
    v_accvgpr_write_b32 a107, 0
    v_accvgpr_write_b32 a108, 0
    v_accvgpr_write_b32 a109, 0
    v_accvgpr_write_b32 a110, 0
    v_accvgpr_write_b32 a111, 0
    v_accvgpr_write_b32 a112, 0
    v_accvgpr_write_b32 a113, 0
    v_accvgpr_write_b32 a114, 0
    v_accvgpr_write_b32 a115, 0
    v_accvgpr_write_b32 a116, 0
    v_accvgpr_write_b32 a117, 0
    v_accvgpr_write_b32 a118, 0
    v_accvgpr_write_b32 a119, 0
    v_accvgpr_write_b32 a120, 0
    v_accvgpr_write_b32 a121, 0
    v_accvgpr_write_b32 a122, 0
    v_accvgpr_write_b32 a123, 0
    v_accvgpr_write_b32 a124, 0
    v_accvgpr_write_b32 a125, 0
    v_accvgpr_write_b32 a126, 0
    v_accvgpr_write_b32 a127, 0
    v_accvgpr_write_b32 a128, 0
    v_accvgpr_write_b32 a129, 0
    v_accvgpr_write_b32 a130, 0
    v_accvgpr_write_b32 a131, 0
    v_accvgpr_write_b32 a132, 0
    v_accvgpr_write_b32 a133, 0
    v_accvgpr_write_b32 a134, 0
    v_accvgpr_write_b32 a135, 0
    v_accvgpr_write_b32 a136, 0
    v_accvgpr_write_b32 a137, 0
    v_accvgpr_write_b32 a138, 0
    v_accvgpr_write_b32 a139, 0
    v_accvgpr_write_b32 a140, 0
    v_accvgpr_write_b32 a141, 0
    v_accvgpr_write_b32 a142, 0
    v_accvgpr_write_b32 a143, 0
    v_accvgpr_write_b32 a144, 0
    v_accvgpr_write_b32 a145, 0
    v_accvgpr_write_b32 a146, 0
    v_accvgpr_write_b32 a147, 0
    v_accvgpr_write_b32 a148, 0
    v_accvgpr_write_b32 a149, 0
    v_accvgpr_write_b32 a150, 0
    v_accvgpr_write_b32 a151, 0
    v_accvgpr_write_b32 a152, 0
    v_accvgpr_write_b32 a153, 0
    v_accvgpr_write_b32 a154, 0
    v_accvgpr_write_b32 a155, 0
    v_accvgpr_write_b32 a156, 0
    v_accvgpr_write_b32 a157, 0
    v_accvgpr_write_b32 a158, 0
    v_accvgpr_write_b32 a159, 0
    v_accvgpr_write_b32 a160, 0
    v_accvgpr_write_b32 a161, 0
    v_accvgpr_write_b32 a162, 0
    v_accvgpr_write_b32 a163, 0
    v_accvgpr_write_b32 a164, 0
    v_accvgpr_write_b32 a165, 0
    v_accvgpr_write_b32 a166, 0
    v_accvgpr_write_b32 a167, 0
    v_accvgpr_write_b32 a168, 0
    v_accvgpr_write_b32 a169, 0
    v_accvgpr_write_b32 a170, 0
    v_accvgpr_write_b32 a171, 0
    v_accvgpr_write_b32 a172, 0
    v_accvgpr_write_b32 a173, 0
    v_accvgpr_write_b32 a174, 0
    v_accvgpr_write_b32 a175, 0
    v_accvgpr_write_b32 a176, 0
    v_accvgpr_write_b32 a177, 0
    v_accvgpr_write_b32 a178, 0
    v_accvgpr_write_b32 a179, 0
    v_accvgpr_write_b32 a180, 0
    v_accvgpr_write_b32 a181, 0
    v_accvgpr_write_b32 a182, 0
    v_accvgpr_write_b32 a183, 0
    v_accvgpr_write_b32 a184, 0
    v_accvgpr_write_b32 a185, 0
    v_accvgpr_write_b32 a186, 0
    v_accvgpr_write_b32 a187, 0
    v_accvgpr_write_b32 a188, 0
    v_accvgpr_write_b32 a189, 0
    v_accvgpr_write_b32 a190, 0
    v_accvgpr_write_b32 a191, 0
    v_accvgpr_write_b32 a192, 0
    v_accvgpr_write_b32 a193, 0
    v_accvgpr_write_b32 a194, 0
    v_accvgpr_write_b32 a195, 0
    v_accvgpr_write_b32 a196, 0
    v_accvgpr_write_b32 a197, 0
    v_accvgpr_write_b32 a198, 0
    v_accvgpr_write_b32 a199, 0
    v_accvgpr_write_b32 a200, 0
    v_accvgpr_write_b32 a201, 0
    v_accvgpr_write_b32 a202, 0
    v_accvgpr_write_b32 a203, 0
    v_accvgpr_write_b32 a204, 0
    v_accvgpr_write_b32 a205, 0
    v_accvgpr_write_b32 a206, 0
    v_accvgpr_write_b32 a207, 0
    v_accvgpr_write_b32 a208, 0
    v_accvgpr_write_b32 a209, 0
    v_accvgpr_write_b32 a210, 0
    v_accvgpr_write_b32 a211, 0
    v_accvgpr_write_b32 a212, 0
    v_accvgpr_write_b32 a213, 0
    v_accvgpr_write_b32 a214, 0
    v_accvgpr_write_b32 a215, 0
    v_accvgpr_write_b32 a216, 0
    v_accvgpr_write_b32 a217, 0
    v_accvgpr_write_b32 a218, 0
    v_accvgpr_write_b32 a219, 0
    v_accvgpr_write_b32 a220, 0
    v_accvgpr_write_b32 a221, 0
    v_accvgpr_write_b32 a222, 0
    v_accvgpr_write_b32 a223, 0
    s_waitcnt vmcnt(24)
    s_barrier
    ds_read_b128 v[52:55], v10 offset:0
    ds_read_b128 v[56:59], v10 offset:1024
    ds_read_b128 v[60:63], v10 offset:2048
    ds_read_b128 v[64:67], v10 offset:3072
    ds_read_b64_tr_b16 v[68:69], v14 offset:0
    ds_read_b64_tr_b16 v[70:71], v14 offset:1024
    ds_read_b64_tr_b16 v[72:73], v18 offset:0
    ds_read_b64_tr_b16 v[74:75], v18 offset:1024
    ds_read_b64_tr_b16 v[76:77], v22 offset:0
    ds_read_b64_tr_b16 v[78:79], v22 offset:1024
    ds_read_b64_tr_b16 v[80:81], v26 offset:0
    ds_read_b64_tr_b16 v[82:83], v26 offset:1024
    ds_read_b64_tr_b16 v[84:85], v30 offset:0
    ds_read_b64_tr_b16 v[86:87], v30 offset:1024
    ds_read_b64_tr_b16 v[88:89], v34 offset:0
    ds_read_b64_tr_b16 v[90:91], v34 offset:1024
    ds_read_b64_tr_b16 v[92:93], v38 offset:0
    ds_read_b64_tr_b16 v[94:95], v38 offset:1024
    ds_read_b64_tr_b16 v[96:97], v14 offset:8192
    ds_read_b64_tr_b16 v[98:99], v14 offset:9216
    ds_read_b64_tr_b16 v[100:101], v18 offset:8192
    ds_read_b64_tr_b16 v[102:103], v18 offset:9216
    ds_read_b64_tr_b16 v[104:105], v22 offset:8192
    ds_read_b64_tr_b16 v[106:107], v22 offset:9216
    ds_read_b64_tr_b16 v[108:109], v26 offset:8192
    ds_read_b64_tr_b16 v[110:111], v26 offset:9216
    ds_read_b64_tr_b16 v[112:113], v30 offset:8192
    ds_read_b64_tr_b16 v[114:115], v30 offset:9216
    ds_read_b64_tr_b16 v[116:117], v34 offset:8192
    ds_read_b64_tr_b16 v[118:119], v34 offset:9216
    ds_read_b64_tr_b16 v[120:121], v38 offset:8192
    ds_read_b64_tr_b16 v[122:123], v38 offset:9216
    s_waitcnt lgkmcnt(0)
    v_mfma_f32_16x16x32_bf16 a[0:3], v[68:71], v[52:55], a[0:3]
    v_mfma_f32_16x16x32_bf16 a[56:59], v[68:71], v[56:59], a[56:59]
    s_waitcnt vmcnt(16)
    s_barrier
    s_add_u32 m0, s36, 0
    buffer_load_dwordx4 v2, s[4:7], s28 offen lds
    s_add_u32 m0, s37, 0
    buffer_load_dwordx4 v3, s[4:7], s28 offen lds
    s_add_u32 m0, s38, 0
    buffer_load_dwordx4 v4, s[4:7], s28 offen lds
    s_add_u32 m0, s39, 0
    buffer_load_dwordx4 v5, s[4:7], s28 offen lds
    s_add_u32 m0, s40, 0
    buffer_load_dwordx4 v6, s[8:11], s29 offen lds
    s_add_u32 m0, s41, 0
    buffer_load_dwordx4 v7, s[8:11], s29 offen lds
    s_add_u32 m0, s42, 0
    buffer_load_dwordx4 v8, s[12:15], s29 offen lds
    s_add_u32 m0, s43, 0
    buffer_load_dwordx4 v9, s[12:15], s29 offen lds
    s_add_u32 s28, s28, 64
    s_add_u32 s29, s29, 229376
    ds_read_b128 v[124:127], v11 offset:0
    v_mfma_f32_16x16x32_bf16 a[112:115], v[68:71], v[60:63], a[112:115]
    ds_read_b128 v[128:131], v11 offset:1024
    v_mfma_f32_16x16x32_bf16 a[168:171], v[68:71], v[64:67], a[168:171]
    ds_read_b128 v[132:135], v11 offset:2048
    v_mfma_f32_16x16x32_bf16 a[4:7], v[72:75], v[52:55], a[4:7]
    ds_read_b128 v[136:139], v11 offset:3072
    v_mfma_f32_16x16x32_bf16 a[60:63], v[72:75], v[56:59], a[60:63]
    ds_read_b64_tr_b16 v[140:141], v15 offset:0
    v_mfma_f32_16x16x32_bf16 a[116:119], v[72:75], v[60:63], a[116:119]
    ds_read_b64_tr_b16 v[142:143], v15 offset:1024
    v_mfma_f32_16x16x32_bf16 a[172:175], v[72:75], v[64:67], a[172:175]
    ds_read_b64_tr_b16 v[144:145], v19 offset:0
    v_mfma_f32_16x16x32_bf16 a[8:11], v[76:79], v[52:55], a[8:11]
    ds_read_b64_tr_b16 v[146:147], v19 offset:1024
    v_mfma_f32_16x16x32_bf16 a[64:67], v[76:79], v[56:59], a[64:67]
    ds_read_b64_tr_b16 v[148:149], v23 offset:0
    v_mfma_f32_16x16x32_bf16 a[120:123], v[76:79], v[60:63], a[120:123]
    ds_read_b64_tr_b16 v[150:151], v23 offset:1024
    v_mfma_f32_16x16x32_bf16 a[176:179], v[76:79], v[64:67], a[176:179]
    ds_read_b64_tr_b16 v[152:153], v27 offset:0
    v_mfma_f32_16x16x32_bf16 a[12:15], v[80:83], v[52:55], a[12:15]
    ds_read_b64_tr_b16 v[154:155], v27 offset:1024
    v_mfma_f32_16x16x32_bf16 a[68:71], v[80:83], v[56:59], a[68:71]
    ds_read_b64_tr_b16 v[156:157], v31 offset:0
    v_mfma_f32_16x16x32_bf16 a[124:127], v[80:83], v[60:63], a[124:127]
    ds_read_b64_tr_b16 v[158:159], v31 offset:1024
    v_mfma_f32_16x16x32_bf16 a[180:183], v[80:83], v[64:67], a[180:183]
    ds_read_b64_tr_b16 v[160:161], v35 offset:0
    v_mfma_f32_16x16x32_bf16 a[16:19], v[84:87], v[52:55], a[16:19]
    ds_read_b64_tr_b16 v[162:163], v35 offset:1024
    v_mfma_f32_16x16x32_bf16 a[72:75], v[84:87], v[56:59], a[72:75]
    ds_read_b64_tr_b16 v[164:165], v39 offset:0
    v_mfma_f32_16x16x32_bf16 a[128:131], v[84:87], v[60:63], a[128:131]
    ds_read_b64_tr_b16 v[166:167], v39 offset:1024
    v_mfma_f32_16x16x32_bf16 a[184:187], v[84:87], v[64:67], a[184:187]
    ds_read_b64_tr_b16 v[168:169], v15 offset:8192
    v_mfma_f32_16x16x32_bf16 a[20:23], v[88:91], v[52:55], a[20:23]
    ds_read_b64_tr_b16 v[170:171], v15 offset:9216
    v_mfma_f32_16x16x32_bf16 a[76:79], v[88:91], v[56:59], a[76:79]
    ds_read_b64_tr_b16 v[172:173], v19 offset:8192
    v_mfma_f32_16x16x32_bf16 a[132:135], v[88:91], v[60:63], a[132:135]
    ds_read_b64_tr_b16 v[174:175], v19 offset:9216
    v_mfma_f32_16x16x32_bf16 a[188:191], v[88:91], v[64:67], a[188:191]
    ds_read_b64_tr_b16 v[176:177], v23 offset:8192
    v_mfma_f32_16x16x32_bf16 a[24:27], v[92:95], v[52:55], a[24:27]
    ds_read_b64_tr_b16 v[178:179], v23 offset:9216
    v_mfma_f32_16x16x32_bf16 a[80:83], v[92:95], v[56:59], a[80:83]
    ds_read_b64_tr_b16 v[180:181], v27 offset:8192
    v_mfma_f32_16x16x32_bf16 a[136:139], v[92:95], v[60:63], a[136:139]
    ds_read_b64_tr_b16 v[182:183], v27 offset:9216
    v_mfma_f32_16x16x32_bf16 a[192:195], v[92:95], v[64:67], a[192:195]
    ds_read_b64_tr_b16 v[184:185], v31 offset:8192
    v_mfma_f32_16x16x32_bf16 a[28:31], v[96:99], v[52:55], a[28:31]
    ds_read_b64_tr_b16 v[186:187], v31 offset:9216
    v_mfma_f32_16x16x32_bf16 a[84:87], v[96:99], v[56:59], a[84:87]
    ds_read_b64_tr_b16 v[188:189], v35 offset:8192
    v_mfma_f32_16x16x32_bf16 a[140:143], v[96:99], v[60:63], a[140:143]
    ds_read_b64_tr_b16 v[190:191], v35 offset:9216
    v_mfma_f32_16x16x32_bf16 a[196:199], v[96:99], v[64:67], a[196:199]
    ds_read_b64_tr_b16 v[192:193], v39 offset:8192
    v_mfma_f32_16x16x32_bf16 a[32:35], v[100:103], v[52:55], a[32:35]
    ds_read_b64_tr_b16 v[194:195], v39 offset:9216
    v_mfma_f32_16x16x32_bf16 a[88:91], v[100:103], v[56:59], a[88:91]
    v_mfma_f32_16x16x32_bf16 a[144:147], v[100:103], v[60:63], a[144:147]
    v_mfma_f32_16x16x32_bf16 a[200:203], v[100:103], v[64:67], a[200:203]
    v_mfma_f32_16x16x32_bf16 a[36:39], v[104:107], v[52:55], a[36:39]
    v_mfma_f32_16x16x32_bf16 a[92:95], v[104:107], v[56:59], a[92:95]
    v_mfma_f32_16x16x32_bf16 a[148:151], v[104:107], v[60:63], a[148:151]
    v_mfma_f32_16x16x32_bf16 a[204:207], v[104:107], v[64:67], a[204:207]
    v_mfma_f32_16x16x32_bf16 a[40:43], v[108:111], v[52:55], a[40:43]
    v_mfma_f32_16x16x32_bf16 a[96:99], v[108:111], v[56:59], a[96:99]
    v_mfma_f32_16x16x32_bf16 a[152:155], v[108:111], v[60:63], a[152:155]
    v_mfma_f32_16x16x32_bf16 a[208:211], v[108:111], v[64:67], a[208:211]
    v_mfma_f32_16x16x32_bf16 a[44:47], v[112:115], v[52:55], a[44:47]
    v_mfma_f32_16x16x32_bf16 a[100:103], v[112:115], v[56:59], a[100:103]
    v_mfma_f32_16x16x32_bf16 a[156:159], v[112:115], v[60:63], a[156:159]
    v_mfma_f32_16x16x32_bf16 a[212:215], v[112:115], v[64:67], a[212:215]
    v_mfma_f32_16x16x32_bf16 a[48:51], v[116:119], v[52:55], a[48:51]
    v_mfma_f32_16x16x32_bf16 a[104:107], v[116:119], v[56:59], a[104:107]
    v_mfma_f32_16x16x32_bf16 a[160:163], v[116:119], v[60:63], a[160:163]
    v_mfma_f32_16x16x32_bf16 a[216:219], v[116:119], v[64:67], a[216:219]
    v_mfma_f32_16x16x32_bf16 a[52:55], v[120:123], v[52:55], a[52:55]
    v_mfma_f32_16x16x32_bf16 a[108:111], v[120:123], v[56:59], a[108:111]
    v_mfma_f32_16x16x32_bf16 a[164:167], v[120:123], v[60:63], a[164:167]
    v_mfma_f32_16x16x32_bf16 a[220:223], v[120:123], v[64:67], a[220:223]
    s_waitcnt lgkmcnt(0)
    v_mfma_f32_16x16x32_bf16 a[0:3], v[140:143], v[124:127], a[0:3]
    v_mfma_f32_16x16x32_bf16 a[56:59], v[140:143], v[128:131], a[56:59]
    s_waitcnt vmcnt(16)
    s_barrier
    s_add_u32 m0, s36, 32768
    buffer_load_dwordx4 v2, s[4:7], s28 offen lds
    s_add_u32 m0, s37, 32768
    buffer_load_dwordx4 v3, s[4:7], s28 offen lds
    s_add_u32 m0, s38, 32768
    buffer_load_dwordx4 v4, s[4:7], s28 offen lds
    s_add_u32 m0, s39, 32768
    buffer_load_dwordx4 v5, s[4:7], s28 offen lds
    s_add_u32 m0, s40, 32768
    buffer_load_dwordx4 v6, s[8:11], s29 offen lds
    s_add_u32 m0, s41, 32768
    buffer_load_dwordx4 v7, s[8:11], s29 offen lds
    s_add_u32 m0, s42, 32768
    buffer_load_dwordx4 v8, s[12:15], s29 offen lds
    s_add_u32 m0, s43, 32768
    buffer_load_dwordx4 v9, s[12:15], s29 offen lds
    s_add_u32 s28, s28, 64
    s_add_u32 s29, s29, 229376
    ds_read_b128 v[52:55], v12 offset:0
    v_mfma_f32_16x16x32_bf16 a[112:115], v[140:143], v[132:135], a[112:115]
    ds_read_b128 v[56:59], v12 offset:1024
    v_mfma_f32_16x16x32_bf16 a[168:171], v[140:143], v[136:139], a[168:171]
    ds_read_b128 v[60:63], v12 offset:2048
    v_mfma_f32_16x16x32_bf16 a[4:7], v[144:147], v[124:127], a[4:7]
    ds_read_b128 v[64:67], v12 offset:3072
    v_mfma_f32_16x16x32_bf16 a[60:63], v[144:147], v[128:131], a[60:63]
    ds_read_b64_tr_b16 v[68:69], v16 offset:0
    v_mfma_f32_16x16x32_bf16 a[116:119], v[144:147], v[132:135], a[116:119]
    ds_read_b64_tr_b16 v[70:71], v16 offset:1024
    v_mfma_f32_16x16x32_bf16 a[172:175], v[144:147], v[136:139], a[172:175]
    ds_read_b64_tr_b16 v[72:73], v20 offset:0
    v_mfma_f32_16x16x32_bf16 a[8:11], v[148:151], v[124:127], a[8:11]
    ds_read_b64_tr_b16 v[74:75], v20 offset:1024
    v_mfma_f32_16x16x32_bf16 a[64:67], v[148:151], v[128:131], a[64:67]
    ds_read_b64_tr_b16 v[76:77], v24 offset:0
    v_mfma_f32_16x16x32_bf16 a[120:123], v[148:151], v[132:135], a[120:123]
    ds_read_b64_tr_b16 v[78:79], v24 offset:1024
    v_mfma_f32_16x16x32_bf16 a[176:179], v[148:151], v[136:139], a[176:179]
    ds_read_b64_tr_b16 v[80:81], v28 offset:0
    v_mfma_f32_16x16x32_bf16 a[12:15], v[152:155], v[124:127], a[12:15]
    ds_read_b64_tr_b16 v[82:83], v28 offset:1024
    v_mfma_f32_16x16x32_bf16 a[68:71], v[152:155], v[128:131], a[68:71]
    ds_read_b64_tr_b16 v[84:85], v32 offset:0
    v_mfma_f32_16x16x32_bf16 a[124:127], v[152:155], v[132:135], a[124:127]
    ds_read_b64_tr_b16 v[86:87], v32 offset:1024
    v_mfma_f32_16x16x32_bf16 a[180:183], v[152:155], v[136:139], a[180:183]
    ds_read_b64_tr_b16 v[88:89], v36 offset:0
    v_mfma_f32_16x16x32_bf16 a[16:19], v[156:159], v[124:127], a[16:19]
    ds_read_b64_tr_b16 v[90:91], v36 offset:1024
    v_mfma_f32_16x16x32_bf16 a[72:75], v[156:159], v[128:131], a[72:75]
    ds_read_b64_tr_b16 v[92:93], v40 offset:0
    v_mfma_f32_16x16x32_bf16 a[128:131], v[156:159], v[132:135], a[128:131]
    ds_read_b64_tr_b16 v[94:95], v40 offset:1024
    v_mfma_f32_16x16x32_bf16 a[184:187], v[156:159], v[136:139], a[184:187]
    ds_read_b64_tr_b16 v[96:97], v16 offset:8192
    v_mfma_f32_16x16x32_bf16 a[20:23], v[160:163], v[124:127], a[20:23]
    ds_read_b64_tr_b16 v[98:99], v16 offset:9216
    v_mfma_f32_16x16x32_bf16 a[76:79], v[160:163], v[128:131], a[76:79]
    ds_read_b64_tr_b16 v[100:101], v20 offset:8192
    v_mfma_f32_16x16x32_bf16 a[132:135], v[160:163], v[132:135], a[132:135]
    ds_read_b64_tr_b16 v[102:103], v20 offset:9216
    v_mfma_f32_16x16x32_bf16 a[188:191], v[160:163], v[136:139], a[188:191]
    ds_read_b64_tr_b16 v[104:105], v24 offset:8192
    v_mfma_f32_16x16x32_bf16 a[24:27], v[164:167], v[124:127], a[24:27]
    ds_read_b64_tr_b16 v[106:107], v24 offset:9216
    v_mfma_f32_16x16x32_bf16 a[80:83], v[164:167], v[128:131], a[80:83]
    ds_read_b64_tr_b16 v[108:109], v28 offset:8192
    v_mfma_f32_16x16x32_bf16 a[136:139], v[164:167], v[132:135], a[136:139]
    ds_read_b64_tr_b16 v[110:111], v28 offset:9216
    v_mfma_f32_16x16x32_bf16 a[192:195], v[164:167], v[136:139], a[192:195]
    ds_read_b64_tr_b16 v[112:113], v32 offset:8192
    v_mfma_f32_16x16x32_bf16 a[28:31], v[168:171], v[124:127], a[28:31]
    ds_read_b64_tr_b16 v[114:115], v32 offset:9216
    v_mfma_f32_16x16x32_bf16 a[84:87], v[168:171], v[128:131], a[84:87]
    ds_read_b64_tr_b16 v[116:117], v36 offset:8192
    v_mfma_f32_16x16x32_bf16 a[140:143], v[168:171], v[132:135], a[140:143]
    ds_read_b64_tr_b16 v[118:119], v36 offset:9216
    v_mfma_f32_16x16x32_bf16 a[196:199], v[168:171], v[136:139], a[196:199]
    ds_read_b64_tr_b16 v[120:121], v40 offset:8192
    v_mfma_f32_16x16x32_bf16 a[32:35], v[172:175], v[124:127], a[32:35]
    ds_read_b64_tr_b16 v[122:123], v40 offset:9216
    v_mfma_f32_16x16x32_bf16 a[88:91], v[172:175], v[128:131], a[88:91]
    v_mfma_f32_16x16x32_bf16 a[144:147], v[172:175], v[132:135], a[144:147]
    v_mfma_f32_16x16x32_bf16 a[200:203], v[172:175], v[136:139], a[200:203]
    v_mfma_f32_16x16x32_bf16 a[36:39], v[176:179], v[124:127], a[36:39]
    v_mfma_f32_16x16x32_bf16 a[92:95], v[176:179], v[128:131], a[92:95]
    v_mfma_f32_16x16x32_bf16 a[148:151], v[176:179], v[132:135], a[148:151]
    v_mfma_f32_16x16x32_bf16 a[204:207], v[176:179], v[136:139], a[204:207]
    v_mfma_f32_16x16x32_bf16 a[40:43], v[180:183], v[124:127], a[40:43]
    v_mfma_f32_16x16x32_bf16 a[96:99], v[180:183], v[128:131], a[96:99]
    v_mfma_f32_16x16x32_bf16 a[152:155], v[180:183], v[132:135], a[152:155]
    v_mfma_f32_16x16x32_bf16 a[208:211], v[180:183], v[136:139], a[208:211]
    v_mfma_f32_16x16x32_bf16 a[44:47], v[184:187], v[124:127], a[44:47]
    v_mfma_f32_16x16x32_bf16 a[100:103], v[184:187], v[128:131], a[100:103]
    v_mfma_f32_16x16x32_bf16 a[156:159], v[184:187], v[132:135], a[156:159]
    v_mfma_f32_16x16x32_bf16 a[212:215], v[184:187], v[136:139], a[212:215]
    v_mfma_f32_16x16x32_bf16 a[48:51], v[188:191], v[124:127], a[48:51]
    v_mfma_f32_16x16x32_bf16 a[104:107], v[188:191], v[128:131], a[104:107]
    v_mfma_f32_16x16x32_bf16 a[160:163], v[188:191], v[132:135], a[160:163]
    v_mfma_f32_16x16x32_bf16 a[216:219], v[188:191], v[136:139], a[216:219]
    v_mfma_f32_16x16x32_bf16 a[52:55], v[192:195], v[124:127], a[52:55]
    v_mfma_f32_16x16x32_bf16 a[108:111], v[192:195], v[128:131], a[108:111]
    v_mfma_f32_16x16x32_bf16 a[164:167], v[192:195], v[132:135], a[164:167]
    v_mfma_f32_16x16x32_bf16 a[220:223], v[192:195], v[136:139], a[220:223]
    s_waitcnt lgkmcnt(0)
    v_mfma_f32_16x16x32_bf16 a[0:3], v[68:71], v[52:55], a[0:3]
    v_mfma_f32_16x16x32_bf16 a[56:59], v[68:71], v[56:59], a[56:59]
    s_waitcnt vmcnt(16)
    s_barrier
    s_add_u32 m0, s36, 65536
    buffer_load_dwordx4 v2, s[4:7], s28 offen lds
    s_add_u32 m0, s37, 65536
    buffer_load_dwordx4 v3, s[4:7], s28 offen lds
    s_add_u32 m0, s38, 65536
    buffer_load_dwordx4 v4, s[4:7], s28 offen lds
    s_add_u32 m0, s39, 65536
    buffer_load_dwordx4 v5, s[4:7], s28 offen lds
    s_add_u32 m0, s40, 65536
    buffer_load_dwordx4 v6, s[8:11], s29 offen lds
    s_add_u32 m0, s41, 65536
    buffer_load_dwordx4 v7, s[8:11], s29 offen lds
    s_add_u32 m0, s42, 65536
    buffer_load_dwordx4 v8, s[12:15], s29 offen lds
    s_add_u32 m0, s43, 65536
    buffer_load_dwordx4 v9, s[12:15], s29 offen lds
    s_add_u32 s28, s28, 64
    s_add_u32 s29, s29, 229376
    ds_read_b128 v[124:127], v13 offset:0
    v_mfma_f32_16x16x32_bf16 a[112:115], v[68:71], v[60:63], a[112:115]
    ds_read_b128 v[128:131], v13 offset:1024
    v_mfma_f32_16x16x32_bf16 a[168:171], v[68:71], v[64:67], a[168:171]
    ds_read_b128 v[132:135], v13 offset:2048
    v_mfma_f32_16x16x32_bf16 a[4:7], v[72:75], v[52:55], a[4:7]
    ds_read_b128 v[136:139], v13 offset:3072
    v_mfma_f32_16x16x32_bf16 a[60:63], v[72:75], v[56:59], a[60:63]
    ds_read_b64_tr_b16 v[140:141], v17 offset:0
    v_mfma_f32_16x16x32_bf16 a[116:119], v[72:75], v[60:63], a[116:119]
    ds_read_b64_tr_b16 v[142:143], v17 offset:1024
    v_mfma_f32_16x16x32_bf16 a[172:175], v[72:75], v[64:67], a[172:175]
    ds_read_b64_tr_b16 v[144:145], v21 offset:0
    v_mfma_f32_16x16x32_bf16 a[8:11], v[76:79], v[52:55], a[8:11]
    ds_read_b64_tr_b16 v[146:147], v21 offset:1024
    v_mfma_f32_16x16x32_bf16 a[64:67], v[76:79], v[56:59], a[64:67]
    ds_read_b64_tr_b16 v[148:149], v25 offset:0
    v_mfma_f32_16x16x32_bf16 a[120:123], v[76:79], v[60:63], a[120:123]
    ds_read_b64_tr_b16 v[150:151], v25 offset:1024
    v_mfma_f32_16x16x32_bf16 a[176:179], v[76:79], v[64:67], a[176:179]
    ds_read_b64_tr_b16 v[152:153], v29 offset:0
    v_mfma_f32_16x16x32_bf16 a[12:15], v[80:83], v[52:55], a[12:15]
    ds_read_b64_tr_b16 v[154:155], v29 offset:1024
    v_mfma_f32_16x16x32_bf16 a[68:71], v[80:83], v[56:59], a[68:71]
    ds_read_b64_tr_b16 v[156:157], v33 offset:0
    v_mfma_f32_16x16x32_bf16 a[124:127], v[80:83], v[60:63], a[124:127]
    ds_read_b64_tr_b16 v[158:159], v33 offset:1024
    v_mfma_f32_16x16x32_bf16 a[180:183], v[80:83], v[64:67], a[180:183]
    ds_read_b64_tr_b16 v[160:161], v37 offset:0
    v_mfma_f32_16x16x32_bf16 a[16:19], v[84:87], v[52:55], a[16:19]
    ds_read_b64_tr_b16 v[162:163], v37 offset:1024
    v_mfma_f32_16x16x32_bf16 a[72:75], v[84:87], v[56:59], a[72:75]
    ds_read_b64_tr_b16 v[164:165], v41 offset:0
    v_mfma_f32_16x16x32_bf16 a[128:131], v[84:87], v[60:63], a[128:131]
    ds_read_b64_tr_b16 v[166:167], v41 offset:1024
    v_mfma_f32_16x16x32_bf16 a[184:187], v[84:87], v[64:67], a[184:187]
    ds_read_b64_tr_b16 v[168:169], v17 offset:8192
    v_mfma_f32_16x16x32_bf16 a[20:23], v[88:91], v[52:55], a[20:23]
    ds_read_b64_tr_b16 v[170:171], v17 offset:9216
    v_mfma_f32_16x16x32_bf16 a[76:79], v[88:91], v[56:59], a[76:79]
    ds_read_b64_tr_b16 v[172:173], v21 offset:8192
    v_mfma_f32_16x16x32_bf16 a[132:135], v[88:91], v[60:63], a[132:135]
    ds_read_b64_tr_b16 v[174:175], v21 offset:9216
    v_mfma_f32_16x16x32_bf16 a[188:191], v[88:91], v[64:67], a[188:191]
    ds_read_b64_tr_b16 v[176:177], v25 offset:8192
    v_mfma_f32_16x16x32_bf16 a[24:27], v[92:95], v[52:55], a[24:27]
    ds_read_b64_tr_b16 v[178:179], v25 offset:9216
    v_mfma_f32_16x16x32_bf16 a[80:83], v[92:95], v[56:59], a[80:83]
    ds_read_b64_tr_b16 v[180:181], v29 offset:8192
    v_mfma_f32_16x16x32_bf16 a[136:139], v[92:95], v[60:63], a[136:139]
    ds_read_b64_tr_b16 v[182:183], v29 offset:9216
    v_mfma_f32_16x16x32_bf16 a[192:195], v[92:95], v[64:67], a[192:195]
    ds_read_b64_tr_b16 v[184:185], v33 offset:8192
    v_mfma_f32_16x16x32_bf16 a[28:31], v[96:99], v[52:55], a[28:31]
    ds_read_b64_tr_b16 v[186:187], v33 offset:9216
    v_mfma_f32_16x16x32_bf16 a[84:87], v[96:99], v[56:59], a[84:87]
    ds_read_b64_tr_b16 v[188:189], v37 offset:8192
    v_mfma_f32_16x16x32_bf16 a[140:143], v[96:99], v[60:63], a[140:143]
    ds_read_b64_tr_b16 v[190:191], v37 offset:9216
    v_mfma_f32_16x16x32_bf16 a[196:199], v[96:99], v[64:67], a[196:199]
    ds_read_b64_tr_b16 v[192:193], v41 offset:8192
    v_mfma_f32_16x16x32_bf16 a[32:35], v[100:103], v[52:55], a[32:35]
    ds_read_b64_tr_b16 v[194:195], v41 offset:9216
    v_mfma_f32_16x16x32_bf16 a[88:91], v[100:103], v[56:59], a[88:91]
    v_mfma_f32_16x16x32_bf16 a[144:147], v[100:103], v[60:63], a[144:147]
    v_mfma_f32_16x16x32_bf16 a[200:203], v[100:103], v[64:67], a[200:203]
    v_mfma_f32_16x16x32_bf16 a[36:39], v[104:107], v[52:55], a[36:39]
    v_mfma_f32_16x16x32_bf16 a[92:95], v[104:107], v[56:59], a[92:95]
    v_mfma_f32_16x16x32_bf16 a[148:151], v[104:107], v[60:63], a[148:151]
    v_mfma_f32_16x16x32_bf16 a[204:207], v[104:107], v[64:67], a[204:207]
    v_mfma_f32_16x16x32_bf16 a[40:43], v[108:111], v[52:55], a[40:43]
    v_mfma_f32_16x16x32_bf16 a[96:99], v[108:111], v[56:59], a[96:99]
    v_mfma_f32_16x16x32_bf16 a[152:155], v[108:111], v[60:63], a[152:155]
    v_mfma_f32_16x16x32_bf16 a[208:211], v[108:111], v[64:67], a[208:211]
    v_mfma_f32_16x16x32_bf16 a[44:47], v[112:115], v[52:55], a[44:47]
    v_mfma_f32_16x16x32_bf16 a[100:103], v[112:115], v[56:59], a[100:103]
    v_mfma_f32_16x16x32_bf16 a[156:159], v[112:115], v[60:63], a[156:159]
    v_mfma_f32_16x16x32_bf16 a[212:215], v[112:115], v[64:67], a[212:215]
    v_mfma_f32_16x16x32_bf16 a[48:51], v[116:119], v[52:55], a[48:51]
    v_mfma_f32_16x16x32_bf16 a[104:107], v[116:119], v[56:59], a[104:107]
    v_mfma_f32_16x16x32_bf16 a[160:163], v[116:119], v[60:63], a[160:163]
    v_mfma_f32_16x16x32_bf16 a[216:219], v[116:119], v[64:67], a[216:219]
    v_mfma_f32_16x16x32_bf16 a[52:55], v[120:123], v[52:55], a[52:55]
    v_mfma_f32_16x16x32_bf16 a[108:111], v[120:123], v[56:59], a[108:111]
    v_mfma_f32_16x16x32_bf16 a[164:167], v[120:123], v[60:63], a[164:167]
    v_mfma_f32_16x16x32_bf16 a[220:223], v[120:123], v[64:67], a[220:223]
    s_waitcnt lgkmcnt(0)
    v_mfma_f32_16x16x32_bf16 a[0:3], v[140:143], v[124:127], a[0:3]
    v_mfma_f32_16x16x32_bf16 a[56:59], v[140:143], v[128:131], a[56:59]
    s_waitcnt vmcnt(16)
    s_barrier
    s_add_u32 m0, s36, 98304
    buffer_load_dwordx4 v2, s[4:7], s28 offen lds
    s_add_u32 m0, s37, 98304
    buffer_load_dwordx4 v3, s[4:7], s28 offen lds
    s_add_u32 m0, s38, 98304
    buffer_load_dwordx4 v4, s[4:7], s28 offen lds
    s_add_u32 m0, s39, 98304
    buffer_load_dwordx4 v5, s[4:7], s28 offen lds
    s_add_u32 m0, s40, 98304
    buffer_load_dwordx4 v6, s[8:11], s29 offen lds
    s_add_u32 m0, s41, 98304
    buffer_load_dwordx4 v7, s[8:11], s29 offen lds
    s_add_u32 m0, s42, 98304
    buffer_load_dwordx4 v8, s[12:15], s29 offen lds
    s_add_u32 m0, s43, 98304
    buffer_load_dwordx4 v9, s[12:15], s29 offen lds
    s_add_u32 s28, s28, 64
    s_add_u32 s29, s29, 229376
    ds_read_b128 v[52:55], v10 offset:0
    v_mfma_f32_16x16x32_bf16 a[112:115], v[140:143], v[132:135], a[112:115]
    ds_read_b128 v[56:59], v10 offset:1024
    v_mfma_f32_16x16x32_bf16 a[168:171], v[140:143], v[136:139], a[168:171]
    ds_read_b128 v[60:63], v10 offset:2048
    v_mfma_f32_16x16x32_bf16 a[4:7], v[144:147], v[124:127], a[4:7]
    ds_read_b128 v[64:67], v10 offset:3072
    v_mfma_f32_16x16x32_bf16 a[60:63], v[144:147], v[128:131], a[60:63]
    ds_read_b64_tr_b16 v[68:69], v14 offset:0
    v_mfma_f32_16x16x32_bf16 a[116:119], v[144:147], v[132:135], a[116:119]
    ds_read_b64_tr_b16 v[70:71], v14 offset:1024
    v_mfma_f32_16x16x32_bf16 a[172:175], v[144:147], v[136:139], a[172:175]
    ds_read_b64_tr_b16 v[72:73], v18 offset:0
    v_mfma_f32_16x16x32_bf16 a[8:11], v[148:151], v[124:127], a[8:11]
    ds_read_b64_tr_b16 v[74:75], v18 offset:1024
    v_mfma_f32_16x16x32_bf16 a[64:67], v[148:151], v[128:131], a[64:67]
    ds_read_b64_tr_b16 v[76:77], v22 offset:0
    v_mfma_f32_16x16x32_bf16 a[120:123], v[148:151], v[132:135], a[120:123]
    ds_read_b64_tr_b16 v[78:79], v22 offset:1024
    v_mfma_f32_16x16x32_bf16 a[176:179], v[148:151], v[136:139], a[176:179]
    ds_read_b64_tr_b16 v[80:81], v26 offset:0
    v_mfma_f32_16x16x32_bf16 a[12:15], v[152:155], v[124:127], a[12:15]
    ds_read_b64_tr_b16 v[82:83], v26 offset:1024
    v_mfma_f32_16x16x32_bf16 a[68:71], v[152:155], v[128:131], a[68:71]
    ds_read_b64_tr_b16 v[84:85], v30 offset:0
    v_mfma_f32_16x16x32_bf16 a[124:127], v[152:155], v[132:135], a[124:127]
    ds_read_b64_tr_b16 v[86:87], v30 offset:1024
    v_mfma_f32_16x16x32_bf16 a[180:183], v[152:155], v[136:139], a[180:183]
    ds_read_b64_tr_b16 v[88:89], v34 offset:0
    v_mfma_f32_16x16x32_bf16 a[16:19], v[156:159], v[124:127], a[16:19]
    ds_read_b64_tr_b16 v[90:91], v34 offset:1024
    v_mfma_f32_16x16x32_bf16 a[72:75], v[156:159], v[128:131], a[72:75]
    ds_read_b64_tr_b16 v[92:93], v38 offset:0
    v_mfma_f32_16x16x32_bf16 a[128:131], v[156:159], v[132:135], a[128:131]
    ds_read_b64_tr_b16 v[94:95], v38 offset:1024
    v_mfma_f32_16x16x32_bf16 a[184:187], v[156:159], v[136:139], a[184:187]
    ds_read_b64_tr_b16 v[96:97], v14 offset:8192
    v_mfma_f32_16x16x32_bf16 a[20:23], v[160:163], v[124:127], a[20:23]
    ds_read_b64_tr_b16 v[98:99], v14 offset:9216
    v_mfma_f32_16x16x32_bf16 a[76:79], v[160:163], v[128:131], a[76:79]
    ds_read_b64_tr_b16 v[100:101], v18 offset:8192
    v_mfma_f32_16x16x32_bf16 a[132:135], v[160:163], v[132:135], a[132:135]
    ds_read_b64_tr_b16 v[102:103], v18 offset:9216
    v_mfma_f32_16x16x32_bf16 a[188:191], v[160:163], v[136:139], a[188:191]
    ds_read_b64_tr_b16 v[104:105], v22 offset:8192
    v_mfma_f32_16x16x32_bf16 a[24:27], v[164:167], v[124:127], a[24:27]
    ds_read_b64_tr_b16 v[106:107], v22 offset:9216
    v_mfma_f32_16x16x32_bf16 a[80:83], v[164:167], v[128:131], a[80:83]
    ds_read_b64_tr_b16 v[108:109], v26 offset:8192
    v_mfma_f32_16x16x32_bf16 a[136:139], v[164:167], v[132:135], a[136:139]
    ds_read_b64_tr_b16 v[110:111], v26 offset:9216
    v_mfma_f32_16x16x32_bf16 a[192:195], v[164:167], v[136:139], a[192:195]
    ds_read_b64_tr_b16 v[112:113], v30 offset:8192
    v_mfma_f32_16x16x32_bf16 a[28:31], v[168:171], v[124:127], a[28:31]
    ds_read_b64_tr_b16 v[114:115], v30 offset:9216
    v_mfma_f32_16x16x32_bf16 a[84:87], v[168:171], v[128:131], a[84:87]
    ds_read_b64_tr_b16 v[116:117], v34 offset:8192
    v_mfma_f32_16x16x32_bf16 a[140:143], v[168:171], v[132:135], a[140:143]
    ds_read_b64_tr_b16 v[118:119], v34 offset:9216
    v_mfma_f32_16x16x32_bf16 a[196:199], v[168:171], v[136:139], a[196:199]
    ds_read_b64_tr_b16 v[120:121], v38 offset:8192
    v_mfma_f32_16x16x32_bf16 a[32:35], v[172:175], v[124:127], a[32:35]
    ds_read_b64_tr_b16 v[122:123], v38 offset:9216
    v_mfma_f32_16x16x32_bf16 a[88:91], v[172:175], v[128:131], a[88:91]
    v_mfma_f32_16x16x32_bf16 a[144:147], v[172:175], v[132:135], a[144:147]
    v_mfma_f32_16x16x32_bf16 a[200:203], v[172:175], v[136:139], a[200:203]
    v_mfma_f32_16x16x32_bf16 a[36:39], v[176:179], v[124:127], a[36:39]
    v_mfma_f32_16x16x32_bf16 a[92:95], v[176:179], v[128:131], a[92:95]
    v_mfma_f32_16x16x32_bf16 a[148:151], v[176:179], v[132:135], a[148:151]
    v_mfma_f32_16x16x32_bf16 a[204:207], v[176:179], v[136:139], a[204:207]
    v_mfma_f32_16x16x32_bf16 a[40:43], v[180:183], v[124:127], a[40:43]
    v_mfma_f32_16x16x32_bf16 a[96:99], v[180:183], v[128:131], a[96:99]
    v_mfma_f32_16x16x32_bf16 a[152:155], v[180:183], v[132:135], a[152:155]
    v_mfma_f32_16x16x32_bf16 a[208:211], v[180:183], v[136:139], a[208:211]
    v_mfma_f32_16x16x32_bf16 a[44:47], v[184:187], v[124:127], a[44:47]
    v_mfma_f32_16x16x32_bf16 a[100:103], v[184:187], v[128:131], a[100:103]
    v_mfma_f32_16x16x32_bf16 a[156:159], v[184:187], v[132:135], a[156:159]
    v_mfma_f32_16x16x32_bf16 a[212:215], v[184:187], v[136:139], a[212:215]
    v_mfma_f32_16x16x32_bf16 a[48:51], v[188:191], v[124:127], a[48:51]
    v_mfma_f32_16x16x32_bf16 a[104:107], v[188:191], v[128:131], a[104:107]
    v_mfma_f32_16x16x32_bf16 a[160:163], v[188:191], v[132:135], a[160:163]
    v_mfma_f32_16x16x32_bf16 a[216:219], v[188:191], v[136:139], a[216:219]
    v_mfma_f32_16x16x32_bf16 a[52:55], v[192:195], v[124:127], a[52:55]
    v_mfma_f32_16x16x32_bf16 a[108:111], v[192:195], v[128:131], a[108:111]
    v_mfma_f32_16x16x32_bf16 a[164:167], v[192:195], v[132:135], a[164:167]
    v_mfma_f32_16x16x32_bf16 a[220:223], v[192:195], v[136:139], a[220:223]
    s_waitcnt lgkmcnt(0)
    v_mfma_f32_16x16x32_bf16 a[0:3], v[68:71], v[52:55], a[0:3]
    v_mfma_f32_16x16x32_bf16 a[56:59], v[68:71], v[56:59], a[56:59]
    s_waitcnt vmcnt(16)
    s_barrier
    s_add_u32 m0, s36, 0
    buffer_load_dwordx4 v2, s[4:7], s28 offen lds
    s_add_u32 m0, s37, 0
    buffer_load_dwordx4 v3, s[4:7], s28 offen lds
    s_add_u32 m0, s38, 0
    buffer_load_dwordx4 v4, s[4:7], s28 offen lds
    s_add_u32 m0, s39, 0
    buffer_load_dwordx4 v5, s[4:7], s28 offen lds
    s_add_u32 m0, s40, 0
    buffer_load_dwordx4 v6, s[8:11], s29 offen lds
    s_add_u32 m0, s41, 0
    buffer_load_dwordx4 v7, s[8:11], s29 offen lds
    s_add_u32 m0, s42, 0
    buffer_load_dwordx4 v8, s[12:15], s29 offen lds
    s_add_u32 m0, s43, 0
    buffer_load_dwordx4 v9, s[12:15], s29 offen lds
    s_add_u32 s28, s28, 64
    s_add_u32 s29, s29, 229376
    ds_read_b128 v[124:127], v11 offset:0
    v_mfma_f32_16x16x32_bf16 a[112:115], v[68:71], v[60:63], a[112:115]
    ds_read_b128 v[128:131], v11 offset:1024
    v_mfma_f32_16x16x32_bf16 a[168:171], v[68:71], v[64:67], a[168:171]
    ds_read_b128 v[132:135], v11 offset:2048
    v_mfma_f32_16x16x32_bf16 a[4:7], v[72:75], v[52:55], a[4:7]
    ds_read_b128 v[136:139], v11 offset:3072
    v_mfma_f32_16x16x32_bf16 a[60:63], v[72:75], v[56:59], a[60:63]
    ds_read_b64_tr_b16 v[140:141], v15 offset:0
    v_mfma_f32_16x16x32_bf16 a[116:119], v[72:75], v[60:63], a[116:119]
    ds_read_b64_tr_b16 v[142:143], v15 offset:1024
    v_mfma_f32_16x16x32_bf16 a[172:175], v[72:75], v[64:67], a[172:175]
    ds_read_b64_tr_b16 v[144:145], v19 offset:0
    v_mfma_f32_16x16x32_bf16 a[8:11], v[76:79], v[52:55], a[8:11]
    ds_read_b64_tr_b16 v[146:147], v19 offset:1024
    v_mfma_f32_16x16x32_bf16 a[64:67], v[76:79], v[56:59], a[64:67]
    ds_read_b64_tr_b16 v[148:149], v23 offset:0
    v_mfma_f32_16x16x32_bf16 a[120:123], v[76:79], v[60:63], a[120:123]
    ds_read_b64_tr_b16 v[150:151], v23 offset:1024
    v_mfma_f32_16x16x32_bf16 a[176:179], v[76:79], v[64:67], a[176:179]
    ds_read_b64_tr_b16 v[152:153], v27 offset:0
    v_mfma_f32_16x16x32_bf16 a[12:15], v[80:83], v[52:55], a[12:15]
    ds_read_b64_tr_b16 v[154:155], v27 offset:1024
    v_mfma_f32_16x16x32_bf16 a[68:71], v[80:83], v[56:59], a[68:71]
    ds_read_b64_tr_b16 v[156:157], v31 offset:0
    v_mfma_f32_16x16x32_bf16 a[124:127], v[80:83], v[60:63], a[124:127]
    ds_read_b64_tr_b16 v[158:159], v31 offset:1024
    v_mfma_f32_16x16x32_bf16 a[180:183], v[80:83], v[64:67], a[180:183]
    ds_read_b64_tr_b16 v[160:161], v35 offset:0
    v_mfma_f32_16x16x32_bf16 a[16:19], v[84:87], v[52:55], a[16:19]
    ds_read_b64_tr_b16 v[162:163], v35 offset:1024
    v_mfma_f32_16x16x32_bf16 a[72:75], v[84:87], v[56:59], a[72:75]
    ds_read_b64_tr_b16 v[164:165], v39 offset:0
    v_mfma_f32_16x16x32_bf16 a[128:131], v[84:87], v[60:63], a[128:131]
    ds_read_b64_tr_b16 v[166:167], v39 offset:1024
    v_mfma_f32_16x16x32_bf16 a[184:187], v[84:87], v[64:67], a[184:187]
    ds_read_b64_tr_b16 v[168:169], v15 offset:8192
    v_mfma_f32_16x16x32_bf16 a[20:23], v[88:91], v[52:55], a[20:23]
    ds_read_b64_tr_b16 v[170:171], v15 offset:9216
    v_mfma_f32_16x16x32_bf16 a[76:79], v[88:91], v[56:59], a[76:79]
    ds_read_b64_tr_b16 v[172:173], v19 offset:8192
    v_mfma_f32_16x16x32_bf16 a[132:135], v[88:91], v[60:63], a[132:135]
    ds_read_b64_tr_b16 v[174:175], v19 offset:9216
    v_mfma_f32_16x16x32_bf16 a[188:191], v[88:91], v[64:67], a[188:191]
    ds_read_b64_tr_b16 v[176:177], v23 offset:8192
    v_mfma_f32_16x16x32_bf16 a[24:27], v[92:95], v[52:55], a[24:27]
    ds_read_b64_tr_b16 v[178:179], v23 offset:9216
    v_mfma_f32_16x16x32_bf16 a[80:83], v[92:95], v[56:59], a[80:83]
    ds_read_b64_tr_b16 v[180:181], v27 offset:8192
    v_mfma_f32_16x16x32_bf16 a[136:139], v[92:95], v[60:63], a[136:139]
    ds_read_b64_tr_b16 v[182:183], v27 offset:9216
    v_mfma_f32_16x16x32_bf16 a[192:195], v[92:95], v[64:67], a[192:195]
    ds_read_b64_tr_b16 v[184:185], v31 offset:8192
    v_mfma_f32_16x16x32_bf16 a[28:31], v[96:99], v[52:55], a[28:31]
    ds_read_b64_tr_b16 v[186:187], v31 offset:9216
    v_mfma_f32_16x16x32_bf16 a[84:87], v[96:99], v[56:59], a[84:87]
    ds_read_b64_tr_b16 v[188:189], v35 offset:8192
    v_mfma_f32_16x16x32_bf16 a[140:143], v[96:99], v[60:63], a[140:143]
    ds_read_b64_tr_b16 v[190:191], v35 offset:9216
    v_mfma_f32_16x16x32_bf16 a[196:199], v[96:99], v[64:67], a[196:199]
    ds_read_b64_tr_b16 v[192:193], v39 offset:8192
    v_mfma_f32_16x16x32_bf16 a[32:35], v[100:103], v[52:55], a[32:35]
    ds_read_b64_tr_b16 v[194:195], v39 offset:9216
    v_mfma_f32_16x16x32_bf16 a[88:91], v[100:103], v[56:59], a[88:91]
    v_mfma_f32_16x16x32_bf16 a[144:147], v[100:103], v[60:63], a[144:147]
    v_mfma_f32_16x16x32_bf16 a[200:203], v[100:103], v[64:67], a[200:203]
    v_mfma_f32_16x16x32_bf16 a[36:39], v[104:107], v[52:55], a[36:39]
    v_mfma_f32_16x16x32_bf16 a[92:95], v[104:107], v[56:59], a[92:95]
    v_mfma_f32_16x16x32_bf16 a[148:151], v[104:107], v[60:63], a[148:151]
    v_mfma_f32_16x16x32_bf16 a[204:207], v[104:107], v[64:67], a[204:207]
    v_mfma_f32_16x16x32_bf16 a[40:43], v[108:111], v[52:55], a[40:43]
    v_mfma_f32_16x16x32_bf16 a[96:99], v[108:111], v[56:59], a[96:99]
    v_mfma_f32_16x16x32_bf16 a[152:155], v[108:111], v[60:63], a[152:155]
    v_mfma_f32_16x16x32_bf16 a[208:211], v[108:111], v[64:67], a[208:211]
    v_mfma_f32_16x16x32_bf16 a[44:47], v[112:115], v[52:55], a[44:47]
    v_mfma_f32_16x16x32_bf16 a[100:103], v[112:115], v[56:59], a[100:103]
    v_mfma_f32_16x16x32_bf16 a[156:159], v[112:115], v[60:63], a[156:159]
    v_mfma_f32_16x16x32_bf16 a[212:215], v[112:115], v[64:67], a[212:215]
    v_mfma_f32_16x16x32_bf16 a[48:51], v[116:119], v[52:55], a[48:51]
    v_mfma_f32_16x16x32_bf16 a[104:107], v[116:119], v[56:59], a[104:107]
    v_mfma_f32_16x16x32_bf16 a[160:163], v[116:119], v[60:63], a[160:163]
    v_mfma_f32_16x16x32_bf16 a[216:219], v[116:119], v[64:67], a[216:219]
    v_mfma_f32_16x16x32_bf16 a[52:55], v[120:123], v[52:55], a[52:55]
    v_mfma_f32_16x16x32_bf16 a[108:111], v[120:123], v[56:59], a[108:111]
    v_mfma_f32_16x16x32_bf16 a[164:167], v[120:123], v[60:63], a[164:167]
    v_mfma_f32_16x16x32_bf16 a[220:223], v[120:123], v[64:67], a[220:223]
    s_waitcnt lgkmcnt(0)
    v_mfma_f32_16x16x32_bf16 a[0:3], v[140:143], v[124:127], a[0:3]
    v_mfma_f32_16x16x32_bf16 a[56:59], v[140:143], v[128:131], a[56:59]
    s_waitcnt vmcnt(16)
    s_barrier
    s_add_u32 m0, s36, 32768
    buffer_load_dwordx4 v2, s[4:7], s28 offen lds
    s_add_u32 m0, s37, 32768
    buffer_load_dwordx4 v3, s[4:7], s28 offen lds
    s_add_u32 m0, s38, 32768
    buffer_load_dwordx4 v4, s[4:7], s28 offen lds
    s_add_u32 m0, s39, 32768
    buffer_load_dwordx4 v5, s[4:7], s28 offen lds
    s_add_u32 m0, s40, 32768
    buffer_load_dwordx4 v6, s[8:11], s29 offen lds
    s_add_u32 m0, s41, 32768
    buffer_load_dwordx4 v7, s[8:11], s29 offen lds
    s_add_u32 m0, s42, 32768
    buffer_load_dwordx4 v8, s[12:15], s29 offen lds
    s_add_u32 m0, s43, 32768
    buffer_load_dwordx4 v9, s[12:15], s29 offen lds
    s_add_u32 s28, s28, 64
    s_add_u32 s29, s29, 229376
    ds_read_b128 v[52:55], v12 offset:0
    v_mfma_f32_16x16x32_bf16 a[112:115], v[140:143], v[132:135], a[112:115]
    ds_read_b128 v[56:59], v12 offset:1024
    v_mfma_f32_16x16x32_bf16 a[168:171], v[140:143], v[136:139], a[168:171]
    ds_read_b128 v[60:63], v12 offset:2048
    v_mfma_f32_16x16x32_bf16 a[4:7], v[144:147], v[124:127], a[4:7]
    ds_read_b128 v[64:67], v12 offset:3072
    v_mfma_f32_16x16x32_bf16 a[60:63], v[144:147], v[128:131], a[60:63]
    ds_read_b64_tr_b16 v[68:69], v16 offset:0
    v_mfma_f32_16x16x32_bf16 a[116:119], v[144:147], v[132:135], a[116:119]
    ds_read_b64_tr_b16 v[70:71], v16 offset:1024
    v_mfma_f32_16x16x32_bf16 a[172:175], v[144:147], v[136:139], a[172:175]
    ds_read_b64_tr_b16 v[72:73], v20 offset:0
    v_mfma_f32_16x16x32_bf16 a[8:11], v[148:151], v[124:127], a[8:11]
    ds_read_b64_tr_b16 v[74:75], v20 offset:1024
    v_mfma_f32_16x16x32_bf16 a[64:67], v[148:151], v[128:131], a[64:67]
    ds_read_b64_tr_b16 v[76:77], v24 offset:0
    v_mfma_f32_16x16x32_bf16 a[120:123], v[148:151], v[132:135], a[120:123]
    ds_read_b64_tr_b16 v[78:79], v24 offset:1024
    v_mfma_f32_16x16x32_bf16 a[176:179], v[148:151], v[136:139], a[176:179]
    ds_read_b64_tr_b16 v[80:81], v28 offset:0
    v_mfma_f32_16x16x32_bf16 a[12:15], v[152:155], v[124:127], a[12:15]
    ds_read_b64_tr_b16 v[82:83], v28 offset:1024
    v_mfma_f32_16x16x32_bf16 a[68:71], v[152:155], v[128:131], a[68:71]
    ds_read_b64_tr_b16 v[84:85], v32 offset:0
    v_mfma_f32_16x16x32_bf16 a[124:127], v[152:155], v[132:135], a[124:127]
    ds_read_b64_tr_b16 v[86:87], v32 offset:1024
    v_mfma_f32_16x16x32_bf16 a[180:183], v[152:155], v[136:139], a[180:183]
    ds_read_b64_tr_b16 v[88:89], v36 offset:0
    v_mfma_f32_16x16x32_bf16 a[16:19], v[156:159], v[124:127], a[16:19]
    ds_read_b64_tr_b16 v[90:91], v36 offset:1024
    v_mfma_f32_16x16x32_bf16 a[72:75], v[156:159], v[128:131], a[72:75]
    ds_read_b64_tr_b16 v[92:93], v40 offset:0
    v_mfma_f32_16x16x32_bf16 a[128:131], v[156:159], v[132:135], a[128:131]
    ds_read_b64_tr_b16 v[94:95], v40 offset:1024
    v_mfma_f32_16x16x32_bf16 a[184:187], v[156:159], v[136:139], a[184:187]
    ds_read_b64_tr_b16 v[96:97], v16 offset:8192
    v_mfma_f32_16x16x32_bf16 a[20:23], v[160:163], v[124:127], a[20:23]
    ds_read_b64_tr_b16 v[98:99], v16 offset:9216
    v_mfma_f32_16x16x32_bf16 a[76:79], v[160:163], v[128:131], a[76:79]
    ds_read_b64_tr_b16 v[100:101], v20 offset:8192
    v_mfma_f32_16x16x32_bf16 a[132:135], v[160:163], v[132:135], a[132:135]
    ds_read_b64_tr_b16 v[102:103], v20 offset:9216
    v_mfma_f32_16x16x32_bf16 a[188:191], v[160:163], v[136:139], a[188:191]
    ds_read_b64_tr_b16 v[104:105], v24 offset:8192
    v_mfma_f32_16x16x32_bf16 a[24:27], v[164:167], v[124:127], a[24:27]
    ds_read_b64_tr_b16 v[106:107], v24 offset:9216
    v_mfma_f32_16x16x32_bf16 a[80:83], v[164:167], v[128:131], a[80:83]
    ds_read_b64_tr_b16 v[108:109], v28 offset:8192
    v_mfma_f32_16x16x32_bf16 a[136:139], v[164:167], v[132:135], a[136:139]
    ds_read_b64_tr_b16 v[110:111], v28 offset:9216
    v_mfma_f32_16x16x32_bf16 a[192:195], v[164:167], v[136:139], a[192:195]
    ds_read_b64_tr_b16 v[112:113], v32 offset:8192
    v_mfma_f32_16x16x32_bf16 a[28:31], v[168:171], v[124:127], a[28:31]
    ds_read_b64_tr_b16 v[114:115], v32 offset:9216
    v_mfma_f32_16x16x32_bf16 a[84:87], v[168:171], v[128:131], a[84:87]
    ds_read_b64_tr_b16 v[116:117], v36 offset:8192
    v_mfma_f32_16x16x32_bf16 a[140:143], v[168:171], v[132:135], a[140:143]
    ds_read_b64_tr_b16 v[118:119], v36 offset:9216
    v_mfma_f32_16x16x32_bf16 a[196:199], v[168:171], v[136:139], a[196:199]
    ds_read_b64_tr_b16 v[120:121], v40 offset:8192
    v_mfma_f32_16x16x32_bf16 a[32:35], v[172:175], v[124:127], a[32:35]
    ds_read_b64_tr_b16 v[122:123], v40 offset:9216
    v_mfma_f32_16x16x32_bf16 a[88:91], v[172:175], v[128:131], a[88:91]
    v_mfma_f32_16x16x32_bf16 a[144:147], v[172:175], v[132:135], a[144:147]
    v_mfma_f32_16x16x32_bf16 a[200:203], v[172:175], v[136:139], a[200:203]
    v_mfma_f32_16x16x32_bf16 a[36:39], v[176:179], v[124:127], a[36:39]
    v_mfma_f32_16x16x32_bf16 a[92:95], v[176:179], v[128:131], a[92:95]
    v_mfma_f32_16x16x32_bf16 a[148:151], v[176:179], v[132:135], a[148:151]
    v_mfma_f32_16x16x32_bf16 a[204:207], v[176:179], v[136:139], a[204:207]
    v_mfma_f32_16x16x32_bf16 a[40:43], v[180:183], v[124:127], a[40:43]
    v_mfma_f32_16x16x32_bf16 a[96:99], v[180:183], v[128:131], a[96:99]
    v_mfma_f32_16x16x32_bf16 a[152:155], v[180:183], v[132:135], a[152:155]
    v_mfma_f32_16x16x32_bf16 a[208:211], v[180:183], v[136:139], a[208:211]
    v_mfma_f32_16x16x32_bf16 a[44:47], v[184:187], v[124:127], a[44:47]
    v_mfma_f32_16x16x32_bf16 a[100:103], v[184:187], v[128:131], a[100:103]
    v_mfma_f32_16x16x32_bf16 a[156:159], v[184:187], v[132:135], a[156:159]
    v_mfma_f32_16x16x32_bf16 a[212:215], v[184:187], v[136:139], a[212:215]
    v_mfma_f32_16x16x32_bf16 a[48:51], v[188:191], v[124:127], a[48:51]
    v_mfma_f32_16x16x32_bf16 a[104:107], v[188:191], v[128:131], a[104:107]
    v_mfma_f32_16x16x32_bf16 a[160:163], v[188:191], v[132:135], a[160:163]
    v_mfma_f32_16x16x32_bf16 a[216:219], v[188:191], v[136:139], a[216:219]
    v_mfma_f32_16x16x32_bf16 a[52:55], v[192:195], v[124:127], a[52:55]
    v_mfma_f32_16x16x32_bf16 a[108:111], v[192:195], v[128:131], a[108:111]
    v_mfma_f32_16x16x32_bf16 a[164:167], v[192:195], v[132:135], a[164:167]
    v_mfma_f32_16x16x32_bf16 a[220:223], v[192:195], v[136:139], a[220:223]
    s_waitcnt lgkmcnt(0)
    v_mfma_f32_16x16x32_bf16 a[0:3], v[68:71], v[52:55], a[0:3]
    v_mfma_f32_16x16x32_bf16 a[56:59], v[68:71], v[56:59], a[56:59]
    s_waitcnt vmcnt(16)
    s_barrier
    s_add_u32 m0, s36, 65536
    buffer_load_dwordx4 v2, s[4:7], s28 offen lds
    s_add_u32 m0, s37, 65536
    buffer_load_dwordx4 v3, s[4:7], s28 offen lds
    s_add_u32 m0, s38, 65536
    buffer_load_dwordx4 v4, s[4:7], s28 offen lds
    s_add_u32 m0, s39, 65536
    buffer_load_dwordx4 v5, s[4:7], s28 offen lds
    s_add_u32 m0, s40, 65536
    buffer_load_dwordx4 v6, s[8:11], s29 offen lds
    s_add_u32 m0, s41, 65536
    buffer_load_dwordx4 v7, s[8:11], s29 offen lds
    s_add_u32 m0, s42, 65536
    buffer_load_dwordx4 v8, s[12:15], s29 offen lds
    s_add_u32 m0, s43, 65536
    buffer_load_dwordx4 v9, s[12:15], s29 offen lds
    s_add_u32 s28, s28, 64
    s_add_u32 s29, s29, 229376
    ds_read_b128 v[124:127], v13 offset:0
    v_mfma_f32_16x16x32_bf16 a[112:115], v[68:71], v[60:63], a[112:115]
    ds_read_b128 v[128:131], v13 offset:1024
    v_mfma_f32_16x16x32_bf16 a[168:171], v[68:71], v[64:67], a[168:171]
    ds_read_b128 v[132:135], v13 offset:2048
    v_mfma_f32_16x16x32_bf16 a[4:7], v[72:75], v[52:55], a[4:7]
    ds_read_b128 v[136:139], v13 offset:3072
    v_mfma_f32_16x16x32_bf16 a[60:63], v[72:75], v[56:59], a[60:63]
    ds_read_b64_tr_b16 v[140:141], v17 offset:0
    v_mfma_f32_16x16x32_bf16 a[116:119], v[72:75], v[60:63], a[116:119]
    ds_read_b64_tr_b16 v[142:143], v17 offset:1024
    v_mfma_f32_16x16x32_bf16 a[172:175], v[72:75], v[64:67], a[172:175]
    ds_read_b64_tr_b16 v[144:145], v21 offset:0
    v_mfma_f32_16x16x32_bf16 a[8:11], v[76:79], v[52:55], a[8:11]
    ds_read_b64_tr_b16 v[146:147], v21 offset:1024
    v_mfma_f32_16x16x32_bf16 a[64:67], v[76:79], v[56:59], a[64:67]
    ds_read_b64_tr_b16 v[148:149], v25 offset:0
    v_mfma_f32_16x16x32_bf16 a[120:123], v[76:79], v[60:63], a[120:123]
    ds_read_b64_tr_b16 v[150:151], v25 offset:1024
    v_mfma_f32_16x16x32_bf16 a[176:179], v[76:79], v[64:67], a[176:179]
    ds_read_b64_tr_b16 v[152:153], v29 offset:0
    v_mfma_f32_16x16x32_bf16 a[12:15], v[80:83], v[52:55], a[12:15]
    ds_read_b64_tr_b16 v[154:155], v29 offset:1024
    v_mfma_f32_16x16x32_bf16 a[68:71], v[80:83], v[56:59], a[68:71]
    ds_read_b64_tr_b16 v[156:157], v33 offset:0
    v_mfma_f32_16x16x32_bf16 a[124:127], v[80:83], v[60:63], a[124:127]
    ds_read_b64_tr_b16 v[158:159], v33 offset:1024
    v_mfma_f32_16x16x32_bf16 a[180:183], v[80:83], v[64:67], a[180:183]
    ds_read_b64_tr_b16 v[160:161], v37 offset:0
    v_mfma_f32_16x16x32_bf16 a[16:19], v[84:87], v[52:55], a[16:19]
    ds_read_b64_tr_b16 v[162:163], v37 offset:1024
    v_mfma_f32_16x16x32_bf16 a[72:75], v[84:87], v[56:59], a[72:75]
    ds_read_b64_tr_b16 v[164:165], v41 offset:0
    v_mfma_f32_16x16x32_bf16 a[128:131], v[84:87], v[60:63], a[128:131]
    ds_read_b64_tr_b16 v[166:167], v41 offset:1024
    v_mfma_f32_16x16x32_bf16 a[184:187], v[84:87], v[64:67], a[184:187]
    ds_read_b64_tr_b16 v[168:169], v17 offset:8192
    v_mfma_f32_16x16x32_bf16 a[20:23], v[88:91], v[52:55], a[20:23]
    ds_read_b64_tr_b16 v[170:171], v17 offset:9216
    v_mfma_f32_16x16x32_bf16 a[76:79], v[88:91], v[56:59], a[76:79]
    ds_read_b64_tr_b16 v[172:173], v21 offset:8192
    v_mfma_f32_16x16x32_bf16 a[132:135], v[88:91], v[60:63], a[132:135]
    ds_read_b64_tr_b16 v[174:175], v21 offset:9216
    v_mfma_f32_16x16x32_bf16 a[188:191], v[88:91], v[64:67], a[188:191]
    ds_read_b64_tr_b16 v[176:177], v25 offset:8192
    v_mfma_f32_16x16x32_bf16 a[24:27], v[92:95], v[52:55], a[24:27]
    ds_read_b64_tr_b16 v[178:179], v25 offset:9216
    v_mfma_f32_16x16x32_bf16 a[80:83], v[92:95], v[56:59], a[80:83]
    ds_read_b64_tr_b16 v[180:181], v29 offset:8192
    v_mfma_f32_16x16x32_bf16 a[136:139], v[92:95], v[60:63], a[136:139]
    ds_read_b64_tr_b16 v[182:183], v29 offset:9216
    v_mfma_f32_16x16x32_bf16 a[192:195], v[92:95], v[64:67], a[192:195]
    ds_read_b64_tr_b16 v[184:185], v33 offset:8192
    v_mfma_f32_16x16x32_bf16 a[28:31], v[96:99], v[52:55], a[28:31]
    ds_read_b64_tr_b16 v[186:187], v33 offset:9216
    v_mfma_f32_16x16x32_bf16 a[84:87], v[96:99], v[56:59], a[84:87]
    ds_read_b64_tr_b16 v[188:189], v37 offset:8192
    v_mfma_f32_16x16x32_bf16 a[140:143], v[96:99], v[60:63], a[140:143]
    ds_read_b64_tr_b16 v[190:191], v37 offset:9216
    v_mfma_f32_16x16x32_bf16 a[196:199], v[96:99], v[64:67], a[196:199]
    ds_read_b64_tr_b16 v[192:193], v41 offset:8192
    v_mfma_f32_16x16x32_bf16 a[32:35], v[100:103], v[52:55], a[32:35]
    ds_read_b64_tr_b16 v[194:195], v41 offset:9216
    v_mfma_f32_16x16x32_bf16 a[88:91], v[100:103], v[56:59], a[88:91]
    v_mfma_f32_16x16x32_bf16 a[144:147], v[100:103], v[60:63], a[144:147]
    v_mfma_f32_16x16x32_bf16 a[200:203], v[100:103], v[64:67], a[200:203]
    v_mfma_f32_16x16x32_bf16 a[36:39], v[104:107], v[52:55], a[36:39]
    v_mfma_f32_16x16x32_bf16 a[92:95], v[104:107], v[56:59], a[92:95]
    v_mfma_f32_16x16x32_bf16 a[148:151], v[104:107], v[60:63], a[148:151]
    v_mfma_f32_16x16x32_bf16 a[204:207], v[104:107], v[64:67], a[204:207]
    v_mfma_f32_16x16x32_bf16 a[40:43], v[108:111], v[52:55], a[40:43]
    v_mfma_f32_16x16x32_bf16 a[96:99], v[108:111], v[56:59], a[96:99]
    v_mfma_f32_16x16x32_bf16 a[152:155], v[108:111], v[60:63], a[152:155]
    v_mfma_f32_16x16x32_bf16 a[208:211], v[108:111], v[64:67], a[208:211]
    v_mfma_f32_16x16x32_bf16 a[44:47], v[112:115], v[52:55], a[44:47]
    v_mfma_f32_16x16x32_bf16 a[100:103], v[112:115], v[56:59], a[100:103]
    v_mfma_f32_16x16x32_bf16 a[156:159], v[112:115], v[60:63], a[156:159]
    v_mfma_f32_16x16x32_bf16 a[212:215], v[112:115], v[64:67], a[212:215]
    v_mfma_f32_16x16x32_bf16 a[48:51], v[116:119], v[52:55], a[48:51]
    v_mfma_f32_16x16x32_bf16 a[104:107], v[116:119], v[56:59], a[104:107]
    v_mfma_f32_16x16x32_bf16 a[160:163], v[116:119], v[60:63], a[160:163]
    v_mfma_f32_16x16x32_bf16 a[216:219], v[116:119], v[64:67], a[216:219]
    v_mfma_f32_16x16x32_bf16 a[52:55], v[120:123], v[52:55], a[52:55]
    v_mfma_f32_16x16x32_bf16 a[108:111], v[120:123], v[56:59], a[108:111]
    v_mfma_f32_16x16x32_bf16 a[164:167], v[120:123], v[60:63], a[164:167]
    v_mfma_f32_16x16x32_bf16 a[220:223], v[120:123], v[64:67], a[220:223]
    s_waitcnt lgkmcnt(0)
    v_mfma_f32_16x16x32_bf16 a[0:3], v[140:143], v[124:127], a[0:3]
    v_mfma_f32_16x16x32_bf16 a[56:59], v[140:143], v[128:131], a[56:59]
    s_waitcnt vmcnt(16)
    s_barrier
    s_add_u32 m0, s36, 98304
    buffer_load_dwordx4 v2, s[4:7], s28 offen lds
    s_add_u32 m0, s37, 98304
    buffer_load_dwordx4 v3, s[4:7], s28 offen lds
    s_add_u32 m0, s38, 98304
    buffer_load_dwordx4 v4, s[4:7], s28 offen lds
    s_add_u32 m0, s39, 98304
    buffer_load_dwordx4 v5, s[4:7], s28 offen lds
    s_add_u32 m0, s40, 98304
    buffer_load_dwordx4 v6, s[8:11], s29 offen lds
    s_add_u32 m0, s41, 98304
    buffer_load_dwordx4 v7, s[8:11], s29 offen lds
    s_add_u32 m0, s42, 98304
    buffer_load_dwordx4 v8, s[12:15], s29 offen lds
    s_add_u32 m0, s43, 98304
    buffer_load_dwordx4 v9, s[12:15], s29 offen lds
    s_add_u32 s28, s28, 64
    s_add_u32 s29, s29, 229376
    ds_read_b128 v[52:55], v10 offset:0
    v_mfma_f32_16x16x32_bf16 a[112:115], v[140:143], v[132:135], a[112:115]
    ds_read_b128 v[56:59], v10 offset:1024
    v_mfma_f32_16x16x32_bf16 a[168:171], v[140:143], v[136:139], a[168:171]
    ds_read_b128 v[60:63], v10 offset:2048
    v_mfma_f32_16x16x32_bf16 a[4:7], v[144:147], v[124:127], a[4:7]
    ds_read_b128 v[64:67], v10 offset:3072
    v_mfma_f32_16x16x32_bf16 a[60:63], v[144:147], v[128:131], a[60:63]
    ds_read_b64_tr_b16 v[68:69], v14 offset:0
    v_mfma_f32_16x16x32_bf16 a[116:119], v[144:147], v[132:135], a[116:119]
    ds_read_b64_tr_b16 v[70:71], v14 offset:1024
    v_mfma_f32_16x16x32_bf16 a[172:175], v[144:147], v[136:139], a[172:175]
    ds_read_b64_tr_b16 v[72:73], v18 offset:0
    v_mfma_f32_16x16x32_bf16 a[8:11], v[148:151], v[124:127], a[8:11]
    ds_read_b64_tr_b16 v[74:75], v18 offset:1024
    v_mfma_f32_16x16x32_bf16 a[64:67], v[148:151], v[128:131], a[64:67]
    ds_read_b64_tr_b16 v[76:77], v22 offset:0
    v_mfma_f32_16x16x32_bf16 a[120:123], v[148:151], v[132:135], a[120:123]
    ds_read_b64_tr_b16 v[78:79], v22 offset:1024
    v_mfma_f32_16x16x32_bf16 a[176:179], v[148:151], v[136:139], a[176:179]
    ds_read_b64_tr_b16 v[80:81], v26 offset:0
    v_mfma_f32_16x16x32_bf16 a[12:15], v[152:155], v[124:127], a[12:15]
    ds_read_b64_tr_b16 v[82:83], v26 offset:1024
    v_mfma_f32_16x16x32_bf16 a[68:71], v[152:155], v[128:131], a[68:71]
    ds_read_b64_tr_b16 v[84:85], v30 offset:0
    v_mfma_f32_16x16x32_bf16 a[124:127], v[152:155], v[132:135], a[124:127]
    ds_read_b64_tr_b16 v[86:87], v30 offset:1024
    v_mfma_f32_16x16x32_bf16 a[180:183], v[152:155], v[136:139], a[180:183]
    ds_read_b64_tr_b16 v[88:89], v34 offset:0
    v_mfma_f32_16x16x32_bf16 a[16:19], v[156:159], v[124:127], a[16:19]
    ds_read_b64_tr_b16 v[90:91], v34 offset:1024
    v_mfma_f32_16x16x32_bf16 a[72:75], v[156:159], v[128:131], a[72:75]
    ds_read_b64_tr_b16 v[92:93], v38 offset:0
    v_mfma_f32_16x16x32_bf16 a[128:131], v[156:159], v[132:135], a[128:131]
    ds_read_b64_tr_b16 v[94:95], v38 offset:1024
    v_mfma_f32_16x16x32_bf16 a[184:187], v[156:159], v[136:139], a[184:187]
    ds_read_b64_tr_b16 v[96:97], v14 offset:8192
    v_mfma_f32_16x16x32_bf16 a[20:23], v[160:163], v[124:127], a[20:23]
    ds_read_b64_tr_b16 v[98:99], v14 offset:9216
    v_mfma_f32_16x16x32_bf16 a[76:79], v[160:163], v[128:131], a[76:79]
    ds_read_b64_tr_b16 v[100:101], v18 offset:8192
    v_mfma_f32_16x16x32_bf16 a[132:135], v[160:163], v[132:135], a[132:135]
    ds_read_b64_tr_b16 v[102:103], v18 offset:9216
    v_mfma_f32_16x16x32_bf16 a[188:191], v[160:163], v[136:139], a[188:191]
    ds_read_b64_tr_b16 v[104:105], v22 offset:8192
    v_mfma_f32_16x16x32_bf16 a[24:27], v[164:167], v[124:127], a[24:27]
    ds_read_b64_tr_b16 v[106:107], v22 offset:9216
    v_mfma_f32_16x16x32_bf16 a[80:83], v[164:167], v[128:131], a[80:83]
    ds_read_b64_tr_b16 v[108:109], v26 offset:8192
    v_mfma_f32_16x16x32_bf16 a[136:139], v[164:167], v[132:135], a[136:139]
    ds_read_b64_tr_b16 v[110:111], v26 offset:9216
    v_mfma_f32_16x16x32_bf16 a[192:195], v[164:167], v[136:139], a[192:195]
    ds_read_b64_tr_b16 v[112:113], v30 offset:8192
    v_mfma_f32_16x16x32_bf16 a[28:31], v[168:171], v[124:127], a[28:31]
    ds_read_b64_tr_b16 v[114:115], v30 offset:9216
    v_mfma_f32_16x16x32_bf16 a[84:87], v[168:171], v[128:131], a[84:87]
    ds_read_b64_tr_b16 v[116:117], v34 offset:8192
    v_mfma_f32_16x16x32_bf16 a[140:143], v[168:171], v[132:135], a[140:143]
    ds_read_b64_tr_b16 v[118:119], v34 offset:9216
    v_mfma_f32_16x16x32_bf16 a[196:199], v[168:171], v[136:139], a[196:199]
    ds_read_b64_tr_b16 v[120:121], v38 offset:8192
    v_mfma_f32_16x16x32_bf16 a[32:35], v[172:175], v[124:127], a[32:35]
    ds_read_b64_tr_b16 v[122:123], v38 offset:9216
    v_mfma_f32_16x16x32_bf16 a[88:91], v[172:175], v[128:131], a[88:91]
    v_mfma_f32_16x16x32_bf16 a[144:147], v[172:175], v[132:135], a[144:147]
    v_mfma_f32_16x16x32_bf16 a[200:203], v[172:175], v[136:139], a[200:203]
    v_mfma_f32_16x16x32_bf16 a[36:39], v[176:179], v[124:127], a[36:39]
    v_mfma_f32_16x16x32_bf16 a[92:95], v[176:179], v[128:131], a[92:95]
    v_mfma_f32_16x16x32_bf16 a[148:151], v[176:179], v[132:135], a[148:151]
    v_mfma_f32_16x16x32_bf16 a[204:207], v[176:179], v[136:139], a[204:207]
    v_mfma_f32_16x16x32_bf16 a[40:43], v[180:183], v[124:127], a[40:43]
    v_mfma_f32_16x16x32_bf16 a[96:99], v[180:183], v[128:131], a[96:99]
    v_mfma_f32_16x16x32_bf16 a[152:155], v[180:183], v[132:135], a[152:155]
    v_mfma_f32_16x16x32_bf16 a[208:211], v[180:183], v[136:139], a[208:211]
    v_mfma_f32_16x16x32_bf16 a[44:47], v[184:187], v[124:127], a[44:47]
    v_mfma_f32_16x16x32_bf16 a[100:103], v[184:187], v[128:131], a[100:103]
    v_mfma_f32_16x16x32_bf16 a[156:159], v[184:187], v[132:135], a[156:159]
    v_mfma_f32_16x16x32_bf16 a[212:215], v[184:187], v[136:139], a[212:215]
    v_mfma_f32_16x16x32_bf16 a[48:51], v[188:191], v[124:127], a[48:51]
    v_mfma_f32_16x16x32_bf16 a[104:107], v[188:191], v[128:131], a[104:107]
    v_mfma_f32_16x16x32_bf16 a[160:163], v[188:191], v[132:135], a[160:163]
    v_mfma_f32_16x16x32_bf16 a[216:219], v[188:191], v[136:139], a[216:219]
    v_mfma_f32_16x16x32_bf16 a[52:55], v[192:195], v[124:127], a[52:55]
    v_mfma_f32_16x16x32_bf16 a[108:111], v[192:195], v[128:131], a[108:111]
    v_mfma_f32_16x16x32_bf16 a[164:167], v[192:195], v[132:135], a[164:167]
    v_mfma_f32_16x16x32_bf16 a[220:223], v[192:195], v[136:139], a[220:223]
    s_waitcnt lgkmcnt(0)
    v_mfma_f32_16x16x32_bf16 a[0:3], v[68:71], v[52:55], a[0:3]
    v_mfma_f32_16x16x32_bf16 a[56:59], v[68:71], v[56:59], a[56:59]
    s_waitcnt vmcnt(16)
    s_barrier
    s_add_u32 m0, s36, 0
    buffer_load_dwordx4 v2, s[4:7], s28 offen lds
    s_add_u32 m0, s37, 0
    buffer_load_dwordx4 v3, s[4:7], s28 offen lds
    s_add_u32 m0, s38, 0
    buffer_load_dwordx4 v4, s[4:7], s28 offen lds
    s_add_u32 m0, s39, 0
    buffer_load_dwordx4 v5, s[4:7], s28 offen lds
    s_add_u32 m0, s40, 0
    buffer_load_dwordx4 v6, s[8:11], s29 offen lds
    s_add_u32 m0, s41, 0
    buffer_load_dwordx4 v7, s[8:11], s29 offen lds
    s_add_u32 m0, s42, 0
    buffer_load_dwordx4 v8, s[12:15], s29 offen lds
    s_add_u32 m0, s43, 0
    buffer_load_dwordx4 v9, s[12:15], s29 offen lds
    s_add_u32 s28, s28, 64
    s_add_u32 s29, s29, 229376
    ds_read_b128 v[124:127], v11 offset:0
    v_mfma_f32_16x16x32_bf16 a[112:115], v[68:71], v[60:63], a[112:115]
    ds_read_b128 v[128:131], v11 offset:1024
    v_mfma_f32_16x16x32_bf16 a[168:171], v[68:71], v[64:67], a[168:171]
    ds_read_b128 v[132:135], v11 offset:2048
    v_mfma_f32_16x16x32_bf16 a[4:7], v[72:75], v[52:55], a[4:7]
    ds_read_b128 v[136:139], v11 offset:3072
    v_mfma_f32_16x16x32_bf16 a[60:63], v[72:75], v[56:59], a[60:63]
    ds_read_b64_tr_b16 v[140:141], v15 offset:0
    v_mfma_f32_16x16x32_bf16 a[116:119], v[72:75], v[60:63], a[116:119]
    ds_read_b64_tr_b16 v[142:143], v15 offset:1024
    v_mfma_f32_16x16x32_bf16 a[172:175], v[72:75], v[64:67], a[172:175]
    ds_read_b64_tr_b16 v[144:145], v19 offset:0
    v_mfma_f32_16x16x32_bf16 a[8:11], v[76:79], v[52:55], a[8:11]
    ds_read_b64_tr_b16 v[146:147], v19 offset:1024
    v_mfma_f32_16x16x32_bf16 a[64:67], v[76:79], v[56:59], a[64:67]
    ds_read_b64_tr_b16 v[148:149], v23 offset:0
    v_mfma_f32_16x16x32_bf16 a[120:123], v[76:79], v[60:63], a[120:123]
    ds_read_b64_tr_b16 v[150:151], v23 offset:1024
    v_mfma_f32_16x16x32_bf16 a[176:179], v[76:79], v[64:67], a[176:179]
    ds_read_b64_tr_b16 v[152:153], v27 offset:0
    v_mfma_f32_16x16x32_bf16 a[12:15], v[80:83], v[52:55], a[12:15]
    ds_read_b64_tr_b16 v[154:155], v27 offset:1024
    v_mfma_f32_16x16x32_bf16 a[68:71], v[80:83], v[56:59], a[68:71]
    ds_read_b64_tr_b16 v[156:157], v31 offset:0
    v_mfma_f32_16x16x32_bf16 a[124:127], v[80:83], v[60:63], a[124:127]
    ds_read_b64_tr_b16 v[158:159], v31 offset:1024
    v_mfma_f32_16x16x32_bf16 a[180:183], v[80:83], v[64:67], a[180:183]
    ds_read_b64_tr_b16 v[160:161], v35 offset:0
    v_mfma_f32_16x16x32_bf16 a[16:19], v[84:87], v[52:55], a[16:19]
    ds_read_b64_tr_b16 v[162:163], v35 offset:1024
    v_mfma_f32_16x16x32_bf16 a[72:75], v[84:87], v[56:59], a[72:75]
    ds_read_b64_tr_b16 v[164:165], v39 offset:0
    v_mfma_f32_16x16x32_bf16 a[128:131], v[84:87], v[60:63], a[128:131]
    ds_read_b64_tr_b16 v[166:167], v39 offset:1024
    v_mfma_f32_16x16x32_bf16 a[184:187], v[84:87], v[64:67], a[184:187]
    ds_read_b64_tr_b16 v[168:169], v15 offset:8192
    v_mfma_f32_16x16x32_bf16 a[20:23], v[88:91], v[52:55], a[20:23]
    ds_read_b64_tr_b16 v[170:171], v15 offset:9216
    v_mfma_f32_16x16x32_bf16 a[76:79], v[88:91], v[56:59], a[76:79]
    ds_read_b64_tr_b16 v[172:173], v19 offset:8192
    v_mfma_f32_16x16x32_bf16 a[132:135], v[88:91], v[60:63], a[132:135]
    ds_read_b64_tr_b16 v[174:175], v19 offset:9216
    v_mfma_f32_16x16x32_bf16 a[188:191], v[88:91], v[64:67], a[188:191]
    ds_read_b64_tr_b16 v[176:177], v23 offset:8192
    v_mfma_f32_16x16x32_bf16 a[24:27], v[92:95], v[52:55], a[24:27]
    ds_read_b64_tr_b16 v[178:179], v23 offset:9216
    v_mfma_f32_16x16x32_bf16 a[80:83], v[92:95], v[56:59], a[80:83]
    ds_read_b64_tr_b16 v[180:181], v27 offset:8192
    v_mfma_f32_16x16x32_bf16 a[136:139], v[92:95], v[60:63], a[136:139]
    ds_read_b64_tr_b16 v[182:183], v27 offset:9216
    v_mfma_f32_16x16x32_bf16 a[192:195], v[92:95], v[64:67], a[192:195]
    ds_read_b64_tr_b16 v[184:185], v31 offset:8192
    v_mfma_f32_16x16x32_bf16 a[28:31], v[96:99], v[52:55], a[28:31]
    ds_read_b64_tr_b16 v[186:187], v31 offset:9216
    v_mfma_f32_16x16x32_bf16 a[84:87], v[96:99], v[56:59], a[84:87]
    ds_read_b64_tr_b16 v[188:189], v35 offset:8192
    v_mfma_f32_16x16x32_bf16 a[140:143], v[96:99], v[60:63], a[140:143]
    ds_read_b64_tr_b16 v[190:191], v35 offset:9216
    v_mfma_f32_16x16x32_bf16 a[196:199], v[96:99], v[64:67], a[196:199]
    ds_read_b64_tr_b16 v[192:193], v39 offset:8192
    v_mfma_f32_16x16x32_bf16 a[32:35], v[100:103], v[52:55], a[32:35]
    ds_read_b64_tr_b16 v[194:195], v39 offset:9216
    v_mfma_f32_16x16x32_bf16 a[88:91], v[100:103], v[56:59], a[88:91]
    v_mfma_f32_16x16x32_bf16 a[144:147], v[100:103], v[60:63], a[144:147]
    v_mfma_f32_16x16x32_bf16 a[200:203], v[100:103], v[64:67], a[200:203]
    v_mfma_f32_16x16x32_bf16 a[36:39], v[104:107], v[52:55], a[36:39]
    v_mfma_f32_16x16x32_bf16 a[92:95], v[104:107], v[56:59], a[92:95]
    v_mfma_f32_16x16x32_bf16 a[148:151], v[104:107], v[60:63], a[148:151]
    v_mfma_f32_16x16x32_bf16 a[204:207], v[104:107], v[64:67], a[204:207]
    v_mfma_f32_16x16x32_bf16 a[40:43], v[108:111], v[52:55], a[40:43]
    v_mfma_f32_16x16x32_bf16 a[96:99], v[108:111], v[56:59], a[96:99]
    v_mfma_f32_16x16x32_bf16 a[152:155], v[108:111], v[60:63], a[152:155]
    v_mfma_f32_16x16x32_bf16 a[208:211], v[108:111], v[64:67], a[208:211]
    v_mfma_f32_16x16x32_bf16 a[44:47], v[112:115], v[52:55], a[44:47]
    v_mfma_f32_16x16x32_bf16 a[100:103], v[112:115], v[56:59], a[100:103]
    v_mfma_f32_16x16x32_bf16 a[156:159], v[112:115], v[60:63], a[156:159]
    v_mfma_f32_16x16x32_bf16 a[212:215], v[112:115], v[64:67], a[212:215]
    v_mfma_f32_16x16x32_bf16 a[48:51], v[116:119], v[52:55], a[48:51]
    v_mfma_f32_16x16x32_bf16 a[104:107], v[116:119], v[56:59], a[104:107]
    v_mfma_f32_16x16x32_bf16 a[160:163], v[116:119], v[60:63], a[160:163]
    v_mfma_f32_16x16x32_bf16 a[216:219], v[116:119], v[64:67], a[216:219]
    v_mfma_f32_16x16x32_bf16 a[52:55], v[120:123], v[52:55], a[52:55]
    v_mfma_f32_16x16x32_bf16 a[108:111], v[120:123], v[56:59], a[108:111]
    v_mfma_f32_16x16x32_bf16 a[164:167], v[120:123], v[60:63], a[164:167]
    v_mfma_f32_16x16x32_bf16 a[220:223], v[120:123], v[64:67], a[220:223]
    s_waitcnt lgkmcnt(0)
    v_mfma_f32_16x16x32_bf16 a[0:3], v[140:143], v[124:127], a[0:3]
    v_mfma_f32_16x16x32_bf16 a[56:59], v[140:143], v[128:131], a[56:59]
    s_waitcnt vmcnt(16)
    s_barrier
    s_add_u32 m0, s36, 32768
    buffer_load_dwordx4 v2, s[4:7], s28 offen lds
    s_add_u32 m0, s37, 32768
    buffer_load_dwordx4 v3, s[4:7], s28 offen lds
    s_add_u32 m0, s38, 32768
    buffer_load_dwordx4 v4, s[4:7], s28 offen lds
    s_add_u32 m0, s39, 32768
    buffer_load_dwordx4 v5, s[4:7], s28 offen lds
    s_add_u32 m0, s40, 32768
    buffer_load_dwordx4 v6, s[8:11], s29 offen lds
    s_add_u32 m0, s41, 32768
    buffer_load_dwordx4 v7, s[8:11], s29 offen lds
    s_add_u32 m0, s42, 32768
    buffer_load_dwordx4 v8, s[12:15], s29 offen lds
    s_add_u32 m0, s43, 32768
    buffer_load_dwordx4 v9, s[12:15], s29 offen lds
    s_add_u32 s28, s28, 64
    s_add_u32 s29, s29, 229376
    ds_read_b128 v[52:55], v12 offset:0
    v_mfma_f32_16x16x32_bf16 a[112:115], v[140:143], v[132:135], a[112:115]
    ds_read_b128 v[56:59], v12 offset:1024
    v_mfma_f32_16x16x32_bf16 a[168:171], v[140:143], v[136:139], a[168:171]
    ds_read_b128 v[60:63], v12 offset:2048
    v_mfma_f32_16x16x32_bf16 a[4:7], v[144:147], v[124:127], a[4:7]
    ds_read_b128 v[64:67], v12 offset:3072
    v_mfma_f32_16x16x32_bf16 a[60:63], v[144:147], v[128:131], a[60:63]
    ds_read_b64_tr_b16 v[68:69], v16 offset:0
    v_mfma_f32_16x16x32_bf16 a[116:119], v[144:147], v[132:135], a[116:119]
    ds_read_b64_tr_b16 v[70:71], v16 offset:1024
    v_mfma_f32_16x16x32_bf16 a[172:175], v[144:147], v[136:139], a[172:175]
    ds_read_b64_tr_b16 v[72:73], v20 offset:0
    v_mfma_f32_16x16x32_bf16 a[8:11], v[148:151], v[124:127], a[8:11]
    ds_read_b64_tr_b16 v[74:75], v20 offset:1024
    v_mfma_f32_16x16x32_bf16 a[64:67], v[148:151], v[128:131], a[64:67]
    ds_read_b64_tr_b16 v[76:77], v24 offset:0
    v_mfma_f32_16x16x32_bf16 a[120:123], v[148:151], v[132:135], a[120:123]
    ds_read_b64_tr_b16 v[78:79], v24 offset:1024
    v_mfma_f32_16x16x32_bf16 a[176:179], v[148:151], v[136:139], a[176:179]
    ds_read_b64_tr_b16 v[80:81], v28 offset:0
    v_mfma_f32_16x16x32_bf16 a[12:15], v[152:155], v[124:127], a[12:15]
    ds_read_b64_tr_b16 v[82:83], v28 offset:1024
    v_mfma_f32_16x16x32_bf16 a[68:71], v[152:155], v[128:131], a[68:71]
    ds_read_b64_tr_b16 v[84:85], v32 offset:0
    v_mfma_f32_16x16x32_bf16 a[124:127], v[152:155], v[132:135], a[124:127]
    ds_read_b64_tr_b16 v[86:87], v32 offset:1024
    v_mfma_f32_16x16x32_bf16 a[180:183], v[152:155], v[136:139], a[180:183]
    ds_read_b64_tr_b16 v[88:89], v36 offset:0
    v_mfma_f32_16x16x32_bf16 a[16:19], v[156:159], v[124:127], a[16:19]
    ds_read_b64_tr_b16 v[90:91], v36 offset:1024
    v_mfma_f32_16x16x32_bf16 a[72:75], v[156:159], v[128:131], a[72:75]
    ds_read_b64_tr_b16 v[92:93], v40 offset:0
    v_mfma_f32_16x16x32_bf16 a[128:131], v[156:159], v[132:135], a[128:131]
    ds_read_b64_tr_b16 v[94:95], v40 offset:1024
    v_mfma_f32_16x16x32_bf16 a[184:187], v[156:159], v[136:139], a[184:187]
    ds_read_b64_tr_b16 v[96:97], v16 offset:8192
    v_mfma_f32_16x16x32_bf16 a[20:23], v[160:163], v[124:127], a[20:23]
    ds_read_b64_tr_b16 v[98:99], v16 offset:9216
    v_mfma_f32_16x16x32_bf16 a[76:79], v[160:163], v[128:131], a[76:79]
    ds_read_b64_tr_b16 v[100:101], v20 offset:8192
    v_mfma_f32_16x16x32_bf16 a[132:135], v[160:163], v[132:135], a[132:135]
    ds_read_b64_tr_b16 v[102:103], v20 offset:9216
    v_mfma_f32_16x16x32_bf16 a[188:191], v[160:163], v[136:139], a[188:191]
    ds_read_b64_tr_b16 v[104:105], v24 offset:8192
    v_mfma_f32_16x16x32_bf16 a[24:27], v[164:167], v[124:127], a[24:27]
    ds_read_b64_tr_b16 v[106:107], v24 offset:9216
    v_mfma_f32_16x16x32_bf16 a[80:83], v[164:167], v[128:131], a[80:83]
    ds_read_b64_tr_b16 v[108:109], v28 offset:8192
    v_mfma_f32_16x16x32_bf16 a[136:139], v[164:167], v[132:135], a[136:139]
    ds_read_b64_tr_b16 v[110:111], v28 offset:9216
    v_mfma_f32_16x16x32_bf16 a[192:195], v[164:167], v[136:139], a[192:195]
    ds_read_b64_tr_b16 v[112:113], v32 offset:8192
    v_mfma_f32_16x16x32_bf16 a[28:31], v[168:171], v[124:127], a[28:31]
    ds_read_b64_tr_b16 v[114:115], v32 offset:9216
    v_mfma_f32_16x16x32_bf16 a[84:87], v[168:171], v[128:131], a[84:87]
    ds_read_b64_tr_b16 v[116:117], v36 offset:8192
    v_mfma_f32_16x16x32_bf16 a[140:143], v[168:171], v[132:135], a[140:143]
    ds_read_b64_tr_b16 v[118:119], v36 offset:9216
    v_mfma_f32_16x16x32_bf16 a[196:199], v[168:171], v[136:139], a[196:199]
    ds_read_b64_tr_b16 v[120:121], v40 offset:8192
    v_mfma_f32_16x16x32_bf16 a[32:35], v[172:175], v[124:127], a[32:35]
    ds_read_b64_tr_b16 v[122:123], v40 offset:9216
    v_mfma_f32_16x16x32_bf16 a[88:91], v[172:175], v[128:131], a[88:91]
    v_mfma_f32_16x16x32_bf16 a[144:147], v[172:175], v[132:135], a[144:147]
    v_mfma_f32_16x16x32_bf16 a[200:203], v[172:175], v[136:139], a[200:203]
    v_mfma_f32_16x16x32_bf16 a[36:39], v[176:179], v[124:127], a[36:39]
    v_mfma_f32_16x16x32_bf16 a[92:95], v[176:179], v[128:131], a[92:95]
    v_mfma_f32_16x16x32_bf16 a[148:151], v[176:179], v[132:135], a[148:151]
    v_mfma_f32_16x16x32_bf16 a[204:207], v[176:179], v[136:139], a[204:207]
    v_mfma_f32_16x16x32_bf16 a[40:43], v[180:183], v[124:127], a[40:43]
    v_mfma_f32_16x16x32_bf16 a[96:99], v[180:183], v[128:131], a[96:99]
    v_mfma_f32_16x16x32_bf16 a[152:155], v[180:183], v[132:135], a[152:155]
    v_mfma_f32_16x16x32_bf16 a[208:211], v[180:183], v[136:139], a[208:211]
    v_mfma_f32_16x16x32_bf16 a[44:47], v[184:187], v[124:127], a[44:47]
    v_mfma_f32_16x16x32_bf16 a[100:103], v[184:187], v[128:131], a[100:103]
    v_mfma_f32_16x16x32_bf16 a[156:159], v[184:187], v[132:135], a[156:159]
    v_mfma_f32_16x16x32_bf16 a[212:215], v[184:187], v[136:139], a[212:215]
    v_mfma_f32_16x16x32_bf16 a[48:51], v[188:191], v[124:127], a[48:51]
    v_mfma_f32_16x16x32_bf16 a[104:107], v[188:191], v[128:131], a[104:107]
    v_mfma_f32_16x16x32_bf16 a[160:163], v[188:191], v[132:135], a[160:163]
    v_mfma_f32_16x16x32_bf16 a[216:219], v[188:191], v[136:139], a[216:219]
    v_mfma_f32_16x16x32_bf16 a[52:55], v[192:195], v[124:127], a[52:55]
    v_mfma_f32_16x16x32_bf16 a[108:111], v[192:195], v[128:131], a[108:111]
    v_mfma_f32_16x16x32_bf16 a[164:167], v[192:195], v[132:135], a[164:167]
    v_mfma_f32_16x16x32_bf16 a[220:223], v[192:195], v[136:139], a[220:223]
    s_waitcnt lgkmcnt(0)
    v_mfma_f32_16x16x32_bf16 a[0:3], v[68:71], v[52:55], a[0:3]
    v_mfma_f32_16x16x32_bf16 a[56:59], v[68:71], v[56:59], a[56:59]
    s_waitcnt vmcnt(16)
    s_barrier
    s_add_u32 m0, s36, 65536
    buffer_load_dwordx4 v2, s[4:7], s28 offen lds
    s_add_u32 m0, s37, 65536
    buffer_load_dwordx4 v3, s[4:7], s28 offen lds
    s_add_u32 m0, s38, 65536
    buffer_load_dwordx4 v4, s[4:7], s28 offen lds
    s_add_u32 m0, s39, 65536
    buffer_load_dwordx4 v5, s[4:7], s28 offen lds
    s_add_u32 m0, s40, 65536
    buffer_load_dwordx4 v6, s[8:11], s29 offen lds
    s_add_u32 m0, s41, 65536
    buffer_load_dwordx4 v7, s[8:11], s29 offen lds
    s_add_u32 m0, s42, 65536
    buffer_load_dwordx4 v8, s[12:15], s29 offen lds
    s_add_u32 m0, s43, 65536
    buffer_load_dwordx4 v9, s[12:15], s29 offen lds
    s_add_u32 s28, s28, 64
    s_add_u32 s29, s29, 229376
    ds_read_b128 v[124:127], v13 offset:0
    v_mfma_f32_16x16x32_bf16 a[112:115], v[68:71], v[60:63], a[112:115]
    ds_read_b128 v[128:131], v13 offset:1024
    v_mfma_f32_16x16x32_bf16 a[168:171], v[68:71], v[64:67], a[168:171]
    ds_read_b128 v[132:135], v13 offset:2048
    v_mfma_f32_16x16x32_bf16 a[4:7], v[72:75], v[52:55], a[4:7]
    ds_read_b128 v[136:139], v13 offset:3072
    v_mfma_f32_16x16x32_bf16 a[60:63], v[72:75], v[56:59], a[60:63]
    ds_read_b64_tr_b16 v[140:141], v17 offset:0
    v_mfma_f32_16x16x32_bf16 a[116:119], v[72:75], v[60:63], a[116:119]
    ds_read_b64_tr_b16 v[142:143], v17 offset:1024
    v_mfma_f32_16x16x32_bf16 a[172:175], v[72:75], v[64:67], a[172:175]
    ds_read_b64_tr_b16 v[144:145], v21 offset:0
    v_mfma_f32_16x16x32_bf16 a[8:11], v[76:79], v[52:55], a[8:11]
    ds_read_b64_tr_b16 v[146:147], v21 offset:1024
    v_mfma_f32_16x16x32_bf16 a[64:67], v[76:79], v[56:59], a[64:67]
    ds_read_b64_tr_b16 v[148:149], v25 offset:0
    v_mfma_f32_16x16x32_bf16 a[120:123], v[76:79], v[60:63], a[120:123]
    ds_read_b64_tr_b16 v[150:151], v25 offset:1024
    v_mfma_f32_16x16x32_bf16 a[176:179], v[76:79], v[64:67], a[176:179]
    ds_read_b64_tr_b16 v[152:153], v29 offset:0
    v_mfma_f32_16x16x32_bf16 a[12:15], v[80:83], v[52:55], a[12:15]
    ds_read_b64_tr_b16 v[154:155], v29 offset:1024
    v_mfma_f32_16x16x32_bf16 a[68:71], v[80:83], v[56:59], a[68:71]
    ds_read_b64_tr_b16 v[156:157], v33 offset:0
    v_mfma_f32_16x16x32_bf16 a[124:127], v[80:83], v[60:63], a[124:127]
    ds_read_b64_tr_b16 v[158:159], v33 offset:1024
    v_mfma_f32_16x16x32_bf16 a[180:183], v[80:83], v[64:67], a[180:183]
    ds_read_b64_tr_b16 v[160:161], v37 offset:0
    v_mfma_f32_16x16x32_bf16 a[16:19], v[84:87], v[52:55], a[16:19]
    ds_read_b64_tr_b16 v[162:163], v37 offset:1024
    v_mfma_f32_16x16x32_bf16 a[72:75], v[84:87], v[56:59], a[72:75]
    ds_read_b64_tr_b16 v[164:165], v41 offset:0
    v_mfma_f32_16x16x32_bf16 a[128:131], v[84:87], v[60:63], a[128:131]
    ds_read_b64_tr_b16 v[166:167], v41 offset:1024
    v_mfma_f32_16x16x32_bf16 a[184:187], v[84:87], v[64:67], a[184:187]
    ds_read_b64_tr_b16 v[168:169], v17 offset:8192
    v_mfma_f32_16x16x32_bf16 a[20:23], v[88:91], v[52:55], a[20:23]
    ds_read_b64_tr_b16 v[170:171], v17 offset:9216
    v_mfma_f32_16x16x32_bf16 a[76:79], v[88:91], v[56:59], a[76:79]
    ds_read_b64_tr_b16 v[172:173], v21 offset:8192
    v_mfma_f32_16x16x32_bf16 a[132:135], v[88:91], v[60:63], a[132:135]
    ds_read_b64_tr_b16 v[174:175], v21 offset:9216
    v_mfma_f32_16x16x32_bf16 a[188:191], v[88:91], v[64:67], a[188:191]
    ds_read_b64_tr_b16 v[176:177], v25 offset:8192
    v_mfma_f32_16x16x32_bf16 a[24:27], v[92:95], v[52:55], a[24:27]
    ds_read_b64_tr_b16 v[178:179], v25 offset:9216
    v_mfma_f32_16x16x32_bf16 a[80:83], v[92:95], v[56:59], a[80:83]
    ds_read_b64_tr_b16 v[180:181], v29 offset:8192
    v_mfma_f32_16x16x32_bf16 a[136:139], v[92:95], v[60:63], a[136:139]
    ds_read_b64_tr_b16 v[182:183], v29 offset:9216
    v_mfma_f32_16x16x32_bf16 a[192:195], v[92:95], v[64:67], a[192:195]
    ds_read_b64_tr_b16 v[184:185], v33 offset:8192
    v_mfma_f32_16x16x32_bf16 a[28:31], v[96:99], v[52:55], a[28:31]
    ds_read_b64_tr_b16 v[186:187], v33 offset:9216
    v_mfma_f32_16x16x32_bf16 a[84:87], v[96:99], v[56:59], a[84:87]
    ds_read_b64_tr_b16 v[188:189], v37 offset:8192
    v_mfma_f32_16x16x32_bf16 a[140:143], v[96:99], v[60:63], a[140:143]
    ds_read_b64_tr_b16 v[190:191], v37 offset:9216
    v_mfma_f32_16x16x32_bf16 a[196:199], v[96:99], v[64:67], a[196:199]
    ds_read_b64_tr_b16 v[192:193], v41 offset:8192
    v_mfma_f32_16x16x32_bf16 a[32:35], v[100:103], v[52:55], a[32:35]
    ds_read_b64_tr_b16 v[194:195], v41 offset:9216
    v_mfma_f32_16x16x32_bf16 a[88:91], v[100:103], v[56:59], a[88:91]
    v_mfma_f32_16x16x32_bf16 a[144:147], v[100:103], v[60:63], a[144:147]
    v_mfma_f32_16x16x32_bf16 a[200:203], v[100:103], v[64:67], a[200:203]
    v_mfma_f32_16x16x32_bf16 a[36:39], v[104:107], v[52:55], a[36:39]
    v_mfma_f32_16x16x32_bf16 a[92:95], v[104:107], v[56:59], a[92:95]
    v_mfma_f32_16x16x32_bf16 a[148:151], v[104:107], v[60:63], a[148:151]
    v_mfma_f32_16x16x32_bf16 a[204:207], v[104:107], v[64:67], a[204:207]
    v_mfma_f32_16x16x32_bf16 a[40:43], v[108:111], v[52:55], a[40:43]
    v_mfma_f32_16x16x32_bf16 a[96:99], v[108:111], v[56:59], a[96:99]
    v_mfma_f32_16x16x32_bf16 a[152:155], v[108:111], v[60:63], a[152:155]
    v_mfma_f32_16x16x32_bf16 a[208:211], v[108:111], v[64:67], a[208:211]
    v_mfma_f32_16x16x32_bf16 a[44:47], v[112:115], v[52:55], a[44:47]
    v_mfma_f32_16x16x32_bf16 a[100:103], v[112:115], v[56:59], a[100:103]
    v_mfma_f32_16x16x32_bf16 a[156:159], v[112:115], v[60:63], a[156:159]
    v_mfma_f32_16x16x32_bf16 a[212:215], v[112:115], v[64:67], a[212:215]
    v_mfma_f32_16x16x32_bf16 a[48:51], v[116:119], v[52:55], a[48:51]
    v_mfma_f32_16x16x32_bf16 a[104:107], v[116:119], v[56:59], a[104:107]
    v_mfma_f32_16x16x32_bf16 a[160:163], v[116:119], v[60:63], a[160:163]
    v_mfma_f32_16x16x32_bf16 a[216:219], v[116:119], v[64:67], a[216:219]
    v_mfma_f32_16x16x32_bf16 a[52:55], v[120:123], v[52:55], a[52:55]
    v_mfma_f32_16x16x32_bf16 a[108:111], v[120:123], v[56:59], a[108:111]
    v_mfma_f32_16x16x32_bf16 a[164:167], v[120:123], v[60:63], a[164:167]
    v_mfma_f32_16x16x32_bf16 a[220:223], v[120:123], v[64:67], a[220:223]
    s_waitcnt lgkmcnt(0)
    v_mfma_f32_16x16x32_bf16 a[0:3], v[140:143], v[124:127], a[0:3]
    v_mfma_f32_16x16x32_bf16 a[56:59], v[140:143], v[128:131], a[56:59]
    s_waitcnt vmcnt(16)
    s_barrier
    s_add_u32 m0, s36, 98304
    buffer_load_dwordx4 v2, s[4:7], s28 offen lds
    s_add_u32 m0, s37, 98304
    buffer_load_dwordx4 v3, s[4:7], s28 offen lds
    s_add_u32 m0, s38, 98304
    buffer_load_dwordx4 v4, s[4:7], s28 offen lds
    s_add_u32 m0, s39, 98304
    buffer_load_dwordx4 v5, s[4:7], s28 offen lds
    s_add_u32 m0, s40, 98304
    buffer_load_dwordx4 v6, s[8:11], s29 offen lds
    s_add_u32 m0, s41, 98304
    buffer_load_dwordx4 v7, s[8:11], s29 offen lds
    s_add_u32 m0, s42, 98304
    buffer_load_dwordx4 v8, s[12:15], s29 offen lds
    s_add_u32 m0, s43, 98304
    buffer_load_dwordx4 v9, s[12:15], s29 offen lds
    s_add_u32 s28, s28, 64
    s_add_u32 s29, s29, 229376
    ds_read_b128 v[52:55], v10 offset:0
    v_mfma_f32_16x16x32_bf16 a[112:115], v[140:143], v[132:135], a[112:115]
    ds_read_b128 v[56:59], v10 offset:1024
    v_mfma_f32_16x16x32_bf16 a[168:171], v[140:143], v[136:139], a[168:171]
    ds_read_b128 v[60:63], v10 offset:2048
    v_mfma_f32_16x16x32_bf16 a[4:7], v[144:147], v[124:127], a[4:7]
    ds_read_b128 v[64:67], v10 offset:3072
    v_mfma_f32_16x16x32_bf16 a[60:63], v[144:147], v[128:131], a[60:63]
    ds_read_b64_tr_b16 v[68:69], v14 offset:0
    v_mfma_f32_16x16x32_bf16 a[116:119], v[144:147], v[132:135], a[116:119]
    ds_read_b64_tr_b16 v[70:71], v14 offset:1024
    v_mfma_f32_16x16x32_bf16 a[172:175], v[144:147], v[136:139], a[172:175]
    ds_read_b64_tr_b16 v[72:73], v18 offset:0
    v_mfma_f32_16x16x32_bf16 a[8:11], v[148:151], v[124:127], a[8:11]
    ds_read_b64_tr_b16 v[74:75], v18 offset:1024
    v_mfma_f32_16x16x32_bf16 a[64:67], v[148:151], v[128:131], a[64:67]
    ds_read_b64_tr_b16 v[76:77], v22 offset:0
    v_mfma_f32_16x16x32_bf16 a[120:123], v[148:151], v[132:135], a[120:123]
    ds_read_b64_tr_b16 v[78:79], v22 offset:1024
    v_mfma_f32_16x16x32_bf16 a[176:179], v[148:151], v[136:139], a[176:179]
    ds_read_b64_tr_b16 v[80:81], v26 offset:0
    v_mfma_f32_16x16x32_bf16 a[12:15], v[152:155], v[124:127], a[12:15]
    ds_read_b64_tr_b16 v[82:83], v26 offset:1024
    v_mfma_f32_16x16x32_bf16 a[68:71], v[152:155], v[128:131], a[68:71]
    ds_read_b64_tr_b16 v[84:85], v30 offset:0
    v_mfma_f32_16x16x32_bf16 a[124:127], v[152:155], v[132:135], a[124:127]
    ds_read_b64_tr_b16 v[86:87], v30 offset:1024
    v_mfma_f32_16x16x32_bf16 a[180:183], v[152:155], v[136:139], a[180:183]
    ds_read_b64_tr_b16 v[88:89], v34 offset:0
    v_mfma_f32_16x16x32_bf16 a[16:19], v[156:159], v[124:127], a[16:19]
    ds_read_b64_tr_b16 v[90:91], v34 offset:1024
    v_mfma_f32_16x16x32_bf16 a[72:75], v[156:159], v[128:131], a[72:75]
    ds_read_b64_tr_b16 v[92:93], v38 offset:0
    v_mfma_f32_16x16x32_bf16 a[128:131], v[156:159], v[132:135], a[128:131]
    ds_read_b64_tr_b16 v[94:95], v38 offset:1024
    v_mfma_f32_16x16x32_bf16 a[184:187], v[156:159], v[136:139], a[184:187]
    ds_read_b64_tr_b16 v[96:97], v14 offset:8192
    v_mfma_f32_16x16x32_bf16 a[20:23], v[160:163], v[124:127], a[20:23]
    ds_read_b64_tr_b16 v[98:99], v14 offset:9216
    v_mfma_f32_16x16x32_bf16 a[76:79], v[160:163], v[128:131], a[76:79]
    ds_read_b64_tr_b16 v[100:101], v18 offset:8192
    v_mfma_f32_16x16x32_bf16 a[132:135], v[160:163], v[132:135], a[132:135]
    ds_read_b64_tr_b16 v[102:103], v18 offset:9216
    v_mfma_f32_16x16x32_bf16 a[188:191], v[160:163], v[136:139], a[188:191]
    ds_read_b64_tr_b16 v[104:105], v22 offset:8192
    v_mfma_f32_16x16x32_bf16 a[24:27], v[164:167], v[124:127], a[24:27]
    ds_read_b64_tr_b16 v[106:107], v22 offset:9216
    v_mfma_f32_16x16x32_bf16 a[80:83], v[164:167], v[128:131], a[80:83]
    ds_read_b64_tr_b16 v[108:109], v26 offset:8192
    v_mfma_f32_16x16x32_bf16 a[136:139], v[164:167], v[132:135], a[136:139]
    ds_read_b64_tr_b16 v[110:111], v26 offset:9216
    v_mfma_f32_16x16x32_bf16 a[192:195], v[164:167], v[136:139], a[192:195]
    ds_read_b64_tr_b16 v[112:113], v30 offset:8192
    v_mfma_f32_16x16x32_bf16 a[28:31], v[168:171], v[124:127], a[28:31]
    ds_read_b64_tr_b16 v[114:115], v30 offset:9216
    v_mfma_f32_16x16x32_bf16 a[84:87], v[168:171], v[128:131], a[84:87]
    ds_read_b64_tr_b16 v[116:117], v34 offset:8192
    v_mfma_f32_16x16x32_bf16 a[140:143], v[168:171], v[132:135], a[140:143]
    ds_read_b64_tr_b16 v[118:119], v34 offset:9216
    v_mfma_f32_16x16x32_bf16 a[196:199], v[168:171], v[136:139], a[196:199]
    ds_read_b64_tr_b16 v[120:121], v38 offset:8192
    v_mfma_f32_16x16x32_bf16 a[32:35], v[172:175], v[124:127], a[32:35]
    ds_read_b64_tr_b16 v[122:123], v38 offset:9216
    v_mfma_f32_16x16x32_bf16 a[88:91], v[172:175], v[128:131], a[88:91]
    v_mfma_f32_16x16x32_bf16 a[144:147], v[172:175], v[132:135], a[144:147]
    v_mfma_f32_16x16x32_bf16 a[200:203], v[172:175], v[136:139], a[200:203]
    v_mfma_f32_16x16x32_bf16 a[36:39], v[176:179], v[124:127], a[36:39]
    v_mfma_f32_16x16x32_bf16 a[92:95], v[176:179], v[128:131], a[92:95]
    v_mfma_f32_16x16x32_bf16 a[148:151], v[176:179], v[132:135], a[148:151]
    v_mfma_f32_16x16x32_bf16 a[204:207], v[176:179], v[136:139], a[204:207]
    v_mfma_f32_16x16x32_bf16 a[40:43], v[180:183], v[124:127], a[40:43]
    v_mfma_f32_16x16x32_bf16 a[96:99], v[180:183], v[128:131], a[96:99]
    v_mfma_f32_16x16x32_bf16 a[152:155], v[180:183], v[132:135], a[152:155]
    v_mfma_f32_16x16x32_bf16 a[208:211], v[180:183], v[136:139], a[208:211]
    v_mfma_f32_16x16x32_bf16 a[44:47], v[184:187], v[124:127], a[44:47]
    v_mfma_f32_16x16x32_bf16 a[100:103], v[184:187], v[128:131], a[100:103]
    v_mfma_f32_16x16x32_bf16 a[156:159], v[184:187], v[132:135], a[156:159]
    v_mfma_f32_16x16x32_bf16 a[212:215], v[184:187], v[136:139], a[212:215]
    v_mfma_f32_16x16x32_bf16 a[48:51], v[188:191], v[124:127], a[48:51]
    v_mfma_f32_16x16x32_bf16 a[104:107], v[188:191], v[128:131], a[104:107]
    v_mfma_f32_16x16x32_bf16 a[160:163], v[188:191], v[132:135], a[160:163]
    v_mfma_f32_16x16x32_bf16 a[216:219], v[188:191], v[136:139], a[216:219]
    v_mfma_f32_16x16x32_bf16 a[52:55], v[192:195], v[124:127], a[52:55]
    v_mfma_f32_16x16x32_bf16 a[108:111], v[192:195], v[128:131], a[108:111]
    v_mfma_f32_16x16x32_bf16 a[164:167], v[192:195], v[132:135], a[164:167]
    v_mfma_f32_16x16x32_bf16 a[220:223], v[192:195], v[136:139], a[220:223]
    s_waitcnt lgkmcnt(0)
    v_mfma_f32_16x16x32_bf16 a[0:3], v[68:71], v[52:55], a[0:3]
    v_mfma_f32_16x16x32_bf16 a[56:59], v[68:71], v[56:59], a[56:59]
    s_waitcnt vmcnt(16)
    s_barrier
    s_add_u32 m0, s36, 0
    buffer_load_dwordx4 v2, s[4:7], s28 offen lds
    s_add_u32 m0, s37, 0
    buffer_load_dwordx4 v3, s[4:7], s28 offen lds
    s_add_u32 m0, s38, 0
    buffer_load_dwordx4 v4, s[4:7], s28 offen lds
    s_add_u32 m0, s39, 0
    buffer_load_dwordx4 v5, s[4:7], s28 offen lds
    s_add_u32 m0, s40, 0
    buffer_load_dwordx4 v6, s[8:11], s29 offen lds
    s_add_u32 m0, s41, 0
    buffer_load_dwordx4 v7, s[8:11], s29 offen lds
    s_add_u32 m0, s42, 0
    buffer_load_dwordx4 v8, s[12:15], s29 offen lds
    s_add_u32 m0, s43, 0
    buffer_load_dwordx4 v9, s[12:15], s29 offen lds
    s_add_u32 s28, s28, 64
    s_add_u32 s29, s29, 229376
    ds_read_b128 v[124:127], v11 offset:0
    v_mfma_f32_16x16x32_bf16 a[112:115], v[68:71], v[60:63], a[112:115]
    ds_read_b128 v[128:131], v11 offset:1024
    v_mfma_f32_16x16x32_bf16 a[168:171], v[68:71], v[64:67], a[168:171]
    ds_read_b128 v[132:135], v11 offset:2048
    v_mfma_f32_16x16x32_bf16 a[4:7], v[72:75], v[52:55], a[4:7]
    ds_read_b128 v[136:139], v11 offset:3072
    v_mfma_f32_16x16x32_bf16 a[60:63], v[72:75], v[56:59], a[60:63]
    ds_read_b64_tr_b16 v[140:141], v15 offset:0
    v_mfma_f32_16x16x32_bf16 a[116:119], v[72:75], v[60:63], a[116:119]
    ds_read_b64_tr_b16 v[142:143], v15 offset:1024
    v_mfma_f32_16x16x32_bf16 a[172:175], v[72:75], v[64:67], a[172:175]
    ds_read_b64_tr_b16 v[144:145], v19 offset:0
    v_mfma_f32_16x16x32_bf16 a[8:11], v[76:79], v[52:55], a[8:11]
    ds_read_b64_tr_b16 v[146:147], v19 offset:1024
    v_mfma_f32_16x16x32_bf16 a[64:67], v[76:79], v[56:59], a[64:67]
    ds_read_b64_tr_b16 v[148:149], v23 offset:0
    v_mfma_f32_16x16x32_bf16 a[120:123], v[76:79], v[60:63], a[120:123]
    ds_read_b64_tr_b16 v[150:151], v23 offset:1024
    v_mfma_f32_16x16x32_bf16 a[176:179], v[76:79], v[64:67], a[176:179]
    ds_read_b64_tr_b16 v[152:153], v27 offset:0
    v_mfma_f32_16x16x32_bf16 a[12:15], v[80:83], v[52:55], a[12:15]
    ds_read_b64_tr_b16 v[154:155], v27 offset:1024
    v_mfma_f32_16x16x32_bf16 a[68:71], v[80:83], v[56:59], a[68:71]
    ds_read_b64_tr_b16 v[156:157], v31 offset:0
    v_mfma_f32_16x16x32_bf16 a[124:127], v[80:83], v[60:63], a[124:127]
    ds_read_b64_tr_b16 v[158:159], v31 offset:1024
    v_mfma_f32_16x16x32_bf16 a[180:183], v[80:83], v[64:67], a[180:183]
    ds_read_b64_tr_b16 v[160:161], v35 offset:0
    v_mfma_f32_16x16x32_bf16 a[16:19], v[84:87], v[52:55], a[16:19]
    ds_read_b64_tr_b16 v[162:163], v35 offset:1024
    v_mfma_f32_16x16x32_bf16 a[72:75], v[84:87], v[56:59], a[72:75]
    ds_read_b64_tr_b16 v[164:165], v39 offset:0
    v_mfma_f32_16x16x32_bf16 a[128:131], v[84:87], v[60:63], a[128:131]
    ds_read_b64_tr_b16 v[166:167], v39 offset:1024
    v_mfma_f32_16x16x32_bf16 a[184:187], v[84:87], v[64:67], a[184:187]
    ds_read_b64_tr_b16 v[168:169], v15 offset:8192
    v_mfma_f32_16x16x32_bf16 a[20:23], v[88:91], v[52:55], a[20:23]
    ds_read_b64_tr_b16 v[170:171], v15 offset:9216
    v_mfma_f32_16x16x32_bf16 a[76:79], v[88:91], v[56:59], a[76:79]
    ds_read_b64_tr_b16 v[172:173], v19 offset:8192
    v_mfma_f32_16x16x32_bf16 a[132:135], v[88:91], v[60:63], a[132:135]
    ds_read_b64_tr_b16 v[174:175], v19 offset:9216
    v_mfma_f32_16x16x32_bf16 a[188:191], v[88:91], v[64:67], a[188:191]
    ds_read_b64_tr_b16 v[176:177], v23 offset:8192
    v_mfma_f32_16x16x32_bf16 a[24:27], v[92:95], v[52:55], a[24:27]
    ds_read_b64_tr_b16 v[178:179], v23 offset:9216
    v_mfma_f32_16x16x32_bf16 a[80:83], v[92:95], v[56:59], a[80:83]
    ds_read_b64_tr_b16 v[180:181], v27 offset:8192
    v_mfma_f32_16x16x32_bf16 a[136:139], v[92:95], v[60:63], a[136:139]
    ds_read_b64_tr_b16 v[182:183], v27 offset:9216
    v_mfma_f32_16x16x32_bf16 a[192:195], v[92:95], v[64:67], a[192:195]
    ds_read_b64_tr_b16 v[184:185], v31 offset:8192
    v_mfma_f32_16x16x32_bf16 a[28:31], v[96:99], v[52:55], a[28:31]
    ds_read_b64_tr_b16 v[186:187], v31 offset:9216
    v_mfma_f32_16x16x32_bf16 a[84:87], v[96:99], v[56:59], a[84:87]
    ds_read_b64_tr_b16 v[188:189], v35 offset:8192
    v_mfma_f32_16x16x32_bf16 a[140:143], v[96:99], v[60:63], a[140:143]
    ds_read_b64_tr_b16 v[190:191], v35 offset:9216
    v_mfma_f32_16x16x32_bf16 a[196:199], v[96:99], v[64:67], a[196:199]
    ds_read_b64_tr_b16 v[192:193], v39 offset:8192
    v_mfma_f32_16x16x32_bf16 a[32:35], v[100:103], v[52:55], a[32:35]
    ds_read_b64_tr_b16 v[194:195], v39 offset:9216
    v_mfma_f32_16x16x32_bf16 a[88:91], v[100:103], v[56:59], a[88:91]
    v_mfma_f32_16x16x32_bf16 a[144:147], v[100:103], v[60:63], a[144:147]
    v_mfma_f32_16x16x32_bf16 a[200:203], v[100:103], v[64:67], a[200:203]
    v_mfma_f32_16x16x32_bf16 a[36:39], v[104:107], v[52:55], a[36:39]
    v_mfma_f32_16x16x32_bf16 a[92:95], v[104:107], v[56:59], a[92:95]
    v_mfma_f32_16x16x32_bf16 a[148:151], v[104:107], v[60:63], a[148:151]
    v_mfma_f32_16x16x32_bf16 a[204:207], v[104:107], v[64:67], a[204:207]
    v_mfma_f32_16x16x32_bf16 a[40:43], v[108:111], v[52:55], a[40:43]
    v_mfma_f32_16x16x32_bf16 a[96:99], v[108:111], v[56:59], a[96:99]
    v_mfma_f32_16x16x32_bf16 a[152:155], v[108:111], v[60:63], a[152:155]
    v_mfma_f32_16x16x32_bf16 a[208:211], v[108:111], v[64:67], a[208:211]
    v_mfma_f32_16x16x32_bf16 a[44:47], v[112:115], v[52:55], a[44:47]
    v_mfma_f32_16x16x32_bf16 a[100:103], v[112:115], v[56:59], a[100:103]
    v_mfma_f32_16x16x32_bf16 a[156:159], v[112:115], v[60:63], a[156:159]
    v_mfma_f32_16x16x32_bf16 a[212:215], v[112:115], v[64:67], a[212:215]
    v_mfma_f32_16x16x32_bf16 a[48:51], v[116:119], v[52:55], a[48:51]
    v_mfma_f32_16x16x32_bf16 a[104:107], v[116:119], v[56:59], a[104:107]
    v_mfma_f32_16x16x32_bf16 a[160:163], v[116:119], v[60:63], a[160:163]
    v_mfma_f32_16x16x32_bf16 a[216:219], v[116:119], v[64:67], a[216:219]
    v_mfma_f32_16x16x32_bf16 a[52:55], v[120:123], v[52:55], a[52:55]
    v_mfma_f32_16x16x32_bf16 a[108:111], v[120:123], v[56:59], a[108:111]
    v_mfma_f32_16x16x32_bf16 a[164:167], v[120:123], v[60:63], a[164:167]
    v_mfma_f32_16x16x32_bf16 a[220:223], v[120:123], v[64:67], a[220:223]
    s_waitcnt lgkmcnt(0)
    v_mfma_f32_16x16x32_bf16 a[0:3], v[140:143], v[124:127], a[0:3]
    v_mfma_f32_16x16x32_bf16 a[56:59], v[140:143], v[128:131], a[56:59]
    s_waitcnt vmcnt(16)
    s_barrier
    s_add_u32 m0, s36, 32768
    buffer_load_dwordx4 v2, s[4:7], s28 offen lds
    s_add_u32 m0, s37, 32768
    buffer_load_dwordx4 v3, s[4:7], s28 offen lds
    s_add_u32 m0, s38, 32768
    buffer_load_dwordx4 v4, s[4:7], s28 offen lds
    s_add_u32 m0, s39, 32768
    buffer_load_dwordx4 v5, s[4:7], s28 offen lds
    s_add_u32 m0, s40, 32768
    buffer_load_dwordx4 v6, s[8:11], s29 offen lds
    s_add_u32 m0, s41, 32768
    buffer_load_dwordx4 v7, s[8:11], s29 offen lds
    s_add_u32 m0, s42, 32768
    buffer_load_dwordx4 v8, s[12:15], s29 offen lds
    s_add_u32 m0, s43, 32768
    buffer_load_dwordx4 v9, s[12:15], s29 offen lds
    s_add_u32 s28, s28, 64
    s_add_u32 s29, s29, 229376
    ds_read_b128 v[52:55], v12 offset:0
    v_mfma_f32_16x16x32_bf16 a[112:115], v[140:143], v[132:135], a[112:115]
    ds_read_b128 v[56:59], v12 offset:1024
    v_mfma_f32_16x16x32_bf16 a[168:171], v[140:143], v[136:139], a[168:171]
    ds_read_b128 v[60:63], v12 offset:2048
    v_mfma_f32_16x16x32_bf16 a[4:7], v[144:147], v[124:127], a[4:7]
    ds_read_b128 v[64:67], v12 offset:3072
    v_mfma_f32_16x16x32_bf16 a[60:63], v[144:147], v[128:131], a[60:63]
    ds_read_b64_tr_b16 v[68:69], v16 offset:0
    v_mfma_f32_16x16x32_bf16 a[116:119], v[144:147], v[132:135], a[116:119]
    ds_read_b64_tr_b16 v[70:71], v16 offset:1024
    v_mfma_f32_16x16x32_bf16 a[172:175], v[144:147], v[136:139], a[172:175]
    ds_read_b64_tr_b16 v[72:73], v20 offset:0
    v_mfma_f32_16x16x32_bf16 a[8:11], v[148:151], v[124:127], a[8:11]
    ds_read_b64_tr_b16 v[74:75], v20 offset:1024
    v_mfma_f32_16x16x32_bf16 a[64:67], v[148:151], v[128:131], a[64:67]
    ds_read_b64_tr_b16 v[76:77], v24 offset:0
    v_mfma_f32_16x16x32_bf16 a[120:123], v[148:151], v[132:135], a[120:123]
    ds_read_b64_tr_b16 v[78:79], v24 offset:1024
    v_mfma_f32_16x16x32_bf16 a[176:179], v[148:151], v[136:139], a[176:179]
    ds_read_b64_tr_b16 v[80:81], v28 offset:0
    v_mfma_f32_16x16x32_bf16 a[12:15], v[152:155], v[124:127], a[12:15]
    ds_read_b64_tr_b16 v[82:83], v28 offset:1024
    v_mfma_f32_16x16x32_bf16 a[68:71], v[152:155], v[128:131], a[68:71]
    ds_read_b64_tr_b16 v[84:85], v32 offset:0
    v_mfma_f32_16x16x32_bf16 a[124:127], v[152:155], v[132:135], a[124:127]
    ds_read_b64_tr_b16 v[86:87], v32 offset:1024
    v_mfma_f32_16x16x32_bf16 a[180:183], v[152:155], v[136:139], a[180:183]
    ds_read_b64_tr_b16 v[88:89], v36 offset:0
    v_mfma_f32_16x16x32_bf16 a[16:19], v[156:159], v[124:127], a[16:19]
    ds_read_b64_tr_b16 v[90:91], v36 offset:1024
    v_mfma_f32_16x16x32_bf16 a[72:75], v[156:159], v[128:131], a[72:75]
    ds_read_b64_tr_b16 v[92:93], v40 offset:0
    v_mfma_f32_16x16x32_bf16 a[128:131], v[156:159], v[132:135], a[128:131]
    ds_read_b64_tr_b16 v[94:95], v40 offset:1024
    v_mfma_f32_16x16x32_bf16 a[184:187], v[156:159], v[136:139], a[184:187]
    ds_read_b64_tr_b16 v[96:97], v16 offset:8192
    v_mfma_f32_16x16x32_bf16 a[20:23], v[160:163], v[124:127], a[20:23]
    ds_read_b64_tr_b16 v[98:99], v16 offset:9216
    v_mfma_f32_16x16x32_bf16 a[76:79], v[160:163], v[128:131], a[76:79]
    ds_read_b64_tr_b16 v[100:101], v20 offset:8192
    v_mfma_f32_16x16x32_bf16 a[132:135], v[160:163], v[132:135], a[132:135]
    ds_read_b64_tr_b16 v[102:103], v20 offset:9216
    v_mfma_f32_16x16x32_bf16 a[188:191], v[160:163], v[136:139], a[188:191]
    ds_read_b64_tr_b16 v[104:105], v24 offset:8192
    v_mfma_f32_16x16x32_bf16 a[24:27], v[164:167], v[124:127], a[24:27]
    ds_read_b64_tr_b16 v[106:107], v24 offset:9216
    v_mfma_f32_16x16x32_bf16 a[80:83], v[164:167], v[128:131], a[80:83]
    ds_read_b64_tr_b16 v[108:109], v28 offset:8192
    v_mfma_f32_16x16x32_bf16 a[136:139], v[164:167], v[132:135], a[136:139]
    ds_read_b64_tr_b16 v[110:111], v28 offset:9216
    v_mfma_f32_16x16x32_bf16 a[192:195], v[164:167], v[136:139], a[192:195]
    ds_read_b64_tr_b16 v[112:113], v32 offset:8192
    v_mfma_f32_16x16x32_bf16 a[28:31], v[168:171], v[124:127], a[28:31]
    ds_read_b64_tr_b16 v[114:115], v32 offset:9216
    v_mfma_f32_16x16x32_bf16 a[84:87], v[168:171], v[128:131], a[84:87]
    ds_read_b64_tr_b16 v[116:117], v36 offset:8192
    v_mfma_f32_16x16x32_bf16 a[140:143], v[168:171], v[132:135], a[140:143]
    ds_read_b64_tr_b16 v[118:119], v36 offset:9216
    v_mfma_f32_16x16x32_bf16 a[196:199], v[168:171], v[136:139], a[196:199]
    ds_read_b64_tr_b16 v[120:121], v40 offset:8192
    v_mfma_f32_16x16x32_bf16 a[32:35], v[172:175], v[124:127], a[32:35]
    ds_read_b64_tr_b16 v[122:123], v40 offset:9216
    v_mfma_f32_16x16x32_bf16 a[88:91], v[172:175], v[128:131], a[88:91]
    v_mfma_f32_16x16x32_bf16 a[144:147], v[172:175], v[132:135], a[144:147]
    v_mfma_f32_16x16x32_bf16 a[200:203], v[172:175], v[136:139], a[200:203]
    v_mfma_f32_16x16x32_bf16 a[36:39], v[176:179], v[124:127], a[36:39]
    v_mfma_f32_16x16x32_bf16 a[92:95], v[176:179], v[128:131], a[92:95]
    v_mfma_f32_16x16x32_bf16 a[148:151], v[176:179], v[132:135], a[148:151]
    v_mfma_f32_16x16x32_bf16 a[204:207], v[176:179], v[136:139], a[204:207]
    v_mfma_f32_16x16x32_bf16 a[40:43], v[180:183], v[124:127], a[40:43]
    v_mfma_f32_16x16x32_bf16 a[96:99], v[180:183], v[128:131], a[96:99]
    v_mfma_f32_16x16x32_bf16 a[152:155], v[180:183], v[132:135], a[152:155]
    v_mfma_f32_16x16x32_bf16 a[208:211], v[180:183], v[136:139], a[208:211]
    v_mfma_f32_16x16x32_bf16 a[44:47], v[184:187], v[124:127], a[44:47]
    v_mfma_f32_16x16x32_bf16 a[100:103], v[184:187], v[128:131], a[100:103]
    v_mfma_f32_16x16x32_bf16 a[156:159], v[184:187], v[132:135], a[156:159]
    v_mfma_f32_16x16x32_bf16 a[212:215], v[184:187], v[136:139], a[212:215]
    v_mfma_f32_16x16x32_bf16 a[48:51], v[188:191], v[124:127], a[48:51]
    v_mfma_f32_16x16x32_bf16 a[104:107], v[188:191], v[128:131], a[104:107]
    v_mfma_f32_16x16x32_bf16 a[160:163], v[188:191], v[132:135], a[160:163]
    v_mfma_f32_16x16x32_bf16 a[216:219], v[188:191], v[136:139], a[216:219]
    v_mfma_f32_16x16x32_bf16 a[52:55], v[192:195], v[124:127], a[52:55]
    v_mfma_f32_16x16x32_bf16 a[108:111], v[192:195], v[128:131], a[108:111]
    v_mfma_f32_16x16x32_bf16 a[164:167], v[192:195], v[132:135], a[164:167]
    v_mfma_f32_16x16x32_bf16 a[220:223], v[192:195], v[136:139], a[220:223]
    s_waitcnt lgkmcnt(0)
    v_mfma_f32_16x16x32_bf16 a[0:3], v[68:71], v[52:55], a[0:3]
    v_mfma_f32_16x16x32_bf16 a[56:59], v[68:71], v[56:59], a[56:59]
    s_waitcnt vmcnt(16)
    s_barrier
    s_add_u32 m0, s36, 65536
    buffer_load_dwordx4 v2, s[4:7], s28 offen lds
    s_add_u32 m0, s37, 65536
    buffer_load_dwordx4 v3, s[4:7], s28 offen lds
    s_add_u32 m0, s38, 65536
    buffer_load_dwordx4 v4, s[4:7], s28 offen lds
    s_add_u32 m0, s39, 65536
    buffer_load_dwordx4 v5, s[4:7], s28 offen lds
    s_add_u32 m0, s40, 65536
    buffer_load_dwordx4 v6, s[8:11], s29 offen lds
    s_add_u32 m0, s41, 65536
    buffer_load_dwordx4 v7, s[8:11], s29 offen lds
    s_add_u32 m0, s42, 65536
    buffer_load_dwordx4 v8, s[12:15], s29 offen lds
    s_add_u32 m0, s43, 65536
    buffer_load_dwordx4 v9, s[12:15], s29 offen lds
    s_add_u32 s28, s28, 64
    s_add_u32 s29, s29, 229376
    ds_read_b128 v[124:127], v13 offset:0
    v_mfma_f32_16x16x32_bf16 a[112:115], v[68:71], v[60:63], a[112:115]
    ds_read_b128 v[128:131], v13 offset:1024
    v_mfma_f32_16x16x32_bf16 a[168:171], v[68:71], v[64:67], a[168:171]
    ds_read_b128 v[132:135], v13 offset:2048
    v_mfma_f32_16x16x32_bf16 a[4:7], v[72:75], v[52:55], a[4:7]
    ds_read_b128 v[136:139], v13 offset:3072
    v_mfma_f32_16x16x32_bf16 a[60:63], v[72:75], v[56:59], a[60:63]
    ds_read_b64_tr_b16 v[140:141], v17 offset:0
    v_mfma_f32_16x16x32_bf16 a[116:119], v[72:75], v[60:63], a[116:119]
    ds_read_b64_tr_b16 v[142:143], v17 offset:1024
    v_mfma_f32_16x16x32_bf16 a[172:175], v[72:75], v[64:67], a[172:175]
    ds_read_b64_tr_b16 v[144:145], v21 offset:0
    v_mfma_f32_16x16x32_bf16 a[8:11], v[76:79], v[52:55], a[8:11]
    ds_read_b64_tr_b16 v[146:147], v21 offset:1024
    v_mfma_f32_16x16x32_bf16 a[64:67], v[76:79], v[56:59], a[64:67]
    ds_read_b64_tr_b16 v[148:149], v25 offset:0
    v_mfma_f32_16x16x32_bf16 a[120:123], v[76:79], v[60:63], a[120:123]
    ds_read_b64_tr_b16 v[150:151], v25 offset:1024
    v_mfma_f32_16x16x32_bf16 a[176:179], v[76:79], v[64:67], a[176:179]
    ds_read_b64_tr_b16 v[152:153], v29 offset:0
    v_mfma_f32_16x16x32_bf16 a[12:15], v[80:83], v[52:55], a[12:15]
    ds_read_b64_tr_b16 v[154:155], v29 offset:1024
    v_mfma_f32_16x16x32_bf16 a[68:71], v[80:83], v[56:59], a[68:71]
    ds_read_b64_tr_b16 v[156:157], v33 offset:0
    v_mfma_f32_16x16x32_bf16 a[124:127], v[80:83], v[60:63], a[124:127]
    ds_read_b64_tr_b16 v[158:159], v33 offset:1024
    v_mfma_f32_16x16x32_bf16 a[180:183], v[80:83], v[64:67], a[180:183]
    ds_read_b64_tr_b16 v[160:161], v37 offset:0
    v_mfma_f32_16x16x32_bf16 a[16:19], v[84:87], v[52:55], a[16:19]
    ds_read_b64_tr_b16 v[162:163], v37 offset:1024
    v_mfma_f32_16x16x32_bf16 a[72:75], v[84:87], v[56:59], a[72:75]
    ds_read_b64_tr_b16 v[164:165], v41 offset:0
    v_mfma_f32_16x16x32_bf16 a[128:131], v[84:87], v[60:63], a[128:131]
    ds_read_b64_tr_b16 v[166:167], v41 offset:1024
    v_mfma_f32_16x16x32_bf16 a[184:187], v[84:87], v[64:67], a[184:187]
    ds_read_b64_tr_b16 v[168:169], v17 offset:8192
    v_mfma_f32_16x16x32_bf16 a[20:23], v[88:91], v[52:55], a[20:23]
    ds_read_b64_tr_b16 v[170:171], v17 offset:9216
    v_mfma_f32_16x16x32_bf16 a[76:79], v[88:91], v[56:59], a[76:79]
    ds_read_b64_tr_b16 v[172:173], v21 offset:8192
    v_mfma_f32_16x16x32_bf16 a[132:135], v[88:91], v[60:63], a[132:135]
    ds_read_b64_tr_b16 v[174:175], v21 offset:9216
    v_mfma_f32_16x16x32_bf16 a[188:191], v[88:91], v[64:67], a[188:191]
    ds_read_b64_tr_b16 v[176:177], v25 offset:8192
    v_mfma_f32_16x16x32_bf16 a[24:27], v[92:95], v[52:55], a[24:27]
    ds_read_b64_tr_b16 v[178:179], v25 offset:9216
    v_mfma_f32_16x16x32_bf16 a[80:83], v[92:95], v[56:59], a[80:83]
    ds_read_b64_tr_b16 v[180:181], v29 offset:8192
    v_mfma_f32_16x16x32_bf16 a[136:139], v[92:95], v[60:63], a[136:139]
    ds_read_b64_tr_b16 v[182:183], v29 offset:9216
    v_mfma_f32_16x16x32_bf16 a[192:195], v[92:95], v[64:67], a[192:195]
    ds_read_b64_tr_b16 v[184:185], v33 offset:8192
    v_mfma_f32_16x16x32_bf16 a[28:31], v[96:99], v[52:55], a[28:31]
    ds_read_b64_tr_b16 v[186:187], v33 offset:9216
    v_mfma_f32_16x16x32_bf16 a[84:87], v[96:99], v[56:59], a[84:87]
    ds_read_b64_tr_b16 v[188:189], v37 offset:8192
    v_mfma_f32_16x16x32_bf16 a[140:143], v[96:99], v[60:63], a[140:143]
    ds_read_b64_tr_b16 v[190:191], v37 offset:9216
    v_mfma_f32_16x16x32_bf16 a[196:199], v[96:99], v[64:67], a[196:199]
    ds_read_b64_tr_b16 v[192:193], v41 offset:8192
    v_mfma_f32_16x16x32_bf16 a[32:35], v[100:103], v[52:55], a[32:35]
    ds_read_b64_tr_b16 v[194:195], v41 offset:9216
    v_mfma_f32_16x16x32_bf16 a[88:91], v[100:103], v[56:59], a[88:91]
    v_mfma_f32_16x16x32_bf16 a[144:147], v[100:103], v[60:63], a[144:147]
    v_mfma_f32_16x16x32_bf16 a[200:203], v[100:103], v[64:67], a[200:203]
    v_mfma_f32_16x16x32_bf16 a[36:39], v[104:107], v[52:55], a[36:39]
    v_mfma_f32_16x16x32_bf16 a[92:95], v[104:107], v[56:59], a[92:95]
    v_mfma_f32_16x16x32_bf16 a[148:151], v[104:107], v[60:63], a[148:151]
    v_mfma_f32_16x16x32_bf16 a[204:207], v[104:107], v[64:67], a[204:207]
    v_mfma_f32_16x16x32_bf16 a[40:43], v[108:111], v[52:55], a[40:43]
    v_mfma_f32_16x16x32_bf16 a[96:99], v[108:111], v[56:59], a[96:99]
    v_mfma_f32_16x16x32_bf16 a[152:155], v[108:111], v[60:63], a[152:155]
    v_mfma_f32_16x16x32_bf16 a[208:211], v[108:111], v[64:67], a[208:211]
    v_mfma_f32_16x16x32_bf16 a[44:47], v[112:115], v[52:55], a[44:47]
    v_mfma_f32_16x16x32_bf16 a[100:103], v[112:115], v[56:59], a[100:103]
    v_mfma_f32_16x16x32_bf16 a[156:159], v[112:115], v[60:63], a[156:159]
    v_mfma_f32_16x16x32_bf16 a[212:215], v[112:115], v[64:67], a[212:215]
    v_mfma_f32_16x16x32_bf16 a[48:51], v[116:119], v[52:55], a[48:51]
    v_mfma_f32_16x16x32_bf16 a[104:107], v[116:119], v[56:59], a[104:107]
    v_mfma_f32_16x16x32_bf16 a[160:163], v[116:119], v[60:63], a[160:163]
    v_mfma_f32_16x16x32_bf16 a[216:219], v[116:119], v[64:67], a[216:219]
    v_mfma_f32_16x16x32_bf16 a[52:55], v[120:123], v[52:55], a[52:55]
    v_mfma_f32_16x16x32_bf16 a[108:111], v[120:123], v[56:59], a[108:111]
    v_mfma_f32_16x16x32_bf16 a[164:167], v[120:123], v[60:63], a[164:167]
    v_mfma_f32_16x16x32_bf16 a[220:223], v[120:123], v[64:67], a[220:223]
    s_waitcnt lgkmcnt(0)
    v_mfma_f32_16x16x32_bf16 a[0:3], v[140:143], v[124:127], a[0:3]
    v_mfma_f32_16x16x32_bf16 a[56:59], v[140:143], v[128:131], a[56:59]
    s_waitcnt vmcnt(16)
    s_barrier
    s_add_u32 m0, s36, 98304
    buffer_load_dwordx4 v2, s[4:7], s28 offen lds
    s_add_u32 m0, s37, 98304
    buffer_load_dwordx4 v3, s[4:7], s28 offen lds
    s_add_u32 m0, s38, 98304
    buffer_load_dwordx4 v4, s[4:7], s28 offen lds
    s_add_u32 m0, s39, 98304
    buffer_load_dwordx4 v5, s[4:7], s28 offen lds
    s_add_u32 m0, s40, 98304
    buffer_load_dwordx4 v6, s[8:11], s29 offen lds
    s_add_u32 m0, s41, 98304
    buffer_load_dwordx4 v7, s[8:11], s29 offen lds
    s_add_u32 m0, s42, 98304
    buffer_load_dwordx4 v8, s[12:15], s29 offen lds
    s_add_u32 m0, s43, 98304
    buffer_load_dwordx4 v9, s[12:15], s29 offen lds
    s_add_u32 s28, s28, 64
    s_add_u32 s29, s29, 229376
    ds_read_b128 v[52:55], v10 offset:0
    v_mfma_f32_16x16x32_bf16 a[112:115], v[140:143], v[132:135], a[112:115]
    ds_read_b128 v[56:59], v10 offset:1024
    v_mfma_f32_16x16x32_bf16 a[168:171], v[140:143], v[136:139], a[168:171]
    ds_read_b128 v[60:63], v10 offset:2048
    v_mfma_f32_16x16x32_bf16 a[4:7], v[144:147], v[124:127], a[4:7]
    ds_read_b128 v[64:67], v10 offset:3072
    v_mfma_f32_16x16x32_bf16 a[60:63], v[144:147], v[128:131], a[60:63]
    ds_read_b64_tr_b16 v[68:69], v14 offset:0
    v_mfma_f32_16x16x32_bf16 a[116:119], v[144:147], v[132:135], a[116:119]
    ds_read_b64_tr_b16 v[70:71], v14 offset:1024
    v_mfma_f32_16x16x32_bf16 a[172:175], v[144:147], v[136:139], a[172:175]
    ds_read_b64_tr_b16 v[72:73], v18 offset:0
    v_mfma_f32_16x16x32_bf16 a[8:11], v[148:151], v[124:127], a[8:11]
    ds_read_b64_tr_b16 v[74:75], v18 offset:1024
    v_mfma_f32_16x16x32_bf16 a[64:67], v[148:151], v[128:131], a[64:67]
    ds_read_b64_tr_b16 v[76:77], v22 offset:0
    v_mfma_f32_16x16x32_bf16 a[120:123], v[148:151], v[132:135], a[120:123]
    ds_read_b64_tr_b16 v[78:79], v22 offset:1024
    v_mfma_f32_16x16x32_bf16 a[176:179], v[148:151], v[136:139], a[176:179]
    ds_read_b64_tr_b16 v[80:81], v26 offset:0
    v_mfma_f32_16x16x32_bf16 a[12:15], v[152:155], v[124:127], a[12:15]
    ds_read_b64_tr_b16 v[82:83], v26 offset:1024
    v_mfma_f32_16x16x32_bf16 a[68:71], v[152:155], v[128:131], a[68:71]
    ds_read_b64_tr_b16 v[84:85], v30 offset:0
    v_mfma_f32_16x16x32_bf16 a[124:127], v[152:155], v[132:135], a[124:127]
    ds_read_b64_tr_b16 v[86:87], v30 offset:1024
    v_mfma_f32_16x16x32_bf16 a[180:183], v[152:155], v[136:139], a[180:183]
    ds_read_b64_tr_b16 v[88:89], v34 offset:0
    v_mfma_f32_16x16x32_bf16 a[16:19], v[156:159], v[124:127], a[16:19]
    ds_read_b64_tr_b16 v[90:91], v34 offset:1024
    v_mfma_f32_16x16x32_bf16 a[72:75], v[156:159], v[128:131], a[72:75]
    ds_read_b64_tr_b16 v[92:93], v38 offset:0
    v_mfma_f32_16x16x32_bf16 a[128:131], v[156:159], v[132:135], a[128:131]
    ds_read_b64_tr_b16 v[94:95], v38 offset:1024
    v_mfma_f32_16x16x32_bf16 a[184:187], v[156:159], v[136:139], a[184:187]
    ds_read_b64_tr_b16 v[96:97], v14 offset:8192
    v_mfma_f32_16x16x32_bf16 a[20:23], v[160:163], v[124:127], a[20:23]
    ds_read_b64_tr_b16 v[98:99], v14 offset:9216
    v_mfma_f32_16x16x32_bf16 a[76:79], v[160:163], v[128:131], a[76:79]
    ds_read_b64_tr_b16 v[100:101], v18 offset:8192
    v_mfma_f32_16x16x32_bf16 a[132:135], v[160:163], v[132:135], a[132:135]
    ds_read_b64_tr_b16 v[102:103], v18 offset:9216
    v_mfma_f32_16x16x32_bf16 a[188:191], v[160:163], v[136:139], a[188:191]
    ds_read_b64_tr_b16 v[104:105], v22 offset:8192
    v_mfma_f32_16x16x32_bf16 a[24:27], v[164:167], v[124:127], a[24:27]
    ds_read_b64_tr_b16 v[106:107], v22 offset:9216
    v_mfma_f32_16x16x32_bf16 a[80:83], v[164:167], v[128:131], a[80:83]
    ds_read_b64_tr_b16 v[108:109], v26 offset:8192
    v_mfma_f32_16x16x32_bf16 a[136:139], v[164:167], v[132:135], a[136:139]
    ds_read_b64_tr_b16 v[110:111], v26 offset:9216
    v_mfma_f32_16x16x32_bf16 a[192:195], v[164:167], v[136:139], a[192:195]
    ds_read_b64_tr_b16 v[112:113], v30 offset:8192
    v_mfma_f32_16x16x32_bf16 a[28:31], v[168:171], v[124:127], a[28:31]
    ds_read_b64_tr_b16 v[114:115], v30 offset:9216
    v_mfma_f32_16x16x32_bf16 a[84:87], v[168:171], v[128:131], a[84:87]
    ds_read_b64_tr_b16 v[116:117], v34 offset:8192
    v_mfma_f32_16x16x32_bf16 a[140:143], v[168:171], v[132:135], a[140:143]
    ds_read_b64_tr_b16 v[118:119], v34 offset:9216
    v_mfma_f32_16x16x32_bf16 a[196:199], v[168:171], v[136:139], a[196:199]
    ds_read_b64_tr_b16 v[120:121], v38 offset:8192
    v_mfma_f32_16x16x32_bf16 a[32:35], v[172:175], v[124:127], a[32:35]
    ds_read_b64_tr_b16 v[122:123], v38 offset:9216
    v_mfma_f32_16x16x32_bf16 a[88:91], v[172:175], v[128:131], a[88:91]
    v_mfma_f32_16x16x32_bf16 a[144:147], v[172:175], v[132:135], a[144:147]
    v_mfma_f32_16x16x32_bf16 a[200:203], v[172:175], v[136:139], a[200:203]
    v_mfma_f32_16x16x32_bf16 a[36:39], v[176:179], v[124:127], a[36:39]
    v_mfma_f32_16x16x32_bf16 a[92:95], v[176:179], v[128:131], a[92:95]
    v_mfma_f32_16x16x32_bf16 a[148:151], v[176:179], v[132:135], a[148:151]
    v_mfma_f32_16x16x32_bf16 a[204:207], v[176:179], v[136:139], a[204:207]
    v_mfma_f32_16x16x32_bf16 a[40:43], v[180:183], v[124:127], a[40:43]
    v_mfma_f32_16x16x32_bf16 a[96:99], v[180:183], v[128:131], a[96:99]
    v_mfma_f32_16x16x32_bf16 a[152:155], v[180:183], v[132:135], a[152:155]
    v_mfma_f32_16x16x32_bf16 a[208:211], v[180:183], v[136:139], a[208:211]
    v_mfma_f32_16x16x32_bf16 a[44:47], v[184:187], v[124:127], a[44:47]
    v_mfma_f32_16x16x32_bf16 a[100:103], v[184:187], v[128:131], a[100:103]
    v_mfma_f32_16x16x32_bf16 a[156:159], v[184:187], v[132:135], a[156:159]
    v_mfma_f32_16x16x32_bf16 a[212:215], v[184:187], v[136:139], a[212:215]
    v_mfma_f32_16x16x32_bf16 a[48:51], v[188:191], v[124:127], a[48:51]
    v_mfma_f32_16x16x32_bf16 a[104:107], v[188:191], v[128:131], a[104:107]
    v_mfma_f32_16x16x32_bf16 a[160:163], v[188:191], v[132:135], a[160:163]
    v_mfma_f32_16x16x32_bf16 a[216:219], v[188:191], v[136:139], a[216:219]
    v_mfma_f32_16x16x32_bf16 a[52:55], v[192:195], v[124:127], a[52:55]
    v_mfma_f32_16x16x32_bf16 a[108:111], v[192:195], v[128:131], a[108:111]
    v_mfma_f32_16x16x32_bf16 a[164:167], v[192:195], v[132:135], a[164:167]
    v_mfma_f32_16x16x32_bf16 a[220:223], v[192:195], v[136:139], a[220:223]
    s_waitcnt lgkmcnt(0)
    v_mfma_f32_16x16x32_bf16 a[0:3], v[68:71], v[52:55], a[0:3]
    v_mfma_f32_16x16x32_bf16 a[56:59], v[68:71], v[56:59], a[56:59]
    s_waitcnt vmcnt(16)
    s_barrier
    s_add_u32 m0, s36, 0
    buffer_load_dwordx4 v2, s[4:7], s28 offen lds
    s_add_u32 m0, s37, 0
    buffer_load_dwordx4 v3, s[4:7], s28 offen lds
    s_add_u32 m0, s38, 0
    buffer_load_dwordx4 v4, s[4:7], s28 offen lds
    s_add_u32 m0, s39, 0
    buffer_load_dwordx4 v5, s[4:7], s28 offen lds
    s_add_u32 m0, s40, 0
    buffer_load_dwordx4 v6, s[8:11], s29 offen lds
    s_add_u32 m0, s41, 0
    buffer_load_dwordx4 v7, s[8:11], s29 offen lds
    s_add_u32 m0, s42, 0
    buffer_load_dwordx4 v8, s[12:15], s29 offen lds
    s_add_u32 m0, s43, 0
    buffer_load_dwordx4 v9, s[12:15], s29 offen lds
    s_add_u32 s28, s28, 64
    s_add_u32 s29, s29, 229376
    ds_read_b128 v[124:127], v11 offset:0
    v_mfma_f32_16x16x32_bf16 a[112:115], v[68:71], v[60:63], a[112:115]
    ds_read_b128 v[128:131], v11 offset:1024
    v_mfma_f32_16x16x32_bf16 a[168:171], v[68:71], v[64:67], a[168:171]
    ds_read_b128 v[132:135], v11 offset:2048
    v_mfma_f32_16x16x32_bf16 a[4:7], v[72:75], v[52:55], a[4:7]
    ds_read_b128 v[136:139], v11 offset:3072
    v_mfma_f32_16x16x32_bf16 a[60:63], v[72:75], v[56:59], a[60:63]
    ds_read_b64_tr_b16 v[140:141], v15 offset:0
    v_mfma_f32_16x16x32_bf16 a[116:119], v[72:75], v[60:63], a[116:119]
    ds_read_b64_tr_b16 v[142:143], v15 offset:1024
    v_mfma_f32_16x16x32_bf16 a[172:175], v[72:75], v[64:67], a[172:175]
    ds_read_b64_tr_b16 v[144:145], v19 offset:0
    v_mfma_f32_16x16x32_bf16 a[8:11], v[76:79], v[52:55], a[8:11]
    ds_read_b64_tr_b16 v[146:147], v19 offset:1024
    v_mfma_f32_16x16x32_bf16 a[64:67], v[76:79], v[56:59], a[64:67]
    ds_read_b64_tr_b16 v[148:149], v23 offset:0
    v_mfma_f32_16x16x32_bf16 a[120:123], v[76:79], v[60:63], a[120:123]
    ds_read_b64_tr_b16 v[150:151], v23 offset:1024
    v_mfma_f32_16x16x32_bf16 a[176:179], v[76:79], v[64:67], a[176:179]
    ds_read_b64_tr_b16 v[152:153], v27 offset:0
    v_mfma_f32_16x16x32_bf16 a[12:15], v[80:83], v[52:55], a[12:15]
    ds_read_b64_tr_b16 v[154:155], v27 offset:1024
    v_mfma_f32_16x16x32_bf16 a[68:71], v[80:83], v[56:59], a[68:71]
    ds_read_b64_tr_b16 v[156:157], v31 offset:0
    v_mfma_f32_16x16x32_bf16 a[124:127], v[80:83], v[60:63], a[124:127]
    ds_read_b64_tr_b16 v[158:159], v31 offset:1024
    v_mfma_f32_16x16x32_bf16 a[180:183], v[80:83], v[64:67], a[180:183]
    ds_read_b64_tr_b16 v[160:161], v35 offset:0
    v_mfma_f32_16x16x32_bf16 a[16:19], v[84:87], v[52:55], a[16:19]
    ds_read_b64_tr_b16 v[162:163], v35 offset:1024
    v_mfma_f32_16x16x32_bf16 a[72:75], v[84:87], v[56:59], a[72:75]
    ds_read_b64_tr_b16 v[164:165], v39 offset:0
    v_mfma_f32_16x16x32_bf16 a[128:131], v[84:87], v[60:63], a[128:131]
    ds_read_b64_tr_b16 v[166:167], v39 offset:1024
    v_mfma_f32_16x16x32_bf16 a[184:187], v[84:87], v[64:67], a[184:187]
    ds_read_b64_tr_b16 v[168:169], v15 offset:8192
    v_mfma_f32_16x16x32_bf16 a[20:23], v[88:91], v[52:55], a[20:23]
    ds_read_b64_tr_b16 v[170:171], v15 offset:9216
    v_mfma_f32_16x16x32_bf16 a[76:79], v[88:91], v[56:59], a[76:79]
    ds_read_b64_tr_b16 v[172:173], v19 offset:8192
    v_mfma_f32_16x16x32_bf16 a[132:135], v[88:91], v[60:63], a[132:135]
    ds_read_b64_tr_b16 v[174:175], v19 offset:9216
    v_mfma_f32_16x16x32_bf16 a[188:191], v[88:91], v[64:67], a[188:191]
    ds_read_b64_tr_b16 v[176:177], v23 offset:8192
    v_mfma_f32_16x16x32_bf16 a[24:27], v[92:95], v[52:55], a[24:27]
    ds_read_b64_tr_b16 v[178:179], v23 offset:9216
    v_mfma_f32_16x16x32_bf16 a[80:83], v[92:95], v[56:59], a[80:83]
    ds_read_b64_tr_b16 v[180:181], v27 offset:8192
    v_mfma_f32_16x16x32_bf16 a[136:139], v[92:95], v[60:63], a[136:139]
    ds_read_b64_tr_b16 v[182:183], v27 offset:9216
    v_mfma_f32_16x16x32_bf16 a[192:195], v[92:95], v[64:67], a[192:195]
    ds_read_b64_tr_b16 v[184:185], v31 offset:8192
    v_mfma_f32_16x16x32_bf16 a[28:31], v[96:99], v[52:55], a[28:31]
    ds_read_b64_tr_b16 v[186:187], v31 offset:9216
    v_mfma_f32_16x16x32_bf16 a[84:87], v[96:99], v[56:59], a[84:87]
    ds_read_b64_tr_b16 v[188:189], v35 offset:8192
    v_mfma_f32_16x16x32_bf16 a[140:143], v[96:99], v[60:63], a[140:143]
    ds_read_b64_tr_b16 v[190:191], v35 offset:9216
    v_mfma_f32_16x16x32_bf16 a[196:199], v[96:99], v[64:67], a[196:199]
    ds_read_b64_tr_b16 v[192:193], v39 offset:8192
    v_mfma_f32_16x16x32_bf16 a[32:35], v[100:103], v[52:55], a[32:35]
    ds_read_b64_tr_b16 v[194:195], v39 offset:9216
    v_mfma_f32_16x16x32_bf16 a[88:91], v[100:103], v[56:59], a[88:91]
    v_mfma_f32_16x16x32_bf16 a[144:147], v[100:103], v[60:63], a[144:147]
    v_mfma_f32_16x16x32_bf16 a[200:203], v[100:103], v[64:67], a[200:203]
    v_mfma_f32_16x16x32_bf16 a[36:39], v[104:107], v[52:55], a[36:39]
    v_mfma_f32_16x16x32_bf16 a[92:95], v[104:107], v[56:59], a[92:95]
    v_mfma_f32_16x16x32_bf16 a[148:151], v[104:107], v[60:63], a[148:151]
    v_mfma_f32_16x16x32_bf16 a[204:207], v[104:107], v[64:67], a[204:207]
    v_mfma_f32_16x16x32_bf16 a[40:43], v[108:111], v[52:55], a[40:43]
    v_mfma_f32_16x16x32_bf16 a[96:99], v[108:111], v[56:59], a[96:99]
    v_mfma_f32_16x16x32_bf16 a[152:155], v[108:111], v[60:63], a[152:155]
    v_mfma_f32_16x16x32_bf16 a[208:211], v[108:111], v[64:67], a[208:211]
    v_mfma_f32_16x16x32_bf16 a[44:47], v[112:115], v[52:55], a[44:47]
    v_mfma_f32_16x16x32_bf16 a[100:103], v[112:115], v[56:59], a[100:103]
    v_mfma_f32_16x16x32_bf16 a[156:159], v[112:115], v[60:63], a[156:159]
    v_mfma_f32_16x16x32_bf16 a[212:215], v[112:115], v[64:67], a[212:215]
    v_mfma_f32_16x16x32_bf16 a[48:51], v[116:119], v[52:55], a[48:51]
    v_mfma_f32_16x16x32_bf16 a[104:107], v[116:119], v[56:59], a[104:107]
    v_mfma_f32_16x16x32_bf16 a[160:163], v[116:119], v[60:63], a[160:163]
    v_mfma_f32_16x16x32_bf16 a[216:219], v[116:119], v[64:67], a[216:219]
    v_mfma_f32_16x16x32_bf16 a[52:55], v[120:123], v[52:55], a[52:55]
    v_mfma_f32_16x16x32_bf16 a[108:111], v[120:123], v[56:59], a[108:111]
    v_mfma_f32_16x16x32_bf16 a[164:167], v[120:123], v[60:63], a[164:167]
    v_mfma_f32_16x16x32_bf16 a[220:223], v[120:123], v[64:67], a[220:223]
    s_waitcnt lgkmcnt(0)
    v_mfma_f32_16x16x32_bf16 a[0:3], v[140:143], v[124:127], a[0:3]
    v_mfma_f32_16x16x32_bf16 a[56:59], v[140:143], v[128:131], a[56:59]
    s_waitcnt vmcnt(16)
    s_barrier
    s_add_u32 m0, s36, 32768
    buffer_load_dwordx4 v2, s[4:7], s28 offen lds
    s_add_u32 m0, s37, 32768
    buffer_load_dwordx4 v3, s[4:7], s28 offen lds
    s_add_u32 m0, s38, 32768
    buffer_load_dwordx4 v4, s[4:7], s28 offen lds
    s_add_u32 m0, s39, 32768
    buffer_load_dwordx4 v5, s[4:7], s28 offen lds
    s_add_u32 m0, s40, 32768
    buffer_load_dwordx4 v6, s[8:11], s29 offen lds
    s_add_u32 m0, s41, 32768
    buffer_load_dwordx4 v7, s[8:11], s29 offen lds
    s_add_u32 m0, s42, 32768
    buffer_load_dwordx4 v8, s[12:15], s29 offen lds
    s_add_u32 m0, s43, 32768
    buffer_load_dwordx4 v9, s[12:15], s29 offen lds
    s_add_u32 s28, s28, 64
    s_add_u32 s29, s29, 229376
    ds_read_b128 v[52:55], v12 offset:0
    v_mfma_f32_16x16x32_bf16 a[112:115], v[140:143], v[132:135], a[112:115]
    ds_read_b128 v[56:59], v12 offset:1024
    v_mfma_f32_16x16x32_bf16 a[168:171], v[140:143], v[136:139], a[168:171]
    ds_read_b128 v[60:63], v12 offset:2048
    v_mfma_f32_16x16x32_bf16 a[4:7], v[144:147], v[124:127], a[4:7]
    ds_read_b128 v[64:67], v12 offset:3072
    v_mfma_f32_16x16x32_bf16 a[60:63], v[144:147], v[128:131], a[60:63]
    ds_read_b64_tr_b16 v[68:69], v16 offset:0
    v_mfma_f32_16x16x32_bf16 a[116:119], v[144:147], v[132:135], a[116:119]
    ds_read_b64_tr_b16 v[70:71], v16 offset:1024
    v_mfma_f32_16x16x32_bf16 a[172:175], v[144:147], v[136:139], a[172:175]
    ds_read_b64_tr_b16 v[72:73], v20 offset:0
    v_mfma_f32_16x16x32_bf16 a[8:11], v[148:151], v[124:127], a[8:11]
    ds_read_b64_tr_b16 v[74:75], v20 offset:1024
    v_mfma_f32_16x16x32_bf16 a[64:67], v[148:151], v[128:131], a[64:67]
    ds_read_b64_tr_b16 v[76:77], v24 offset:0
    v_mfma_f32_16x16x32_bf16 a[120:123], v[148:151], v[132:135], a[120:123]
    ds_read_b64_tr_b16 v[78:79], v24 offset:1024
    v_mfma_f32_16x16x32_bf16 a[176:179], v[148:151], v[136:139], a[176:179]
    ds_read_b64_tr_b16 v[80:81], v28 offset:0
    v_mfma_f32_16x16x32_bf16 a[12:15], v[152:155], v[124:127], a[12:15]
    ds_read_b64_tr_b16 v[82:83], v28 offset:1024
    v_mfma_f32_16x16x32_bf16 a[68:71], v[152:155], v[128:131], a[68:71]
    ds_read_b64_tr_b16 v[84:85], v32 offset:0
    v_mfma_f32_16x16x32_bf16 a[124:127], v[152:155], v[132:135], a[124:127]
    ds_read_b64_tr_b16 v[86:87], v32 offset:1024
    v_mfma_f32_16x16x32_bf16 a[180:183], v[152:155], v[136:139], a[180:183]
    ds_read_b64_tr_b16 v[88:89], v36 offset:0
    v_mfma_f32_16x16x32_bf16 a[16:19], v[156:159], v[124:127], a[16:19]
    ds_read_b64_tr_b16 v[90:91], v36 offset:1024
    v_mfma_f32_16x16x32_bf16 a[72:75], v[156:159], v[128:131], a[72:75]
    ds_read_b64_tr_b16 v[92:93], v40 offset:0
    v_mfma_f32_16x16x32_bf16 a[128:131], v[156:159], v[132:135], a[128:131]
    ds_read_b64_tr_b16 v[94:95], v40 offset:1024
    v_mfma_f32_16x16x32_bf16 a[184:187], v[156:159], v[136:139], a[184:187]
    ds_read_b64_tr_b16 v[96:97], v16 offset:8192
    v_mfma_f32_16x16x32_bf16 a[20:23], v[160:163], v[124:127], a[20:23]
    ds_read_b64_tr_b16 v[98:99], v16 offset:9216
    v_mfma_f32_16x16x32_bf16 a[76:79], v[160:163], v[128:131], a[76:79]
    ds_read_b64_tr_b16 v[100:101], v20 offset:8192
    v_mfma_f32_16x16x32_bf16 a[132:135], v[160:163], v[132:135], a[132:135]
    ds_read_b64_tr_b16 v[102:103], v20 offset:9216
    v_mfma_f32_16x16x32_bf16 a[188:191], v[160:163], v[136:139], a[188:191]
    ds_read_b64_tr_b16 v[104:105], v24 offset:8192
    v_mfma_f32_16x16x32_bf16 a[24:27], v[164:167], v[124:127], a[24:27]
    ds_read_b64_tr_b16 v[106:107], v24 offset:9216
    v_mfma_f32_16x16x32_bf16 a[80:83], v[164:167], v[128:131], a[80:83]
    ds_read_b64_tr_b16 v[108:109], v28 offset:8192
    v_mfma_f32_16x16x32_bf16 a[136:139], v[164:167], v[132:135], a[136:139]
    ds_read_b64_tr_b16 v[110:111], v28 offset:9216
    v_mfma_f32_16x16x32_bf16 a[192:195], v[164:167], v[136:139], a[192:195]
    ds_read_b64_tr_b16 v[112:113], v32 offset:8192
    v_mfma_f32_16x16x32_bf16 a[28:31], v[168:171], v[124:127], a[28:31]
    ds_read_b64_tr_b16 v[114:115], v32 offset:9216
    v_mfma_f32_16x16x32_bf16 a[84:87], v[168:171], v[128:131], a[84:87]
    ds_read_b64_tr_b16 v[116:117], v36 offset:8192
    v_mfma_f32_16x16x32_bf16 a[140:143], v[168:171], v[132:135], a[140:143]
    ds_read_b64_tr_b16 v[118:119], v36 offset:9216
    v_mfma_f32_16x16x32_bf16 a[196:199], v[168:171], v[136:139], a[196:199]
    ds_read_b64_tr_b16 v[120:121], v40 offset:8192
    v_mfma_f32_16x16x32_bf16 a[32:35], v[172:175], v[124:127], a[32:35]
    ds_read_b64_tr_b16 v[122:123], v40 offset:9216
    v_mfma_f32_16x16x32_bf16 a[88:91], v[172:175], v[128:131], a[88:91]
    v_mfma_f32_16x16x32_bf16 a[144:147], v[172:175], v[132:135], a[144:147]
    v_mfma_f32_16x16x32_bf16 a[200:203], v[172:175], v[136:139], a[200:203]
    v_mfma_f32_16x16x32_bf16 a[36:39], v[176:179], v[124:127], a[36:39]
    v_mfma_f32_16x16x32_bf16 a[92:95], v[176:179], v[128:131], a[92:95]
    v_mfma_f32_16x16x32_bf16 a[148:151], v[176:179], v[132:135], a[148:151]
    v_mfma_f32_16x16x32_bf16 a[204:207], v[176:179], v[136:139], a[204:207]
    v_mfma_f32_16x16x32_bf16 a[40:43], v[180:183], v[124:127], a[40:43]
    v_mfma_f32_16x16x32_bf16 a[96:99], v[180:183], v[128:131], a[96:99]
    v_mfma_f32_16x16x32_bf16 a[152:155], v[180:183], v[132:135], a[152:155]
    v_mfma_f32_16x16x32_bf16 a[208:211], v[180:183], v[136:139], a[208:211]
    v_mfma_f32_16x16x32_bf16 a[44:47], v[184:187], v[124:127], a[44:47]
    v_mfma_f32_16x16x32_bf16 a[100:103], v[184:187], v[128:131], a[100:103]
    v_mfma_f32_16x16x32_bf16 a[156:159], v[184:187], v[132:135], a[156:159]
    v_mfma_f32_16x16x32_bf16 a[212:215], v[184:187], v[136:139], a[212:215]
    v_mfma_f32_16x16x32_bf16 a[48:51], v[188:191], v[124:127], a[48:51]
    v_mfma_f32_16x16x32_bf16 a[104:107], v[188:191], v[128:131], a[104:107]
    v_mfma_f32_16x16x32_bf16 a[160:163], v[188:191], v[132:135], a[160:163]
    v_mfma_f32_16x16x32_bf16 a[216:219], v[188:191], v[136:139], a[216:219]
    v_mfma_f32_16x16x32_bf16 a[52:55], v[192:195], v[124:127], a[52:55]
    v_mfma_f32_16x16x32_bf16 a[108:111], v[192:195], v[128:131], a[108:111]
    v_mfma_f32_16x16x32_bf16 a[164:167], v[192:195], v[132:135], a[164:167]
    v_mfma_f32_16x16x32_bf16 a[220:223], v[192:195], v[136:139], a[220:223]
    s_waitcnt lgkmcnt(0)
    v_mfma_f32_16x16x32_bf16 a[0:3], v[68:71], v[52:55], a[0:3]
    v_mfma_f32_16x16x32_bf16 a[56:59], v[68:71], v[56:59], a[56:59]
    s_waitcnt vmcnt(16)
    s_barrier
    s_add_u32 m0, s36, 65536
    buffer_load_dwordx4 v2, s[4:7], s28 offen lds
    s_add_u32 m0, s37, 65536
    buffer_load_dwordx4 v3, s[4:7], s28 offen lds
    s_add_u32 m0, s38, 65536
    buffer_load_dwordx4 v4, s[4:7], s28 offen lds
    s_add_u32 m0, s39, 65536
    buffer_load_dwordx4 v5, s[4:7], s28 offen lds
    s_add_u32 m0, s40, 65536
    buffer_load_dwordx4 v6, s[8:11], s29 offen lds
    s_add_u32 m0, s41, 65536
    buffer_load_dwordx4 v7, s[8:11], s29 offen lds
    s_add_u32 m0, s42, 65536
    buffer_load_dwordx4 v8, s[12:15], s29 offen lds
    s_add_u32 m0, s43, 65536
    buffer_load_dwordx4 v9, s[12:15], s29 offen lds
    s_add_u32 s28, s28, 64
    s_add_u32 s29, s29, 229376
    ds_read_b128 v[124:127], v13 offset:0
    v_mfma_f32_16x16x32_bf16 a[112:115], v[68:71], v[60:63], a[112:115]
    ds_read_b128 v[128:131], v13 offset:1024
    v_mfma_f32_16x16x32_bf16 a[168:171], v[68:71], v[64:67], a[168:171]
    ds_read_b128 v[132:135], v13 offset:2048
    v_mfma_f32_16x16x32_bf16 a[4:7], v[72:75], v[52:55], a[4:7]
    ds_read_b128 v[136:139], v13 offset:3072
    v_mfma_f32_16x16x32_bf16 a[60:63], v[72:75], v[56:59], a[60:63]
    ds_read_b64_tr_b16 v[140:141], v17 offset:0
    v_mfma_f32_16x16x32_bf16 a[116:119], v[72:75], v[60:63], a[116:119]
    ds_read_b64_tr_b16 v[142:143], v17 offset:1024
    v_mfma_f32_16x16x32_bf16 a[172:175], v[72:75], v[64:67], a[172:175]
    ds_read_b64_tr_b16 v[144:145], v21 offset:0
    v_mfma_f32_16x16x32_bf16 a[8:11], v[76:79], v[52:55], a[8:11]
    ds_read_b64_tr_b16 v[146:147], v21 offset:1024
    v_mfma_f32_16x16x32_bf16 a[64:67], v[76:79], v[56:59], a[64:67]
    ds_read_b64_tr_b16 v[148:149], v25 offset:0
    v_mfma_f32_16x16x32_bf16 a[120:123], v[76:79], v[60:63], a[120:123]
    ds_read_b64_tr_b16 v[150:151], v25 offset:1024
    v_mfma_f32_16x16x32_bf16 a[176:179], v[76:79], v[64:67], a[176:179]
    ds_read_b64_tr_b16 v[152:153], v29 offset:0
    v_mfma_f32_16x16x32_bf16 a[12:15], v[80:83], v[52:55], a[12:15]
    ds_read_b64_tr_b16 v[154:155], v29 offset:1024
    v_mfma_f32_16x16x32_bf16 a[68:71], v[80:83], v[56:59], a[68:71]
    ds_read_b64_tr_b16 v[156:157], v33 offset:0
    v_mfma_f32_16x16x32_bf16 a[124:127], v[80:83], v[60:63], a[124:127]
    ds_read_b64_tr_b16 v[158:159], v33 offset:1024
    v_mfma_f32_16x16x32_bf16 a[180:183], v[80:83], v[64:67], a[180:183]
    ds_read_b64_tr_b16 v[160:161], v37 offset:0
    v_mfma_f32_16x16x32_bf16 a[16:19], v[84:87], v[52:55], a[16:19]
    ds_read_b64_tr_b16 v[162:163], v37 offset:1024
    v_mfma_f32_16x16x32_bf16 a[72:75], v[84:87], v[56:59], a[72:75]
    ds_read_b64_tr_b16 v[164:165], v41 offset:0
    v_mfma_f32_16x16x32_bf16 a[128:131], v[84:87], v[60:63], a[128:131]
    ds_read_b64_tr_b16 v[166:167], v41 offset:1024
    v_mfma_f32_16x16x32_bf16 a[184:187], v[84:87], v[64:67], a[184:187]
    ds_read_b64_tr_b16 v[168:169], v17 offset:8192
    v_mfma_f32_16x16x32_bf16 a[20:23], v[88:91], v[52:55], a[20:23]
    ds_read_b64_tr_b16 v[170:171], v17 offset:9216
    v_mfma_f32_16x16x32_bf16 a[76:79], v[88:91], v[56:59], a[76:79]
    ds_read_b64_tr_b16 v[172:173], v21 offset:8192
    v_mfma_f32_16x16x32_bf16 a[132:135], v[88:91], v[60:63], a[132:135]
    ds_read_b64_tr_b16 v[174:175], v21 offset:9216
    v_mfma_f32_16x16x32_bf16 a[188:191], v[88:91], v[64:67], a[188:191]
    ds_read_b64_tr_b16 v[176:177], v25 offset:8192
    v_mfma_f32_16x16x32_bf16 a[24:27], v[92:95], v[52:55], a[24:27]
    ds_read_b64_tr_b16 v[178:179], v25 offset:9216
    v_mfma_f32_16x16x32_bf16 a[80:83], v[92:95], v[56:59], a[80:83]
    ds_read_b64_tr_b16 v[180:181], v29 offset:8192
    v_mfma_f32_16x16x32_bf16 a[136:139], v[92:95], v[60:63], a[136:139]
    ds_read_b64_tr_b16 v[182:183], v29 offset:9216
    v_mfma_f32_16x16x32_bf16 a[192:195], v[92:95], v[64:67], a[192:195]
    ds_read_b64_tr_b16 v[184:185], v33 offset:8192
    v_mfma_f32_16x16x32_bf16 a[28:31], v[96:99], v[52:55], a[28:31]
    ds_read_b64_tr_b16 v[186:187], v33 offset:9216
    v_mfma_f32_16x16x32_bf16 a[84:87], v[96:99], v[56:59], a[84:87]
    ds_read_b64_tr_b16 v[188:189], v37 offset:8192
    v_mfma_f32_16x16x32_bf16 a[140:143], v[96:99], v[60:63], a[140:143]
    ds_read_b64_tr_b16 v[190:191], v37 offset:9216
    v_mfma_f32_16x16x32_bf16 a[196:199], v[96:99], v[64:67], a[196:199]
    ds_read_b64_tr_b16 v[192:193], v41 offset:8192
    v_mfma_f32_16x16x32_bf16 a[32:35], v[100:103], v[52:55], a[32:35]
    ds_read_b64_tr_b16 v[194:195], v41 offset:9216
    v_mfma_f32_16x16x32_bf16 a[88:91], v[100:103], v[56:59], a[88:91]
    v_mfma_f32_16x16x32_bf16 a[144:147], v[100:103], v[60:63], a[144:147]
    v_mfma_f32_16x16x32_bf16 a[200:203], v[100:103], v[64:67], a[200:203]
    v_mfma_f32_16x16x32_bf16 a[36:39], v[104:107], v[52:55], a[36:39]
    v_mfma_f32_16x16x32_bf16 a[92:95], v[104:107], v[56:59], a[92:95]
    v_mfma_f32_16x16x32_bf16 a[148:151], v[104:107], v[60:63], a[148:151]
    v_mfma_f32_16x16x32_bf16 a[204:207], v[104:107], v[64:67], a[204:207]
    v_mfma_f32_16x16x32_bf16 a[40:43], v[108:111], v[52:55], a[40:43]
    v_mfma_f32_16x16x32_bf16 a[96:99], v[108:111], v[56:59], a[96:99]
    v_mfma_f32_16x16x32_bf16 a[152:155], v[108:111], v[60:63], a[152:155]
    v_mfma_f32_16x16x32_bf16 a[208:211], v[108:111], v[64:67], a[208:211]
    v_mfma_f32_16x16x32_bf16 a[44:47], v[112:115], v[52:55], a[44:47]
    v_mfma_f32_16x16x32_bf16 a[100:103], v[112:115], v[56:59], a[100:103]
    v_mfma_f32_16x16x32_bf16 a[156:159], v[112:115], v[60:63], a[156:159]
    v_mfma_f32_16x16x32_bf16 a[212:215], v[112:115], v[64:67], a[212:215]
    v_mfma_f32_16x16x32_bf16 a[48:51], v[116:119], v[52:55], a[48:51]
    v_mfma_f32_16x16x32_bf16 a[104:107], v[116:119], v[56:59], a[104:107]
    v_mfma_f32_16x16x32_bf16 a[160:163], v[116:119], v[60:63], a[160:163]
    v_mfma_f32_16x16x32_bf16 a[216:219], v[116:119], v[64:67], a[216:219]
    v_mfma_f32_16x16x32_bf16 a[52:55], v[120:123], v[52:55], a[52:55]
    v_mfma_f32_16x16x32_bf16 a[108:111], v[120:123], v[56:59], a[108:111]
    v_mfma_f32_16x16x32_bf16 a[164:167], v[120:123], v[60:63], a[164:167]
    v_mfma_f32_16x16x32_bf16 a[220:223], v[120:123], v[64:67], a[220:223]
    s_waitcnt lgkmcnt(0)
    v_mfma_f32_16x16x32_bf16 a[0:3], v[140:143], v[124:127], a[0:3]
    v_mfma_f32_16x16x32_bf16 a[56:59], v[140:143], v[128:131], a[56:59]
    s_waitcnt vmcnt(16)
    s_barrier
    s_add_u32 m0, s36, 98304
    buffer_load_dwordx4 v2, s[4:7], s28 offen lds
    s_add_u32 m0, s37, 98304
    buffer_load_dwordx4 v3, s[4:7], s28 offen lds
    s_add_u32 m0, s38, 98304
    buffer_load_dwordx4 v4, s[4:7], s28 offen lds
    s_add_u32 m0, s39, 98304
    buffer_load_dwordx4 v5, s[4:7], s28 offen lds
    s_add_u32 m0, s40, 98304
    buffer_load_dwordx4 v6, s[8:11], s29 offen lds
    s_add_u32 m0, s41, 98304
    buffer_load_dwordx4 v7, s[8:11], s29 offen lds
    s_add_u32 m0, s42, 98304
    buffer_load_dwordx4 v8, s[12:15], s29 offen lds
    s_add_u32 m0, s43, 98304
    buffer_load_dwordx4 v9, s[12:15], s29 offen lds
    s_add_u32 s28, s28, 64
    s_add_u32 s29, s29, 229376
    ds_read_b128 v[52:55], v10 offset:0
    v_mfma_f32_16x16x32_bf16 a[112:115], v[140:143], v[132:135], a[112:115]
    ds_read_b128 v[56:59], v10 offset:1024
    v_mfma_f32_16x16x32_bf16 a[168:171], v[140:143], v[136:139], a[168:171]
    ds_read_b128 v[60:63], v10 offset:2048
    v_mfma_f32_16x16x32_bf16 a[4:7], v[144:147], v[124:127], a[4:7]
    ds_read_b128 v[64:67], v10 offset:3072
    v_mfma_f32_16x16x32_bf16 a[60:63], v[144:147], v[128:131], a[60:63]
    ds_read_b64_tr_b16 v[68:69], v14 offset:0
    v_mfma_f32_16x16x32_bf16 a[116:119], v[144:147], v[132:135], a[116:119]
    ds_read_b64_tr_b16 v[70:71], v14 offset:1024
    v_mfma_f32_16x16x32_bf16 a[172:175], v[144:147], v[136:139], a[172:175]
    ds_read_b64_tr_b16 v[72:73], v18 offset:0
    v_mfma_f32_16x16x32_bf16 a[8:11], v[148:151], v[124:127], a[8:11]
    ds_read_b64_tr_b16 v[74:75], v18 offset:1024
    v_mfma_f32_16x16x32_bf16 a[64:67], v[148:151], v[128:131], a[64:67]
    ds_read_b64_tr_b16 v[76:77], v22 offset:0
    v_mfma_f32_16x16x32_bf16 a[120:123], v[148:151], v[132:135], a[120:123]
    ds_read_b64_tr_b16 v[78:79], v22 offset:1024
    v_mfma_f32_16x16x32_bf16 a[176:179], v[148:151], v[136:139], a[176:179]
    ds_read_b64_tr_b16 v[80:81], v26 offset:0
    v_mfma_f32_16x16x32_bf16 a[12:15], v[152:155], v[124:127], a[12:15]
    ds_read_b64_tr_b16 v[82:83], v26 offset:1024
    v_mfma_f32_16x16x32_bf16 a[68:71], v[152:155], v[128:131], a[68:71]
    ds_read_b64_tr_b16 v[84:85], v30 offset:0
    v_mfma_f32_16x16x32_bf16 a[124:127], v[152:155], v[132:135], a[124:127]
    ds_read_b64_tr_b16 v[86:87], v30 offset:1024
    v_mfma_f32_16x16x32_bf16 a[180:183], v[152:155], v[136:139], a[180:183]
    ds_read_b64_tr_b16 v[88:89], v34 offset:0
    v_mfma_f32_16x16x32_bf16 a[16:19], v[156:159], v[124:127], a[16:19]
    ds_read_b64_tr_b16 v[90:91], v34 offset:1024
    v_mfma_f32_16x16x32_bf16 a[72:75], v[156:159], v[128:131], a[72:75]
    ds_read_b64_tr_b16 v[92:93], v38 offset:0
    v_mfma_f32_16x16x32_bf16 a[128:131], v[156:159], v[132:135], a[128:131]
    ds_read_b64_tr_b16 v[94:95], v38 offset:1024
    v_mfma_f32_16x16x32_bf16 a[184:187], v[156:159], v[136:139], a[184:187]
    ds_read_b64_tr_b16 v[96:97], v14 offset:8192
    v_mfma_f32_16x16x32_bf16 a[20:23], v[160:163], v[124:127], a[20:23]
    ds_read_b64_tr_b16 v[98:99], v14 offset:9216
    v_mfma_f32_16x16x32_bf16 a[76:79], v[160:163], v[128:131], a[76:79]
    ds_read_b64_tr_b16 v[100:101], v18 offset:8192
    v_mfma_f32_16x16x32_bf16 a[132:135], v[160:163], v[132:135], a[132:135]
    ds_read_b64_tr_b16 v[102:103], v18 offset:9216
    v_mfma_f32_16x16x32_bf16 a[188:191], v[160:163], v[136:139], a[188:191]
    ds_read_b64_tr_b16 v[104:105], v22 offset:8192
    v_mfma_f32_16x16x32_bf16 a[24:27], v[164:167], v[124:127], a[24:27]
    ds_read_b64_tr_b16 v[106:107], v22 offset:9216
    v_mfma_f32_16x16x32_bf16 a[80:83], v[164:167], v[128:131], a[80:83]
    ds_read_b64_tr_b16 v[108:109], v26 offset:8192
    v_mfma_f32_16x16x32_bf16 a[136:139], v[164:167], v[132:135], a[136:139]
    ds_read_b64_tr_b16 v[110:111], v26 offset:9216
    v_mfma_f32_16x16x32_bf16 a[192:195], v[164:167], v[136:139], a[192:195]
    ds_read_b64_tr_b16 v[112:113], v30 offset:8192
    v_mfma_f32_16x16x32_bf16 a[28:31], v[168:171], v[124:127], a[28:31]
    ds_read_b64_tr_b16 v[114:115], v30 offset:9216
    v_mfma_f32_16x16x32_bf16 a[84:87], v[168:171], v[128:131], a[84:87]
    ds_read_b64_tr_b16 v[116:117], v34 offset:8192
    v_mfma_f32_16x16x32_bf16 a[140:143], v[168:171], v[132:135], a[140:143]
    ds_read_b64_tr_b16 v[118:119], v34 offset:9216
    v_mfma_f32_16x16x32_bf16 a[196:199], v[168:171], v[136:139], a[196:199]
    ds_read_b64_tr_b16 v[120:121], v38 offset:8192
    v_mfma_f32_16x16x32_bf16 a[32:35], v[172:175], v[124:127], a[32:35]
    ds_read_b64_tr_b16 v[122:123], v38 offset:9216
    v_mfma_f32_16x16x32_bf16 a[88:91], v[172:175], v[128:131], a[88:91]
    v_mfma_f32_16x16x32_bf16 a[144:147], v[172:175], v[132:135], a[144:147]
    v_mfma_f32_16x16x32_bf16 a[200:203], v[172:175], v[136:139], a[200:203]
    v_mfma_f32_16x16x32_bf16 a[36:39], v[176:179], v[124:127], a[36:39]
    v_mfma_f32_16x16x32_bf16 a[92:95], v[176:179], v[128:131], a[92:95]
    v_mfma_f32_16x16x32_bf16 a[148:151], v[176:179], v[132:135], a[148:151]
    v_mfma_f32_16x16x32_bf16 a[204:207], v[176:179], v[136:139], a[204:207]
    v_mfma_f32_16x16x32_bf16 a[40:43], v[180:183], v[124:127], a[40:43]
    v_mfma_f32_16x16x32_bf16 a[96:99], v[180:183], v[128:131], a[96:99]
    v_mfma_f32_16x16x32_bf16 a[152:155], v[180:183], v[132:135], a[152:155]
    v_mfma_f32_16x16x32_bf16 a[208:211], v[180:183], v[136:139], a[208:211]
    v_mfma_f32_16x16x32_bf16 a[44:47], v[184:187], v[124:127], a[44:47]
    v_mfma_f32_16x16x32_bf16 a[100:103], v[184:187], v[128:131], a[100:103]
    v_mfma_f32_16x16x32_bf16 a[156:159], v[184:187], v[132:135], a[156:159]
    v_mfma_f32_16x16x32_bf16 a[212:215], v[184:187], v[136:139], a[212:215]
    v_mfma_f32_16x16x32_bf16 a[48:51], v[188:191], v[124:127], a[48:51]
    v_mfma_f32_16x16x32_bf16 a[104:107], v[188:191], v[128:131], a[104:107]
    v_mfma_f32_16x16x32_bf16 a[160:163], v[188:191], v[132:135], a[160:163]
    v_mfma_f32_16x16x32_bf16 a[216:219], v[188:191], v[136:139], a[216:219]
    v_mfma_f32_16x16x32_bf16 a[52:55], v[192:195], v[124:127], a[52:55]
    v_mfma_f32_16x16x32_bf16 a[108:111], v[192:195], v[128:131], a[108:111]
    v_mfma_f32_16x16x32_bf16 a[164:167], v[192:195], v[132:135], a[164:167]
    v_mfma_f32_16x16x32_bf16 a[220:223], v[192:195], v[136:139], a[220:223]
    s_waitcnt lgkmcnt(0)
    v_mfma_f32_16x16x32_bf16 a[0:3], v[68:71], v[52:55], a[0:3]
    v_mfma_f32_16x16x32_bf16 a[56:59], v[68:71], v[56:59], a[56:59]
    s_waitcnt vmcnt(16)
    s_barrier
    s_add_u32 m0, s36, 0
    buffer_load_dwordx4 v2, s[4:7], s28 offen lds
    s_add_u32 m0, s37, 0
    buffer_load_dwordx4 v3, s[4:7], s28 offen lds
    s_add_u32 m0, s38, 0
    buffer_load_dwordx4 v4, s[4:7], s28 offen lds
    s_add_u32 m0, s39, 0
    buffer_load_dwordx4 v5, s[4:7], s28 offen lds
    s_add_u32 m0, s40, 0
    buffer_load_dwordx4 v6, s[8:11], s29 offen lds
    s_add_u32 m0, s41, 0
    buffer_load_dwordx4 v7, s[8:11], s29 offen lds
    s_add_u32 m0, s42, 0
    buffer_load_dwordx4 v8, s[12:15], s29 offen lds
    s_add_u32 m0, s43, 0
    buffer_load_dwordx4 v9, s[12:15], s29 offen lds
    s_add_u32 s28, s28, 64
    s_add_u32 s29, s29, 229376
    ds_read_b128 v[124:127], v11 offset:0
    v_mfma_f32_16x16x32_bf16 a[112:115], v[68:71], v[60:63], a[112:115]
    ds_read_b128 v[128:131], v11 offset:1024
    v_mfma_f32_16x16x32_bf16 a[168:171], v[68:71], v[64:67], a[168:171]
    ds_read_b128 v[132:135], v11 offset:2048
    v_mfma_f32_16x16x32_bf16 a[4:7], v[72:75], v[52:55], a[4:7]
    ds_read_b128 v[136:139], v11 offset:3072
    v_mfma_f32_16x16x32_bf16 a[60:63], v[72:75], v[56:59], a[60:63]
    ds_read_b64_tr_b16 v[140:141], v15 offset:0
    v_mfma_f32_16x16x32_bf16 a[116:119], v[72:75], v[60:63], a[116:119]
    ds_read_b64_tr_b16 v[142:143], v15 offset:1024
    v_mfma_f32_16x16x32_bf16 a[172:175], v[72:75], v[64:67], a[172:175]
    ds_read_b64_tr_b16 v[144:145], v19 offset:0
    v_mfma_f32_16x16x32_bf16 a[8:11], v[76:79], v[52:55], a[8:11]
    ds_read_b64_tr_b16 v[146:147], v19 offset:1024
    v_mfma_f32_16x16x32_bf16 a[64:67], v[76:79], v[56:59], a[64:67]
    ds_read_b64_tr_b16 v[148:149], v23 offset:0
    v_mfma_f32_16x16x32_bf16 a[120:123], v[76:79], v[60:63], a[120:123]
    ds_read_b64_tr_b16 v[150:151], v23 offset:1024
    v_mfma_f32_16x16x32_bf16 a[176:179], v[76:79], v[64:67], a[176:179]
    ds_read_b64_tr_b16 v[152:153], v27 offset:0
    v_mfma_f32_16x16x32_bf16 a[12:15], v[80:83], v[52:55], a[12:15]
    ds_read_b64_tr_b16 v[154:155], v27 offset:1024
    v_mfma_f32_16x16x32_bf16 a[68:71], v[80:83], v[56:59], a[68:71]
    ds_read_b64_tr_b16 v[156:157], v31 offset:0
    v_mfma_f32_16x16x32_bf16 a[124:127], v[80:83], v[60:63], a[124:127]
    ds_read_b64_tr_b16 v[158:159], v31 offset:1024
    v_mfma_f32_16x16x32_bf16 a[180:183], v[80:83], v[64:67], a[180:183]
    ds_read_b64_tr_b16 v[160:161], v35 offset:0
    v_mfma_f32_16x16x32_bf16 a[16:19], v[84:87], v[52:55], a[16:19]
    ds_read_b64_tr_b16 v[162:163], v35 offset:1024
    v_mfma_f32_16x16x32_bf16 a[72:75], v[84:87], v[56:59], a[72:75]
    ds_read_b64_tr_b16 v[164:165], v39 offset:0
    v_mfma_f32_16x16x32_bf16 a[128:131], v[84:87], v[60:63], a[128:131]
    ds_read_b64_tr_b16 v[166:167], v39 offset:1024
    v_mfma_f32_16x16x32_bf16 a[184:187], v[84:87], v[64:67], a[184:187]
    ds_read_b64_tr_b16 v[168:169], v15 offset:8192
    v_mfma_f32_16x16x32_bf16 a[20:23], v[88:91], v[52:55], a[20:23]
    ds_read_b64_tr_b16 v[170:171], v15 offset:9216
    v_mfma_f32_16x16x32_bf16 a[76:79], v[88:91], v[56:59], a[76:79]
    ds_read_b64_tr_b16 v[172:173], v19 offset:8192
    v_mfma_f32_16x16x32_bf16 a[132:135], v[88:91], v[60:63], a[132:135]
    ds_read_b64_tr_b16 v[174:175], v19 offset:9216
    v_mfma_f32_16x16x32_bf16 a[188:191], v[88:91], v[64:67], a[188:191]
    ds_read_b64_tr_b16 v[176:177], v23 offset:8192
    v_mfma_f32_16x16x32_bf16 a[24:27], v[92:95], v[52:55], a[24:27]
    ds_read_b64_tr_b16 v[178:179], v23 offset:9216
    v_mfma_f32_16x16x32_bf16 a[80:83], v[92:95], v[56:59], a[80:83]
    ds_read_b64_tr_b16 v[180:181], v27 offset:8192
    v_mfma_f32_16x16x32_bf16 a[136:139], v[92:95], v[60:63], a[136:139]
    ds_read_b64_tr_b16 v[182:183], v27 offset:9216
    v_mfma_f32_16x16x32_bf16 a[192:195], v[92:95], v[64:67], a[192:195]
    ds_read_b64_tr_b16 v[184:185], v31 offset:8192
    v_mfma_f32_16x16x32_bf16 a[28:31], v[96:99], v[52:55], a[28:31]
    ds_read_b64_tr_b16 v[186:187], v31 offset:9216
    v_mfma_f32_16x16x32_bf16 a[84:87], v[96:99], v[56:59], a[84:87]
    ds_read_b64_tr_b16 v[188:189], v35 offset:8192
    v_mfma_f32_16x16x32_bf16 a[140:143], v[96:99], v[60:63], a[140:143]
    ds_read_b64_tr_b16 v[190:191], v35 offset:9216
    v_mfma_f32_16x16x32_bf16 a[196:199], v[96:99], v[64:67], a[196:199]
    ds_read_b64_tr_b16 v[192:193], v39 offset:8192
    v_mfma_f32_16x16x32_bf16 a[32:35], v[100:103], v[52:55], a[32:35]
    ds_read_b64_tr_b16 v[194:195], v39 offset:9216
    v_mfma_f32_16x16x32_bf16 a[88:91], v[100:103], v[56:59], a[88:91]
    v_mfma_f32_16x16x32_bf16 a[144:147], v[100:103], v[60:63], a[144:147]
    v_mfma_f32_16x16x32_bf16 a[200:203], v[100:103], v[64:67], a[200:203]
    v_mfma_f32_16x16x32_bf16 a[36:39], v[104:107], v[52:55], a[36:39]
    v_mfma_f32_16x16x32_bf16 a[92:95], v[104:107], v[56:59], a[92:95]
    v_mfma_f32_16x16x32_bf16 a[148:151], v[104:107], v[60:63], a[148:151]
    v_mfma_f32_16x16x32_bf16 a[204:207], v[104:107], v[64:67], a[204:207]
    v_mfma_f32_16x16x32_bf16 a[40:43], v[108:111], v[52:55], a[40:43]
    v_mfma_f32_16x16x32_bf16 a[96:99], v[108:111], v[56:59], a[96:99]
    v_mfma_f32_16x16x32_bf16 a[152:155], v[108:111], v[60:63], a[152:155]
    v_mfma_f32_16x16x32_bf16 a[208:211], v[108:111], v[64:67], a[208:211]
    v_mfma_f32_16x16x32_bf16 a[44:47], v[112:115], v[52:55], a[44:47]
    v_mfma_f32_16x16x32_bf16 a[100:103], v[112:115], v[56:59], a[100:103]
    v_mfma_f32_16x16x32_bf16 a[156:159], v[112:115], v[60:63], a[156:159]
    v_mfma_f32_16x16x32_bf16 a[212:215], v[112:115], v[64:67], a[212:215]
    v_mfma_f32_16x16x32_bf16 a[48:51], v[116:119], v[52:55], a[48:51]
    v_mfma_f32_16x16x32_bf16 a[104:107], v[116:119], v[56:59], a[104:107]
    v_mfma_f32_16x16x32_bf16 a[160:163], v[116:119], v[60:63], a[160:163]
    v_mfma_f32_16x16x32_bf16 a[216:219], v[116:119], v[64:67], a[216:219]
    v_mfma_f32_16x16x32_bf16 a[52:55], v[120:123], v[52:55], a[52:55]
    v_mfma_f32_16x16x32_bf16 a[108:111], v[120:123], v[56:59], a[108:111]
    v_mfma_f32_16x16x32_bf16 a[164:167], v[120:123], v[60:63], a[164:167]
    v_mfma_f32_16x16x32_bf16 a[220:223], v[120:123], v[64:67], a[220:223]
    s_waitcnt lgkmcnt(0)
    v_mfma_f32_16x16x32_bf16 a[0:3], v[140:143], v[124:127], a[0:3]
    v_mfma_f32_16x16x32_bf16 a[56:59], v[140:143], v[128:131], a[56:59]
    s_waitcnt vmcnt(16)
    s_barrier
    s_add_u32 m0, s36, 32768
    buffer_load_dwordx4 v2, s[4:7], s28 offen lds
    s_add_u32 m0, s37, 32768
    buffer_load_dwordx4 v3, s[4:7], s28 offen lds
    s_add_u32 m0, s38, 32768
    buffer_load_dwordx4 v4, s[4:7], s28 offen lds
    s_add_u32 m0, s39, 32768
    buffer_load_dwordx4 v5, s[4:7], s28 offen lds
    s_add_u32 m0, s40, 32768
    buffer_load_dwordx4 v6, s[8:11], s29 offen lds
    s_add_u32 m0, s41, 32768
    buffer_load_dwordx4 v7, s[8:11], s29 offen lds
    s_add_u32 m0, s42, 32768
    buffer_load_dwordx4 v8, s[12:15], s29 offen lds
    s_add_u32 m0, s43, 32768
    buffer_load_dwordx4 v9, s[12:15], s29 offen lds
    s_add_u32 s28, s28, 64
    s_add_u32 s29, s29, 229376
    ds_read_b128 v[52:55], v12 offset:0
    v_mfma_f32_16x16x32_bf16 a[112:115], v[140:143], v[132:135], a[112:115]
    ds_read_b128 v[56:59], v12 offset:1024
    v_mfma_f32_16x16x32_bf16 a[168:171], v[140:143], v[136:139], a[168:171]
    ds_read_b128 v[60:63], v12 offset:2048
    v_mfma_f32_16x16x32_bf16 a[4:7], v[144:147], v[124:127], a[4:7]
    ds_read_b128 v[64:67], v12 offset:3072
    v_mfma_f32_16x16x32_bf16 a[60:63], v[144:147], v[128:131], a[60:63]
    ds_read_b64_tr_b16 v[68:69], v16 offset:0
    v_mfma_f32_16x16x32_bf16 a[116:119], v[144:147], v[132:135], a[116:119]
    ds_read_b64_tr_b16 v[70:71], v16 offset:1024
    v_mfma_f32_16x16x32_bf16 a[172:175], v[144:147], v[136:139], a[172:175]
    ds_read_b64_tr_b16 v[72:73], v20 offset:0
    v_mfma_f32_16x16x32_bf16 a[8:11], v[148:151], v[124:127], a[8:11]
    ds_read_b64_tr_b16 v[74:75], v20 offset:1024
    v_mfma_f32_16x16x32_bf16 a[64:67], v[148:151], v[128:131], a[64:67]
    ds_read_b64_tr_b16 v[76:77], v24 offset:0
    v_mfma_f32_16x16x32_bf16 a[120:123], v[148:151], v[132:135], a[120:123]
    ds_read_b64_tr_b16 v[78:79], v24 offset:1024
    v_mfma_f32_16x16x32_bf16 a[176:179], v[148:151], v[136:139], a[176:179]
    ds_read_b64_tr_b16 v[80:81], v28 offset:0
    v_mfma_f32_16x16x32_bf16 a[12:15], v[152:155], v[124:127], a[12:15]
    ds_read_b64_tr_b16 v[82:83], v28 offset:1024
    v_mfma_f32_16x16x32_bf16 a[68:71], v[152:155], v[128:131], a[68:71]
    ds_read_b64_tr_b16 v[84:85], v32 offset:0
    v_mfma_f32_16x16x32_bf16 a[124:127], v[152:155], v[132:135], a[124:127]
    ds_read_b64_tr_b16 v[86:87], v32 offset:1024
    v_mfma_f32_16x16x32_bf16 a[180:183], v[152:155], v[136:139], a[180:183]
    ds_read_b64_tr_b16 v[88:89], v36 offset:0
    v_mfma_f32_16x16x32_bf16 a[16:19], v[156:159], v[124:127], a[16:19]
    ds_read_b64_tr_b16 v[90:91], v36 offset:1024
    v_mfma_f32_16x16x32_bf16 a[72:75], v[156:159], v[128:131], a[72:75]
    ds_read_b64_tr_b16 v[92:93], v40 offset:0
    v_mfma_f32_16x16x32_bf16 a[128:131], v[156:159], v[132:135], a[128:131]
    ds_read_b64_tr_b16 v[94:95], v40 offset:1024
    v_mfma_f32_16x16x32_bf16 a[184:187], v[156:159], v[136:139], a[184:187]
    ds_read_b64_tr_b16 v[96:97], v16 offset:8192
    v_mfma_f32_16x16x32_bf16 a[20:23], v[160:163], v[124:127], a[20:23]
    ds_read_b64_tr_b16 v[98:99], v16 offset:9216
    v_mfma_f32_16x16x32_bf16 a[76:79], v[160:163], v[128:131], a[76:79]
    ds_read_b64_tr_b16 v[100:101], v20 offset:8192
    v_mfma_f32_16x16x32_bf16 a[132:135], v[160:163], v[132:135], a[132:135]
    ds_read_b64_tr_b16 v[102:103], v20 offset:9216
    v_mfma_f32_16x16x32_bf16 a[188:191], v[160:163], v[136:139], a[188:191]
    ds_read_b64_tr_b16 v[104:105], v24 offset:8192
    v_mfma_f32_16x16x32_bf16 a[24:27], v[164:167], v[124:127], a[24:27]
    ds_read_b64_tr_b16 v[106:107], v24 offset:9216
    v_mfma_f32_16x16x32_bf16 a[80:83], v[164:167], v[128:131], a[80:83]
    ds_read_b64_tr_b16 v[108:109], v28 offset:8192
    v_mfma_f32_16x16x32_bf16 a[136:139], v[164:167], v[132:135], a[136:139]
    ds_read_b64_tr_b16 v[110:111], v28 offset:9216
    v_mfma_f32_16x16x32_bf16 a[192:195], v[164:167], v[136:139], a[192:195]
    ds_read_b64_tr_b16 v[112:113], v32 offset:8192
    v_mfma_f32_16x16x32_bf16 a[28:31], v[168:171], v[124:127], a[28:31]
    ds_read_b64_tr_b16 v[114:115], v32 offset:9216
    v_mfma_f32_16x16x32_bf16 a[84:87], v[168:171], v[128:131], a[84:87]
    ds_read_b64_tr_b16 v[116:117], v36 offset:8192
    v_mfma_f32_16x16x32_bf16 a[140:143], v[168:171], v[132:135], a[140:143]
    ds_read_b64_tr_b16 v[118:119], v36 offset:9216
    v_mfma_f32_16x16x32_bf16 a[196:199], v[168:171], v[136:139], a[196:199]
    ds_read_b64_tr_b16 v[120:121], v40 offset:8192
    v_mfma_f32_16x16x32_bf16 a[32:35], v[172:175], v[124:127], a[32:35]
    ds_read_b64_tr_b16 v[122:123], v40 offset:9216
    v_mfma_f32_16x16x32_bf16 a[88:91], v[172:175], v[128:131], a[88:91]
    v_mfma_f32_16x16x32_bf16 a[144:147], v[172:175], v[132:135], a[144:147]
    v_mfma_f32_16x16x32_bf16 a[200:203], v[172:175], v[136:139], a[200:203]
    v_mfma_f32_16x16x32_bf16 a[36:39], v[176:179], v[124:127], a[36:39]
    v_mfma_f32_16x16x32_bf16 a[92:95], v[176:179], v[128:131], a[92:95]
    v_mfma_f32_16x16x32_bf16 a[148:151], v[176:179], v[132:135], a[148:151]
    v_mfma_f32_16x16x32_bf16 a[204:207], v[176:179], v[136:139], a[204:207]
    v_mfma_f32_16x16x32_bf16 a[40:43], v[180:183], v[124:127], a[40:43]
    v_mfma_f32_16x16x32_bf16 a[96:99], v[180:183], v[128:131], a[96:99]
    v_mfma_f32_16x16x32_bf16 a[152:155], v[180:183], v[132:135], a[152:155]
    v_mfma_f32_16x16x32_bf16 a[208:211], v[180:183], v[136:139], a[208:211]
    v_mfma_f32_16x16x32_bf16 a[44:47], v[184:187], v[124:127], a[44:47]
    v_mfma_f32_16x16x32_bf16 a[100:103], v[184:187], v[128:131], a[100:103]
    v_mfma_f32_16x16x32_bf16 a[156:159], v[184:187], v[132:135], a[156:159]
    v_mfma_f32_16x16x32_bf16 a[212:215], v[184:187], v[136:139], a[212:215]
    v_mfma_f32_16x16x32_bf16 a[48:51], v[188:191], v[124:127], a[48:51]
    v_mfma_f32_16x16x32_bf16 a[104:107], v[188:191], v[128:131], a[104:107]
    v_mfma_f32_16x16x32_bf16 a[160:163], v[188:191], v[132:135], a[160:163]
    v_mfma_f32_16x16x32_bf16 a[216:219], v[188:191], v[136:139], a[216:219]
    v_mfma_f32_16x16x32_bf16 a[52:55], v[192:195], v[124:127], a[52:55]
    v_mfma_f32_16x16x32_bf16 a[108:111], v[192:195], v[128:131], a[108:111]
    v_mfma_f32_16x16x32_bf16 a[164:167], v[192:195], v[132:135], a[164:167]
    v_mfma_f32_16x16x32_bf16 a[220:223], v[192:195], v[136:139], a[220:223]
    s_waitcnt lgkmcnt(0)
    v_mfma_f32_16x16x32_bf16 a[0:3], v[68:71], v[52:55], a[0:3]
    v_mfma_f32_16x16x32_bf16 a[56:59], v[68:71], v[56:59], a[56:59]
    s_waitcnt vmcnt(16)
    s_barrier
    s_add_u32 m0, s36, 65536
    buffer_load_dwordx4 v2, s[4:7], s28 offen lds
    s_add_u32 m0, s37, 65536
    buffer_load_dwordx4 v3, s[4:7], s28 offen lds
    s_add_u32 m0, s38, 65536
    buffer_load_dwordx4 v4, s[4:7], s28 offen lds
    s_add_u32 m0, s39, 65536
    buffer_load_dwordx4 v5, s[4:7], s28 offen lds
    s_add_u32 m0, s40, 65536
    buffer_load_dwordx4 v6, s[8:11], s29 offen lds
    s_add_u32 m0, s41, 65536
    buffer_load_dwordx4 v7, s[8:11], s29 offen lds
    s_add_u32 m0, s42, 65536
    buffer_load_dwordx4 v8, s[12:15], s29 offen lds
    s_add_u32 m0, s43, 65536
    buffer_load_dwordx4 v9, s[12:15], s29 offen lds
    s_add_u32 s28, s28, 64
    s_add_u32 s29, s29, 229376
    ds_read_b128 v[124:127], v13 offset:0
    v_mfma_f32_16x16x32_bf16 a[112:115], v[68:71], v[60:63], a[112:115]
    ds_read_b128 v[128:131], v13 offset:1024
    v_mfma_f32_16x16x32_bf16 a[168:171], v[68:71], v[64:67], a[168:171]
    ds_read_b128 v[132:135], v13 offset:2048
    v_mfma_f32_16x16x32_bf16 a[4:7], v[72:75], v[52:55], a[4:7]
    ds_read_b128 v[136:139], v13 offset:3072
    v_mfma_f32_16x16x32_bf16 a[60:63], v[72:75], v[56:59], a[60:63]
    ds_read_b64_tr_b16 v[140:141], v17 offset:0
    v_mfma_f32_16x16x32_bf16 a[116:119], v[72:75], v[60:63], a[116:119]
    ds_read_b64_tr_b16 v[142:143], v17 offset:1024
    v_mfma_f32_16x16x32_bf16 a[172:175], v[72:75], v[64:67], a[172:175]
    ds_read_b64_tr_b16 v[144:145], v21 offset:0
    v_mfma_f32_16x16x32_bf16 a[8:11], v[76:79], v[52:55], a[8:11]
    ds_read_b64_tr_b16 v[146:147], v21 offset:1024
    v_mfma_f32_16x16x32_bf16 a[64:67], v[76:79], v[56:59], a[64:67]
    ds_read_b64_tr_b16 v[148:149], v25 offset:0
    v_mfma_f32_16x16x32_bf16 a[120:123], v[76:79], v[60:63], a[120:123]
    ds_read_b64_tr_b16 v[150:151], v25 offset:1024
    v_mfma_f32_16x16x32_bf16 a[176:179], v[76:79], v[64:67], a[176:179]
    ds_read_b64_tr_b16 v[152:153], v29 offset:0
    v_mfma_f32_16x16x32_bf16 a[12:15], v[80:83], v[52:55], a[12:15]
    ds_read_b64_tr_b16 v[154:155], v29 offset:1024
    v_mfma_f32_16x16x32_bf16 a[68:71], v[80:83], v[56:59], a[68:71]
    ds_read_b64_tr_b16 v[156:157], v33 offset:0
    v_mfma_f32_16x16x32_bf16 a[124:127], v[80:83], v[60:63], a[124:127]
    ds_read_b64_tr_b16 v[158:159], v33 offset:1024
    v_mfma_f32_16x16x32_bf16 a[180:183], v[80:83], v[64:67], a[180:183]
    ds_read_b64_tr_b16 v[160:161], v37 offset:0
    v_mfma_f32_16x16x32_bf16 a[16:19], v[84:87], v[52:55], a[16:19]
    ds_read_b64_tr_b16 v[162:163], v37 offset:1024
    v_mfma_f32_16x16x32_bf16 a[72:75], v[84:87], v[56:59], a[72:75]
    ds_read_b64_tr_b16 v[164:165], v41 offset:0
    v_mfma_f32_16x16x32_bf16 a[128:131], v[84:87], v[60:63], a[128:131]
    ds_read_b64_tr_b16 v[166:167], v41 offset:1024
    v_mfma_f32_16x16x32_bf16 a[184:187], v[84:87], v[64:67], a[184:187]
    ds_read_b64_tr_b16 v[168:169], v17 offset:8192
    v_mfma_f32_16x16x32_bf16 a[20:23], v[88:91], v[52:55], a[20:23]
    ds_read_b64_tr_b16 v[170:171], v17 offset:9216
    v_mfma_f32_16x16x32_bf16 a[76:79], v[88:91], v[56:59], a[76:79]
    ds_read_b64_tr_b16 v[172:173], v21 offset:8192
    v_mfma_f32_16x16x32_bf16 a[132:135], v[88:91], v[60:63], a[132:135]
    ds_read_b64_tr_b16 v[174:175], v21 offset:9216
    v_mfma_f32_16x16x32_bf16 a[188:191], v[88:91], v[64:67], a[188:191]
    ds_read_b64_tr_b16 v[176:177], v25 offset:8192
    v_mfma_f32_16x16x32_bf16 a[24:27], v[92:95], v[52:55], a[24:27]
    ds_read_b64_tr_b16 v[178:179], v25 offset:9216
    v_mfma_f32_16x16x32_bf16 a[80:83], v[92:95], v[56:59], a[80:83]
    ds_read_b64_tr_b16 v[180:181], v29 offset:8192
    v_mfma_f32_16x16x32_bf16 a[136:139], v[92:95], v[60:63], a[136:139]
    ds_read_b64_tr_b16 v[182:183], v29 offset:9216
    v_mfma_f32_16x16x32_bf16 a[192:195], v[92:95], v[64:67], a[192:195]
    ds_read_b64_tr_b16 v[184:185], v33 offset:8192
    v_mfma_f32_16x16x32_bf16 a[28:31], v[96:99], v[52:55], a[28:31]
    ds_read_b64_tr_b16 v[186:187], v33 offset:9216
    v_mfma_f32_16x16x32_bf16 a[84:87], v[96:99], v[56:59], a[84:87]
    ds_read_b64_tr_b16 v[188:189], v37 offset:8192
    v_mfma_f32_16x16x32_bf16 a[140:143], v[96:99], v[60:63], a[140:143]
    ds_read_b64_tr_b16 v[190:191], v37 offset:9216
    v_mfma_f32_16x16x32_bf16 a[196:199], v[96:99], v[64:67], a[196:199]
    ds_read_b64_tr_b16 v[192:193], v41 offset:8192
    v_mfma_f32_16x16x32_bf16 a[32:35], v[100:103], v[52:55], a[32:35]
    ds_read_b64_tr_b16 v[194:195], v41 offset:9216
    v_mfma_f32_16x16x32_bf16 a[88:91], v[100:103], v[56:59], a[88:91]
    v_mfma_f32_16x16x32_bf16 a[144:147], v[100:103], v[60:63], a[144:147]
    v_mfma_f32_16x16x32_bf16 a[200:203], v[100:103], v[64:67], a[200:203]
    v_mfma_f32_16x16x32_bf16 a[36:39], v[104:107], v[52:55], a[36:39]
    v_mfma_f32_16x16x32_bf16 a[92:95], v[104:107], v[56:59], a[92:95]
    v_mfma_f32_16x16x32_bf16 a[148:151], v[104:107], v[60:63], a[148:151]
    v_mfma_f32_16x16x32_bf16 a[204:207], v[104:107], v[64:67], a[204:207]
    v_mfma_f32_16x16x32_bf16 a[40:43], v[108:111], v[52:55], a[40:43]
    v_mfma_f32_16x16x32_bf16 a[96:99], v[108:111], v[56:59], a[96:99]
    v_mfma_f32_16x16x32_bf16 a[152:155], v[108:111], v[60:63], a[152:155]
    v_mfma_f32_16x16x32_bf16 a[208:211], v[108:111], v[64:67], a[208:211]
    v_mfma_f32_16x16x32_bf16 a[44:47], v[112:115], v[52:55], a[44:47]
    v_mfma_f32_16x16x32_bf16 a[100:103], v[112:115], v[56:59], a[100:103]
    v_mfma_f32_16x16x32_bf16 a[156:159], v[112:115], v[60:63], a[156:159]
    v_mfma_f32_16x16x32_bf16 a[212:215], v[112:115], v[64:67], a[212:215]
    v_mfma_f32_16x16x32_bf16 a[48:51], v[116:119], v[52:55], a[48:51]
    v_mfma_f32_16x16x32_bf16 a[104:107], v[116:119], v[56:59], a[104:107]
    v_mfma_f32_16x16x32_bf16 a[160:163], v[116:119], v[60:63], a[160:163]
    v_mfma_f32_16x16x32_bf16 a[216:219], v[116:119], v[64:67], a[216:219]
    v_mfma_f32_16x16x32_bf16 a[52:55], v[120:123], v[52:55], a[52:55]
    v_mfma_f32_16x16x32_bf16 a[108:111], v[120:123], v[56:59], a[108:111]
    v_mfma_f32_16x16x32_bf16 a[164:167], v[120:123], v[60:63], a[164:167]
    v_mfma_f32_16x16x32_bf16 a[220:223], v[120:123], v[64:67], a[220:223]
    s_waitcnt lgkmcnt(0)
    v_mfma_f32_16x16x32_bf16 a[0:3], v[140:143], v[124:127], a[0:3]
    v_mfma_f32_16x16x32_bf16 a[56:59], v[140:143], v[128:131], a[56:59]
    s_waitcnt vmcnt(16)
    s_barrier
    s_add_u32 m0, s36, 98304
    buffer_load_dwordx4 v2, s[4:7], s28 offen lds
    s_add_u32 m0, s37, 98304
    buffer_load_dwordx4 v3, s[4:7], s28 offen lds
    s_add_u32 m0, s38, 98304
    buffer_load_dwordx4 v4, s[4:7], s28 offen lds
    s_add_u32 m0, s39, 98304
    buffer_load_dwordx4 v5, s[4:7], s28 offen lds
    s_add_u32 m0, s40, 98304
    buffer_load_dwordx4 v6, s[8:11], s29 offen lds
    s_add_u32 m0, s41, 98304
    buffer_load_dwordx4 v7, s[8:11], s29 offen lds
    s_add_u32 m0, s42, 98304
    buffer_load_dwordx4 v8, s[12:15], s29 offen lds
    s_add_u32 m0, s43, 98304
    buffer_load_dwordx4 v9, s[12:15], s29 offen lds
    s_add_u32 s28, s28, 64
    s_add_u32 s29, s29, 229376
    ds_read_b128 v[52:55], v10 offset:0
    v_mfma_f32_16x16x32_bf16 a[112:115], v[140:143], v[132:135], a[112:115]
    ds_read_b128 v[56:59], v10 offset:1024
    v_mfma_f32_16x16x32_bf16 a[168:171], v[140:143], v[136:139], a[168:171]
    ds_read_b128 v[60:63], v10 offset:2048
    v_mfma_f32_16x16x32_bf16 a[4:7], v[144:147], v[124:127], a[4:7]
    ds_read_b128 v[64:67], v10 offset:3072
    v_mfma_f32_16x16x32_bf16 a[60:63], v[144:147], v[128:131], a[60:63]
    ds_read_b64_tr_b16 v[68:69], v14 offset:0
    v_mfma_f32_16x16x32_bf16 a[116:119], v[144:147], v[132:135], a[116:119]
    ds_read_b64_tr_b16 v[70:71], v14 offset:1024
    v_mfma_f32_16x16x32_bf16 a[172:175], v[144:147], v[136:139], a[172:175]
    ds_read_b64_tr_b16 v[72:73], v18 offset:0
    v_mfma_f32_16x16x32_bf16 a[8:11], v[148:151], v[124:127], a[8:11]
    ds_read_b64_tr_b16 v[74:75], v18 offset:1024
    v_mfma_f32_16x16x32_bf16 a[64:67], v[148:151], v[128:131], a[64:67]
    ds_read_b64_tr_b16 v[76:77], v22 offset:0
    v_mfma_f32_16x16x32_bf16 a[120:123], v[148:151], v[132:135], a[120:123]
    ds_read_b64_tr_b16 v[78:79], v22 offset:1024
    v_mfma_f32_16x16x32_bf16 a[176:179], v[148:151], v[136:139], a[176:179]
    ds_read_b64_tr_b16 v[80:81], v26 offset:0
    v_mfma_f32_16x16x32_bf16 a[12:15], v[152:155], v[124:127], a[12:15]
    ds_read_b64_tr_b16 v[82:83], v26 offset:1024
    v_mfma_f32_16x16x32_bf16 a[68:71], v[152:155], v[128:131], a[68:71]
    ds_read_b64_tr_b16 v[84:85], v30 offset:0
    v_mfma_f32_16x16x32_bf16 a[124:127], v[152:155], v[132:135], a[124:127]
    ds_read_b64_tr_b16 v[86:87], v30 offset:1024
    v_mfma_f32_16x16x32_bf16 a[180:183], v[152:155], v[136:139], a[180:183]
    ds_read_b64_tr_b16 v[88:89], v34 offset:0
    v_mfma_f32_16x16x32_bf16 a[16:19], v[156:159], v[124:127], a[16:19]
    ds_read_b64_tr_b16 v[90:91], v34 offset:1024
    v_mfma_f32_16x16x32_bf16 a[72:75], v[156:159], v[128:131], a[72:75]
    ds_read_b64_tr_b16 v[92:93], v38 offset:0
    v_mfma_f32_16x16x32_bf16 a[128:131], v[156:159], v[132:135], a[128:131]
    ds_read_b64_tr_b16 v[94:95], v38 offset:1024
    v_mfma_f32_16x16x32_bf16 a[184:187], v[156:159], v[136:139], a[184:187]
    ds_read_b64_tr_b16 v[96:97], v14 offset:8192
    v_mfma_f32_16x16x32_bf16 a[20:23], v[160:163], v[124:127], a[20:23]
    ds_read_b64_tr_b16 v[98:99], v14 offset:9216
    v_mfma_f32_16x16x32_bf16 a[76:79], v[160:163], v[128:131], a[76:79]
    ds_read_b64_tr_b16 v[100:101], v18 offset:8192
    v_mfma_f32_16x16x32_bf16 a[132:135], v[160:163], v[132:135], a[132:135]
    ds_read_b64_tr_b16 v[102:103], v18 offset:9216
    v_mfma_f32_16x16x32_bf16 a[188:191], v[160:163], v[136:139], a[188:191]
    ds_read_b64_tr_b16 v[104:105], v22 offset:8192
    v_mfma_f32_16x16x32_bf16 a[24:27], v[164:167], v[124:127], a[24:27]
    ds_read_b64_tr_b16 v[106:107], v22 offset:9216
    v_mfma_f32_16x16x32_bf16 a[80:83], v[164:167], v[128:131], a[80:83]
    ds_read_b64_tr_b16 v[108:109], v26 offset:8192
    v_mfma_f32_16x16x32_bf16 a[136:139], v[164:167], v[132:135], a[136:139]
    ds_read_b64_tr_b16 v[110:111], v26 offset:9216
    v_mfma_f32_16x16x32_bf16 a[192:195], v[164:167], v[136:139], a[192:195]
    ds_read_b64_tr_b16 v[112:113], v30 offset:8192
    v_mfma_f32_16x16x32_bf16 a[28:31], v[168:171], v[124:127], a[28:31]
    ds_read_b64_tr_b16 v[114:115], v30 offset:9216
    v_mfma_f32_16x16x32_bf16 a[84:87], v[168:171], v[128:131], a[84:87]
    ds_read_b64_tr_b16 v[116:117], v34 offset:8192
    v_mfma_f32_16x16x32_bf16 a[140:143], v[168:171], v[132:135], a[140:143]
    ds_read_b64_tr_b16 v[118:119], v34 offset:9216
    v_mfma_f32_16x16x32_bf16 a[196:199], v[168:171], v[136:139], a[196:199]
    ds_read_b64_tr_b16 v[120:121], v38 offset:8192
    v_mfma_f32_16x16x32_bf16 a[32:35], v[172:175], v[124:127], a[32:35]
    ds_read_b64_tr_b16 v[122:123], v38 offset:9216
    v_mfma_f32_16x16x32_bf16 a[88:91], v[172:175], v[128:131], a[88:91]
    v_mfma_f32_16x16x32_bf16 a[144:147], v[172:175], v[132:135], a[144:147]
    v_mfma_f32_16x16x32_bf16 a[200:203], v[172:175], v[136:139], a[200:203]
    v_mfma_f32_16x16x32_bf16 a[36:39], v[176:179], v[124:127], a[36:39]
    v_mfma_f32_16x16x32_bf16 a[92:95], v[176:179], v[128:131], a[92:95]
    v_mfma_f32_16x16x32_bf16 a[148:151], v[176:179], v[132:135], a[148:151]
    v_mfma_f32_16x16x32_bf16 a[204:207], v[176:179], v[136:139], a[204:207]
    v_mfma_f32_16x16x32_bf16 a[40:43], v[180:183], v[124:127], a[40:43]
    v_mfma_f32_16x16x32_bf16 a[96:99], v[180:183], v[128:131], a[96:99]
    v_mfma_f32_16x16x32_bf16 a[152:155], v[180:183], v[132:135], a[152:155]
    v_mfma_f32_16x16x32_bf16 a[208:211], v[180:183], v[136:139], a[208:211]
    v_mfma_f32_16x16x32_bf16 a[44:47], v[184:187], v[124:127], a[44:47]
    v_mfma_f32_16x16x32_bf16 a[100:103], v[184:187], v[128:131], a[100:103]
    v_mfma_f32_16x16x32_bf16 a[156:159], v[184:187], v[132:135], a[156:159]
    v_mfma_f32_16x16x32_bf16 a[212:215], v[184:187], v[136:139], a[212:215]
    v_mfma_f32_16x16x32_bf16 a[48:51], v[188:191], v[124:127], a[48:51]
    v_mfma_f32_16x16x32_bf16 a[104:107], v[188:191], v[128:131], a[104:107]
    v_mfma_f32_16x16x32_bf16 a[160:163], v[188:191], v[132:135], a[160:163]
    v_mfma_f32_16x16x32_bf16 a[216:219], v[188:191], v[136:139], a[216:219]
    v_mfma_f32_16x16x32_bf16 a[52:55], v[192:195], v[124:127], a[52:55]
    v_mfma_f32_16x16x32_bf16 a[108:111], v[192:195], v[128:131], a[108:111]
    v_mfma_f32_16x16x32_bf16 a[164:167], v[192:195], v[132:135], a[164:167]
    v_mfma_f32_16x16x32_bf16 a[220:223], v[192:195], v[136:139], a[220:223]
    s_waitcnt lgkmcnt(0)
    v_mfma_f32_16x16x32_bf16 a[0:3], v[68:71], v[52:55], a[0:3]
    v_mfma_f32_16x16x32_bf16 a[56:59], v[68:71], v[56:59], a[56:59]
    s_waitcnt vmcnt(16)
    s_barrier
    s_add_u32 m0, s36, 0
    buffer_load_dwordx4 v2, s[4:7], s28 offen lds
    s_add_u32 m0, s37, 0
    buffer_load_dwordx4 v3, s[4:7], s28 offen lds
    s_add_u32 m0, s38, 0
    buffer_load_dwordx4 v4, s[4:7], s28 offen lds
    s_add_u32 m0, s39, 0
    buffer_load_dwordx4 v5, s[4:7], s28 offen lds
    s_add_u32 m0, s40, 0
    buffer_load_dwordx4 v6, s[8:11], s29 offen lds
    s_add_u32 m0, s41, 0
    buffer_load_dwordx4 v7, s[8:11], s29 offen lds
    s_add_u32 m0, s42, 0
    buffer_load_dwordx4 v8, s[12:15], s29 offen lds
    s_add_u32 m0, s43, 0
    buffer_load_dwordx4 v9, s[12:15], s29 offen lds
    s_add_u32 s28, s28, 64
    s_add_u32 s29, s29, 229376
    ds_read_b128 v[124:127], v11 offset:0
    v_mfma_f32_16x16x32_bf16 a[112:115], v[68:71], v[60:63], a[112:115]
    ds_read_b128 v[128:131], v11 offset:1024
    v_mfma_f32_16x16x32_bf16 a[168:171], v[68:71], v[64:67], a[168:171]
    ds_read_b128 v[132:135], v11 offset:2048
    v_mfma_f32_16x16x32_bf16 a[4:7], v[72:75], v[52:55], a[4:7]
    ds_read_b128 v[136:139], v11 offset:3072
    v_mfma_f32_16x16x32_bf16 a[60:63], v[72:75], v[56:59], a[60:63]
    ds_read_b64_tr_b16 v[140:141], v15 offset:0
    v_mfma_f32_16x16x32_bf16 a[116:119], v[72:75], v[60:63], a[116:119]
    ds_read_b64_tr_b16 v[142:143], v15 offset:1024
    v_mfma_f32_16x16x32_bf16 a[172:175], v[72:75], v[64:67], a[172:175]
    ds_read_b64_tr_b16 v[144:145], v19 offset:0
    v_mfma_f32_16x16x32_bf16 a[8:11], v[76:79], v[52:55], a[8:11]
    ds_read_b64_tr_b16 v[146:147], v19 offset:1024
    v_mfma_f32_16x16x32_bf16 a[64:67], v[76:79], v[56:59], a[64:67]
    ds_read_b64_tr_b16 v[148:149], v23 offset:0
    v_mfma_f32_16x16x32_bf16 a[120:123], v[76:79], v[60:63], a[120:123]
    ds_read_b64_tr_b16 v[150:151], v23 offset:1024
    v_mfma_f32_16x16x32_bf16 a[176:179], v[76:79], v[64:67], a[176:179]
    ds_read_b64_tr_b16 v[152:153], v27 offset:0
    v_mfma_f32_16x16x32_bf16 a[12:15], v[80:83], v[52:55], a[12:15]
    ds_read_b64_tr_b16 v[154:155], v27 offset:1024
    v_mfma_f32_16x16x32_bf16 a[68:71], v[80:83], v[56:59], a[68:71]
    ds_read_b64_tr_b16 v[156:157], v31 offset:0
    v_mfma_f32_16x16x32_bf16 a[124:127], v[80:83], v[60:63], a[124:127]
    ds_read_b64_tr_b16 v[158:159], v31 offset:1024
    v_mfma_f32_16x16x32_bf16 a[180:183], v[80:83], v[64:67], a[180:183]
    ds_read_b64_tr_b16 v[160:161], v35 offset:0
    v_mfma_f32_16x16x32_bf16 a[16:19], v[84:87], v[52:55], a[16:19]
    ds_read_b64_tr_b16 v[162:163], v35 offset:1024
    v_mfma_f32_16x16x32_bf16 a[72:75], v[84:87], v[56:59], a[72:75]
    ds_read_b64_tr_b16 v[164:165], v39 offset:0
    v_mfma_f32_16x16x32_bf16 a[128:131], v[84:87], v[60:63], a[128:131]
    ds_read_b64_tr_b16 v[166:167], v39 offset:1024
    v_mfma_f32_16x16x32_bf16 a[184:187], v[84:87], v[64:67], a[184:187]
    ds_read_b64_tr_b16 v[168:169], v15 offset:8192
    v_mfma_f32_16x16x32_bf16 a[20:23], v[88:91], v[52:55], a[20:23]
    ds_read_b64_tr_b16 v[170:171], v15 offset:9216
    v_mfma_f32_16x16x32_bf16 a[76:79], v[88:91], v[56:59], a[76:79]
    ds_read_b64_tr_b16 v[172:173], v19 offset:8192
    v_mfma_f32_16x16x32_bf16 a[132:135], v[88:91], v[60:63], a[132:135]
    ds_read_b64_tr_b16 v[174:175], v19 offset:9216
    v_mfma_f32_16x16x32_bf16 a[188:191], v[88:91], v[64:67], a[188:191]
    ds_read_b64_tr_b16 v[176:177], v23 offset:8192
    v_mfma_f32_16x16x32_bf16 a[24:27], v[92:95], v[52:55], a[24:27]
    ds_read_b64_tr_b16 v[178:179], v23 offset:9216
    v_mfma_f32_16x16x32_bf16 a[80:83], v[92:95], v[56:59], a[80:83]
    ds_read_b64_tr_b16 v[180:181], v27 offset:8192
    v_mfma_f32_16x16x32_bf16 a[136:139], v[92:95], v[60:63], a[136:139]
    ds_read_b64_tr_b16 v[182:183], v27 offset:9216
    v_mfma_f32_16x16x32_bf16 a[192:195], v[92:95], v[64:67], a[192:195]
    ds_read_b64_tr_b16 v[184:185], v31 offset:8192
    v_mfma_f32_16x16x32_bf16 a[28:31], v[96:99], v[52:55], a[28:31]
    ds_read_b64_tr_b16 v[186:187], v31 offset:9216
    v_mfma_f32_16x16x32_bf16 a[84:87], v[96:99], v[56:59], a[84:87]
    ds_read_b64_tr_b16 v[188:189], v35 offset:8192
    v_mfma_f32_16x16x32_bf16 a[140:143], v[96:99], v[60:63], a[140:143]
    ds_read_b64_tr_b16 v[190:191], v35 offset:9216
    v_mfma_f32_16x16x32_bf16 a[196:199], v[96:99], v[64:67], a[196:199]
    ds_read_b64_tr_b16 v[192:193], v39 offset:8192
    v_mfma_f32_16x16x32_bf16 a[32:35], v[100:103], v[52:55], a[32:35]
    ds_read_b64_tr_b16 v[194:195], v39 offset:9216
    v_mfma_f32_16x16x32_bf16 a[88:91], v[100:103], v[56:59], a[88:91]
    v_mfma_f32_16x16x32_bf16 a[144:147], v[100:103], v[60:63], a[144:147]
    v_mfma_f32_16x16x32_bf16 a[200:203], v[100:103], v[64:67], a[200:203]
    v_mfma_f32_16x16x32_bf16 a[36:39], v[104:107], v[52:55], a[36:39]
    v_mfma_f32_16x16x32_bf16 a[92:95], v[104:107], v[56:59], a[92:95]
    v_mfma_f32_16x16x32_bf16 a[148:151], v[104:107], v[60:63], a[148:151]
    v_mfma_f32_16x16x32_bf16 a[204:207], v[104:107], v[64:67], a[204:207]
    v_mfma_f32_16x16x32_bf16 a[40:43], v[108:111], v[52:55], a[40:43]
    v_mfma_f32_16x16x32_bf16 a[96:99], v[108:111], v[56:59], a[96:99]
    v_mfma_f32_16x16x32_bf16 a[152:155], v[108:111], v[60:63], a[152:155]
    v_mfma_f32_16x16x32_bf16 a[208:211], v[108:111], v[64:67], a[208:211]
    v_mfma_f32_16x16x32_bf16 a[44:47], v[112:115], v[52:55], a[44:47]
    v_mfma_f32_16x16x32_bf16 a[100:103], v[112:115], v[56:59], a[100:103]
    v_mfma_f32_16x16x32_bf16 a[156:159], v[112:115], v[60:63], a[156:159]
    v_mfma_f32_16x16x32_bf16 a[212:215], v[112:115], v[64:67], a[212:215]
    v_mfma_f32_16x16x32_bf16 a[48:51], v[116:119], v[52:55], a[48:51]
    v_mfma_f32_16x16x32_bf16 a[104:107], v[116:119], v[56:59], a[104:107]
    v_mfma_f32_16x16x32_bf16 a[160:163], v[116:119], v[60:63], a[160:163]
    v_mfma_f32_16x16x32_bf16 a[216:219], v[116:119], v[64:67], a[216:219]
    v_mfma_f32_16x16x32_bf16 a[52:55], v[120:123], v[52:55], a[52:55]
    v_mfma_f32_16x16x32_bf16 a[108:111], v[120:123], v[56:59], a[108:111]
    v_mfma_f32_16x16x32_bf16 a[164:167], v[120:123], v[60:63], a[164:167]
    v_mfma_f32_16x16x32_bf16 a[220:223], v[120:123], v[64:67], a[220:223]
    s_waitcnt lgkmcnt(0)
    v_mfma_f32_16x16x32_bf16 a[0:3], v[140:143], v[124:127], a[0:3]
    v_mfma_f32_16x16x32_bf16 a[56:59], v[140:143], v[128:131], a[56:59]
    s_waitcnt vmcnt(16)
    s_barrier
    s_add_u32 m0, s36, 32768
    buffer_load_dwordx4 v2, s[4:7], s28 offen lds
    s_add_u32 m0, s37, 32768
    buffer_load_dwordx4 v3, s[4:7], s28 offen lds
    s_add_u32 m0, s38, 32768
    buffer_load_dwordx4 v4, s[4:7], s28 offen lds
    s_add_u32 m0, s39, 32768
    buffer_load_dwordx4 v5, s[4:7], s28 offen lds
    s_add_u32 m0, s40, 32768
    buffer_load_dwordx4 v6, s[8:11], s29 offen lds
    s_add_u32 m0, s41, 32768
    buffer_load_dwordx4 v7, s[8:11], s29 offen lds
    s_add_u32 m0, s42, 32768
    buffer_load_dwordx4 v8, s[12:15], s29 offen lds
    s_add_u32 m0, s43, 32768
    buffer_load_dwordx4 v9, s[12:15], s29 offen lds
    s_add_u32 s28, s28, 64
    s_add_u32 s29, s29, 229376
    ds_read_b128 v[52:55], v12 offset:0
    v_mfma_f32_16x16x32_bf16 a[112:115], v[140:143], v[132:135], a[112:115]
    ds_read_b128 v[56:59], v12 offset:1024
    v_mfma_f32_16x16x32_bf16 a[168:171], v[140:143], v[136:139], a[168:171]
    ds_read_b128 v[60:63], v12 offset:2048
    v_mfma_f32_16x16x32_bf16 a[4:7], v[144:147], v[124:127], a[4:7]
    ds_read_b128 v[64:67], v12 offset:3072
    v_mfma_f32_16x16x32_bf16 a[60:63], v[144:147], v[128:131], a[60:63]
    ds_read_b64_tr_b16 v[68:69], v16 offset:0
    v_mfma_f32_16x16x32_bf16 a[116:119], v[144:147], v[132:135], a[116:119]
    ds_read_b64_tr_b16 v[70:71], v16 offset:1024
    v_mfma_f32_16x16x32_bf16 a[172:175], v[144:147], v[136:139], a[172:175]
    ds_read_b64_tr_b16 v[72:73], v20 offset:0
    v_mfma_f32_16x16x32_bf16 a[8:11], v[148:151], v[124:127], a[8:11]
    ds_read_b64_tr_b16 v[74:75], v20 offset:1024
    v_mfma_f32_16x16x32_bf16 a[64:67], v[148:151], v[128:131], a[64:67]
    ds_read_b64_tr_b16 v[76:77], v24 offset:0
    v_mfma_f32_16x16x32_bf16 a[120:123], v[148:151], v[132:135], a[120:123]
    ds_read_b64_tr_b16 v[78:79], v24 offset:1024
    v_mfma_f32_16x16x32_bf16 a[176:179], v[148:151], v[136:139], a[176:179]
    ds_read_b64_tr_b16 v[80:81], v28 offset:0
    v_mfma_f32_16x16x32_bf16 a[12:15], v[152:155], v[124:127], a[12:15]
    ds_read_b64_tr_b16 v[82:83], v28 offset:1024
    v_mfma_f32_16x16x32_bf16 a[68:71], v[152:155], v[128:131], a[68:71]
    ds_read_b64_tr_b16 v[84:85], v32 offset:0
    v_mfma_f32_16x16x32_bf16 a[124:127], v[152:155], v[132:135], a[124:127]
    ds_read_b64_tr_b16 v[86:87], v32 offset:1024
    v_mfma_f32_16x16x32_bf16 a[180:183], v[152:155], v[136:139], a[180:183]
    ds_read_b64_tr_b16 v[88:89], v36 offset:0
    v_mfma_f32_16x16x32_bf16 a[16:19], v[156:159], v[124:127], a[16:19]
    ds_read_b64_tr_b16 v[90:91], v36 offset:1024
    v_mfma_f32_16x16x32_bf16 a[72:75], v[156:159], v[128:131], a[72:75]
    ds_read_b64_tr_b16 v[92:93], v40 offset:0
    v_mfma_f32_16x16x32_bf16 a[128:131], v[156:159], v[132:135], a[128:131]
    ds_read_b64_tr_b16 v[94:95], v40 offset:1024
    v_mfma_f32_16x16x32_bf16 a[184:187], v[156:159], v[136:139], a[184:187]
    ds_read_b64_tr_b16 v[96:97], v16 offset:8192
    v_mfma_f32_16x16x32_bf16 a[20:23], v[160:163], v[124:127], a[20:23]
    ds_read_b64_tr_b16 v[98:99], v16 offset:9216
    v_mfma_f32_16x16x32_bf16 a[76:79], v[160:163], v[128:131], a[76:79]
    ds_read_b64_tr_b16 v[100:101], v20 offset:8192
    v_mfma_f32_16x16x32_bf16 a[132:135], v[160:163], v[132:135], a[132:135]
    ds_read_b64_tr_b16 v[102:103], v20 offset:9216
    v_mfma_f32_16x16x32_bf16 a[188:191], v[160:163], v[136:139], a[188:191]
    ds_read_b64_tr_b16 v[104:105], v24 offset:8192
    v_mfma_f32_16x16x32_bf16 a[24:27], v[164:167], v[124:127], a[24:27]
    ds_read_b64_tr_b16 v[106:107], v24 offset:9216
    v_mfma_f32_16x16x32_bf16 a[80:83], v[164:167], v[128:131], a[80:83]
    ds_read_b64_tr_b16 v[108:109], v28 offset:8192
    v_mfma_f32_16x16x32_bf16 a[136:139], v[164:167], v[132:135], a[136:139]
    ds_read_b64_tr_b16 v[110:111], v28 offset:9216
    v_mfma_f32_16x16x32_bf16 a[192:195], v[164:167], v[136:139], a[192:195]
    ds_read_b64_tr_b16 v[112:113], v32 offset:8192
    v_mfma_f32_16x16x32_bf16 a[28:31], v[168:171], v[124:127], a[28:31]
    ds_read_b64_tr_b16 v[114:115], v32 offset:9216
    v_mfma_f32_16x16x32_bf16 a[84:87], v[168:171], v[128:131], a[84:87]
    ds_read_b64_tr_b16 v[116:117], v36 offset:8192
    v_mfma_f32_16x16x32_bf16 a[140:143], v[168:171], v[132:135], a[140:143]
    ds_read_b64_tr_b16 v[118:119], v36 offset:9216
    v_mfma_f32_16x16x32_bf16 a[196:199], v[168:171], v[136:139], a[196:199]
    ds_read_b64_tr_b16 v[120:121], v40 offset:8192
    v_mfma_f32_16x16x32_bf16 a[32:35], v[172:175], v[124:127], a[32:35]
    ds_read_b64_tr_b16 v[122:123], v40 offset:9216
    v_mfma_f32_16x16x32_bf16 a[88:91], v[172:175], v[128:131], a[88:91]
    v_mfma_f32_16x16x32_bf16 a[144:147], v[172:175], v[132:135], a[144:147]
    v_mfma_f32_16x16x32_bf16 a[200:203], v[172:175], v[136:139], a[200:203]
    v_mfma_f32_16x16x32_bf16 a[36:39], v[176:179], v[124:127], a[36:39]
    v_mfma_f32_16x16x32_bf16 a[92:95], v[176:179], v[128:131], a[92:95]
    v_mfma_f32_16x16x32_bf16 a[148:151], v[176:179], v[132:135], a[148:151]
    v_mfma_f32_16x16x32_bf16 a[204:207], v[176:179], v[136:139], a[204:207]
    v_mfma_f32_16x16x32_bf16 a[40:43], v[180:183], v[124:127], a[40:43]
    v_mfma_f32_16x16x32_bf16 a[96:99], v[180:183], v[128:131], a[96:99]
    v_mfma_f32_16x16x32_bf16 a[152:155], v[180:183], v[132:135], a[152:155]
    v_mfma_f32_16x16x32_bf16 a[208:211], v[180:183], v[136:139], a[208:211]
    v_mfma_f32_16x16x32_bf16 a[44:47], v[184:187], v[124:127], a[44:47]
    v_mfma_f32_16x16x32_bf16 a[100:103], v[184:187], v[128:131], a[100:103]
    v_mfma_f32_16x16x32_bf16 a[156:159], v[184:187], v[132:135], a[156:159]
    v_mfma_f32_16x16x32_bf16 a[212:215], v[184:187], v[136:139], a[212:215]
    v_mfma_f32_16x16x32_bf16 a[48:51], v[188:191], v[124:127], a[48:51]
    v_mfma_f32_16x16x32_bf16 a[104:107], v[188:191], v[128:131], a[104:107]
    v_mfma_f32_16x16x32_bf16 a[160:163], v[188:191], v[132:135], a[160:163]
    v_mfma_f32_16x16x32_bf16 a[216:219], v[188:191], v[136:139], a[216:219]
    v_mfma_f32_16x16x32_bf16 a[52:55], v[192:195], v[124:127], a[52:55]
    v_mfma_f32_16x16x32_bf16 a[108:111], v[192:195], v[128:131], a[108:111]
    v_mfma_f32_16x16x32_bf16 a[164:167], v[192:195], v[132:135], a[164:167]
    v_mfma_f32_16x16x32_bf16 a[220:223], v[192:195], v[136:139], a[220:223]
    s_waitcnt lgkmcnt(0)
    v_mfma_f32_16x16x32_bf16 a[0:3], v[68:71], v[52:55], a[0:3]
    v_mfma_f32_16x16x32_bf16 a[56:59], v[68:71], v[56:59], a[56:59]
    s_waitcnt vmcnt(16)
    s_barrier
    s_add_u32 m0, s36, 65536
    buffer_load_dwordx4 v2, s[4:7], s28 offen lds
    s_add_u32 m0, s37, 65536
    buffer_load_dwordx4 v3, s[4:7], s28 offen lds
    s_add_u32 m0, s38, 65536
    buffer_load_dwordx4 v4, s[4:7], s28 offen lds
    s_add_u32 m0, s39, 65536
    buffer_load_dwordx4 v5, s[4:7], s28 offen lds
    s_add_u32 m0, s40, 65536
    buffer_load_dwordx4 v6, s[8:11], s29 offen lds
    s_add_u32 m0, s41, 65536
    buffer_load_dwordx4 v7, s[8:11], s29 offen lds
    s_add_u32 m0, s42, 65536
    buffer_load_dwordx4 v8, s[12:15], s29 offen lds
    s_add_u32 m0, s43, 65536
    buffer_load_dwordx4 v9, s[12:15], s29 offen lds
    s_add_u32 s28, s28, 64
    s_add_u32 s29, s29, 229376
    ds_read_b128 v[124:127], v13 offset:0
    v_mfma_f32_16x16x32_bf16 a[112:115], v[68:71], v[60:63], a[112:115]
    ds_read_b128 v[128:131], v13 offset:1024
    v_mfma_f32_16x16x32_bf16 a[168:171], v[68:71], v[64:67], a[168:171]
    ds_read_b128 v[132:135], v13 offset:2048
    v_mfma_f32_16x16x32_bf16 a[4:7], v[72:75], v[52:55], a[4:7]
    ds_read_b128 v[136:139], v13 offset:3072
    v_mfma_f32_16x16x32_bf16 a[60:63], v[72:75], v[56:59], a[60:63]
    ds_read_b64_tr_b16 v[140:141], v17 offset:0
    v_mfma_f32_16x16x32_bf16 a[116:119], v[72:75], v[60:63], a[116:119]
    ds_read_b64_tr_b16 v[142:143], v17 offset:1024
    v_mfma_f32_16x16x32_bf16 a[172:175], v[72:75], v[64:67], a[172:175]
    ds_read_b64_tr_b16 v[144:145], v21 offset:0
    v_mfma_f32_16x16x32_bf16 a[8:11], v[76:79], v[52:55], a[8:11]
    ds_read_b64_tr_b16 v[146:147], v21 offset:1024
    v_mfma_f32_16x16x32_bf16 a[64:67], v[76:79], v[56:59], a[64:67]
    ds_read_b64_tr_b16 v[148:149], v25 offset:0
    v_mfma_f32_16x16x32_bf16 a[120:123], v[76:79], v[60:63], a[120:123]
    ds_read_b64_tr_b16 v[150:151], v25 offset:1024
    v_mfma_f32_16x16x32_bf16 a[176:179], v[76:79], v[64:67], a[176:179]
    ds_read_b64_tr_b16 v[152:153], v29 offset:0
    v_mfma_f32_16x16x32_bf16 a[12:15], v[80:83], v[52:55], a[12:15]
    ds_read_b64_tr_b16 v[154:155], v29 offset:1024
    v_mfma_f32_16x16x32_bf16 a[68:71], v[80:83], v[56:59], a[68:71]
    ds_read_b64_tr_b16 v[156:157], v33 offset:0
    v_mfma_f32_16x16x32_bf16 a[124:127], v[80:83], v[60:63], a[124:127]
    ds_read_b64_tr_b16 v[158:159], v33 offset:1024
    v_mfma_f32_16x16x32_bf16 a[180:183], v[80:83], v[64:67], a[180:183]
    ds_read_b64_tr_b16 v[160:161], v37 offset:0
    v_mfma_f32_16x16x32_bf16 a[16:19], v[84:87], v[52:55], a[16:19]
    ds_read_b64_tr_b16 v[162:163], v37 offset:1024
    v_mfma_f32_16x16x32_bf16 a[72:75], v[84:87], v[56:59], a[72:75]
    ds_read_b64_tr_b16 v[164:165], v41 offset:0
    v_mfma_f32_16x16x32_bf16 a[128:131], v[84:87], v[60:63], a[128:131]
    ds_read_b64_tr_b16 v[166:167], v41 offset:1024
    v_mfma_f32_16x16x32_bf16 a[184:187], v[84:87], v[64:67], a[184:187]
    ds_read_b64_tr_b16 v[168:169], v17 offset:8192
    v_mfma_f32_16x16x32_bf16 a[20:23], v[88:91], v[52:55], a[20:23]
    ds_read_b64_tr_b16 v[170:171], v17 offset:9216
    v_mfma_f32_16x16x32_bf16 a[76:79], v[88:91], v[56:59], a[76:79]
    ds_read_b64_tr_b16 v[172:173], v21 offset:8192
    v_mfma_f32_16x16x32_bf16 a[132:135], v[88:91], v[60:63], a[132:135]
    ds_read_b64_tr_b16 v[174:175], v21 offset:9216
    v_mfma_f32_16x16x32_bf16 a[188:191], v[88:91], v[64:67], a[188:191]
    ds_read_b64_tr_b16 v[176:177], v25 offset:8192
    v_mfma_f32_16x16x32_bf16 a[24:27], v[92:95], v[52:55], a[24:27]
    ds_read_b64_tr_b16 v[178:179], v25 offset:9216
    v_mfma_f32_16x16x32_bf16 a[80:83], v[92:95], v[56:59], a[80:83]
    ds_read_b64_tr_b16 v[180:181], v29 offset:8192
    v_mfma_f32_16x16x32_bf16 a[136:139], v[92:95], v[60:63], a[136:139]
    ds_read_b64_tr_b16 v[182:183], v29 offset:9216
    v_mfma_f32_16x16x32_bf16 a[192:195], v[92:95], v[64:67], a[192:195]
    ds_read_b64_tr_b16 v[184:185], v33 offset:8192
    v_mfma_f32_16x16x32_bf16 a[28:31], v[96:99], v[52:55], a[28:31]
    ds_read_b64_tr_b16 v[186:187], v33 offset:9216
    v_mfma_f32_16x16x32_bf16 a[84:87], v[96:99], v[56:59], a[84:87]
    ds_read_b64_tr_b16 v[188:189], v37 offset:8192
    v_mfma_f32_16x16x32_bf16 a[140:143], v[96:99], v[60:63], a[140:143]
    ds_read_b64_tr_b16 v[190:191], v37 offset:9216
    v_mfma_f32_16x16x32_bf16 a[196:199], v[96:99], v[64:67], a[196:199]
    ds_read_b64_tr_b16 v[192:193], v41 offset:8192
    v_mfma_f32_16x16x32_bf16 a[32:35], v[100:103], v[52:55], a[32:35]
    ds_read_b64_tr_b16 v[194:195], v41 offset:9216
    v_mfma_f32_16x16x32_bf16 a[88:91], v[100:103], v[56:59], a[88:91]
    v_mfma_f32_16x16x32_bf16 a[144:147], v[100:103], v[60:63], a[144:147]
    v_mfma_f32_16x16x32_bf16 a[200:203], v[100:103], v[64:67], a[200:203]
    v_mfma_f32_16x16x32_bf16 a[36:39], v[104:107], v[52:55], a[36:39]
    v_mfma_f32_16x16x32_bf16 a[92:95], v[104:107], v[56:59], a[92:95]
    v_mfma_f32_16x16x32_bf16 a[148:151], v[104:107], v[60:63], a[148:151]
    v_mfma_f32_16x16x32_bf16 a[204:207], v[104:107], v[64:67], a[204:207]
    v_mfma_f32_16x16x32_bf16 a[40:43], v[108:111], v[52:55], a[40:43]
    v_mfma_f32_16x16x32_bf16 a[96:99], v[108:111], v[56:59], a[96:99]
    v_mfma_f32_16x16x32_bf16 a[152:155], v[108:111], v[60:63], a[152:155]
    v_mfma_f32_16x16x32_bf16 a[208:211], v[108:111], v[64:67], a[208:211]
    v_mfma_f32_16x16x32_bf16 a[44:47], v[112:115], v[52:55], a[44:47]
    v_mfma_f32_16x16x32_bf16 a[100:103], v[112:115], v[56:59], a[100:103]
    v_mfma_f32_16x16x32_bf16 a[156:159], v[112:115], v[60:63], a[156:159]
    v_mfma_f32_16x16x32_bf16 a[212:215], v[112:115], v[64:67], a[212:215]
    v_mfma_f32_16x16x32_bf16 a[48:51], v[116:119], v[52:55], a[48:51]
    v_mfma_f32_16x16x32_bf16 a[104:107], v[116:119], v[56:59], a[104:107]
    v_mfma_f32_16x16x32_bf16 a[160:163], v[116:119], v[60:63], a[160:163]
    v_mfma_f32_16x16x32_bf16 a[216:219], v[116:119], v[64:67], a[216:219]
    v_mfma_f32_16x16x32_bf16 a[52:55], v[120:123], v[52:55], a[52:55]
    v_mfma_f32_16x16x32_bf16 a[108:111], v[120:123], v[56:59], a[108:111]
    v_mfma_f32_16x16x32_bf16 a[164:167], v[120:123], v[60:63], a[164:167]
    v_mfma_f32_16x16x32_bf16 a[220:223], v[120:123], v[64:67], a[220:223]
    s_waitcnt lgkmcnt(0)
    v_mfma_f32_16x16x32_bf16 a[0:3], v[140:143], v[124:127], a[0:3]
    v_mfma_f32_16x16x32_bf16 a[56:59], v[140:143], v[128:131], a[56:59]
    s_waitcnt vmcnt(16)
    s_barrier
    s_add_u32 m0, s36, 98304
    buffer_load_dwordx4 v2, s[4:7], s28 offen lds
    s_add_u32 m0, s37, 98304
    buffer_load_dwordx4 v3, s[4:7], s28 offen lds
    s_add_u32 m0, s38, 98304
    buffer_load_dwordx4 v4, s[4:7], s28 offen lds
    s_add_u32 m0, s39, 98304
    buffer_load_dwordx4 v5, s[4:7], s28 offen lds
    s_add_u32 m0, s40, 98304
    buffer_load_dwordx4 v6, s[8:11], s29 offen lds
    s_add_u32 m0, s41, 98304
    buffer_load_dwordx4 v7, s[8:11], s29 offen lds
    s_add_u32 m0, s42, 98304
    buffer_load_dwordx4 v8, s[12:15], s29 offen lds
    s_add_u32 m0, s43, 98304
    buffer_load_dwordx4 v9, s[12:15], s29 offen lds
    s_add_u32 s28, s28, 64
    s_add_u32 s29, s29, 229376
    ds_read_b128 v[52:55], v10 offset:0
    v_mfma_f32_16x16x32_bf16 a[112:115], v[140:143], v[132:135], a[112:115]
    ds_read_b128 v[56:59], v10 offset:1024
    v_mfma_f32_16x16x32_bf16 a[168:171], v[140:143], v[136:139], a[168:171]
    ds_read_b128 v[60:63], v10 offset:2048
    v_mfma_f32_16x16x32_bf16 a[4:7], v[144:147], v[124:127], a[4:7]
    ds_read_b128 v[64:67], v10 offset:3072
    v_mfma_f32_16x16x32_bf16 a[60:63], v[144:147], v[128:131], a[60:63]
    ds_read_b64_tr_b16 v[68:69], v14 offset:0
    v_mfma_f32_16x16x32_bf16 a[116:119], v[144:147], v[132:135], a[116:119]
    ds_read_b64_tr_b16 v[70:71], v14 offset:1024
    v_mfma_f32_16x16x32_bf16 a[172:175], v[144:147], v[136:139], a[172:175]
    ds_read_b64_tr_b16 v[72:73], v18 offset:0
    v_mfma_f32_16x16x32_bf16 a[8:11], v[148:151], v[124:127], a[8:11]
    ds_read_b64_tr_b16 v[74:75], v18 offset:1024
    v_mfma_f32_16x16x32_bf16 a[64:67], v[148:151], v[128:131], a[64:67]
    ds_read_b64_tr_b16 v[76:77], v22 offset:0
    v_mfma_f32_16x16x32_bf16 a[120:123], v[148:151], v[132:135], a[120:123]
    ds_read_b64_tr_b16 v[78:79], v22 offset:1024
    v_mfma_f32_16x16x32_bf16 a[176:179], v[148:151], v[136:139], a[176:179]
    ds_read_b64_tr_b16 v[80:81], v26 offset:0
    v_mfma_f32_16x16x32_bf16 a[12:15], v[152:155], v[124:127], a[12:15]
    ds_read_b64_tr_b16 v[82:83], v26 offset:1024
    v_mfma_f32_16x16x32_bf16 a[68:71], v[152:155], v[128:131], a[68:71]
    ds_read_b64_tr_b16 v[84:85], v30 offset:0
    v_mfma_f32_16x16x32_bf16 a[124:127], v[152:155], v[132:135], a[124:127]
    ds_read_b64_tr_b16 v[86:87], v30 offset:1024
    v_mfma_f32_16x16x32_bf16 a[180:183], v[152:155], v[136:139], a[180:183]
    ds_read_b64_tr_b16 v[88:89], v34 offset:0
    v_mfma_f32_16x16x32_bf16 a[16:19], v[156:159], v[124:127], a[16:19]
    ds_read_b64_tr_b16 v[90:91], v34 offset:1024
    v_mfma_f32_16x16x32_bf16 a[72:75], v[156:159], v[128:131], a[72:75]
    ds_read_b64_tr_b16 v[92:93], v38 offset:0
    v_mfma_f32_16x16x32_bf16 a[128:131], v[156:159], v[132:135], a[128:131]
    ds_read_b64_tr_b16 v[94:95], v38 offset:1024
    v_mfma_f32_16x16x32_bf16 a[184:187], v[156:159], v[136:139], a[184:187]
    ds_read_b64_tr_b16 v[96:97], v14 offset:8192
    v_mfma_f32_16x16x32_bf16 a[20:23], v[160:163], v[124:127], a[20:23]
    ds_read_b64_tr_b16 v[98:99], v14 offset:9216
    v_mfma_f32_16x16x32_bf16 a[76:79], v[160:163], v[128:131], a[76:79]
    ds_read_b64_tr_b16 v[100:101], v18 offset:8192
    v_mfma_f32_16x16x32_bf16 a[132:135], v[160:163], v[132:135], a[132:135]
    ds_read_b64_tr_b16 v[102:103], v18 offset:9216
    v_mfma_f32_16x16x32_bf16 a[188:191], v[160:163], v[136:139], a[188:191]
    ds_read_b64_tr_b16 v[104:105], v22 offset:8192
    v_mfma_f32_16x16x32_bf16 a[24:27], v[164:167], v[124:127], a[24:27]
    ds_read_b64_tr_b16 v[106:107], v22 offset:9216
    v_mfma_f32_16x16x32_bf16 a[80:83], v[164:167], v[128:131], a[80:83]
    ds_read_b64_tr_b16 v[108:109], v26 offset:8192
    v_mfma_f32_16x16x32_bf16 a[136:139], v[164:167], v[132:135], a[136:139]
    ds_read_b64_tr_b16 v[110:111], v26 offset:9216
    v_mfma_f32_16x16x32_bf16 a[192:195], v[164:167], v[136:139], a[192:195]
    ds_read_b64_tr_b16 v[112:113], v30 offset:8192
    v_mfma_f32_16x16x32_bf16 a[28:31], v[168:171], v[124:127], a[28:31]
    ds_read_b64_tr_b16 v[114:115], v30 offset:9216
    v_mfma_f32_16x16x32_bf16 a[84:87], v[168:171], v[128:131], a[84:87]
    ds_read_b64_tr_b16 v[116:117], v34 offset:8192
    v_mfma_f32_16x16x32_bf16 a[140:143], v[168:171], v[132:135], a[140:143]
    ds_read_b64_tr_b16 v[118:119], v34 offset:9216
    v_mfma_f32_16x16x32_bf16 a[196:199], v[168:171], v[136:139], a[196:199]
    ds_read_b64_tr_b16 v[120:121], v38 offset:8192
    v_mfma_f32_16x16x32_bf16 a[32:35], v[172:175], v[124:127], a[32:35]
    ds_read_b64_tr_b16 v[122:123], v38 offset:9216
    v_mfma_f32_16x16x32_bf16 a[88:91], v[172:175], v[128:131], a[88:91]
    v_mfma_f32_16x16x32_bf16 a[144:147], v[172:175], v[132:135], a[144:147]
    v_mfma_f32_16x16x32_bf16 a[200:203], v[172:175], v[136:139], a[200:203]
    v_mfma_f32_16x16x32_bf16 a[36:39], v[176:179], v[124:127], a[36:39]
    v_mfma_f32_16x16x32_bf16 a[92:95], v[176:179], v[128:131], a[92:95]
    v_mfma_f32_16x16x32_bf16 a[148:151], v[176:179], v[132:135], a[148:151]
    v_mfma_f32_16x16x32_bf16 a[204:207], v[176:179], v[136:139], a[204:207]
    v_mfma_f32_16x16x32_bf16 a[40:43], v[180:183], v[124:127], a[40:43]
    v_mfma_f32_16x16x32_bf16 a[96:99], v[180:183], v[128:131], a[96:99]
    v_mfma_f32_16x16x32_bf16 a[152:155], v[180:183], v[132:135], a[152:155]
    v_mfma_f32_16x16x32_bf16 a[208:211], v[180:183], v[136:139], a[208:211]
    v_mfma_f32_16x16x32_bf16 a[44:47], v[184:187], v[124:127], a[44:47]
    v_mfma_f32_16x16x32_bf16 a[100:103], v[184:187], v[128:131], a[100:103]
    v_mfma_f32_16x16x32_bf16 a[156:159], v[184:187], v[132:135], a[156:159]
    v_mfma_f32_16x16x32_bf16 a[212:215], v[184:187], v[136:139], a[212:215]
    v_mfma_f32_16x16x32_bf16 a[48:51], v[188:191], v[124:127], a[48:51]
    v_mfma_f32_16x16x32_bf16 a[104:107], v[188:191], v[128:131], a[104:107]
    v_mfma_f32_16x16x32_bf16 a[160:163], v[188:191], v[132:135], a[160:163]
    v_mfma_f32_16x16x32_bf16 a[216:219], v[188:191], v[136:139], a[216:219]
    v_mfma_f32_16x16x32_bf16 a[52:55], v[192:195], v[124:127], a[52:55]
    v_mfma_f32_16x16x32_bf16 a[108:111], v[192:195], v[128:131], a[108:111]
    v_mfma_f32_16x16x32_bf16 a[164:167], v[192:195], v[132:135], a[164:167]
    v_mfma_f32_16x16x32_bf16 a[220:223], v[192:195], v[136:139], a[220:223]
    s_waitcnt lgkmcnt(0)
    v_mfma_f32_16x16x32_bf16 a[0:3], v[68:71], v[52:55], a[0:3]
    v_mfma_f32_16x16x32_bf16 a[56:59], v[68:71], v[56:59], a[56:59]
    s_waitcnt vmcnt(16)
    s_barrier
    ds_read_b128 v[124:127], v11 offset:0
    v_mfma_f32_16x16x32_bf16 a[112:115], v[68:71], v[60:63], a[112:115]
    ds_read_b128 v[128:131], v11 offset:1024
    v_mfma_f32_16x16x32_bf16 a[168:171], v[68:71], v[64:67], a[168:171]
    ds_read_b128 v[132:135], v11 offset:2048
    v_mfma_f32_16x16x32_bf16 a[4:7], v[72:75], v[52:55], a[4:7]
    ds_read_b128 v[136:139], v11 offset:3072
    v_mfma_f32_16x16x32_bf16 a[60:63], v[72:75], v[56:59], a[60:63]
    ds_read_b64_tr_b16 v[140:141], v15 offset:0
    v_mfma_f32_16x16x32_bf16 a[116:119], v[72:75], v[60:63], a[116:119]
    ds_read_b64_tr_b16 v[142:143], v15 offset:1024
    v_mfma_f32_16x16x32_bf16 a[172:175], v[72:75], v[64:67], a[172:175]
    ds_read_b64_tr_b16 v[144:145], v19 offset:0
    v_mfma_f32_16x16x32_bf16 a[8:11], v[76:79], v[52:55], a[8:11]
    ds_read_b64_tr_b16 v[146:147], v19 offset:1024
    v_mfma_f32_16x16x32_bf16 a[64:67], v[76:79], v[56:59], a[64:67]
    ds_read_b64_tr_b16 v[148:149], v23 offset:0
    v_mfma_f32_16x16x32_bf16 a[120:123], v[76:79], v[60:63], a[120:123]
    ds_read_b64_tr_b16 v[150:151], v23 offset:1024
    v_mfma_f32_16x16x32_bf16 a[176:179], v[76:79], v[64:67], a[176:179]
    ds_read_b64_tr_b16 v[152:153], v27 offset:0
    v_mfma_f32_16x16x32_bf16 a[12:15], v[80:83], v[52:55], a[12:15]
    ds_read_b64_tr_b16 v[154:155], v27 offset:1024
    v_mfma_f32_16x16x32_bf16 a[68:71], v[80:83], v[56:59], a[68:71]
    ds_read_b64_tr_b16 v[156:157], v31 offset:0
    v_mfma_f32_16x16x32_bf16 a[124:127], v[80:83], v[60:63], a[124:127]
    ds_read_b64_tr_b16 v[158:159], v31 offset:1024
    v_mfma_f32_16x16x32_bf16 a[180:183], v[80:83], v[64:67], a[180:183]
    ds_read_b64_tr_b16 v[160:161], v35 offset:0
    v_mfma_f32_16x16x32_bf16 a[16:19], v[84:87], v[52:55], a[16:19]
    ds_read_b64_tr_b16 v[162:163], v35 offset:1024
    v_mfma_f32_16x16x32_bf16 a[72:75], v[84:87], v[56:59], a[72:75]
    ds_read_b64_tr_b16 v[164:165], v39 offset:0
    v_mfma_f32_16x16x32_bf16 a[128:131], v[84:87], v[60:63], a[128:131]
    ds_read_b64_tr_b16 v[166:167], v39 offset:1024
    v_mfma_f32_16x16x32_bf16 a[184:187], v[84:87], v[64:67], a[184:187]
    ds_read_b64_tr_b16 v[168:169], v15 offset:8192
    v_mfma_f32_16x16x32_bf16 a[20:23], v[88:91], v[52:55], a[20:23]
    ds_read_b64_tr_b16 v[170:171], v15 offset:9216
    v_mfma_f32_16x16x32_bf16 a[76:79], v[88:91], v[56:59], a[76:79]
    ds_read_b64_tr_b16 v[172:173], v19 offset:8192
    v_mfma_f32_16x16x32_bf16 a[132:135], v[88:91], v[60:63], a[132:135]
    ds_read_b64_tr_b16 v[174:175], v19 offset:9216
    v_mfma_f32_16x16x32_bf16 a[188:191], v[88:91], v[64:67], a[188:191]
    ds_read_b64_tr_b16 v[176:177], v23 offset:8192
    v_mfma_f32_16x16x32_bf16 a[24:27], v[92:95], v[52:55], a[24:27]
    ds_read_b64_tr_b16 v[178:179], v23 offset:9216
    v_mfma_f32_16x16x32_bf16 a[80:83], v[92:95], v[56:59], a[80:83]
    ds_read_b64_tr_b16 v[180:181], v27 offset:8192
    v_mfma_f32_16x16x32_bf16 a[136:139], v[92:95], v[60:63], a[136:139]
    ds_read_b64_tr_b16 v[182:183], v27 offset:9216
    v_mfma_f32_16x16x32_bf16 a[192:195], v[92:95], v[64:67], a[192:195]
    ds_read_b64_tr_b16 v[184:185], v31 offset:8192
    v_mfma_f32_16x16x32_bf16 a[28:31], v[96:99], v[52:55], a[28:31]
    ds_read_b64_tr_b16 v[186:187], v31 offset:9216
    v_mfma_f32_16x16x32_bf16 a[84:87], v[96:99], v[56:59], a[84:87]
    ds_read_b64_tr_b16 v[188:189], v35 offset:8192
    v_mfma_f32_16x16x32_bf16 a[140:143], v[96:99], v[60:63], a[140:143]
    ds_read_b64_tr_b16 v[190:191], v35 offset:9216
    v_mfma_f32_16x16x32_bf16 a[196:199], v[96:99], v[64:67], a[196:199]
    ds_read_b64_tr_b16 v[192:193], v39 offset:8192
    v_mfma_f32_16x16x32_bf16 a[32:35], v[100:103], v[52:55], a[32:35]
    ds_read_b64_tr_b16 v[194:195], v39 offset:9216
    v_mfma_f32_16x16x32_bf16 a[88:91], v[100:103], v[56:59], a[88:91]
    v_mfma_f32_16x16x32_bf16 a[144:147], v[100:103], v[60:63], a[144:147]
    v_mfma_f32_16x16x32_bf16 a[200:203], v[100:103], v[64:67], a[200:203]
    v_mfma_f32_16x16x32_bf16 a[36:39], v[104:107], v[52:55], a[36:39]
    v_mfma_f32_16x16x32_bf16 a[92:95], v[104:107], v[56:59], a[92:95]
    v_mfma_f32_16x16x32_bf16 a[148:151], v[104:107], v[60:63], a[148:151]
    v_mfma_f32_16x16x32_bf16 a[204:207], v[104:107], v[64:67], a[204:207]
    v_mfma_f32_16x16x32_bf16 a[40:43], v[108:111], v[52:55], a[40:43]
    v_mfma_f32_16x16x32_bf16 a[96:99], v[108:111], v[56:59], a[96:99]
    v_mfma_f32_16x16x32_bf16 a[152:155], v[108:111], v[60:63], a[152:155]
    v_mfma_f32_16x16x32_bf16 a[208:211], v[108:111], v[64:67], a[208:211]
    v_mfma_f32_16x16x32_bf16 a[44:47], v[112:115], v[52:55], a[44:47]
    v_mfma_f32_16x16x32_bf16 a[100:103], v[112:115], v[56:59], a[100:103]
    v_mfma_f32_16x16x32_bf16 a[156:159], v[112:115], v[60:63], a[156:159]
    v_mfma_f32_16x16x32_bf16 a[212:215], v[112:115], v[64:67], a[212:215]
    v_mfma_f32_16x16x32_bf16 a[48:51], v[116:119], v[52:55], a[48:51]
    v_mfma_f32_16x16x32_bf16 a[104:107], v[116:119], v[56:59], a[104:107]
    v_mfma_f32_16x16x32_bf16 a[160:163], v[116:119], v[60:63], a[160:163]
    v_mfma_f32_16x16x32_bf16 a[216:219], v[116:119], v[64:67], a[216:219]
    v_mfma_f32_16x16x32_bf16 a[52:55], v[120:123], v[52:55], a[52:55]
    v_mfma_f32_16x16x32_bf16 a[108:111], v[120:123], v[56:59], a[108:111]
    v_mfma_f32_16x16x32_bf16 a[164:167], v[120:123], v[60:63], a[164:167]
    v_mfma_f32_16x16x32_bf16 a[220:223], v[120:123], v[64:67], a[220:223]
    s_waitcnt lgkmcnt(0)
    v_mfma_f32_16x16x32_bf16 a[0:3], v[140:143], v[124:127], a[0:3]
    v_mfma_f32_16x16x32_bf16 a[56:59], v[140:143], v[128:131], a[56:59]
    s_waitcnt vmcnt(8)
    s_barrier
    ds_read_b128 v[52:55], v12 offset:0
    v_mfma_f32_16x16x32_bf16 a[112:115], v[140:143], v[132:135], a[112:115]
    ds_read_b128 v[56:59], v12 offset:1024
    v_mfma_f32_16x16x32_bf16 a[168:171], v[140:143], v[136:139], a[168:171]
    ds_read_b128 v[60:63], v12 offset:2048
    v_mfma_f32_16x16x32_bf16 a[4:7], v[144:147], v[124:127], a[4:7]
    ds_read_b128 v[64:67], v12 offset:3072
    v_mfma_f32_16x16x32_bf16 a[60:63], v[144:147], v[128:131], a[60:63]
    ds_read_b64_tr_b16 v[68:69], v16 offset:0
    v_mfma_f32_16x16x32_bf16 a[116:119], v[144:147], v[132:135], a[116:119]
    ds_read_b64_tr_b16 v[70:71], v16 offset:1024
    v_mfma_f32_16x16x32_bf16 a[172:175], v[144:147], v[136:139], a[172:175]
    ds_read_b64_tr_b16 v[72:73], v20 offset:0
    v_mfma_f32_16x16x32_bf16 a[8:11], v[148:151], v[124:127], a[8:11]
    ds_read_b64_tr_b16 v[74:75], v20 offset:1024
    v_mfma_f32_16x16x32_bf16 a[64:67], v[148:151], v[128:131], a[64:67]
    ds_read_b64_tr_b16 v[76:77], v24 offset:0
    v_mfma_f32_16x16x32_bf16 a[120:123], v[148:151], v[132:135], a[120:123]
    ds_read_b64_tr_b16 v[78:79], v24 offset:1024
    v_mfma_f32_16x16x32_bf16 a[176:179], v[148:151], v[136:139], a[176:179]
    ds_read_b64_tr_b16 v[80:81], v28 offset:0
    v_mfma_f32_16x16x32_bf16 a[12:15], v[152:155], v[124:127], a[12:15]
    ds_read_b64_tr_b16 v[82:83], v28 offset:1024
    v_mfma_f32_16x16x32_bf16 a[68:71], v[152:155], v[128:131], a[68:71]
    ds_read_b64_tr_b16 v[84:85], v32 offset:0
    v_mfma_f32_16x16x32_bf16 a[124:127], v[152:155], v[132:135], a[124:127]
    ds_read_b64_tr_b16 v[86:87], v32 offset:1024
    v_mfma_f32_16x16x32_bf16 a[180:183], v[152:155], v[136:139], a[180:183]
    ds_read_b64_tr_b16 v[88:89], v36 offset:0
    v_mfma_f32_16x16x32_bf16 a[16:19], v[156:159], v[124:127], a[16:19]
    ds_read_b64_tr_b16 v[90:91], v36 offset:1024
    v_mfma_f32_16x16x32_bf16 a[72:75], v[156:159], v[128:131], a[72:75]
    ds_read_b64_tr_b16 v[92:93], v40 offset:0
    v_mfma_f32_16x16x32_bf16 a[128:131], v[156:159], v[132:135], a[128:131]
    ds_read_b64_tr_b16 v[94:95], v40 offset:1024
    v_mfma_f32_16x16x32_bf16 a[184:187], v[156:159], v[136:139], a[184:187]
    ds_read_b64_tr_b16 v[96:97], v16 offset:8192
    v_mfma_f32_16x16x32_bf16 a[20:23], v[160:163], v[124:127], a[20:23]
    ds_read_b64_tr_b16 v[98:99], v16 offset:9216
    v_mfma_f32_16x16x32_bf16 a[76:79], v[160:163], v[128:131], a[76:79]
    ds_read_b64_tr_b16 v[100:101], v20 offset:8192
    v_mfma_f32_16x16x32_bf16 a[132:135], v[160:163], v[132:135], a[132:135]
    ds_read_b64_tr_b16 v[102:103], v20 offset:9216
    v_mfma_f32_16x16x32_bf16 a[188:191], v[160:163], v[136:139], a[188:191]
    ds_read_b64_tr_b16 v[104:105], v24 offset:8192
    v_mfma_f32_16x16x32_bf16 a[24:27], v[164:167], v[124:127], a[24:27]
    ds_read_b64_tr_b16 v[106:107], v24 offset:9216
    v_mfma_f32_16x16x32_bf16 a[80:83], v[164:167], v[128:131], a[80:83]
    ds_read_b64_tr_b16 v[108:109], v28 offset:8192
    v_mfma_f32_16x16x32_bf16 a[136:139], v[164:167], v[132:135], a[136:139]
    ds_read_b64_tr_b16 v[110:111], v28 offset:9216
    v_mfma_f32_16x16x32_bf16 a[192:195], v[164:167], v[136:139], a[192:195]
    ds_read_b64_tr_b16 v[112:113], v32 offset:8192
    v_mfma_f32_16x16x32_bf16 a[28:31], v[168:171], v[124:127], a[28:31]
    ds_read_b64_tr_b16 v[114:115], v32 offset:9216
    v_mfma_f32_16x16x32_bf16 a[84:87], v[168:171], v[128:131], a[84:87]
    ds_read_b64_tr_b16 v[116:117], v36 offset:8192
    v_mfma_f32_16x16x32_bf16 a[140:143], v[168:171], v[132:135], a[140:143]
    ds_read_b64_tr_b16 v[118:119], v36 offset:9216
    v_mfma_f32_16x16x32_bf16 a[196:199], v[168:171], v[136:139], a[196:199]
    ds_read_b64_tr_b16 v[120:121], v40 offset:8192
    v_mfma_f32_16x16x32_bf16 a[32:35], v[172:175], v[124:127], a[32:35]
    ds_read_b64_tr_b16 v[122:123], v40 offset:9216
    v_mfma_f32_16x16x32_bf16 a[88:91], v[172:175], v[128:131], a[88:91]
    v_mfma_f32_16x16x32_bf16 a[144:147], v[172:175], v[132:135], a[144:147]
    v_mfma_f32_16x16x32_bf16 a[200:203], v[172:175], v[136:139], a[200:203]
    v_mfma_f32_16x16x32_bf16 a[36:39], v[176:179], v[124:127], a[36:39]
    v_mfma_f32_16x16x32_bf16 a[92:95], v[176:179], v[128:131], a[92:95]
    v_mfma_f32_16x16x32_bf16 a[148:151], v[176:179], v[132:135], a[148:151]
    v_mfma_f32_16x16x32_bf16 a[204:207], v[176:179], v[136:139], a[204:207]
    v_mfma_f32_16x16x32_bf16 a[40:43], v[180:183], v[124:127], a[40:43]
    v_mfma_f32_16x16x32_bf16 a[96:99], v[180:183], v[128:131], a[96:99]
    v_mfma_f32_16x16x32_bf16 a[152:155], v[180:183], v[132:135], a[152:155]
    v_mfma_f32_16x16x32_bf16 a[208:211], v[180:183], v[136:139], a[208:211]
    v_mfma_f32_16x16x32_bf16 a[44:47], v[184:187], v[124:127], a[44:47]
    v_mfma_f32_16x16x32_bf16 a[100:103], v[184:187], v[128:131], a[100:103]
    v_mfma_f32_16x16x32_bf16 a[156:159], v[184:187], v[132:135], a[156:159]
    v_mfma_f32_16x16x32_bf16 a[212:215], v[184:187], v[136:139], a[212:215]
    v_mfma_f32_16x16x32_bf16 a[48:51], v[188:191], v[124:127], a[48:51]
    v_mfma_f32_16x16x32_bf16 a[104:107], v[188:191], v[128:131], a[104:107]
    v_mfma_f32_16x16x32_bf16 a[160:163], v[188:191], v[132:135], a[160:163]
    v_mfma_f32_16x16x32_bf16 a[216:219], v[188:191], v[136:139], a[216:219]
    v_mfma_f32_16x16x32_bf16 a[52:55], v[192:195], v[124:127], a[52:55]
    v_mfma_f32_16x16x32_bf16 a[108:111], v[192:195], v[128:131], a[108:111]
    v_mfma_f32_16x16x32_bf16 a[164:167], v[192:195], v[132:135], a[164:167]
    v_mfma_f32_16x16x32_bf16 a[220:223], v[192:195], v[136:139], a[220:223]
    s_waitcnt lgkmcnt(0)
    v_mfma_f32_16x16x32_bf16 a[0:3], v[68:71], v[52:55], a[0:3]
    v_mfma_f32_16x16x32_bf16 a[56:59], v[68:71], v[56:59], a[56:59]
    s_waitcnt vmcnt(0)
    s_barrier
    ds_read_b128 v[124:127], v13 offset:0
    v_mfma_f32_16x16x32_bf16 a[112:115], v[68:71], v[60:63], a[112:115]
    ds_read_b128 v[128:131], v13 offset:1024
    v_mfma_f32_16x16x32_bf16 a[168:171], v[68:71], v[64:67], a[168:171]
    ds_read_b128 v[132:135], v13 offset:2048
    v_mfma_f32_16x16x32_bf16 a[4:7], v[72:75], v[52:55], a[4:7]
    ds_read_b128 v[136:139], v13 offset:3072
    v_mfma_f32_16x16x32_bf16 a[60:63], v[72:75], v[56:59], a[60:63]
    ds_read_b64_tr_b16 v[140:141], v17 offset:0
    v_mfma_f32_16x16x32_bf16 a[116:119], v[72:75], v[60:63], a[116:119]
    ds_read_b64_tr_b16 v[142:143], v17 offset:1024
    v_mfma_f32_16x16x32_bf16 a[172:175], v[72:75], v[64:67], a[172:175]
    ds_read_b64_tr_b16 v[144:145], v21 offset:0
    v_mfma_f32_16x16x32_bf16 a[8:11], v[76:79], v[52:55], a[8:11]
    ds_read_b64_tr_b16 v[146:147], v21 offset:1024
    v_mfma_f32_16x16x32_bf16 a[64:67], v[76:79], v[56:59], a[64:67]
    ds_read_b64_tr_b16 v[148:149], v25 offset:0
    v_mfma_f32_16x16x32_bf16 a[120:123], v[76:79], v[60:63], a[120:123]
    ds_read_b64_tr_b16 v[150:151], v25 offset:1024
    v_mfma_f32_16x16x32_bf16 a[176:179], v[76:79], v[64:67], a[176:179]
    ds_read_b64_tr_b16 v[152:153], v29 offset:0
    v_mfma_f32_16x16x32_bf16 a[12:15], v[80:83], v[52:55], a[12:15]
    ds_read_b64_tr_b16 v[154:155], v29 offset:1024
    v_mfma_f32_16x16x32_bf16 a[68:71], v[80:83], v[56:59], a[68:71]
    ds_read_b64_tr_b16 v[156:157], v33 offset:0
    v_mfma_f32_16x16x32_bf16 a[124:127], v[80:83], v[60:63], a[124:127]
    ds_read_b64_tr_b16 v[158:159], v33 offset:1024
    v_mfma_f32_16x16x32_bf16 a[180:183], v[80:83], v[64:67], a[180:183]
    ds_read_b64_tr_b16 v[160:161], v37 offset:0
    v_mfma_f32_16x16x32_bf16 a[16:19], v[84:87], v[52:55], a[16:19]
    ds_read_b64_tr_b16 v[162:163], v37 offset:1024
    v_mfma_f32_16x16x32_bf16 a[72:75], v[84:87], v[56:59], a[72:75]
    ds_read_b64_tr_b16 v[164:165], v41 offset:0
    v_mfma_f32_16x16x32_bf16 a[128:131], v[84:87], v[60:63], a[128:131]
    ds_read_b64_tr_b16 v[166:167], v41 offset:1024
    v_mfma_f32_16x16x32_bf16 a[184:187], v[84:87], v[64:67], a[184:187]
    ds_read_b64_tr_b16 v[168:169], v17 offset:8192
    v_mfma_f32_16x16x32_bf16 a[20:23], v[88:91], v[52:55], a[20:23]
    ds_read_b64_tr_b16 v[170:171], v17 offset:9216
    v_mfma_f32_16x16x32_bf16 a[76:79], v[88:91], v[56:59], a[76:79]
    ds_read_b64_tr_b16 v[172:173], v21 offset:8192
    v_mfma_f32_16x16x32_bf16 a[132:135], v[88:91], v[60:63], a[132:135]
    ds_read_b64_tr_b16 v[174:175], v21 offset:9216
    v_mfma_f32_16x16x32_bf16 a[188:191], v[88:91], v[64:67], a[188:191]
    ds_read_b64_tr_b16 v[176:177], v25 offset:8192
    v_mfma_f32_16x16x32_bf16 a[24:27], v[92:95], v[52:55], a[24:27]
    ds_read_b64_tr_b16 v[178:179], v25 offset:9216
    v_mfma_f32_16x16x32_bf16 a[80:83], v[92:95], v[56:59], a[80:83]
    ds_read_b64_tr_b16 v[180:181], v29 offset:8192
    v_mfma_f32_16x16x32_bf16 a[136:139], v[92:95], v[60:63], a[136:139]
    ds_read_b64_tr_b16 v[182:183], v29 offset:9216
    v_mfma_f32_16x16x32_bf16 a[192:195], v[92:95], v[64:67], a[192:195]
    ds_read_b64_tr_b16 v[184:185], v33 offset:8192
    v_mfma_f32_16x16x32_bf16 a[28:31], v[96:99], v[52:55], a[28:31]
    ds_read_b64_tr_b16 v[186:187], v33 offset:9216
    v_mfma_f32_16x16x32_bf16 a[84:87], v[96:99], v[56:59], a[84:87]
    ds_read_b64_tr_b16 v[188:189], v37 offset:8192
    v_mfma_f32_16x16x32_bf16 a[140:143], v[96:99], v[60:63], a[140:143]
    ds_read_b64_tr_b16 v[190:191], v37 offset:9216
    v_mfma_f32_16x16x32_bf16 a[196:199], v[96:99], v[64:67], a[196:199]
    ds_read_b64_tr_b16 v[192:193], v41 offset:8192
    v_mfma_f32_16x16x32_bf16 a[32:35], v[100:103], v[52:55], a[32:35]
    ds_read_b64_tr_b16 v[194:195], v41 offset:9216
    v_mfma_f32_16x16x32_bf16 a[88:91], v[100:103], v[56:59], a[88:91]
    v_mfma_f32_16x16x32_bf16 a[144:147], v[100:103], v[60:63], a[144:147]
    v_mfma_f32_16x16x32_bf16 a[200:203], v[100:103], v[64:67], a[200:203]
    v_mfma_f32_16x16x32_bf16 a[36:39], v[104:107], v[52:55], a[36:39]
    v_mfma_f32_16x16x32_bf16 a[92:95], v[104:107], v[56:59], a[92:95]
    v_mfma_f32_16x16x32_bf16 a[148:151], v[104:107], v[60:63], a[148:151]
    v_mfma_f32_16x16x32_bf16 a[204:207], v[104:107], v[64:67], a[204:207]
    v_mfma_f32_16x16x32_bf16 a[40:43], v[108:111], v[52:55], a[40:43]
    v_mfma_f32_16x16x32_bf16 a[96:99], v[108:111], v[56:59], a[96:99]
    v_mfma_f32_16x16x32_bf16 a[152:155], v[108:111], v[60:63], a[152:155]
    v_mfma_f32_16x16x32_bf16 a[208:211], v[108:111], v[64:67], a[208:211]
    v_mfma_f32_16x16x32_bf16 a[44:47], v[112:115], v[52:55], a[44:47]
    v_mfma_f32_16x16x32_bf16 a[100:103], v[112:115], v[56:59], a[100:103]
    v_mfma_f32_16x16x32_bf16 a[156:159], v[112:115], v[60:63], a[156:159]
    v_mfma_f32_16x16x32_bf16 a[212:215], v[112:115], v[64:67], a[212:215]
    v_mfma_f32_16x16x32_bf16 a[48:51], v[116:119], v[52:55], a[48:51]
    v_mfma_f32_16x16x32_bf16 a[104:107], v[116:119], v[56:59], a[104:107]
    v_mfma_f32_16x16x32_bf16 a[160:163], v[116:119], v[60:63], a[160:163]
    v_mfma_f32_16x16x32_bf16 a[216:219], v[116:119], v[64:67], a[216:219]
    v_mfma_f32_16x16x32_bf16 a[52:55], v[120:123], v[52:55], a[52:55]
    v_mfma_f32_16x16x32_bf16 a[108:111], v[120:123], v[56:59], a[108:111]
    v_mfma_f32_16x16x32_bf16 a[164:167], v[120:123], v[60:63], a[164:167]
    v_mfma_f32_16x16x32_bf16 a[220:223], v[120:123], v[64:67], a[220:223]
    s_waitcnt lgkmcnt(0)
    v_mfma_f32_16x16x32_bf16 a[0:3], v[140:143], v[124:127], a[0:3]
    v_mfma_f32_16x16x32_bf16 a[56:59], v[140:143], v[128:131], a[56:59]
    v_mfma_f32_16x16x32_bf16 a[112:115], v[140:143], v[132:135], a[112:115]
    v_mfma_f32_16x16x32_bf16 a[168:171], v[140:143], v[136:139], a[168:171]
    v_mfma_f32_16x16x32_bf16 a[4:7], v[144:147], v[124:127], a[4:7]
    v_mfma_f32_16x16x32_bf16 a[60:63], v[144:147], v[128:131], a[60:63]
    v_mfma_f32_16x16x32_bf16 a[116:119], v[144:147], v[132:135], a[116:119]
    v_mfma_f32_16x16x32_bf16 a[172:175], v[144:147], v[136:139], a[172:175]
    v_mfma_f32_16x16x32_bf16 a[8:11], v[148:151], v[124:127], a[8:11]
    v_mfma_f32_16x16x32_bf16 a[64:67], v[148:151], v[128:131], a[64:67]
    v_mfma_f32_16x16x32_bf16 a[120:123], v[148:151], v[132:135], a[120:123]
    v_mfma_f32_16x16x32_bf16 a[176:179], v[148:151], v[136:139], a[176:179]
    v_mfma_f32_16x16x32_bf16 a[12:15], v[152:155], v[124:127], a[12:15]
    v_mfma_f32_16x16x32_bf16 a[68:71], v[152:155], v[128:131], a[68:71]
    v_mfma_f32_16x16x32_bf16 a[124:127], v[152:155], v[132:135], a[124:127]
    v_mfma_f32_16x16x32_bf16 a[180:183], v[152:155], v[136:139], a[180:183]
    v_mfma_f32_16x16x32_bf16 a[16:19], v[156:159], v[124:127], a[16:19]
    v_mfma_f32_16x16x32_bf16 a[72:75], v[156:159], v[128:131], a[72:75]
    v_mfma_f32_16x16x32_bf16 a[128:131], v[156:159], v[132:135], a[128:131]
    v_mfma_f32_16x16x32_bf16 a[184:187], v[156:159], v[136:139], a[184:187]
    v_mfma_f32_16x16x32_bf16 a[20:23], v[160:163], v[124:127], a[20:23]
    v_mfma_f32_16x16x32_bf16 a[76:79], v[160:163], v[128:131], a[76:79]
    v_mfma_f32_16x16x32_bf16 a[132:135], v[160:163], v[132:135], a[132:135]
    v_mfma_f32_16x16x32_bf16 a[188:191], v[160:163], v[136:139], a[188:191]
    v_mfma_f32_16x16x32_bf16 a[24:27], v[164:167], v[124:127], a[24:27]
    v_mfma_f32_16x16x32_bf16 a[80:83], v[164:167], v[128:131], a[80:83]
    v_mfma_f32_16x16x32_bf16 a[136:139], v[164:167], v[132:135], a[136:139]
    v_mfma_f32_16x16x32_bf16 a[192:195], v[164:167], v[136:139], a[192:195]
    v_mfma_f32_16x16x32_bf16 a[28:31], v[168:171], v[124:127], a[28:31]
    v_mfma_f32_16x16x32_bf16 a[84:87], v[168:171], v[128:131], a[84:87]
    v_mfma_f32_16x16x32_bf16 a[140:143], v[168:171], v[132:135], a[140:143]
    v_mfma_f32_16x16x32_bf16 a[196:199], v[168:171], v[136:139], a[196:199]
    v_mfma_f32_16x16x32_bf16 a[32:35], v[172:175], v[124:127], a[32:35]
    v_mfma_f32_16x16x32_bf16 a[88:91], v[172:175], v[128:131], a[88:91]
    v_mfma_f32_16x16x32_bf16 a[144:147], v[172:175], v[132:135], a[144:147]
    v_mfma_f32_16x16x32_bf16 a[200:203], v[172:175], v[136:139], a[200:203]
    v_mfma_f32_16x16x32_bf16 a[36:39], v[176:179], v[124:127], a[36:39]
    v_mfma_f32_16x16x32_bf16 a[92:95], v[176:179], v[128:131], a[92:95]
    v_mfma_f32_16x16x32_bf16 a[148:151], v[176:179], v[132:135], a[148:151]
    v_mfma_f32_16x16x32_bf16 a[204:207], v[176:179], v[136:139], a[204:207]
    v_mfma_f32_16x16x32_bf16 a[40:43], v[180:183], v[124:127], a[40:43]
    v_mfma_f32_16x16x32_bf16 a[96:99], v[180:183], v[128:131], a[96:99]
    v_mfma_f32_16x16x32_bf16 a[152:155], v[180:183], v[132:135], a[152:155]
    v_mfma_f32_16x16x32_bf16 a[208:211], v[180:183], v[136:139], a[208:211]
    v_mfma_f32_16x16x32_bf16 a[44:47], v[184:187], v[124:127], a[44:47]
    v_mfma_f32_16x16x32_bf16 a[100:103], v[184:187], v[128:131], a[100:103]
    v_mfma_f32_16x16x32_bf16 a[156:159], v[184:187], v[132:135], a[156:159]
    v_mfma_f32_16x16x32_bf16 a[212:215], v[184:187], v[136:139], a[212:215]
    v_mfma_f32_16x16x32_bf16 a[48:51], v[188:191], v[124:127], a[48:51]
    v_mfma_f32_16x16x32_bf16 a[104:107], v[188:191], v[128:131], a[104:107]
    v_mfma_f32_16x16x32_bf16 a[160:163], v[188:191], v[132:135], a[160:163]
    v_mfma_f32_16x16x32_bf16 a[216:219], v[188:191], v[136:139], a[216:219]
    v_mfma_f32_16x16x32_bf16 a[52:55], v[192:195], v[124:127], a[52:55]
    v_mfma_f32_16x16x32_bf16 a[108:111], v[192:195], v[128:131], a[108:111]
    v_mfma_f32_16x16x32_bf16 a[164:167], v[192:195], v[132:135], a[164:167]
    v_mfma_f32_16x16x32_bf16 a[220:223], v[192:195], v[136:139], a[220:223]
    s_nop 7
    s_nop 7
    s_barrier
    v_and_b32 v42, 15, v0
    v_lshrrev_b32 v43, 4, v0
    s_mul_i32 s30, s26, 64
    v_add_u32 v42, s30, v42
    v_mul_u32_u24 v42, 464, v42
    s_mul_i32 s30, s27, 448
    v_lshl_add_u32 v42, v43, 4, v42
    v_add_u32 v44, s30, v42
    v_accvgpr_read_b32 v52, a0
    v_accvgpr_read_b32 v53, a1
    v_accvgpr_read_b32 v54, a2
    v_accvgpr_read_b32 v55, a3
    v_accvgpr_read_b32 v56, a28
    v_accvgpr_read_b32 v57, a29
    v_accvgpr_read_b32 v58, a30
    v_accvgpr_read_b32 v59, a31
    v_mul_f32 v60, 0xbfb8aa3b, v52
    v_mul_f32 v61, 0xbfb8aa3b, v53
    v_mul_f32 v62, 0xbfb8aa3b, v54
    v_mul_f32 v63, 0xbfb8aa3b, v55
    v_exp_f32 v60, v60
    v_exp_f32 v61, v61
    v_exp_f32 v62, v62
    v_exp_f32 v63, v63
    s_nop 0
    v_add_f32 v60, 1.0, v60
    v_add_f32 v61, 1.0, v61
    v_add_f32 v62, 1.0, v62
    v_add_f32 v63, 1.0, v63
    v_rcp_f32 v60, v60
    v_rcp_f32 v61, v61
    v_rcp_f32 v62, v62
    v_rcp_f32 v63, v63
    s_nop 0
    v_mul_f32 v52, v52, v60
    v_mul_f32 v53, v53, v61
    v_mul_f32 v54, v54, v62
    v_mul_f32 v55, v55, v63
    v_mul_f32 v52, v52, v56
    v_mul_f32 v53, v53, v57
    v_mul_f32 v54, v54, v58
    v_mul_f32 v55, v55, v59
    ds_write_b128 v44, v[52:55] offset:0
    v_accvgpr_read_b32 v68, a4
    v_accvgpr_read_b32 v69, a5
    v_accvgpr_read_b32 v70, a6
    v_accvgpr_read_b32 v71, a7
    v_accvgpr_read_b32 v72, a32
    v_accvgpr_read_b32 v73, a33
    v_accvgpr_read_b32 v74, a34
    v_accvgpr_read_b32 v75, a35
    v_mul_f32 v76, 0xbfb8aa3b, v68
    v_mul_f32 v77, 0xbfb8aa3b, v69
    v_mul_f32 v78, 0xbfb8aa3b, v70
    v_mul_f32 v79, 0xbfb8aa3b, v71
    v_exp_f32 v76, v76
    v_exp_f32 v77, v77
    v_exp_f32 v78, v78
    v_exp_f32 v79, v79
    s_nop 0
    v_add_f32 v76, 1.0, v76
    v_add_f32 v77, 1.0, v77
    v_add_f32 v78, 1.0, v78
    v_add_f32 v79, 1.0, v79
    v_rcp_f32 v76, v76
    v_rcp_f32 v77, v77
    v_rcp_f32 v78, v78
    v_rcp_f32 v79, v79
    s_nop 0
    v_mul_f32 v68, v68, v76
    v_mul_f32 v69, v69, v77
    v_mul_f32 v70, v70, v78
    v_mul_f32 v71, v71, v79
    v_mul_f32 v68, v68, v72
    v_mul_f32 v69, v69, v73
    v_mul_f32 v70, v70, v74
    v_mul_f32 v71, v71, v75
    ds_write_b128 v44, v[68:71] offset:64
    v_accvgpr_read_b32 v52, a8
    v_accvgpr_read_b32 v53, a9
    v_accvgpr_read_b32 v54, a10
    v_accvgpr_read_b32 v55, a11
    v_accvgpr_read_b32 v56, a36
    v_accvgpr_read_b32 v57, a37
    v_accvgpr_read_b32 v58, a38
    v_accvgpr_read_b32 v59, a39
    v_mul_f32 v60, 0xbfb8aa3b, v52
    v_mul_f32 v61, 0xbfb8aa3b, v53
    v_mul_f32 v62, 0xbfb8aa3b, v54
    v_mul_f32 v63, 0xbfb8aa3b, v55
    v_exp_f32 v60, v60
    v_exp_f32 v61, v61
    v_exp_f32 v62, v62
    v_exp_f32 v63, v63
    s_nop 0
    v_add_f32 v60, 1.0, v60
    v_add_f32 v61, 1.0, v61
    v_add_f32 v62, 1.0, v62
    v_add_f32 v63, 1.0, v63
    v_rcp_f32 v60, v60
    v_rcp_f32 v61, v61
    v_rcp_f32 v62, v62
    v_rcp_f32 v63, v63
    s_nop 0
    v_mul_f32 v52, v52, v60
    v_mul_f32 v53, v53, v61
    v_mul_f32 v54, v54, v62
    v_mul_f32 v55, v55, v63
    v_mul_f32 v52, v52, v56
    v_mul_f32 v53, v53, v57
    v_mul_f32 v54, v54, v58
    v_mul_f32 v55, v55, v59
    ds_write_b128 v44, v[52:55] offset:128
    v_accvgpr_read_b32 v68, a12
    v_accvgpr_read_b32 v69, a13
    v_accvgpr_read_b32 v70, a14
    v_accvgpr_read_b32 v71, a15
    v_accvgpr_read_b32 v72, a40
    v_accvgpr_read_b32 v73, a41
    v_accvgpr_read_b32 v74, a42
    v_accvgpr_read_b32 v75, a43
    v_mul_f32 v76, 0xbfb8aa3b, v68
    v_mul_f32 v77, 0xbfb8aa3b, v69
    v_mul_f32 v78, 0xbfb8aa3b, v70
    v_mul_f32 v79, 0xbfb8aa3b, v71
    v_exp_f32 v76, v76
    v_exp_f32 v77, v77
    v_exp_f32 v78, v78
    v_exp_f32 v79, v79
    s_nop 0
    v_add_f32 v76, 1.0, v76
    v_add_f32 v77, 1.0, v77
    v_add_f32 v78, 1.0, v78
    v_add_f32 v79, 1.0, v79
    v_rcp_f32 v76, v76
    v_rcp_f32 v77, v77
    v_rcp_f32 v78, v78
    v_rcp_f32 v79, v79
    s_nop 0
    v_mul_f32 v68, v68, v76
    v_mul_f32 v69, v69, v77
    v_mul_f32 v70, v70, v78
    v_mul_f32 v71, v71, v79
    v_mul_f32 v68, v68, v72
    v_mul_f32 v69, v69, v73
    v_mul_f32 v70, v70, v74
    v_mul_f32 v71, v71, v75
    ds_write_b128 v44, v[68:71] offset:192
    v_accvgpr_read_b32 v52, a16
    v_accvgpr_read_b32 v53, a17
    v_accvgpr_read_b32 v54, a18
    v_accvgpr_read_b32 v55, a19
    v_accvgpr_read_b32 v56, a44
    v_accvgpr_read_b32 v57, a45
    v_accvgpr_read_b32 v58, a46
    v_accvgpr_read_b32 v59, a47
    v_mul_f32 v60, 0xbfb8aa3b, v52
    v_mul_f32 v61, 0xbfb8aa3b, v53
    v_mul_f32 v62, 0xbfb8aa3b, v54
    v_mul_f32 v63, 0xbfb8aa3b, v55
    v_exp_f32 v60, v60
    v_exp_f32 v61, v61
    v_exp_f32 v62, v62
    v_exp_f32 v63, v63
    s_nop 0
    v_add_f32 v60, 1.0, v60
    v_add_f32 v61, 1.0, v61
    v_add_f32 v62, 1.0, v62
    v_add_f32 v63, 1.0, v63
    v_rcp_f32 v60, v60
    v_rcp_f32 v61, v61
    v_rcp_f32 v62, v62
    v_rcp_f32 v63, v63
    s_nop 0
    v_mul_f32 v52, v52, v60
    v_mul_f32 v53, v53, v61
    v_mul_f32 v54, v54, v62
    v_mul_f32 v55, v55, v63
    v_mul_f32 v52, v52, v56
    v_mul_f32 v53, v53, v57
    v_mul_f32 v54, v54, v58
    v_mul_f32 v55, v55, v59
    ds_write_b128 v44, v[52:55] offset:256
    v_accvgpr_read_b32 v68, a20
    v_accvgpr_read_b32 v69, a21
    v_accvgpr_read_b32 v70, a22
    v_accvgpr_read_b32 v71, a23
    v_accvgpr_read_b32 v72, a48
    v_accvgpr_read_b32 v73, a49
    v_accvgpr_read_b32 v74, a50
    v_accvgpr_read_b32 v75, a51
    v_mul_f32 v76, 0xbfb8aa3b, v68
    v_mul_f32 v77, 0xbfb8aa3b, v69
    v_mul_f32 v78, 0xbfb8aa3b, v70
    v_mul_f32 v79, 0xbfb8aa3b, v71
    v_exp_f32 v76, v76
    v_exp_f32 v77, v77
    v_exp_f32 v78, v78
    v_exp_f32 v79, v79
    s_nop 0
    v_add_f32 v76, 1.0, v76
    v_add_f32 v77, 1.0, v77
    v_add_f32 v78, 1.0, v78
    v_add_f32 v79, 1.0, v79
    v_rcp_f32 v76, v76
    v_rcp_f32 v77, v77
    v_rcp_f32 v78, v78
    v_rcp_f32 v79, v79
    s_nop 0
    v_mul_f32 v68, v68, v76
    v_mul_f32 v69, v69, v77
    v_mul_f32 v70, v70, v78
    v_mul_f32 v71, v71, v79
    v_mul_f32 v68, v68, v72
    v_mul_f32 v69, v69, v73
    v_mul_f32 v70, v70, v74
    v_mul_f32 v71, v71, v75
    ds_write_b128 v44, v[68:71] offset:320
    v_accvgpr_read_b32 v52, a24
    v_accvgpr_read_b32 v53, a25
    v_accvgpr_read_b32 v54, a26
    v_accvgpr_read_b32 v55, a27
    v_accvgpr_read_b32 v56, a52
    v_accvgpr_read_b32 v57, a53
    v_accvgpr_read_b32 v58, a54
    v_accvgpr_read_b32 v59, a55
    v_mul_f32 v60, 0xbfb8aa3b, v52
    v_mul_f32 v61, 0xbfb8aa3b, v53
    v_mul_f32 v62, 0xbfb8aa3b, v54
    v_mul_f32 v63, 0xbfb8aa3b, v55
    v_exp_f32 v60, v60
    v_exp_f32 v61, v61
    v_exp_f32 v62, v62
    v_exp_f32 v63, v63
    s_nop 0
    v_add_f32 v60, 1.0, v60
    v_add_f32 v61, 1.0, v61
    v_add_f32 v62, 1.0, v62
    v_add_f32 v63, 1.0, v63
    v_rcp_f32 v60, v60
    v_rcp_f32 v61, v61
    v_rcp_f32 v62, v62
    v_rcp_f32 v63, v63
    s_nop 0
    v_mul_f32 v52, v52, v60
    v_mul_f32 v53, v53, v61
    v_mul_f32 v54, v54, v62
    v_mul_f32 v55, v55, v63
    v_mul_f32 v52, v52, v56
    v_mul_f32 v53, v53, v57
    v_mul_f32 v54, v54, v58
    v_mul_f32 v55, v55, v59
    ds_write_b128 v44, v[52:55] offset:384
    v_accvgpr_read_b32 v52, a56
    v_accvgpr_read_b32 v53, a57
    v_accvgpr_read_b32 v54, a58
    v_accvgpr_read_b32 v55, a59
    v_accvgpr_read_b32 v56, a84
    v_accvgpr_read_b32 v57, a85
    v_accvgpr_read_b32 v58, a86
    v_accvgpr_read_b32 v59, a87
    v_mul_f32 v60, 0xbfb8aa3b, v52
    v_mul_f32 v61, 0xbfb8aa3b, v53
    v_mul_f32 v62, 0xbfb8aa3b, v54
    v_mul_f32 v63, 0xbfb8aa3b, v55
    v_exp_f32 v60, v60
    v_exp_f32 v61, v61
    v_exp_f32 v62, v62
    v_exp_f32 v63, v63
    s_nop 0
    v_add_f32 v60, 1.0, v60
    v_add_f32 v61, 1.0, v61
    v_add_f32 v62, 1.0, v62
    v_add_f32 v63, 1.0, v63
    v_rcp_f32 v60, v60
    v_rcp_f32 v61, v61
    v_rcp_f32 v62, v62
    v_rcp_f32 v63, v63
    s_nop 0
    v_mul_f32 v52, v52, v60
    v_mul_f32 v53, v53, v61
    v_mul_f32 v54, v54, v62
    v_mul_f32 v55, v55, v63
    v_mul_f32 v52, v52, v56
    v_mul_f32 v53, v53, v57
    v_mul_f32 v54, v54, v58
    v_mul_f32 v55, v55, v59
    ds_write_b128 v44, v[52:55] offset:7424
    v_accvgpr_read_b32 v68, a60
    v_accvgpr_read_b32 v69, a61
    v_accvgpr_read_b32 v70, a62
    v_accvgpr_read_b32 v71, a63
    v_accvgpr_read_b32 v72, a88
    v_accvgpr_read_b32 v73, a89
    v_accvgpr_read_b32 v74, a90
    v_accvgpr_read_b32 v75, a91
    v_mul_f32 v76, 0xbfb8aa3b, v68
    v_mul_f32 v77, 0xbfb8aa3b, v69
    v_mul_f32 v78, 0xbfb8aa3b, v70
    v_mul_f32 v79, 0xbfb8aa3b, v71
    v_exp_f32 v76, v76
    v_exp_f32 v77, v77
    v_exp_f32 v78, v78
    v_exp_f32 v79, v79
    s_nop 0
    v_add_f32 v76, 1.0, v76
    v_add_f32 v77, 1.0, v77
    v_add_f32 v78, 1.0, v78
    v_add_f32 v79, 1.0, v79
    v_rcp_f32 v76, v76
    v_rcp_f32 v77, v77
    v_rcp_f32 v78, v78
    v_rcp_f32 v79, v79
    s_nop 0
    v_mul_f32 v68, v68, v76
    v_mul_f32 v69, v69, v77
    v_mul_f32 v70, v70, v78
    v_mul_f32 v71, v71, v79
    v_mul_f32 v68, v68, v72
    v_mul_f32 v69, v69, v73
    v_mul_f32 v70, v70, v74
    v_mul_f32 v71, v71, v75
    ds_write_b128 v44, v[68:71] offset:7488
    v_accvgpr_read_b32 v52, a64
    v_accvgpr_read_b32 v53, a65
    v_accvgpr_read_b32 v54, a66
    v_accvgpr_read_b32 v55, a67
    v_accvgpr_read_b32 v56, a92
    v_accvgpr_read_b32 v57, a93
    v_accvgpr_read_b32 v58, a94
    v_accvgpr_read_b32 v59, a95
    v_mul_f32 v60, 0xbfb8aa3b, v52
    v_mul_f32 v61, 0xbfb8aa3b, v53
    v_mul_f32 v62, 0xbfb8aa3b, v54
    v_mul_f32 v63, 0xbfb8aa3b, v55
    v_exp_f32 v60, v60
    v_exp_f32 v61, v61
    v_exp_f32 v62, v62
    v_exp_f32 v63, v63
    s_nop 0
    v_add_f32 v60, 1.0, v60
    v_add_f32 v61, 1.0, v61
    v_add_f32 v62, 1.0, v62
    v_add_f32 v63, 1.0, v63
    v_rcp_f32 v60, v60
    v_rcp_f32 v61, v61
    v_rcp_f32 v62, v62
    v_rcp_f32 v63, v63
    s_nop 0
    v_mul_f32 v52, v52, v60
    v_mul_f32 v53, v53, v61
    v_mul_f32 v54, v54, v62
    v_mul_f32 v55, v55, v63
    v_mul_f32 v52, v52, v56
    v_mul_f32 v53, v53, v57
    v_mul_f32 v54, v54, v58
    v_mul_f32 v55, v55, v59
    ds_write_b128 v44, v[52:55] offset:7552
    v_accvgpr_read_b32 v68, a68
    v_accvgpr_read_b32 v69, a69
    v_accvgpr_read_b32 v70, a70
    v_accvgpr_read_b32 v71, a71
    v_accvgpr_read_b32 v72, a96
    v_accvgpr_read_b32 v73, a97
    v_accvgpr_read_b32 v74, a98
    v_accvgpr_read_b32 v75, a99
    v_mul_f32 v76, 0xbfb8aa3b, v68
    v_mul_f32 v77, 0xbfb8aa3b, v69
    v_mul_f32 v78, 0xbfb8aa3b, v70
    v_mul_f32 v79, 0xbfb8aa3b, v71
    v_exp_f32 v76, v76
    v_exp_f32 v77, v77
    v_exp_f32 v78, v78
    v_exp_f32 v79, v79
    s_nop 0
    v_add_f32 v76, 1.0, v76
    v_add_f32 v77, 1.0, v77
    v_add_f32 v78, 1.0, v78
    v_add_f32 v79, 1.0, v79
    v_rcp_f32 v76, v76
    v_rcp_f32 v77, v77
    v_rcp_f32 v78, v78
    v_rcp_f32 v79, v79
    s_nop 0
    v_mul_f32 v68, v68, v76
    v_mul_f32 v69, v69, v77
    v_mul_f32 v70, v70, v78
    v_mul_f32 v71, v71, v79
    v_mul_f32 v68, v68, v72
    v_mul_f32 v69, v69, v73
    v_mul_f32 v70, v70, v74
    v_mul_f32 v71, v71, v75
    ds_write_b128 v44, v[68:71] offset:7616
    v_accvgpr_read_b32 v52, a72
    v_accvgpr_read_b32 v53, a73
    v_accvgpr_read_b32 v54, a74
    v_accvgpr_read_b32 v55, a75
    v_accvgpr_read_b32 v56, a100
    v_accvgpr_read_b32 v57, a101
    v_accvgpr_read_b32 v58, a102
    v_accvgpr_read_b32 v59, a103
    v_mul_f32 v60, 0xbfb8aa3b, v52
    v_mul_f32 v61, 0xbfb8aa3b, v53
    v_mul_f32 v62, 0xbfb8aa3b, v54
    v_mul_f32 v63, 0xbfb8aa3b, v55
    v_exp_f32 v60, v60
    v_exp_f32 v61, v61
    v_exp_f32 v62, v62
    v_exp_f32 v63, v63
    s_nop 0
    v_add_f32 v60, 1.0, v60
    v_add_f32 v61, 1.0, v61
    v_add_f32 v62, 1.0, v62
    v_add_f32 v63, 1.0, v63
    v_rcp_f32 v60, v60
    v_rcp_f32 v61, v61
    v_rcp_f32 v62, v62
    v_rcp_f32 v63, v63
    s_nop 0
    v_mul_f32 v52, v52, v60
    v_mul_f32 v53, v53, v61
    v_mul_f32 v54, v54, v62
    v_mul_f32 v55, v55, v63
    v_mul_f32 v52, v52, v56
    v_mul_f32 v53, v53, v57
    v_mul_f32 v54, v54, v58
    v_mul_f32 v55, v55, v59
    ds_write_b128 v44, v[52:55] offset:7680
    v_accvgpr_read_b32 v68, a76
    v_accvgpr_read_b32 v69, a77
    v_accvgpr_read_b32 v70, a78
    v_accvgpr_read_b32 v71, a79
    v_accvgpr_read_b32 v72, a104
    v_accvgpr_read_b32 v73, a105
    v_accvgpr_read_b32 v74, a106
    v_accvgpr_read_b32 v75, a107
    v_mul_f32 v76, 0xbfb8aa3b, v68
    v_mul_f32 v77, 0xbfb8aa3b, v69
    v_mul_f32 v78, 0xbfb8aa3b, v70
    v_mul_f32 v79, 0xbfb8aa3b, v71
    v_exp_f32 v76, v76
    v_exp_f32 v77, v77
    v_exp_f32 v78, v78
    v_exp_f32 v79, v79
    s_nop 0
    v_add_f32 v76, 1.0, v76
    v_add_f32 v77, 1.0, v77
    v_add_f32 v78, 1.0, v78
    v_add_f32 v79, 1.0, v79
    v_rcp_f32 v76, v76
    v_rcp_f32 v77, v77
    v_rcp_f32 v78, v78
    v_rcp_f32 v79, v79
    s_nop 0
    v_mul_f32 v68, v68, v76
    v_mul_f32 v69, v69, v77
    v_mul_f32 v70, v70, v78
    v_mul_f32 v71, v71, v79
    v_mul_f32 v68, v68, v72
    v_mul_f32 v69, v69, v73
    v_mul_f32 v70, v70, v74
    v_mul_f32 v71, v71, v75
    ds_write_b128 v44, v[68:71] offset:7744
    v_accvgpr_read_b32 v52, a80
    v_accvgpr_read_b32 v53, a81
    v_accvgpr_read_b32 v54, a82
    v_accvgpr_read_b32 v55, a83
    v_accvgpr_read_b32 v56, a108
    v_accvgpr_read_b32 v57, a109
    v_accvgpr_read_b32 v58, a110
    v_accvgpr_read_b32 v59, a111
    v_mul_f32 v60, 0xbfb8aa3b, v52
    v_mul_f32 v61, 0xbfb8aa3b, v53
    v_mul_f32 v62, 0xbfb8aa3b, v54
    v_mul_f32 v63, 0xbfb8aa3b, v55
    v_exp_f32 v60, v60
    v_exp_f32 v61, v61
    v_exp_f32 v62, v62
    v_exp_f32 v63, v63
    s_nop 0
    v_add_f32 v60, 1.0, v60
    v_add_f32 v61, 1.0, v61
    v_add_f32 v62, 1.0, v62
    v_add_f32 v63, 1.0, v63
    v_rcp_f32 v60, v60
    v_rcp_f32 v61, v61
    v_rcp_f32 v62, v62
    v_rcp_f32 v63, v63
    s_nop 0
    v_mul_f32 v52, v52, v60
    v_mul_f32 v53, v53, v61
    v_mul_f32 v54, v54, v62
    v_mul_f32 v55, v55, v63
    v_mul_f32 v52, v52, v56
    v_mul_f32 v53, v53, v57
    v_mul_f32 v54, v54, v58
    v_mul_f32 v55, v55, v59
    ds_write_b128 v44, v[52:55] offset:7808
    v_accvgpr_read_b32 v52, a112
    v_accvgpr_read_b32 v53, a113
    v_accvgpr_read_b32 v54, a114
    v_accvgpr_read_b32 v55, a115
    v_accvgpr_read_b32 v56, a140
    v_accvgpr_read_b32 v57, a141
    v_accvgpr_read_b32 v58, a142
    v_accvgpr_read_b32 v59, a143
    v_mul_f32 v60, 0xbfb8aa3b, v52
    v_mul_f32 v61, 0xbfb8aa3b, v53
    v_mul_f32 v62, 0xbfb8aa3b, v54
    v_mul_f32 v63, 0xbfb8aa3b, v55
    v_exp_f32 v60, v60
    v_exp_f32 v61, v61
    v_exp_f32 v62, v62
    v_exp_f32 v63, v63
    s_nop 0
    v_add_f32 v60, 1.0, v60
    v_add_f32 v61, 1.0, v61
    v_add_f32 v62, 1.0, v62
    v_add_f32 v63, 1.0, v63
    v_rcp_f32 v60, v60
    v_rcp_f32 v61, v61
    v_rcp_f32 v62, v62
    v_rcp_f32 v63, v63
    s_nop 0
    v_mul_f32 v52, v52, v60
    v_mul_f32 v53, v53, v61
    v_mul_f32 v54, v54, v62
    v_mul_f32 v55, v55, v63
    v_mul_f32 v52, v52, v56
    v_mul_f32 v53, v53, v57
    v_mul_f32 v54, v54, v58
    v_mul_f32 v55, v55, v59
    ds_write_b128 v44, v[52:55] offset:14848
    v_accvgpr_read_b32 v68, a116
    v_accvgpr_read_b32 v69, a117
    v_accvgpr_read_b32 v70, a118
    v_accvgpr_read_b32 v71, a119
    v_accvgpr_read_b32 v72, a144
    v_accvgpr_read_b32 v73, a145
    v_accvgpr_read_b32 v74, a146
    v_accvgpr_read_b32 v75, a147
    v_mul_f32 v76, 0xbfb8aa3b, v68
    v_mul_f32 v77, 0xbfb8aa3b, v69
    v_mul_f32 v78, 0xbfb8aa3b, v70
    v_mul_f32 v79, 0xbfb8aa3b, v71
    v_exp_f32 v76, v76
    v_exp_f32 v77, v77
    v_exp_f32 v78, v78
    v_exp_f32 v79, v79
    s_nop 0
    v_add_f32 v76, 1.0, v76
    v_add_f32 v77, 1.0, v77
    v_add_f32 v78, 1.0, v78
    v_add_f32 v79, 1.0, v79
    v_rcp_f32 v76, v76
    v_rcp_f32 v77, v77
    v_rcp_f32 v78, v78
    v_rcp_f32 v79, v79
    s_nop 0
    v_mul_f32 v68, v68, v76
    v_mul_f32 v69, v69, v77
    v_mul_f32 v70, v70, v78
    v_mul_f32 v71, v71, v79
    v_mul_f32 v68, v68, v72
    v_mul_f32 v69, v69, v73
    v_mul_f32 v70, v70, v74
    v_mul_f32 v71, v71, v75
    ds_write_b128 v44, v[68:71] offset:14912
    v_accvgpr_read_b32 v52, a120
    v_accvgpr_read_b32 v53, a121
    v_accvgpr_read_b32 v54, a122
    v_accvgpr_read_b32 v55, a123
    v_accvgpr_read_b32 v56, a148
    v_accvgpr_read_b32 v57, a149
    v_accvgpr_read_b32 v58, a150
    v_accvgpr_read_b32 v59, a151
    v_mul_f32 v60, 0xbfb8aa3b, v52
    v_mul_f32 v61, 0xbfb8aa3b, v53
    v_mul_f32 v62, 0xbfb8aa3b, v54
    v_mul_f32 v63, 0xbfb8aa3b, v55
    v_exp_f32 v60, v60
    v_exp_f32 v61, v61
    v_exp_f32 v62, v62
    v_exp_f32 v63, v63
    s_nop 0
    v_add_f32 v60, 1.0, v60
    v_add_f32 v61, 1.0, v61
    v_add_f32 v62, 1.0, v62
    v_add_f32 v63, 1.0, v63
    v_rcp_f32 v60, v60
    v_rcp_f32 v61, v61
    v_rcp_f32 v62, v62
    v_rcp_f32 v63, v63
    s_nop 0
    v_mul_f32 v52, v52, v60
    v_mul_f32 v53, v53, v61
    v_mul_f32 v54, v54, v62
    v_mul_f32 v55, v55, v63
    v_mul_f32 v52, v52, v56
    v_mul_f32 v53, v53, v57
    v_mul_f32 v54, v54, v58
    v_mul_f32 v55, v55, v59
    ds_write_b128 v44, v[52:55] offset:14976
    v_accvgpr_read_b32 v68, a124
    v_accvgpr_read_b32 v69, a125
    v_accvgpr_read_b32 v70, a126
    v_accvgpr_read_b32 v71, a127
    v_accvgpr_read_b32 v72, a152
    v_accvgpr_read_b32 v73, a153
    v_accvgpr_read_b32 v74, a154
    v_accvgpr_read_b32 v75, a155
    v_mul_f32 v76, 0xbfb8aa3b, v68
    v_mul_f32 v77, 0xbfb8aa3b, v69
    v_mul_f32 v78, 0xbfb8aa3b, v70
    v_mul_f32 v79, 0xbfb8aa3b, v71
    v_exp_f32 v76, v76
    v_exp_f32 v77, v77
    v_exp_f32 v78, v78
    v_exp_f32 v79, v79
    s_nop 0
    v_add_f32 v76, 1.0, v76
    v_add_f32 v77, 1.0, v77
    v_add_f32 v78, 1.0, v78
    v_add_f32 v79, 1.0, v79
    v_rcp_f32 v76, v76
    v_rcp_f32 v77, v77
    v_rcp_f32 v78, v78
    v_rcp_f32 v79, v79
    s_nop 0
    v_mul_f32 v68, v68, v76
    v_mul_f32 v69, v69, v77
    v_mul_f32 v70, v70, v78
    v_mul_f32 v71, v71, v79
    v_mul_f32 v68, v68, v72
    v_mul_f32 v69, v69, v73
    v_mul_f32 v70, v70, v74
    v_mul_f32 v71, v71, v75
    ds_write_b128 v44, v[68:71] offset:15040
    v_accvgpr_read_b32 v52, a128
    v_accvgpr_read_b32 v53, a129
    v_accvgpr_read_b32 v54, a130
    v_accvgpr_read_b32 v55, a131
    v_accvgpr_read_b32 v56, a156
    v_accvgpr_read_b32 v57, a157
    v_accvgpr_read_b32 v58, a158
    v_accvgpr_read_b32 v59, a159
    v_mul_f32 v60, 0xbfb8aa3b, v52
    v_mul_f32 v61, 0xbfb8aa3b, v53
    v_mul_f32 v62, 0xbfb8aa3b, v54
    v_mul_f32 v63, 0xbfb8aa3b, v55
    v_exp_f32 v60, v60
    v_exp_f32 v61, v61
    v_exp_f32 v62, v62
    v_exp_f32 v63, v63
    s_nop 0
    v_add_f32 v60, 1.0, v60
    v_add_f32 v61, 1.0, v61
    v_add_f32 v62, 1.0, v62
    v_add_f32 v63, 1.0, v63
    v_rcp_f32 v60, v60
    v_rcp_f32 v61, v61
    v_rcp_f32 v62, v62
    v_rcp_f32 v63, v63
    s_nop 0
    v_mul_f32 v52, v52, v60
    v_mul_f32 v53, v53, v61
    v_mul_f32 v54, v54, v62
    v_mul_f32 v55, v55, v63
    v_mul_f32 v52, v52, v56
    v_mul_f32 v53, v53, v57
    v_mul_f32 v54, v54, v58
    v_mul_f32 v55, v55, v59
    ds_write_b128 v44, v[52:55] offset:15104
    v_accvgpr_read_b32 v68, a132
    v_accvgpr_read_b32 v69, a133
    v_accvgpr_read_b32 v70, a134
    v_accvgpr_read_b32 v71, a135
    v_accvgpr_read_b32 v72, a160
    v_accvgpr_read_b32 v73, a161
    v_accvgpr_read_b32 v74, a162
    v_accvgpr_read_b32 v75, a163
    v_mul_f32 v76, 0xbfb8aa3b, v68
    v_mul_f32 v77, 0xbfb8aa3b, v69
    v_mul_f32 v78, 0xbfb8aa3b, v70
    v_mul_f32 v79, 0xbfb8aa3b, v71
    v_exp_f32 v76, v76
    v_exp_f32 v77, v77
    v_exp_f32 v78, v78
    v_exp_f32 v79, v79
    s_nop 0
    v_add_f32 v76, 1.0, v76
    v_add_f32 v77, 1.0, v77
    v_add_f32 v78, 1.0, v78
    v_add_f32 v79, 1.0, v79
    v_rcp_f32 v76, v76
    v_rcp_f32 v77, v77
    v_rcp_f32 v78, v78
    v_rcp_f32 v79, v79
    s_nop 0
    v_mul_f32 v68, v68, v76
    v_mul_f32 v69, v69, v77
    v_mul_f32 v70, v70, v78
    v_mul_f32 v71, v71, v79
    v_mul_f32 v68, v68, v72
    v_mul_f32 v69, v69, v73
    v_mul_f32 v70, v70, v74
    v_mul_f32 v71, v71, v75
    ds_write_b128 v44, v[68:71] offset:15168
    v_accvgpr_read_b32 v52, a136
    v_accvgpr_read_b32 v53, a137
    v_accvgpr_read_b32 v54, a138
    v_accvgpr_read_b32 v55, a139
    v_accvgpr_read_b32 v56, a164
    v_accvgpr_read_b32 v57, a165
    v_accvgpr_read_b32 v58, a166
    v_accvgpr_read_b32 v59, a167
    v_mul_f32 v60, 0xbfb8aa3b, v52
    v_mul_f32 v61, 0xbfb8aa3b, v53
    v_mul_f32 v62, 0xbfb8aa3b, v54
    v_mul_f32 v63, 0xbfb8aa3b, v55
    v_exp_f32 v60, v60
    v_exp_f32 v61, v61
    v_exp_f32 v62, v62
    v_exp_f32 v63, v63
    s_nop 0
    v_add_f32 v60, 1.0, v60
    v_add_f32 v61, 1.0, v61
    v_add_f32 v62, 1.0, v62
    v_add_f32 v63, 1.0, v63
    v_rcp_f32 v60, v60
    v_rcp_f32 v61, v61
    v_rcp_f32 v62, v62
    v_rcp_f32 v63, v63
    s_nop 0
    v_mul_f32 v52, v52, v60
    v_mul_f32 v53, v53, v61
    v_mul_f32 v54, v54, v62
    v_mul_f32 v55, v55, v63
    v_mul_f32 v52, v52, v56
    v_mul_f32 v53, v53, v57
    v_mul_f32 v54, v54, v58
    v_mul_f32 v55, v55, v59
    ds_write_b128 v44, v[52:55] offset:15232
    v_accvgpr_read_b32 v52, a168
    v_accvgpr_read_b32 v53, a169
    v_accvgpr_read_b32 v54, a170
    v_accvgpr_read_b32 v55, a171
    v_accvgpr_read_b32 v56, a196
    v_accvgpr_read_b32 v57, a197
    v_accvgpr_read_b32 v58, a198
    v_accvgpr_read_b32 v59, a199
    v_mul_f32 v60, 0xbfb8aa3b, v52
    v_mul_f32 v61, 0xbfb8aa3b, v53
    v_mul_f32 v62, 0xbfb8aa3b, v54
    v_mul_f32 v63, 0xbfb8aa3b, v55
    v_exp_f32 v60, v60
    v_exp_f32 v61, v61
    v_exp_f32 v62, v62
    v_exp_f32 v63, v63
    s_nop 0
    v_add_f32 v60, 1.0, v60
    v_add_f32 v61, 1.0, v61
    v_add_f32 v62, 1.0, v62
    v_add_f32 v63, 1.0, v63
    v_rcp_f32 v60, v60
    v_rcp_f32 v61, v61
    v_rcp_f32 v62, v62
    v_rcp_f32 v63, v63
    s_nop 0
    v_mul_f32 v52, v52, v60
    v_mul_f32 v53, v53, v61
    v_mul_f32 v54, v54, v62
    v_mul_f32 v55, v55, v63
    v_mul_f32 v52, v52, v56
    v_mul_f32 v53, v53, v57
    v_mul_f32 v54, v54, v58
    v_mul_f32 v55, v55, v59
    ds_write_b128 v44, v[52:55] offset:22272
    v_accvgpr_read_b32 v68, a172
    v_accvgpr_read_b32 v69, a173
    v_accvgpr_read_b32 v70, a174
    v_accvgpr_read_b32 v71, a175
    v_accvgpr_read_b32 v72, a200
    v_accvgpr_read_b32 v73, a201
    v_accvgpr_read_b32 v74, a202
    v_accvgpr_read_b32 v75, a203
    v_mul_f32 v76, 0xbfb8aa3b, v68
    v_mul_f32 v77, 0xbfb8aa3b, v69
    v_mul_f32 v78, 0xbfb8aa3b, v70
    v_mul_f32 v79, 0xbfb8aa3b, v71
    v_exp_f32 v76, v76
    v_exp_f32 v77, v77
    v_exp_f32 v78, v78
    v_exp_f32 v79, v79
    s_nop 0
    v_add_f32 v76, 1.0, v76
    v_add_f32 v77, 1.0, v77
    v_add_f32 v78, 1.0, v78
    v_add_f32 v79, 1.0, v79
    v_rcp_f32 v76, v76
    v_rcp_f32 v77, v77
    v_rcp_f32 v78, v78
    v_rcp_f32 v79, v79
    s_nop 0
    v_mul_f32 v68, v68, v76
    v_mul_f32 v69, v69, v77
    v_mul_f32 v70, v70, v78
    v_mul_f32 v71, v71, v79
    v_mul_f32 v68, v68, v72
    v_mul_f32 v69, v69, v73
    v_mul_f32 v70, v70, v74
    v_mul_f32 v71, v71, v75
    ds_write_b128 v44, v[68:71] offset:22336
    v_accvgpr_read_b32 v52, a176
    v_accvgpr_read_b32 v53, a177
    v_accvgpr_read_b32 v54, a178
    v_accvgpr_read_b32 v55, a179
    v_accvgpr_read_b32 v56, a204
    v_accvgpr_read_b32 v57, a205
    v_accvgpr_read_b32 v58, a206
    v_accvgpr_read_b32 v59, a207
    v_mul_f32 v60, 0xbfb8aa3b, v52
    v_mul_f32 v61, 0xbfb8aa3b, v53
    v_mul_f32 v62, 0xbfb8aa3b, v54
    v_mul_f32 v63, 0xbfb8aa3b, v55
    v_exp_f32 v60, v60
    v_exp_f32 v61, v61
    v_exp_f32 v62, v62
    v_exp_f32 v63, v63
    s_nop 0
    v_add_f32 v60, 1.0, v60
    v_add_f32 v61, 1.0, v61
    v_add_f32 v62, 1.0, v62
    v_add_f32 v63, 1.0, v63
    v_rcp_f32 v60, v60
    v_rcp_f32 v61, v61
    v_rcp_f32 v62, v62
    v_rcp_f32 v63, v63
    s_nop 0
    v_mul_f32 v52, v52, v60
    v_mul_f32 v53, v53, v61
    v_mul_f32 v54, v54, v62
    v_mul_f32 v55, v55, v63
    v_mul_f32 v52, v52, v56
    v_mul_f32 v53, v53, v57
    v_mul_f32 v54, v54, v58
    v_mul_f32 v55, v55, v59
    ds_write_b128 v44, v[52:55] offset:22400
    v_accvgpr_read_b32 v68, a180
    v_accvgpr_read_b32 v69, a181
    v_accvgpr_read_b32 v70, a182
    v_accvgpr_read_b32 v71, a183
    v_accvgpr_read_b32 v72, a208
    v_accvgpr_read_b32 v73, a209
    v_accvgpr_read_b32 v74, a210
    v_accvgpr_read_b32 v75, a211
    v_mul_f32 v76, 0xbfb8aa3b, v68
    v_mul_f32 v77, 0xbfb8aa3b, v69
    v_mul_f32 v78, 0xbfb8aa3b, v70
    v_mul_f32 v79, 0xbfb8aa3b, v71
    v_exp_f32 v76, v76
    v_exp_f32 v77, v77
    v_exp_f32 v78, v78
    v_exp_f32 v79, v79
    s_nop 0
    v_add_f32 v76, 1.0, v76
    v_add_f32 v77, 1.0, v77
    v_add_f32 v78, 1.0, v78
    v_add_f32 v79, 1.0, v79
    v_rcp_f32 v76, v76
    v_rcp_f32 v77, v77
    v_rcp_f32 v78, v78
    v_rcp_f32 v79, v79
    s_nop 0
    v_mul_f32 v68, v68, v76
    v_mul_f32 v69, v69, v77
    v_mul_f32 v70, v70, v78
    v_mul_f32 v71, v71, v79
    v_mul_f32 v68, v68, v72
    v_mul_f32 v69, v69, v73
    v_mul_f32 v70, v70, v74
    v_mul_f32 v71, v71, v75
    ds_write_b128 v44, v[68:71] offset:22464
    v_accvgpr_read_b32 v52, a184
    v_accvgpr_read_b32 v53, a185
    v_accvgpr_read_b32 v54, a186
    v_accvgpr_read_b32 v55, a187
    v_accvgpr_read_b32 v56, a212
    v_accvgpr_read_b32 v57, a213
    v_accvgpr_read_b32 v58, a214
    v_accvgpr_read_b32 v59, a215
    v_mul_f32 v60, 0xbfb8aa3b, v52
    v_mul_f32 v61, 0xbfb8aa3b, v53
    v_mul_f32 v62, 0xbfb8aa3b, v54
    v_mul_f32 v63, 0xbfb8aa3b, v55
    v_exp_f32 v60, v60
    v_exp_f32 v61, v61
    v_exp_f32 v62, v62
    v_exp_f32 v63, v63
    s_nop 0
    v_add_f32 v60, 1.0, v60
    v_add_f32 v61, 1.0, v61
    v_add_f32 v62, 1.0, v62
    v_add_f32 v63, 1.0, v63
    v_rcp_f32 v60, v60
    v_rcp_f32 v61, v61
    v_rcp_f32 v62, v62
    v_rcp_f32 v63, v63
    s_nop 0
    v_mul_f32 v52, v52, v60
    v_mul_f32 v53, v53, v61
    v_mul_f32 v54, v54, v62
    v_mul_f32 v55, v55, v63
    v_mul_f32 v52, v52, v56
    v_mul_f32 v53, v53, v57
    v_mul_f32 v54, v54, v58
    v_mul_f32 v55, v55, v59
    ds_write_b128 v44, v[52:55] offset:22528
    v_accvgpr_read_b32 v68, a188
    v_accvgpr_read_b32 v69, a189
    v_accvgpr_read_b32 v70, a190
    v_accvgpr_read_b32 v71, a191
    v_accvgpr_read_b32 v72, a216
    v_accvgpr_read_b32 v73, a217
    v_accvgpr_read_b32 v74, a218
    v_accvgpr_read_b32 v75, a219
    v_mul_f32 v76, 0xbfb8aa3b, v68
    v_mul_f32 v77, 0xbfb8aa3b, v69
    v_mul_f32 v78, 0xbfb8aa3b, v70
    v_mul_f32 v79, 0xbfb8aa3b, v71
    v_exp_f32 v76, v76
    v_exp_f32 v77, v77
    v_exp_f32 v78, v78
    v_exp_f32 v79, v79
    s_nop 0
    v_add_f32 v76, 1.0, v76
    v_add_f32 v77, 1.0, v77
    v_add_f32 v78, 1.0, v78
    v_add_f32 v79, 1.0, v79
    v_rcp_f32 v76, v76
    v_rcp_f32 v77, v77
    v_rcp_f32 v78, v78
    v_rcp_f32 v79, v79
    s_nop 0
    v_mul_f32 v68, v68, v76
    v_mul_f32 v69, v69, v77
    v_mul_f32 v70, v70, v78
    v_mul_f32 v71, v71, v79
    v_mul_f32 v68, v68, v72
    v_mul_f32 v69, v69, v73
    v_mul_f32 v70, v70, v74
    v_mul_f32 v71, v71, v75
    ds_write_b128 v44, v[68:71] offset:22592
    v_accvgpr_read_b32 v52, a192
    v_accvgpr_read_b32 v53, a193
    v_accvgpr_read_b32 v54, a194
    v_accvgpr_read_b32 v55, a195
    v_accvgpr_read_b32 v56, a220
    v_accvgpr_read_b32 v57, a221
    v_accvgpr_read_b32 v58, a222
    v_accvgpr_read_b32 v59, a223
    v_mul_f32 v60, 0xbfb8aa3b, v52
    v_mul_f32 v61, 0xbfb8aa3b, v53
    v_mul_f32 v62, 0xbfb8aa3b, v54
    v_mul_f32 v63, 0xbfb8aa3b, v55
    v_exp_f32 v60, v60
    v_exp_f32 v61, v61
    v_exp_f32 v62, v62
    v_exp_f32 v63, v63
    s_nop 0
    v_add_f32 v60, 1.0, v60
    v_add_f32 v61, 1.0, v61
    v_add_f32 v62, 1.0, v62
    v_add_f32 v63, 1.0, v63
    v_rcp_f32 v60, v60
    v_rcp_f32 v61, v61
    v_rcp_f32 v62, v62
    v_rcp_f32 v63, v63
    s_nop 0
    v_mul_f32 v52, v52, v60
    v_mul_f32 v53, v53, v61
    v_mul_f32 v54, v54, v62
    v_mul_f32 v55, v55, v63
    v_mul_f32 v52, v52, v56
    v_mul_f32 v53, v53, v57
    v_mul_f32 v54, v54, v58
    v_mul_f32 v55, v55, v59
    ds_write_b128 v44, v[52:55] offset:22656
    s_waitcnt lgkmcnt(0)
    s_barrier
    s_lshl_b32 s30, s31, 6
    v_add_u32 v45, s30, v0
    v_add_u32 v42, 0, v45
    s_mov_b32 s30, 74899
    v_mul_lo_u32 v43, v42, s30
    v_lshrrev_b32 v43, 20, v43
    v_mul_u32_u24 v44, 14, v43
    v_sub_u32 v44, v42, v44
    v_mul_u32_u24 v42, 464, v43
    v_lshl_add_u32 v42, v44, 5, v42
    ds_read_b128 v[52:55], v42
    ds_read_b128 v[56:59], v42 offset:16
    v_add_u32 v43, s24, v43
    s_mov_b32 s30, 7168
    v_mul_lo_u32 v43, v43, s30
    v_lshl_add_u32 v43, v44, 4, v43
    s_lshl_b32 s30, s25, 1
    v_add_u32 v64, s30, v43
    v_add_u32 v42, 256, v45
    s_mov_b32 s30, 74899
    v_mul_lo_u32 v43, v42, s30
    v_lshrrev_b32 v43, 20, v43
    v_mul_u32_u24 v44, 14, v43
    v_sub_u32 v44, v42, v44
    v_mul_u32_u24 v42, 464, v43
    v_lshl_add_u32 v42, v44, 5, v42
    ds_read_b128 v[68:71], v42
    ds_read_b128 v[72:75], v42 offset:16
    v_add_u32 v43, s24, v43
    s_mov_b32 s30, 7168
    v_mul_lo_u32 v43, v43, s30
    v_lshl_add_u32 v43, v44, 4, v43
    s_lshl_b32 s30, s25, 1
    v_add_u32 v80, s30, v43
    v_add_u32 v42, 512, v45
    s_mov_b32 s30, 74899
    v_mul_lo_u32 v43, v42, s30
    v_lshrrev_b32 v43, 20, v43
    v_mul_u32_u24 v44, 14, v43
    v_sub_u32 v44, v42, v44
    v_mul_u32_u24 v42, 464, v43
    v_lshl_add_u32 v42, v44, 5, v42
    ds_read_b128 v[84:87], v42
    ds_read_b128 v[88:91], v42 offset:16
    v_add_u32 v43, s24, v43
    s_mov_b32 s30, 7168
    v_mul_lo_u32 v43, v43, s30
    v_lshl_add_u32 v43, v44, 4, v43
    s_lshl_b32 s30, s25, 1
    v_add_u32 v96, s30, v43
    v_add_u32 v42, 768, v45
    s_mov_b32 s30, 74899
    v_mul_lo_u32 v43, v42, s30
    v_lshrrev_b32 v43, 20, v43
    v_mul_u32_u24 v44, 14, v43
    v_sub_u32 v44, v42, v44
    v_mul_u32_u24 v42, 464, v43
    v_lshl_add_u32 v42, v44, 5, v42
    ds_read_b128 v[100:103], v42
    ds_read_b128 v[104:107], v42 offset:16
    v_add_u32 v43, s24, v43
    s_mov_b32 s30, 7168
    v_mul_lo_u32 v43, v43, s30
    v_lshl_add_u32 v43, v44, 4, v43
    s_lshl_b32 s30, s25, 1
    v_add_u32 v112, s30, v43
    s_waitcnt vmcnt(0) lgkmcnt(0)
    v_cvt_pk_bf16_f32 v60, v52, v53
    v_cvt_pk_bf16_f32 v61, v54, v55
    v_cvt_pk_bf16_f32 v62, v56, v57
    v_cvt_pk_bf16_f32 v63, v58, v59
    buffer_store_dwordx4 v[60:63], v64, s[16:19], 0 offen
    v_cvt_pk_bf16_f32 v76, v68, v69
    v_cvt_pk_bf16_f32 v77, v70, v71
    v_cvt_pk_bf16_f32 v78, v72, v73
    v_cvt_pk_bf16_f32 v79, v74, v75
    buffer_store_dwordx4 v[76:79], v80, s[16:19], 0 offen
    v_cvt_pk_bf16_f32 v92, v84, v85
    v_cvt_pk_bf16_f32 v93, v86, v87
    v_cvt_pk_bf16_f32 v94, v88, v89
    v_cvt_pk_bf16_f32 v95, v90, v91
    buffer_store_dwordx4 v[92:95], v96, s[16:19], 0 offen
    v_cvt_pk_bf16_f32 v108, v100, v101
    v_cvt_pk_bf16_f32 v109, v102, v103
    v_cvt_pk_bf16_f32 v110, v104, v105
    v_cvt_pk_bf16_f32 v111, v106, v107
    buffer_store_dwordx4 v[108:111], v112, s[16:19], 0 offen
    s_nop 1
    v_add_u32 v42, 1024, v45
    s_mov_b32 s30, 74899
    v_mul_lo_u32 v43, v42, s30
    v_lshrrev_b32 v43, 20, v43
    v_mul_u32_u24 v44, 14, v43
    v_sub_u32 v44, v42, v44
    v_mul_u32_u24 v42, 464, v43
    v_lshl_add_u32 v42, v44, 5, v42
    ds_read_b128 v[52:55], v42
    ds_read_b128 v[56:59], v42 offset:16
    v_add_u32 v43, s24, v43
    s_mov_b32 s30, 7168
    v_mul_lo_u32 v43, v43, s30
    v_lshl_add_u32 v43, v44, 4, v43
    s_lshl_b32 s30, s25, 1
    v_add_u32 v64, s30, v43
    v_add_u32 v42, 1280, v45
    s_mov_b32 s30, 74899
    v_mul_lo_u32 v43, v42, s30
    v_lshrrev_b32 v43, 20, v43
    v_mul_u32_u24 v44, 14, v43
    v_sub_u32 v44, v42, v44
    v_mul_u32_u24 v42, 464, v43
    v_lshl_add_u32 v42, v44, 5, v42
    ds_read_b128 v[68:71], v42
    ds_read_b128 v[72:75], v42 offset:16
    v_add_u32 v43, s24, v43
    s_mov_b32 s30, 7168
    v_mul_lo_u32 v43, v43, s30
    v_lshl_add_u32 v43, v44, 4, v43
    s_lshl_b32 s30, s25, 1
    v_add_u32 v80, s30, v43
    v_add_u32 v42, 1536, v45
    s_mov_b32 s30, 74899
    v_mul_lo_u32 v43, v42, s30
    v_lshrrev_b32 v43, 20, v43
    v_mul_u32_u24 v44, 14, v43
    v_sub_u32 v44, v42, v44
    v_mul_u32_u24 v42, 464, v43
    v_lshl_add_u32 v42, v44, 5, v42
    ds_read_b128 v[84:87], v42
    ds_read_b128 v[88:91], v42 offset:16
    v_add_u32 v43, s24, v43
    s_mov_b32 s30, 7168
    v_mul_lo_u32 v43, v43, s30
    v_lshl_add_u32 v43, v44, 4, v43
    s_lshl_b32 s30, s25, 1
    v_add_u32 v96, s30, v43
    v_add_u32 v42, 1792, v45
    s_mov_b32 s30, 74899
    v_mul_lo_u32 v43, v42, s30
    v_lshrrev_b32 v43, 20, v43
    v_mul_u32_u24 v44, 14, v43
    v_sub_u32 v44, v42, v44
    v_mul_u32_u24 v42, 464, v43
    v_lshl_add_u32 v42, v44, 5, v42
    ds_read_b128 v[100:103], v42
    ds_read_b128 v[104:107], v42 offset:16
    v_add_u32 v43, s24, v43
    s_mov_b32 s30, 7168
    v_mul_lo_u32 v43, v43, s30
    v_lshl_add_u32 v43, v44, 4, v43
    s_lshl_b32 s30, s25, 1
    v_add_u32 v112, s30, v43
    s_waitcnt vmcnt(0) lgkmcnt(0)
    v_cvt_pk_bf16_f32 v60, v52, v53
    v_cvt_pk_bf16_f32 v61, v54, v55
    v_cvt_pk_bf16_f32 v62, v56, v57
    v_cvt_pk_bf16_f32 v63, v58, v59
    buffer_store_dwordx4 v[60:63], v64, s[16:19], 0 offen
    v_cvt_pk_bf16_f32 v76, v68, v69
    v_cvt_pk_bf16_f32 v77, v70, v71
    v_cvt_pk_bf16_f32 v78, v72, v73
    v_cvt_pk_bf16_f32 v79, v74, v75
    buffer_store_dwordx4 v[76:79], v80, s[16:19], 0 offen
    v_cvt_pk_bf16_f32 v92, v84, v85
    v_cvt_pk_bf16_f32 v93, v86, v87
    v_cvt_pk_bf16_f32 v94, v88, v89
    v_cvt_pk_bf16_f32 v95, v90, v91
    buffer_store_dwordx4 v[92:95], v96, s[16:19], 0 offen
    v_cvt_pk_bf16_f32 v108, v100, v101
    v_cvt_pk_bf16_f32 v109, v102, v103
    v_cvt_pk_bf16_f32 v110, v104, v105
    v_cvt_pk_bf16_f32 v111, v106, v107
    buffer_store_dwordx4 v[108:111], v112, s[16:19], 0 offen
    s_nop 1
    v_add_u32 v42, 2048, v45
    s_mov_b32 s30, 74899
    v_mul_lo_u32 v43, v42, s30
    v_lshrrev_b32 v43, 20, v43
    v_mul_u32_u24 v44, 14, v43
    v_sub_u32 v44, v42, v44
    v_mul_u32_u24 v42, 464, v43
    v_lshl_add_u32 v42, v44, 5, v42
    ds_read_b128 v[52:55], v42
    ds_read_b128 v[56:59], v42 offset:16
    v_add_u32 v43, s24, v43
    s_mov_b32 s30, 7168
    v_mul_lo_u32 v43, v43, s30
    v_lshl_add_u32 v43, v44, 4, v43
    s_lshl_b32 s30, s25, 1
    v_add_u32 v64, s30, v43
    v_add_u32 v42, 2304, v45
    s_mov_b32 s30, 74899
    v_mul_lo_u32 v43, v42, s30
    v_lshrrev_b32 v43, 20, v43
    v_mul_u32_u24 v44, 14, v43
    v_sub_u32 v44, v42, v44
    v_mul_u32_u24 v42, 464, v43
    v_lshl_add_u32 v42, v44, 5, v42
    ds_read_b128 v[68:71], v42
    ds_read_b128 v[72:75], v42 offset:16
    v_add_u32 v43, s24, v43
    s_mov_b32 s30, 7168
    v_mul_lo_u32 v43, v43, s30
    v_lshl_add_u32 v43, v44, 4, v43
    s_lshl_b32 s30, s25, 1
    v_add_u32 v80, s30, v43
    v_add_u32 v42, 2560, v45
    s_mov_b32 s30, 74899
    v_mul_lo_u32 v43, v42, s30
    v_lshrrev_b32 v43, 20, v43
    v_mul_u32_u24 v44, 14, v43
    v_sub_u32 v44, v42, v44
    v_mul_u32_u24 v42, 464, v43
    v_lshl_add_u32 v42, v44, 5, v42
    ds_read_b128 v[84:87], v42
    ds_read_b128 v[88:91], v42 offset:16
    v_add_u32 v43, s24, v43
    s_mov_b32 s30, 7168
    v_mul_lo_u32 v43, v43, s30
    v_lshl_add_u32 v43, v44, 4, v43
    s_lshl_b32 s30, s25, 1
    v_add_u32 v96, s30, v43
    v_add_u32 v42, 2816, v45
    s_mov_b32 s30, 74899
    v_mul_lo_u32 v43, v42, s30
    v_lshrrev_b32 v43, 20, v43
    v_mul_u32_u24 v44, 14, v43
    v_sub_u32 v44, v42, v44
    v_mul_u32_u24 v42, 464, v43
    v_lshl_add_u32 v42, v44, 5, v42
    ds_read_b128 v[100:103], v42
    ds_read_b128 v[104:107], v42 offset:16
    v_add_u32 v43, s24, v43
    s_mov_b32 s30, 7168
    v_mul_lo_u32 v43, v43, s30
    v_lshl_add_u32 v43, v44, 4, v43
    s_lshl_b32 s30, s25, 1
    v_add_u32 v112, s30, v43
    s_waitcnt vmcnt(0) lgkmcnt(0)
    v_cvt_pk_bf16_f32 v60, v52, v53
    v_cvt_pk_bf16_f32 v61, v54, v55
    v_cvt_pk_bf16_f32 v62, v56, v57
    v_cvt_pk_bf16_f32 v63, v58, v59
    buffer_store_dwordx4 v[60:63], v64, s[16:19], 0 offen
    v_cvt_pk_bf16_f32 v76, v68, v69
    v_cvt_pk_bf16_f32 v77, v70, v71
    v_cvt_pk_bf16_f32 v78, v72, v73
    v_cvt_pk_bf16_f32 v79, v74, v75
    buffer_store_dwordx4 v[76:79], v80, s[16:19], 0 offen
    v_cvt_pk_bf16_f32 v92, v84, v85
    v_cvt_pk_bf16_f32 v93, v86, v87
    v_cvt_pk_bf16_f32 v94, v88, v89
    v_cvt_pk_bf16_f32 v95, v90, v91
    buffer_store_dwordx4 v[92:95], v96, s[16:19], 0 offen
    v_cvt_pk_bf16_f32 v108, v100, v101
    v_cvt_pk_bf16_f32 v109, v102, v103
    v_cvt_pk_bf16_f32 v110, v104, v105
    v_cvt_pk_bf16_f32 v111, v106, v107
    buffer_store_dwordx4 v[108:111], v112, s[16:19], 0 offen
    s_nop 1
    v_add_u32 v42, 3072, v45
    s_mov_b32 s30, 74899
    v_mul_lo_u32 v43, v42, s30
    v_lshrrev_b32 v43, 20, v43
    v_mul_u32_u24 v44, 14, v43
    v_sub_u32 v44, v42, v44
    v_mul_u32_u24 v42, 464, v43
    v_lshl_add_u32 v42, v44, 5, v42
    ds_read_b128 v[52:55], v42
    ds_read_b128 v[56:59], v42 offset:16
    v_add_u32 v43, s24, v43
    s_mov_b32 s30, 7168
    v_mul_lo_u32 v43, v43, s30
    v_lshl_add_u32 v43, v44, 4, v43
    s_lshl_b32 s30, s25, 1
    v_add_u32 v64, s30, v43
    v_add_u32 v42, 3328, v45
    s_mov_b32 s30, 74899
    v_mul_lo_u32 v43, v42, s30
    v_lshrrev_b32 v43, 20, v43
    v_mul_u32_u24 v44, 14, v43
    v_sub_u32 v44, v42, v44
    v_mul_u32_u24 v42, 464, v43
    v_lshl_add_u32 v42, v44, 5, v42
    ds_read_b128 v[68:71], v42
    ds_read_b128 v[72:75], v42 offset:16
    v_add_u32 v43, s24, v43
    s_mov_b32 s30, 7168
    v_mul_lo_u32 v43, v43, s30
    v_lshl_add_u32 v43, v44, 4, v43
    s_lshl_b32 s30, s25, 1
    v_add_u32 v80, s30, v43
    s_waitcnt vmcnt(0) lgkmcnt(0)
    v_cvt_pk_bf16_f32 v60, v52, v53
    v_cvt_pk_bf16_f32 v61, v54, v55
    v_cvt_pk_bf16_f32 v62, v56, v57
    v_cvt_pk_bf16_f32 v63, v58, v59
    buffer_store_dwordx4 v[60:63], v64, s[16:19], 0 offen
    v_cvt_pk_bf16_f32 v76, v68, v69
    v_cvt_pk_bf16_f32 v77, v70, v71
    v_cvt_pk_bf16_f32 v78, v72, v73
    v_cvt_pk_bf16_f32 v79, v74, v75
    buffer_store_dwordx4 v[76:79], v80, s[16:19], 0 offen
    s_nop 1
L_gu_kernel_end:
    s_endpgm
.section .rodata,"a"
.p2align 6
.amdhsa_kernel gu_kernel
  .amdhsa_next_free_vgpr 420
  .amdhsa_next_free_sgpr 102
  .amdhsa_accum_offset 196
  .amdhsa_group_segment_fixed_size 0
  .amdhsa_kernarg_size 80
  .amdhsa_user_sgpr_count 2
  .amdhsa_user_sgpr_kernarg_segment_ptr 1
  .amdhsa_system_sgpr_workgroup_id_x 1
.end_amdhsa_kernel
.text
.globl dn_kernel
.p2align 8
.type dn_kernel,@function
dn_kernel:
    s_cmp_ge_u32 s2, 256
    s_cbranch_scc1 L_dn_kernel_end
    s_load_dwordx2 s[4:5], s[0:1], 72
    s_load_dwordx2 s[8:9], s[0:1], 48
    s_load_dwordx2 s[16:17], s[0:1], 56
    s_load_dwordx2 s[20:21], s[0:1], 72
    s_and_b32 s30, s2, 7
    s_lshr_b32 s31, s2, 3
    s_and_b32 s33, s31, 0
    s_lshr_b32 s31, s31, 0
    s_mul_i32 s34, s30, 32
    s_add_u32 s34, s34, s31
    s_and_b32 s24, s31, 3
    s_lshr_b32 s25, s31, 2
    s_lshr_b32 s31, s30, 1
    s_mul_i32 s31, s31, 4
    s_add_u32 s24, s24, s31
    s_and_b32 s31, s30, 1
    s_mul_i32 s31, s31, 8
    s_add_u32 s25, s25, s31
    s_mul_i32 s24, s24, 128
    s_mul_i32 s25, s25, 64
    v_lshrrev_b32 v1, 6, v0
    s_nop 0
    v_readfirstlane_b32 s31, v1
    v_and_b32 v0, 63, v0
    s_nop 3
    s_lshr_b32 s26, s31, 0
    s_and_b32 s27, s31, 0
    s_mul_i32 s60, s33, 7168
    s_mul_i32 s61, s33, 7340032
    s_add_u32 s62, s60, 7168
    s_lshr_b32 s30, s2, 3
    s_mul_i32 s30, s30, 0
    s_mul_hi_u32 s28, s30, 76695845
    s_mul_i32 s28, s28, 56
    s_sub_u32 s30, s30, s28
    s_mul_i32 s28, s30, 128
    s_add_u32 s28, s28, s60
    s_mul_i32 s29, s30, 131072
    s_add_u32 s29, s29, s61
    s_waitcnt lgkmcnt(0)
    s_add_u32 s4, s4, 29360128
    s_addc_u32 s5, s5, 0
    s_mov_b32 s6, 14680064
    s_mov_b32 s7, 0x00020000
    s_mov_b32 s10, 7340032
    s_mov_b32 s11, 0x00020000
    s_mov_b32 s18, 4194304
    s_mov_b32 s19, 0x00020000
    s_add_u32 s20, s20, 20971520
    s_addc_u32 s21, s21, 0
    s_mov_b32 s22, 4194304
    s_mov_b32 s23, 0x00020000
    s_add_u32 s30, s31, 0
    s_min_u32 s30, s30, 15
    s_lshl_b32 s30, s30, 10
    s_add_u32 s36, s30, 0
    v_lshlrev_b32 v32, 4, v0
    v_add_u32 v32, s30, v32
    s_mov_b32 s30, 8192
    v_mul_lo_u32 v33, v32, s30
    v_lshrrev_b32 v33, 20, v33
    s_mov_b32 s30, 128
    v_mul_lo_u32 v34, v33, s30
    v_sub_u32 v34, v32, v34
    v_lshrrev_b32 v34, 4, v34
    v_bfe_u32 v35, v33, 1, 3
    v_xor_b32 v34, v34, v35
    v_add_u32 v33, s24, v33
    s_mov_b32 s30, 7168
    v_mul_lo_u32 v33, v33, s30
    v_lshl_add_u32 v2, v34, 4, v33
    s_add_u32 s30, s31, 4
    s_min_u32 s30, s30, 15
    s_lshl_b32 s30, s30, 10
    s_add_u32 s37, s30, 0
    v_lshlrev_b32 v32, 4, v0
    v_add_u32 v32, s30, v32
    s_mov_b32 s30, 8192
    v_mul_lo_u32 v33, v32, s30
    v_lshrrev_b32 v33, 20, v33
    s_mov_b32 s30, 128
    v_mul_lo_u32 v34, v33, s30
    v_sub_u32 v34, v32, v34
    v_lshrrev_b32 v34, 4, v34
    v_bfe_u32 v35, v33, 1, 3
    v_xor_b32 v34, v34, v35
    v_add_u32 v33, s24, v33
    s_mov_b32 s30, 7168
    v_mul_lo_u32 v33, v33, s30
    v_lshl_add_u32 v3, v34, 4, v33
    s_add_u32 s30, s31, 8
    s_min_u32 s30, s30, 15
    s_lshl_b32 s30, s30, 10
    s_add_u32 s38, s30, 0
    v_lshlrev_b32 v32, 4, v0
    v_add_u32 v32, s30, v32
    s_mov_b32 s30, 8192
    v_mul_lo_u32 v33, v32, s30
    v_lshrrev_b32 v33, 20, v33
    s_mov_b32 s30, 128
    v_mul_lo_u32 v34, v33, s30
    v_sub_u32 v34, v32, v34
    v_lshrrev_b32 v34, 4, v34
    v_bfe_u32 v35, v33, 1, 3
    v_xor_b32 v34, v34, v35
    v_add_u32 v33, s24, v33
    s_mov_b32 s30, 7168
    v_mul_lo_u32 v33, v33, s30
    v_lshl_add_u32 v4, v34, 4, v33
    s_add_u32 s30, s31, 12
    s_min_u32 s30, s30, 15
    s_lshl_b32 s30, s30, 10
    s_add_u32 s39, s30, 0
    v_lshlrev_b32 v32, 4, v0
    v_add_u32 v32, s30, v32
    s_mov_b32 s30, 8192
    v_mul_lo_u32 v33, v32, s30
    v_lshrrev_b32 v33, 20, v33
    s_mov_b32 s30, 128
    v_mul_lo_u32 v34, v33, s30
    v_sub_u32 v34, v32, v34
    v_lshrrev_b32 v34, 4, v34
    v_bfe_u32 v35, v33, 1, 3
    v_xor_b32 v34, v34, v35
    v_add_u32 v33, s24, v33
    s_mov_b32 s30, 7168
    v_mul_lo_u32 v33, v33, s30
    v_lshl_add_u32 v5, v34, 4, v33
    s_add_u32 s30, s31, 0
    s_min_u32 s30, s30, 7
    s_lshl_b32 s30, s30, 10
    s_add_u32 s40, s30, 16384
    v_lshlrev_b32 v32, 4, v0
    v_add_u32 v32, s30, v32
    s_mov_b32 s30, 8192
    v_mul_lo_u32 v33, v32, s30
    v_lshrrev_b32 v33, 20, v33
    s_mov_b32 s30, 128
    v_mul_lo_u32 v34, v33, s30
    v_sub_u32 v34, v32, v34
    v_lshrrev_b32 v34, 4, v34
    v_mov_b32 v35, 0
    v_bfe_u32 v36, v33, 1, 1
    v_lshl_or_b32 v35, v36, 1, v35
    v_bfe_u32 v36, v33, 3, 1
    v_lshl_or_b32 v35, v36, 2, v35
    v_xor_b32 v34, v34, v35
    v_min_u32 v34, 7, v34
    s_mov_b32 s30, 2048
    v_mul_lo_u32 v33, v33, s30
    v_lshl_add_u32 v33, v34, 4, v33
    s_lshl_b32 s30, s25, 1
    v_add_u32 v6, s30, v33
    s_add_u32 s30, s31, 4
    s_min_u32 s30, s30, 7
    s_lshl_b32 s30, s30, 10
    s_add_u32 s41, s30, 16384
    v_lshlrev_b32 v32, 4, v0
    v_add_u32 v32, s30, v32
    s_mov_b32 s30, 8192
    v_mul_lo_u32 v33, v32, s30
    v_lshrrev_b32 v33, 20, v33
    s_mov_b32 s30, 128
    v_mul_lo_u32 v34, v33, s30
    v_sub_u32 v34, v32, v34
    v_lshrrev_b32 v34, 4, v34
    v_mov_b32 v35, 0
    v_bfe_u32 v36, v33, 1, 1
    v_lshl_or_b32 v35, v36, 1, v35
    v_bfe_u32 v36, v33, 3, 1
    v_lshl_or_b32 v35, v36, 2, v35
    v_xor_b32 v34, v34, v35
    v_min_u32 v34, 7, v34
    s_mov_b32 s30, 2048
    v_mul_lo_u32 v33, v33, s30
    v_lshl_add_u32 v33, v34, 4, v33
    s_lshl_b32 s30, s25, 1
    v_add_u32 v7, s30, v33
    v_and_b32 v32, 15, v0
    v_lshrrev_b32 v33, 4, v0
    s_mul_i32 s30, s26, 32
    v_add_u32 v34, s30, v32
    v_bfe_u32 v35, v32, 1, 3
    v_add_u32 v36, 0, v33
    v_xor_b32 v36, v36, v35
    v_lshlrev_b32 v36, 4, v36
    v_mul_u32_u24 v8, 128, v34
    v_add_u32 v8, v8, v36
    v_add_u32 v9, 24576, v8
    v_add_u32 v10, 49152, v8
    v_add_u32 v11, 73728, v8
    v_add_u32 v36, 4, v33
    v_xor_b32 v36, v36, v35
    v_lshlrev_b32 v36, 4, v36
    v_mul_u32_u24 v12, 128, v34
    v_add_u32 v12, v12, v36
    v_add_u32 v13, 24576, v12
    v_add_u32 v14, 49152, v12
    v_add_u32 v15, 73728, v12
    v_bfe_u32 v32, v0, 2, 2
    v_lshl_add_u32 v32, v33, 3, v32
    v_and_b32 v34, 3, v0
    v_mov_b32 v35, 0
    v_bfe_u32 v36, v32, 1, 1
    v_lshl_or_b32 v35, v36, 1, v35
    v_bfe_u32 v36, v32, 3, 1
    v_lshl_or_b32 v35, v36, 2, v35
    s_mul_i32 s30, s27, 128
    s_add_u32 s30, s30, 0
    v_lshlrev_b32 v36, 3, v34
    v_add_u32 v36, s30, v36
    v_lshrrev_b32 v33, 4, v36
    v_xor_b32 v33, v33, v35
    v_and_b32 v36, 15, v36
    v_lshl_add_u32 v36, v33, 4, v36
    v_mul_u32_u24 v16, 128, v32
    v_add_u32 v16, v16, v36
    v_add_u32 v16, 16384, v16
    v_add_u32 v17, 24576, v16
    v_add_u32 v18, 49152, v16
    v_add_u32 v19, 73728, v16
    s_mul_i32 s30, s27, 128
    s_add_u32 s30, s30, 32
    v_lshlrev_b32 v36, 3, v34
    v_add_u32 v36, s30, v36
    v_lshrrev_b32 v33, 4, v36
    v_xor_b32 v33, v33, v35
    v_and_b32 v36, 15, v36
    v_lshl_add_u32 v36, v33, 4, v36
    v_mul_u32_u24 v20, 128, v32
    v_add_u32 v20, v20, v36
    v_add_u32 v20, 16384, v20
    v_add_u32 v21, 24576, v20
    v_add_u32 v22, 49152, v20
    v_add_u32 v23, 73728, v20
    s_mul_i32 s30, s27, 128
    s_add_u32 s30, s30, 64
    v_lshlrev_b32 v36, 3, v34
    v_add_u32 v36, s30, v36
    v_lshrrev_b32 v33, 4, v36
    v_xor_b32 v33, v33, v35
    v_and_b32 v36, 15, v36
    v_lshl_add_u32 v36, v33, 4, v36
    v_mul_u32_u24 v24, 128, v32
    v_add_u32 v24, v24, v36
    v_add_u32 v24, 16384, v24
    v_add_u32 v25, 24576, v24
    v_add_u32 v26, 49152, v24
    v_add_u32 v27, 73728, v24
    s_mul_i32 s30, s27, 128
    s_add_u32 s30, s30, 96
    v_lshlrev_b32 v36, 3, v34
    v_add_u32 v36, s30, v36
    v_lshrrev_b32 v33, 4, v36
    v_xor_b32 v33, v33, v35
    v_and_b32 v36, 15, v36
    v_lshl_add_u32 v36, v33, 4, v36
    v_mul_u32_u24 v28, 128, v32
    v_add_u32 v28, v28, v36
    v_add_u32 v28, 16384, v28
    v_add_u32 v29, 24576, v28
    v_add_u32 v30, 49152, v28
    v_add_u32 v31, 73728, v28
    s_add_u32 m0, s36, 0
    buffer_load_dwordx4 v2, s[4:7], s28 offen lds
    s_add_u32 m0, s37, 0
    buffer_load_dwordx4 v3, s[4:7], s28 offen lds
    s_add_u32 m0, s38, 0
    buffer_load_dwordx4 v4, s[4:7], s28 offen lds
    s_add_u32 m0, s39, 0
    buffer_load_dwordx4 v5, s[4:7], s28 offen lds
    s_add_u32 m0, s40, 0
    buffer_load_dwordx4 v6, s[8:11], s29 offen lds
    s_add_u32 m0, s41, 0
    buffer_load_dwordx4 v7, s[8:11], s29 offen lds
    s_add_u32 s28, s28, 128
    s_add_u32 s29, s29, 131072
    s_add_u32 m0, s36, 24576
    buffer_load_dwordx4 v2, s[4:7], s28 offen lds
    s_add_u32 m0, s37, 24576
    buffer_load_dwordx4 v3, s[4:7], s28 offen lds
    s_add_u32 m0, s38, 24576
    buffer_load_dwordx4 v4, s[4:7], s28 offen lds
    s_add_u32 m0, s39, 24576
    buffer_load_dwordx4 v5, s[4:7], s28 offen lds
    s_add_u32 m0, s40, 24576
    buffer_load_dwordx4 v6, s[8:11], s29 offen lds
    s_add_u32 m0, s41, 24576
    buffer_load_dwordx4 v7, s[8:11], s29 offen lds
    s_add_u32 s28, s28, 128
    s_add_u32 s29, s29, 131072
    s_add_u32 m0, s36, 49152
    buffer_load_dwordx4 v2, s[4:7], s28 offen lds
    s_add_u32 m0, s37, 49152
    buffer_load_dwordx4 v3, s[4:7], s28 offen lds
    s_add_u32 m0, s38, 49152
    buffer_load_dwordx4 v4, s[4:7], s28 offen lds
    s_add_u32 m0, s39, 49152
    buffer_load_dwordx4 v5, s[4:7], s28 offen lds
    s_add_u32 m0, s40, 49152
    buffer_load_dwordx4 v6, s[8:11], s29 offen lds
    s_add_u32 m0, s41, 49152
    buffer_load_dwordx4 v7, s[8:11], s29 offen lds
    s_add_u32 s28, s28, 128
    s_add_u32 s29, s29, 131072
    s_add_u32 m0, s36, 73728
    buffer_load_dwordx4 v2, s[4:7], s28 offen lds
    s_add_u32 m0, s37, 73728
    buffer_load_dwordx4 v3, s[4:7], s28 offen lds
    s_add_u32 m0, s38, 73728
    buffer_load_dwordx4 v4, s[4:7], s28 offen lds
    s_add_u32 m0, s39, 73728
    buffer_load_dwordx4 v5, s[4:7], s28 offen lds
    s_add_u32 m0, s40, 73728
    buffer_load_dwordx4 v6, s[8:11], s29 offen lds
    s_add_u32 m0, s41, 73728
    buffer_load_dwordx4 v7, s[8:11], s29 offen lds
    s_add_u32 s28, s28, 128
    s_add_u32 s29, s29, 131072
    v_accvgpr_write_b32 a0, 0
    v_accvgpr_write_b32 a1, 0
    v_accvgpr_write_b32 a2, 0
    v_accvgpr_write_b32 a3, 0
    v_accvgpr_write_b32 a4, 0
    v_accvgpr_write_b32 a5, 0
    v_accvgpr_write_b32 a6, 0
    v_accvgpr_write_b32 a7, 0
    v_accvgpr_write_b32 a8, 0
    v_accvgpr_write_b32 a9, 0
    v_accvgpr_write_b32 a10, 0
    v_accvgpr_write_b32 a11, 0
    v_accvgpr_write_b32 a12, 0
    v_accvgpr_write_b32 a13, 0
    v_accvgpr_write_b32 a14, 0
    v_accvgpr_write_b32 a15, 0
    v_accvgpr_write_b32 a16, 0
    v_accvgpr_write_b32 a17, 0
    v_accvgpr_write_b32 a18, 0
    v_accvgpr_write_b32 a19, 0
    v_accvgpr_write_b32 a20, 0
    v_accvgpr_write_b32 a21, 0
    v_accvgpr_write_b32 a22, 0
    v_accvgpr_write_b32 a23, 0
    v_accvgpr_write_b32 a24, 0
    v_accvgpr_write_b32 a25, 0
    v_accvgpr_write_b32 a26, 0
    v_accvgpr_write_b32 a27, 0
    v_accvgpr_write_b32 a28, 0
    v_accvgpr_write_b32 a29, 0
    v_accvgpr_write_b32 a30, 0
    v_accvgpr_write_b32 a31, 0
    s_waitcnt vmcnt(18)
    s_barrier
    ds_read_b128 v[40:43], v8 offset:0
    ds_read_b128 v[44:47], v8 offset:2048
    ds_read_b64_tr_b16 v[48:49], v16 offset:0
    ds_read_b64_tr_b16 v[50:51], v16 offset:512
    ds_read_b64_tr_b16 v[52:53], v20 offset:0
    ds_read_b64_tr_b16 v[54:55], v20 offset:512
    ds_read_b64_tr_b16 v[56:57], v24 offset:0
    ds_read_b64_tr_b16 v[58:59], v24 offset:512
    ds_read_b64_tr_b16 v[60:61], v28 offset:0
    ds_read_b64_tr_b16 v[62:63], v28 offset:512
    s_mov_b32 s32, 13
L_dn_kernel_loop:
    s_waitcnt lgkmcnt(0)
    ds_read_b128 v[64:67], v12 offset:0
    v_mfma_f32_16x16x32_bf16 a[0:3], v[48:51], v[40:43], a[0:3]
    ds_read_b128 v[68:71], v12 offset:2048
    v_mfma_f32_16x16x32_bf16 a[16:19], v[48:51], v[44:47], a[16:19]
    ds_read_b64_tr_b16 v[72:73], v16 offset:4096
    v_mfma_f32_16x16x32_bf16 a[4:7], v[52:55], v[40:43], a[4:7]
    ds_read_b64_tr_b16 v[74:75], v16 offset:4608
    v_mfma_f32_16x16x32_bf16 a[20:23], v[52:55], v[44:47], a[20:23]
    ds_read_b64_tr_b16 v[76:77], v20 offset:4096
    v_mfma_f32_16x16x32_bf16 a[8:11], v[56:59], v[40:43], a[8:11]
    ds_read_b64_tr_b16 v[78:79], v20 offset:4608
    v_mfma_f32_16x16x32_bf16 a[24:27], v[56:59], v[44:47], a[24:27]
    ds_read_b64_tr_b16 v[80:81], v24 offset:4096
    v_mfma_f32_16x16x32_bf16 a[12:15], v[60:63], v[40:43], a[12:15]
    ds_read_b64_tr_b16 v[82:83], v24 offset:4608
    v_mfma_f32_16x16x32_bf16 a[28:31], v[60:63], v[44:47], a[28:31]
    ds_read_b64_tr_b16 v[84:85], v28 offset:4096
    ds_read_b64_tr_b16 v[86:87], v28 offset:4608
    s_waitcnt lgkmcnt(0)
    v_mfma_f32_16x16x32_bf16 a[0:3], v[72:75], v[64:67], a[0:3]
    v_mfma_f32_16x16x32_bf16 a[16:19], v[72:75], v[68:71], a[16:19]
    s_waitcnt vmcnt(12)
    s_barrier
    s_add_u32 m0, s36, 0
    buffer_load_dwordx4 v2, s[4:7], s28 offen lds
    s_add_u32 m0, s37, 0
    buffer_load_dwordx4 v3, s[4:7], s28 offen lds
    s_add_u32 m0, s38, 0
    buffer_load_dwordx4 v4, s[4:7], s28 offen lds
    s_add_u32 m0, s39, 0
    buffer_load_dwordx4 v5, s[4:7], s28 offen lds
    s_add_u32 m0, s40, 0
    buffer_load_dwordx4 v6, s[8:11], s29 offen lds
    s_add_u32 m0, s41, 0
    buffer_load_dwordx4 v7, s[8:11], s29 offen lds
    s_add_u32 s28, s28, 128
    s_add_u32 s29, s29, 131072
    ds_read_b128 v[40:43], v9 offset:0
    v_mfma_f32_16x16x32_bf16 a[4:7], v[76:79], v[64:67], a[4:7]
    ds_read_b128 v[44:47], v9 offset:2048
    v_mfma_f32_16x16x32_bf16 a[20:23], v[76:79], v[68:71], a[20:23]
    ds_read_b64_tr_b16 v[48:49], v17 offset:0
    v_mfma_f32_16x16x32_bf16 a[8:11], v[80:83], v[64:67], a[8:11]
    ds_read_b64_tr_b16 v[50:51], v17 offset:512
    v_mfma_f32_16x16x32_bf16 a[24:27], v[80:83], v[68:71], a[24:27]
    ds_read_b64_tr_b16 v[52:53], v21 offset:0
    v_mfma_f32_16x16x32_bf16 a[12:15], v[84:87], v[64:67], a[12:15]
    ds_read_b64_tr_b16 v[54:55], v21 offset:512
    v_mfma_f32_16x16x32_bf16 a[28:31], v[84:87], v[68:71], a[28:31]
    ds_read_b64_tr_b16 v[56:57], v25 offset:0
    ds_read_b64_tr_b16 v[58:59], v25 offset:512
    ds_read_b64_tr_b16 v[60:61], v29 offset:0
    ds_read_b64_tr_b16 v[62:63], v29 offset:512
    s_waitcnt lgkmcnt(0)
    ds_read_b128 v[64:67], v13 offset:0
    v_mfma_f32_16x16x32_bf16 a[0:3], v[48:51], v[40:43], a[0:3]
    ds_read_b128 v[68:71], v13 offset:2048
    v_mfma_f32_16x16x32_bf16 a[16:19], v[48:51], v[44:47], a[16:19]
    ds_read_b64_tr_b16 v[72:73], v17 offset:4096
    v_mfma_f32_16x16x32_bf16 a[4:7], v[52:55], v[40:43], a[4:7]
    ds_read_b64_tr_b16 v[74:75], v17 offset:4608
    v_mfma_f32_16x16x32_bf16 a[20:23], v[52:55], v[44:47], a[20:23]
    ds_read_b64_tr_b16 v[76:77], v21 offset:4096
    v_mfma_f32_16x16x32_bf16 a[8:11], v[56:59], v[40:43], a[8:11]
    ds_read_b64_tr_b16 v[78:79], v21 offset:4608
    v_mfma_f32_16x16x32_bf16 a[24:27], v[56:59], v[44:47], a[24:27]
    ds_read_b64_tr_b16 v[80:81], v25 offset:4096
    v_mfma_f32_16x16x32_bf16 a[12:15], v[60:63], v[40:43], a[12:15]
    ds_read_b64_tr_b16 v[82:83], v25 offset:4608
    v_mfma_f32_16x16x32_bf16 a[28:31], v[60:63], v[44:47], a[28:31]
    ds_read_b64_tr_b16 v[84:85], v29 offset:4096
    ds_read_b64_tr_b16 v[86:87], v29 offset:4608
    s_waitcnt lgkmcnt(0)
    v_mfma_f32_16x16x32_bf16 a[0:3], v[72:75], v[64:67], a[0:3]
    v_mfma_f32_16x16x32_bf16 a[16:19], v[72:75], v[68:71], a[16:19]
    s_waitcnt vmcnt(12)
    s_barrier
    s_add_u32 m0, s36, 24576
    buffer_load_dwordx4 v2, s[4:7], s28 offen lds
    s_add_u32 m0, s37, 24576
    buffer_load_dwordx4 v3, s[4:7], s28 offen lds
    s_add_u32 m0, s38, 24576
    buffer_load_dwordx4 v4, s[4:7], s28 offen lds
    s_add_u32 m0, s39, 24576
    buffer_load_dwordx4 v5, s[4:7], s28 offen lds
    s_add_u32 m0, s40, 24576
    buffer_load_dwordx4 v6, s[8:11], s29 offen lds
    s_add_u32 m0, s41, 24576
    buffer_load_dwordx4 v7, s[8:11], s29 offen lds
    s_add_u32 s28, s28, 128
    s_add_u32 s29, s29, 131072
    ds_read_b128 v[40:43], v10 offset:0
    v_mfma_f32_16x16x32_bf16 a[4:7], v[76:79], v[64:67], a[4:7]
    ds_read_b128 v[44:47], v10 offset:2048
    v_mfma_f32_16x16x32_bf16 a[20:23], v[76:79], v[68:71], a[20:23]
    ds_read_b64_tr_b16 v[48:49], v18 offset:0
    v_mfma_f32_16x16x32_bf16 a[8:11], v[80:83], v[64:67], a[8:11]
    ds_read_b64_tr_b16 v[50:51], v18 offset:512
    v_mfma_f32_16x16x32_bf16 a[24:27], v[80:83], v[68:71], a[24:27]
    ds_read_b64_tr_b16 v[52:53], v22 offset:0
    v_mfma_f32_16x16x32_bf16 a[12:15], v[84:87], v[64:67], a[12:15]
    ds_read_b64_tr_b16 v[54:55], v22 offset:512
    v_mfma_f32_16x16x32_bf16 a[28:31], v[84:87], v[68:71], a[28:31]
    ds_read_b64_tr_b16 v[56:57], v26 offset:0
    ds_read_b64_tr_b16 v[58:59], v26 offset:512
    ds_read_b64_tr_b16 v[60:61], v30 offset:0
    ds_read_b64_tr_b16 v[62:63], v30 offset:512
    s_waitcnt lgkmcnt(0)
    ds_read_b128 v[64:67], v14 offset:0
    v_mfma_f32_16x16x32_bf16 a[0:3], v[48:51], v[40:43], a[0:3]
    ds_read_b128 v[68:71], v14 offset:2048
    v_mfma_f32_16x16x32_bf16 a[16:19], v[48:51], v[44:47], a[16:19]
    ds_read_b64_tr_b16 v[72:73], v18 offset:4096
    v_mfma_f32_16x16x32_bf16 a[4:7], v[52:55], v[40:43], a[4:7]
    ds_read_b64_tr_b16 v[74:75], v18 offset:4608
    v_mfma_f32_16x16x32_bf16 a[20:23], v[52:55], v[44:47], a[20:23]
    ds_read_b64_tr_b16 v[76:77], v22 offset:4096
    v_mfma_f32_16x16x32_bf16 a[8:11], v[56:59], v[40:43], a[8:11]
    ds_read_b64_tr_b16 v[78:79], v22 offset:4608
    v_mfma_f32_16x16x32_bf16 a[24:27], v[56:59], v[44:47], a[24:27]
    ds_read_b64_tr_b16 v[80:81], v26 offset:4096
    v_mfma_f32_16x16x32_bf16 a[12:15], v[60:63], v[40:43], a[12:15]
    ds_read_b64_tr_b16 v[82:83], v26 offset:4608
    v_mfma_f32_16x16x32_bf16 a[28:31], v[60:63], v[44:47], a[28:31]
    ds_read_b64_tr_b16 v[84:85], v30 offset:4096
    ds_read_b64_tr_b16 v[86:87], v30 offset:4608
    s_waitcnt lgkmcnt(0)
    v_mfma_f32_16x16x32_bf16 a[0:3], v[72:75], v[64:67], a[0:3]
    v_mfma_f32_16x16x32_bf16 a[16:19], v[72:75], v[68:71], a[16:19]
    s_waitcnt vmcnt(12)
    s_barrier
    s_add_u32 m0, s36, 49152
    buffer_load_dwordx4 v2, s[4:7], s28 offen lds
    s_add_u32 m0, s37, 49152
    buffer_load_dwordx4 v3, s[4:7], s28 offen lds
    s_add_u32 m0, s38, 49152
    buffer_load_dwordx4 v4, s[4:7], s28 offen lds
    s_add_u32 m0, s39, 49152
    buffer_load_dwordx4 v5, s[4:7], s28 offen lds
    s_add_u32 m0, s40, 49152
    buffer_load_dwordx4 v6, s[8:11], s29 offen lds
    s_add_u32 m0, s41, 49152
    buffer_load_dwordx4 v7, s[8:11], s29 offen lds
    s_add_u32 s28, s28, 128
    s_add_u32 s29, s29, 131072
    ds_read_b128 v[40:43], v11 offset:0
    v_mfma_f32_16x16x32_bf16 a[4:7], v[76:79], v[64:67], a[4:7]
    ds_read_b128 v[44:47], v11 offset:2048
    v_mfma_f32_16x16x32_bf16 a[20:23], v[76:79], v[68:71], a[20:23]
    ds_read_b64_tr_b16 v[48:49], v19 offset:0
    v_mfma_f32_16x16x32_bf16 a[8:11], v[80:83], v[64:67], a[8:11]
    ds_read_b64_tr_b16 v[50:51], v19 offset:512
    v_mfma_f32_16x16x32_bf16 a[24:27], v[80:83], v[68:71], a[24:27]
    ds_read_b64_tr_b16 v[52:53], v23 offset:0
    v_mfma_f32_16x16x32_bf16 a[12:15], v[84:87], v[64:67], a[12:15]
    ds_read_b64_tr_b16 v[54:55], v23 offset:512
    v_mfma_f32_16x16x32_bf16 a[28:31], v[84:87], v[68:71], a[28:31]
    ds_read_b64_tr_b16 v[56:57], v27 offset:0
    ds_read_b64_tr_b16 v[58:59], v27 offset:512
    ds_read_b64_tr_b16 v[60:61], v31 offset:0
    ds_read_b64_tr_b16 v[62:63], v31 offset:512
    s_waitcnt lgkmcnt(0)
    ds_read_b128 v[64:67], v15 offset:0
    v_mfma_f32_16x16x32_bf16 a[0:3], v[48:51], v[40:43], a[0:3]
    ds_read_b128 v[68:71], v15 offset:2048
    v_mfma_f32_16x16x32_bf16 a[16:19], v[48:51], v[44:47], a[16:19]
    ds_read_b64_tr_b16 v[72:73], v19 offset:4096
    v_mfma_f32_16x16x32_bf16 a[4:7], v[52:55], v[40:43], a[4:7]
    ds_read_b64_tr_b16 v[74:75], v19 offset:4608
    v_mfma_f32_16x16x32_bf16 a[20:23], v[52:55], v[44:47], a[20:23]
    ds_read_b64_tr_b16 v[76:77], v23 offset:4096
    v_mfma_f32_16x16x32_bf16 a[8:11], v[56:59], v[40:43], a[8:11]
    ds_read_b64_tr_b16 v[78:79], v23 offset:4608
    v_mfma_f32_16x16x32_bf16 a[24:27], v[56:59], v[44:47], a[24:27]
    ds_read_b64_tr_b16 v[80:81], v27 offset:4096
    v_mfma_f32_16x16x32_bf16 a[12:15], v[60:63], v[40:43], a[12:15]
    ds_read_b64_tr_b16 v[82:83], v27 offset:4608
    v_mfma_f32_16x16x32_bf16 a[28:31], v[60:63], v[44:47], a[28:31]
    ds_read_b64_tr_b16 v[84:85], v31 offset:4096
    ds_read_b64_tr_b16 v[86:87], v31 offset:4608
    s_waitcnt lgkmcnt(0)
    v_mfma_f32_16x16x32_bf16 a[0:3], v[72:75], v[64:67], a[0:3]
    v_mfma_f32_16x16x32_bf16 a[16:19], v[72:75], v[68:71], a[16:19]
    s_waitcnt vmcnt(12)
    s_barrier
    s_add_u32 m0, s36, 73728
    buffer_load_dwordx4 v2, s[4:7], s28 offen lds
    s_add_u32 m0, s37, 73728
    buffer_load_dwordx4 v3, s[4:7], s28 offen lds
    s_add_u32 m0, s38, 73728
    buffer_load_dwordx4 v4, s[4:7], s28 offen lds
    s_add_u32 m0, s39, 73728
    buffer_load_dwordx4 v5, s[4:7], s28 offen lds
    s_add_u32 m0, s40, 73728
    buffer_load_dwordx4 v6, s[8:11], s29 offen lds
    s_add_u32 m0, s41, 73728
    buffer_load_dwordx4 v7, s[8:11], s29 offen lds
    s_add_u32 s28, s28, 128
    s_add_u32 s29, s29, 131072
    ds_read_b128 v[40:43], v8 offset:0
    v_mfma_f32_16x16x32_bf16 a[4:7], v[76:79], v[64:67], a[4:7]
    ds_read_b128 v[44:47], v8 offset:2048
    v_mfma_f32_16x16x32_bf16 a[20:23], v[76:79], v[68:71], a[20:23]
    ds_read_b64_tr_b16 v[48:49], v16 offset:0
    v_mfma_f32_16x16x32_bf16 a[8:11], v[80:83], v[64:67], a[8:11]
    ds_read_b64_tr_b16 v[50:51], v16 offset:512
    v_mfma_f32_16x16x32_bf16 a[24:27], v[80:83], v[68:71], a[24:27]
    ds_read_b64_tr_b16 v[52:53], v20 offset:0
    v_mfma_f32_16x16x32_bf16 a[12:15], v[84:87], v[64:67], a[12:15]
    ds_read_b64_tr_b16 v[54:55], v20 offset:512
    v_mfma_f32_16x16x32_bf16 a[28:31], v[84:87], v[68:71], a[28:31]
    ds_read_b64_tr_b16 v[56:57], v24 offset:0
    ds_read_b64_tr_b16 v[58:59], v24 offset:512
    ds_read_b64_tr_b16 v[60:61], v28 offset:0
    ds_read_b64_tr_b16 v[62:63], v28 offset:512
    s_sub_u32 s32, s32, 1
    s_cmp_lg_u32 s32, 0
    s_cbranch_scc1 L_dn_kernel_loop
    s_waitcnt lgkmcnt(0)
    ds_read_b128 v[64:67], v12 offset:0
    v_mfma_f32_16x16x32_bf16 a[0:3], v[48:51], v[40:43], a[0:3]
    ds_read_b128 v[68:71], v12 offset:2048
    v_mfma_f32_16x16x32_bf16 a[16:19], v[48:51], v[44:47], a[16:19]
    ds_read_b64_tr_b16 v[72:73], v16 offset:4096
    v_mfma_f32_16x16x32_bf16 a[4:7], v[52:55], v[40:43], a[4:7]
    ds_read_b64_tr_b16 v[74:75], v16 offset:4608
    v_mfma_f32_16x16x32_bf16 a[20:23], v[52:55], v[44:47], a[20:23]
    ds_read_b64_tr_b16 v[76:77], v20 offset:4096
    v_mfma_f32_16x16x32_bf16 a[8:11], v[56:59], v[40:43], a[8:11]
    ds_read_b64_tr_b16 v[78:79], v20 offset:4608
    v_mfma_f32_16x16x32_bf16 a[24:27], v[56:59], v[44:47], a[24:27]
    ds_read_b64_tr_b16 v[80:81], v24 offset:4096
    v_mfma_f32_16x16x32_bf16 a[12:15], v[60:63], v[40:43], a[12:15]
    ds_read_b64_tr_b16 v[82:83], v24 offset:4608
    v_mfma_f32_16x16x32_bf16 a[28:31], v[60:63], v[44:47], a[28:31]
    ds_read_b64_tr_b16 v[84:85], v28 offset:4096
    ds_read_b64_tr_b16 v[86:87], v28 offset:4608
    s_waitcnt lgkmcnt(0)
    v_mfma_f32_16x16x32_bf16 a[0:3], v[72:75], v[64:67], a[0:3]
    v_mfma_f32_16x16x32_bf16 a[16:19], v[72:75], v[68:71], a[16:19]
    s_waitcnt vmcnt(12)
    s_barrier
    ds_read_b128 v[40:43], v9 offset:0
    v_mfma_f32_16x16x32_bf16 a[4:7], v[76:79], v[64:67], a[4:7]
    ds_read_b128 v[44:47], v9 offset:2048
    v_mfma_f32_16x16x32_bf16 a[20:23], v[76:79], v[68:71], a[20:23]
    ds_read_b64_tr_b16 v[48:49], v17 offset:0
    v_mfma_f32_16x16x32_bf16 a[8:11], v[80:83], v[64:67], a[8:11]
    ds_read_b64_tr_b16 v[50:51], v17 offset:512
    v_mfma_f32_16x16x32_bf16 a[24:27], v[80:83], v[68:71], a[24:27]
    ds_read_b64_tr_b16 v[52:53], v21 offset:0
    v_mfma_f32_16x16x32_bf16 a[12:15], v[84:87], v[64:67], a[12:15]
    ds_read_b64_tr_b16 v[54:55], v21 offset:512
    v_mfma_f32_16x16x32_bf16 a[28:31], v[84:87], v[68:71], a[28:31]
    ds_read_b64_tr_b16 v[56:57], v25 offset:0
    ds_read_b64_tr_b16 v[58:59], v25 offset:512
    ds_read_b64_tr_b16 v[60:61], v29 offset:0
    ds_read_b64_tr_b16 v[62:63], v29 offset:512
    s_waitcnt lgkmcnt(0)
    ds_read_b128 v[64:67], v13 offset:0
    v_mfma_f32_16x16x32_bf16 a[0:3], v[48:51], v[40:43], a[0:3]
    ds_read_b128 v[68:71], v13 offset:2048
    v_mfma_f32_16x16x32_bf16 a[16:19], v[48:51], v[44:47], a[16:19]
    ds_read_b64_tr_b16 v[72:73], v17 offset:4096
    v_mfma_f32_16x16x32_bf16 a[4:7], v[52:55], v[40:43], a[4:7]
    ds_read_b64_tr_b16 v[74:75], v17 offset:4608
    v_mfma_f32_16x16x32_bf16 a[20:23], v[52:55], v[44:47], a[20:23]
    ds_read_b64_tr_b16 v[76:77], v21 offset:4096
    v_mfma_f32_16x16x32_bf16 a[8:11], v[56:59], v[40:43], a[8:11]
    ds_read_b64_tr_b16 v[78:79], v21 offset:4608
    v_mfma_f32_16x16x32_bf16 a[24:27], v[56:59], v[44:47], a[24:27]
    ds_read_b64_tr_b16 v[80:81], v25 offset:4096
    v_mfma_f32_16x16x32_bf16 a[12:15], v[60:63], v[40:43], a[12:15]
    ds_read_b64_tr_b16 v[82:83], v25 offset:4608
    v_mfma_f32_16x16x32_bf16 a[28:31], v[60:63], v[44:47], a[28:31]
    ds_read_b64_tr_b16 v[84:85], v29 offset:4096
    ds_read_b64_tr_b16 v[86:87], v29 offset:4608
    s_waitcnt lgkmcnt(0)
    v_mfma_f32_16x16x32_bf16 a[0:3], v[72:75], v[64:67], a[0:3]
    v_mfma_f32_16x16x32_bf16 a[16:19], v[72:75], v[68:71], a[16:19]
    s_waitcnt vmcnt(6)
    s_barrier
    ds_read_b128 v[40:43], v10 offset:0
    v_mfma_f32_16x16x32_bf16 a[4:7], v[76:79], v[64:67], a[4:7]
    ds_read_b128 v[44:47], v10 offset:2048
    v_mfma_f32_16x16x32_bf16 a[20:23], v[76:79], v[68:71], a[20:23]
    ds_read_b64_tr_b16 v[48:49], v18 offset:0
    v_mfma_f32_16x16x32_bf16 a[8:11], v[80:83], v[64:67], a[8:11]
    ds_read_b64_tr_b16 v[50:51], v18 offset:512
    v_mfma_f32_16x16x32_bf16 a[24:27], v[80:83], v[68:71], a[24:27]
    ds_read_b64_tr_b16 v[52:53], v22 offset:0
    v_mfma_f32_16x16x32_bf16 a[12:15], v[84:87], v[64:67], a[12:15]
    ds_read_b64_tr_b16 v[54:55], v22 offset:512
    v_mfma_f32_16x16x32_bf16 a[28:31], v[84:87], v[68:71], a[28:31]
    ds_read_b64_tr_b16 v[56:57], v26 offset:0
    ds_read_b64_tr_b16 v[58:59], v26 offset:512
    ds_read_b64_tr_b16 v[60:61], v30 offset:0
    ds_read_b64_tr_b16 v[62:63], v30 offset:512
    s_waitcnt lgkmcnt(0)
    ds_read_b128 v[64:67], v14 offset:0
    v_mfma_f32_16x16x32_bf16 a[0:3], v[48:51], v[40:43], a[0:3]
    ds_read_b128 v[68:71], v14 offset:2048
    v_mfma_f32_16x16x32_bf16 a[16:19], v[48:51], v[44:47], a[16:19]
    ds_read_b64_tr_b16 v[72:73], v18 offset:4096
    v_mfma_f32_16x16x32_bf16 a[4:7], v[52:55], v[40:43], a[4:7]
    ds_read_b64_tr_b16 v[74:75], v18 offset:4608
    v_mfma_f32_16x16x32_bf16 a[20:23], v[52:55], v[44:47], a[20:23]
    ds_read_b64_tr_b16 v[76:77], v22 offset:4096
    v_mfma_f32_16x16x32_bf16 a[8:11], v[56:59], v[40:43], a[8:11]
    ds_read_b64_tr_b16 v[78:79], v22 offset:4608
    v_mfma_f32_16x16x32_bf16 a[24:27], v[56:59], v[44:47], a[24:27]
    ds_read_b64_tr_b16 v[80:81], v26 offset:4096
    v_mfma_f32_16x16x32_bf16 a[12:15], v[60:63], v[40:43], a[12:15]
    ds_read_b64_tr_b16 v[82:83], v26 offset:4608
    v_mfma_f32_16x16x32_bf16 a[28:31], v[60:63], v[44:47], a[28:31]
    ds_read_b64_tr_b16 v[84:85], v30 offset:4096
    ds_read_b64_tr_b16 v[86:87], v30 offset:4608
    s_waitcnt lgkmcnt(0)
    v_mfma_f32_16x16x32_bf16 a[0:3], v[72:75], v[64:67], a[0:3]
    v_mfma_f32_16x16x32_bf16 a[16:19], v[72:75], v[68:71], a[16:19]
    s_waitcnt vmcnt(0)
    s_barrier
    ds_read_b128 v[40:43], v11 offset:0
    v_mfma_f32_16x16x32_bf16 a[4:7], v[76:79], v[64:67], a[4:7]
    ds_read_b128 v[44:47], v11 offset:2048
    v_mfma_f32_16x16x32_bf16 a[20:23], v[76:79], v[68:71], a[20:23]
    ds_read_b64_tr_b16 v[48:49], v19 offset:0
    v_mfma_f32_16x16x32_bf16 a[8:11], v[80:83], v[64:67], a[8:11]
    ds_read_b64_tr_b16 v[50:51], v19 offset:512
    v_mfma_f32_16x16x32_bf16 a[24:27], v[80:83], v[68:71], a[24:27]
    ds_read_b64_tr_b16 v[52:53], v23 offset:0
    v_mfma_f32_16x16x32_bf16 a[12:15], v[84:87], v[64:67], a[12:15]
    ds_read_b64_tr_b16 v[54:55], v23 offset:512
    v_mfma_f32_16x16x32_bf16 a[28:31], v[84:87], v[68:71], a[28:31]
    ds_read_b64_tr_b16 v[56:57], v27 offset:0
    ds_read_b64_tr_b16 v[58:59], v27 offset:512
    ds_read_b64_tr_b16 v[60:61], v31 offset:0
    ds_read_b64_tr_b16 v[62:63], v31 offset:512
    s_waitcnt lgkmcnt(0)
    ds_read_b128 v[64:67], v15 offset:0
    v_mfma_f32_16x16x32_bf16 a[0:3], v[48:51], v[40:43], a[0:3]
    ds_read_b128 v[68:71], v15 offset:2048
    v_mfma_f32_16x16x32_bf16 a[16:19], v[48:51], v[44:47], a[16:19]
    ds_read_b64_tr_b16 v[72:73], v19 offset:4096
    v_mfma_f32_16x16x32_bf16 a[4:7], v[52:55], v[40:43], a[4:7]
    ds_read_b64_tr_b16 v[74:75], v19 offset:4608
    v_mfma_f32_16x16x32_bf16 a[20:23], v[52:55], v[44:47], a[20:23]
    ds_read_b64_tr_b16 v[76:77], v23 offset:4096
    v_mfma_f32_16x16x32_bf16 a[8:11], v[56:59], v[40:43], a[8:11]
    ds_read_b64_tr_b16 v[78:79], v23 offset:4608
    v_mfma_f32_16x16x32_bf16 a[24:27], v[56:59], v[44:47], a[24:27]
    ds_read_b64_tr_b16 v[80:81], v27 offset:4096
    v_mfma_f32_16x16x32_bf16 a[12:15], v[60:63], v[40:43], a[12:15]
    ds_read_b64_tr_b16 v[82:83], v27 offset:4608
    v_mfma_f32_16x16x32_bf16 a[28:31], v[60:63], v[44:47], a[28:31]
    ds_read_b64_tr_b16 v[84:85], v31 offset:4096
    ds_read_b64_tr_b16 v[86:87], v31 offset:4608
    s_waitcnt lgkmcnt(0)
    v_mfma_f32_16x16x32_bf16 a[0:3], v[72:75], v[64:67], a[0:3]
    v_mfma_f32_16x16x32_bf16 a[16:19], v[72:75], v[68:71], a[16:19]
    v_mfma_f32_16x16x32_bf16 a[4:7], v[76:79], v[64:67], a[4:7]
    v_mfma_f32_16x16x32_bf16 a[20:23], v[76:79], v[68:71], a[20:23]
    v_mfma_f32_16x16x32_bf16 a[8:11], v[80:83], v[64:67], a[8:11]
    v_mfma_f32_16x16x32_bf16 a[24:27], v[80:83], v[68:71], a[24:27]
    v_mfma_f32_16x16x32_bf16 a[12:15], v[84:87], v[64:67], a[12:15]
    v_mfma_f32_16x16x32_bf16 a[28:31], v[84:87], v[68:71], a[28:31]
    s_nop 7
    s_nop 7
    s_barrier
    v_and_b32 v32, 15, v0
    v_lshrrev_b32 v33, 4, v0
    s_mul_i32 s30, s26, 32
    v_add_u32 v32, s30, v32
    v_mul_u32_u24 v32, 272, v32
    s_mul_i32 s30, s27, 256
    v_lshl_add_u32 v32, v33, 4, v32
    v_add_u32 v34, s30, v32
    v_accvgpr_read_b32 v40, a0
    v_accvgpr_read_b32 v41, a1
    v_accvgpr_read_b32 v42, a2
    v_accvgpr_read_b32 v43, a3
    ds_write_b128 v34, v[40:43] offset:0
    v_accvgpr_read_b32 v56, a4
    v_accvgpr_read_b32 v57, a5
    v_accvgpr_read_b32 v58, a6
    v_accvgpr_read_b32 v59, a7
    ds_write_b128 v34, v[56:59] offset:64
    v_accvgpr_read_b32 v40, a8
    v_accvgpr_read_b32 v41, a9
    v_accvgpr_read_b32 v42, a10
    v_accvgpr_read_b32 v43, a11
    ds_write_b128 v34, v[40:43] offset:128
    v_accvgpr_read_b32 v56, a12
    v_accvgpr_read_b32 v57, a13
    v_accvgpr_read_b32 v58, a14
    v_accvgpr_read_b32 v59, a15
    ds_write_b128 v34, v[56:59] offset:192
    v_accvgpr_read_b32 v40, a16
    v_accvgpr_read_b32 v41, a17
    v_accvgpr_read_b32 v42, a18
    v_accvgpr_read_b32 v43, a19
    ds_write_b128 v34, v[40:43] offset:4352
    v_accvgpr_read_b32 v56, a20
    v_accvgpr_read_b32 v57, a21
    v_accvgpr_read_b32 v58, a22
    v_accvgpr_read_b32 v59, a23
    ds_write_b128 v34, v[56:59] offset:4416
    v_accvgpr_read_b32 v40, a24
    v_accvgpr_read_b32 v41, a25
    v_accvgpr_read_b32 v42, a26
    v_accvgpr_read_b32 v43, a27
    ds_write_b128 v34, v[40:43] offset:4480
    v_accvgpr_read_b32 v56, a28
    v_accvgpr_read_b32 v57, a29
    v_accvgpr_read_b32 v58, a30
    v_accvgpr_read_b32 v59, a31
    ds_write_b128 v34, v[56:59] offset:4544
    s_waitcnt lgkmcnt(0)
    s_barrier
    s_lshl_b32 s30, s31, 6
    v_add_u32 v35, s30, v0
    v_add_u32 v32, 0, v35
    s_mov_b32 s30, 131072
    v_mul_lo_u32 v33, v32, s30
    v_lshrrev_b32 v33, 20, v33
    v_mul_u32_u24 v34, 8, v33
    v_sub_u32 v34, v32, v34
    v_mul_u32_u24 v32, 272, v33
    v_lshl_add_u32 v32, v34, 5, v32
    ds_read_b128 v[40:43], v32
    ds_read_b128 v[44:47], v32 offset:16
    v_add_u32 v33, s24, v33
    s_mov_b32 s30, 2048
    v_mul_lo_u32 v33, v33, s30
    v_lshl_add_u32 v33, v34, 4, v33
    s_lshl_b32 s30, s25, 1
    v_add_u32 v52, s30, v33
    buffer_load_dwordx4 v[48:51], v52, s[20:23], 0 offen
    v_add_u32 v32, 256, v35
    s_mov_b32 s30, 131072
    v_mul_lo_u32 v33, v32, s30
    v_lshrrev_b32 v33, 20, v33
    v_mul_u32_u24 v34, 8, v33
    v_sub_u32 v34, v32, v34
    v_mul_u32_u24 v32, 272, v33
    v_lshl_add_u32 v32, v34, 5, v32
    ds_read_b128 v[56:59], v32
    ds_read_b128 v[60:63], v32 offset:16
    v_add_u32 v33, s24, v33
    s_mov_b32 s30, 2048
    v_mul_lo_u32 v33, v33, s30
    v_lshl_add_u32 v33, v34, 4, v33
    s_lshl_b32 s30, s25, 1
    v_add_u32 v68, s30, v33
    buffer_load_dwordx4 v[64:67], v68, s[20:23], 0 offen
    v_add_u32 v32, 512, v35
    s_mov_b32 s30, 131072
    v_mul_lo_u32 v33, v32, s30
    v_lshrrev_b32 v33, 20, v33
    v_mul_u32_u24 v34, 8, v33
    v_sub_u32 v34, v32, v34
    v_mul_u32_u24 v32, 272, v33
    v_lshl_add_u32 v32, v34, 5, v32
    ds_read_b128 v[72:75], v32
    ds_read_b128 v[76:79], v32 offset:16
    v_add_u32 v33, s24, v33
    s_mov_b32 s30, 2048
    v_mul_lo_u32 v33, v33, s30
    v_lshl_add_u32 v33, v34, 4, v33
    s_lshl_b32 s30, s25, 1
    v_add_u32 v84, s30, v33
    buffer_load_dwordx4 v[80:83], v84, s[20:23], 0 offen
    v_add_u32 v32, 768, v35
    s_mov_b32 s30, 131072
    v_mul_lo_u32 v33, v32, s30
    v_lshrrev_b32 v33, 20, v33
    v_mul_u32_u24 v34, 8, v33
    v_sub_u32 v34, v32, v34
    v_mul_u32_u24 v32, 272, v33
    v_lshl_add_u32 v32, v34, 5, v32
    ds_read_b128 v[88:91], v32
    ds_read_b128 v[92:95], v32 offset:16
    v_add_u32 v33, s24, v33
    s_mov_b32 s30, 2048
    v_mul_lo_u32 v33, v33, s30
    v_lshl_add_u32 v33, v34, 4, v33
    s_lshl_b32 s30, s25, 1
    v_add_u32 v100, s30, v33
    buffer_load_dwordx4 v[96:99], v100, s[20:23], 0 offen
    s_waitcnt vmcnt(0) lgkmcnt(0)
    v_lshlrev_b32 v32, 16, v48
    v_and_b32 v33, 0xffff0000, v48
    v_add_f32 v40, v40, v32
    v_add_f32 v41, v41, v33
    v_lshlrev_b32 v32, 16, v49
    v_and_b32 v33, 0xffff0000, v49
    v_add_f32 v42, v42, v32
    v_add_f32 v43, v43, v33
    v_lshlrev_b32 v32, 16, v50
    v_and_b32 v33, 0xffff0000, v50
    v_add_f32 v44, v44, v32
    v_add_f32 v45, v45, v33
    v_lshlrev_b32 v32, 16, v51
    v_and_b32 v33, 0xffff0000, v51
    v_add_f32 v46, v46, v32
    v_add_f32 v47, v47, v33
    v_cvt_pk_bf16_f32 v48, v40, v41
    v_cvt_pk_bf16_f32 v49, v42, v43
    v_cvt_pk_bf16_f32 v50, v44, v45
    v_cvt_pk_bf16_f32 v51, v46, v47
    buffer_store_dwordx4 v[48:51], v52, s[16:19], 0 offen
    v_lshlrev_b32 v32, 16, v64
    v_and_b32 v33, 0xffff0000, v64
    v_add_f32 v56, v56, v32
    v_add_f32 v57, v57, v33
    v_lshlrev_b32 v32, 16, v65
    v_and_b32 v33, 0xffff0000, v65
    v_add_f32 v58, v58, v32
    v_add_f32 v59, v59, v33
    v_lshlrev_b32 v32, 16, v66
    v_and_b32 v33, 0xffff0000, v66
    v_add_f32 v60, v60, v32
    v_add_f32 v61, v61, v33
    v_lshlrev_b32 v32, 16, v67
    v_and_b32 v33, 0xffff0000, v67
    v_add_f32 v62, v62, v32
    v_add_f32 v63, v63, v33
    v_cvt_pk_bf16_f32 v64, v56, v57
    v_cvt_pk_bf16_f32 v65, v58, v59
    v_cvt_pk_bf16_f32 v66, v60, v61
    v_cvt_pk_bf16_f32 v67, v62, v63
    buffer_store_dwordx4 v[64:67], v68, s[16:19], 0 offen
    v_lshlrev_b32 v32, 16, v80
    v_and_b32 v33, 0xffff0000, v80
    v_add_f32 v72, v72, v32
    v_add_f32 v73, v73, v33
    v_lshlrev_b32 v32, 16, v81
    v_and_b32 v33, 0xffff0000, v81
    v_add_f32 v74, v74, v32
    v_add_f32 v75, v75, v33
    v_lshlrev_b32 v32, 16, v82
    v_and_b32 v33, 0xffff0000, v82
    v_add_f32 v76, v76, v32
    v_add_f32 v77, v77, v33
    v_lshlrev_b32 v32, 16, v83
    v_and_b32 v33, 0xffff0000, v83
    v_add_f32 v78, v78, v32
    v_add_f32 v79, v79, v33
    v_cvt_pk_bf16_f32 v80, v72, v73
    v_cvt_pk_bf16_f32 v81, v74, v75
    v_cvt_pk_bf16_f32 v82, v76, v77
    v_cvt_pk_bf16_f32 v83, v78, v79
    buffer_store_dwordx4 v[80:83], v84, s[16:19], 0 offen
    v_lshlrev_b32 v32, 16, v96
    v_and_b32 v33, 0xffff0000, v96
    v_add_f32 v88, v88, v32
    v_add_f32 v89, v89, v33
    v_lshlrev_b32 v32, 16, v97
    v_and_b32 v33, 0xffff0000, v97
    v_add_f32 v90, v90, v32
    v_add_f32 v91, v91, v33
    v_lshlrev_b32 v32, 16, v98
    v_and_b32 v33, 0xffff0000, v98
    v_add_f32 v92, v92, v32
    v_add_f32 v93, v93, v33
    v_lshlrev_b32 v32, 16, v99
    v_and_b32 v33, 0xffff0000, v99
    v_add_f32 v94, v94, v32
    v_add_f32 v95, v95, v33
    v_cvt_pk_bf16_f32 v96, v88, v89
    v_cvt_pk_bf16_f32 v97, v90, v91
    v_cvt_pk_bf16_f32 v98, v92, v93
    v_cvt_pk_bf16_f32 v99, v94, v95
    buffer_store_dwordx4 v[96:99], v100, s[16:19], 0 offen
    s_nop 1
L_dn_kernel_end:
    s_endpgm
.section .rodata,"a"
.p2align 6
.amdhsa_kernel dn_kernel
  .amdhsa_next_free_vgpr 136
  .amdhsa_next_free_sgpr 102
  .amdhsa_accum_offset 104
  .amdhsa_group_segment_fixed_size 0
  .amdhsa_kernarg_size 80
  .amdhsa_user_sgpr_count 2
  .amdhsa_user_sgpr_kernarg_segment_ptr 1
  .amdhsa_system_sgpr_workgroup_id_x 1
.end_amdhsa_kernel
.text
```
